```python
import torch

def _softmax(x, axis=-1):
    return torch.softmax(x, dim=axis)
def _gelu(x):
    return torch.nn.functional.gelu(x, approximate="tanh")
def _silu(x):
    return torch.nn.functional.silu(x)
def _sigmoid(x):
    return torch.sigmoid(x)
def _layernorm(x, axis=-1, eps=1e-5):
    m = x.mean(dim=axis, keepdim=True)
    v = x.var(dim=axis, keepdim=True, unbiased=False)
    return (x - m) / torch.sqrt(v + eps)
def _scatter_add(tgt, idx, src, axis=0):
    return tgt.clone().index_add_(axis, idx, src)
def _segment_sum(src, seg, n):
    out = torch.zeros((n,) + src.shape[1:], dtype=src.dtype)
    return out.index_add_(0, seg, src)
def _pad(x, pw):
    flat = tuple(v for pair in reversed(pw) for v in pair)
    return torch.nn.functional.pad(x, flat)

kernel_name = 'parallel_sum__linear_attn_block__dense_activation_silu__prompt'

def setup_inputs():

    _w = (lambda a: (lambda t: t.to(torch.bfloat16) if t.is_floating_point() else t)(torch.as_tensor(a)))
    def _A_setup():
        B, S, D = 1, 2048, 576
        return {
            "x": _w((lambda *s: torch.randn(*s, dtype=torch.bfloat16) * 0.05)(B, S, D)),
            "wqkv": _w((lambda *s: torch.randn(*s, dtype=torch.bfloat16) * 0.1)(D, 3 * D)),
            "wo": _w((lambda *s: torch.randn(*s, dtype=torch.bfloat16) * 0.05)(D, D)),
        }
    _A_in = _A_setup()

    def _B_setup():
        B, S, D, F = 1, 2048, 576, 4608
        return {
            "x": _w((lambda *s: torch.randn(*s, dtype=torch.bfloat16) * 0.05)(B, S, D)),
            "w1": _w((lambda *s: torch.randn(*s, dtype=torch.bfloat16) * 0.8)(D, F) * (D ** -0.5)),
            "w2": _w((lambda *s: torch.randn(*s, dtype=torch.bfloat16) * 0.1)(F, D) * (F ** -0.5)),
        }
    _B_in = _B_setup()

    return {
        "A_x": _A_in["x"],
        "A_wqkv": _A_in["wqkv"],
        "A_wo": _A_in["wo"],
        "B_x": _B_in["x"],
        "B_w1": _B_in["w1"],
        "B_w2": _B_in["w2"],
    }

def reference(A_x, A_wqkv, A_wo, B_x, B_w1, B_w2):
    def _A_ref(x, wqkv, wo):
        B, S, D = x.shape
        H = 32; Dh = D // H
        qkv = (lambda x, *d: x.permute(*d))((x @ wqkv).reshape(B, S, 3, H, Dh), 2, 0, 3, 1, 4)
        q, k, v = qkv[0], qkv[1], qkv[2]
        phi = lambda t: torch.where(t > 0, t + 1, torch.exp(t)) + 1e-6
        pq, pk = phi(q), phi(k)
        kv = torch.einsum("bhsd,bhse->bhde", pk, v)
        z = torch.einsum("bhsd->bhd", pk)
        num = torch.einsum("bhqd,bhde->bhqe", pq, kv)
        den = torch.einsum("bhqd,bhd->bhq", pq, z)[..., None] + 1e-6
        o = num / den
        return (lambda x, *d: x.permute(*d))(o, 0, 2, 1, 3).reshape(B, S, D) @ wo

    def _B_ref(x, w1, w2):
        h = torch.einsum("bsd,df->bsf", x, w1)
        h = _silu(h)
        out = torch.einsum("bsf,fd->bsd", h, w2)
        return out

    x = A_x
    xn = _layernorm(x, axis=-1)
    return x + _A_ref(xn, A_wqkv, A_wo) + _B_ref(xn, B_w1, B_w2)
```

```asm
; @launch grid=(256,1,1) block=(512,1,1) lds=163840
.amdgcn_target "amdgcn-amd-amdhsa--gfx950"
.text
.globl parallel_sum__linear_attn_block__dense_activation_silu__prompt_kernel
.p2align 8
.type parallel_sum__linear_attn_block__dense_activation_silu__prompt_kernel,@function
parallel_sum__linear_attn_block__dense_activation_silu__prompt_kernel:
    s_cmp_ge_u32 s2, 256
    s_cbranch_scc1 L_k1_end
    s_load_dwordx16 s[4:19], s[0:1], 0
    s_load_dwordx2 s[20:21], s[0:1], 64
    v_lshrrev_b32 v1, 6, v0
    s_nop 0
    v_readfirstlane_b32 s40, v1
    s_mov_b32 s50, 0x3f803f80
    s_mov_b32 s51, 0x3fb8aa3b
    s_mov_b32 s53, 0x00003f80
    s_mov_b32 s54, 0x3f800000
    s_and_b32 s41, s40, 3
    s_lshr_b32 s42, s40, 2
    s_and_b32 s46, s2, 7
    s_lshr_b32 s47, s2, 3
    s_lshr_b32 s48, s46, 1
    s_and_b32 s46, s46, 1
    s_lshl_b32 s46, s46, 3
    s_and_b32 s44, s47, 7
    s_add_u32 s44, s44, s46
    s_lshr_b32 s47, s47, 3
    s_mul_i32 s49, s48, 3
    s_add_u32 s43, s49, s47
    s_sub_u32 s43, s43, 1
    s_waitcnt lgkmcnt(0)
    s_mov_b32 s24, s4
    s_and_b32 s25, s5, 0xffff
    s_mov_b32 s26, 0x240000
    s_mov_b32 s27, 0x20000
    s_cmp_lg_u32 s2, 0
    s_cbranch_scc1 L_notag
    s_cmp_lg_u32 s40, 0
    s_cbranch_scc1 L_notag
    s_memrealtime s[56:57]
    s_mov_b32 s28, s18
    s_and_b32 s29, s19, 0xffff
    s_mov_b32 s30, 256
    s_mov_b32 s31, 0x20000
    s_waitcnt lgkmcnt(0)
    s_or_b32 s56, s56, 1
    v_mov_b32 v2, s56
    v_mov_b32 v3, 240
    s_mov_b64 exec, 1
    buffer_store_dword v2, v3, s[28:31], 0 offen sc0 sc1
    s_mov_b64 exec, -1
L_notag:
    s_cmp_lg_u32 s47, 0
    s_cbranch_scc1 L_mlp
    s_mov_b32 s43, s48
    s_cmp_eq_u32 s42, 0
    s_cbranch_scc1 L_att0_j
    s_branch L_att1_j
L_k1_end:
    s_endpgm
L_mlp:
    s_cmp_eq_u32 s42, 0
    s_cbranch_scc1 L_mlp0
    s_branch L_mlp1_j
L_att0_j:
    s_branch L_att0_j2
L_att1_j:
    s_branch L_att1_j2
L_mlp1_j:
    s_branch L_mlp1
L_mlp0:
    v_and_b32 v250, 63, v0
    s_lshl_b32 s46, s44, 7
    s_lshl_b32 s47, s40, 4
    s_add_u32 s46, s46, s47
    s_mul_i32 s46, s46, 1152
    v_lshrrev_b32 v251, 3, v250
    v_mul_u32_u24 v252, 1152, v251
    v_add_u32 v252, s46, v252
    v_lshrrev_b32 v253, 4, v250
    v_and_b32 v254, 7, v250
    v_xor_b32 v244, v254, v253
    v_lshl_add_u32 v244, v244, 4, v252
    v_add_u32 v253, 4, v253
    v_xor_b32 v245, v254, v253
    v_lshl_add_u32 v245, v245, 4, v252
    v_add_u32 v245, 9216, v245
    s_lshl_b32 s52, s40, 11
    s_add_u32 s52, s52, 65536
    s_add_u32 m0, s52, 0
    s_movk_i32 s49, 0
    buffer_load_dwordx4 v244, s[24:27], s49 offen lds
    s_add_u32 m0, s52, 1024
    s_movk_i32 s49, 0
    buffer_load_dwordx4 v245, s[24:27], s49 offen lds
    s_add_u32 m0, s52, 16384
    s_movk_i32 s49, 128
    buffer_load_dwordx4 v244, s[24:27], s49 offen lds
    s_add_u32 m0, s52, 17408
    s_movk_i32 s49, 128
    buffer_load_dwordx4 v245, s[24:27], s49 offen lds
    s_add_u32 m0, s52, 32768
    s_movk_i32 s49, 256
    buffer_load_dwordx4 v244, s[24:27], s49 offen lds
    s_add_u32 m0, s52, 33792
    s_movk_i32 s49, 256
    buffer_load_dwordx4 v245, s[24:27], s49 offen lds
    s_mul_i32 s46, s43, 768
    s_add_u32 s28, s12, s46
    s_addc_u32 s29, s13, 0
    s_and_b32 s29, s29, 0xffff
    s_sub_u32 s30, 0x510000, s46
    s_mov_b32 s31, 0x20000
    s_lshl_b32 s46, s40, 3
    v_add_u32 v251, s46, v251
    v_lshrrev_b32 v253, 2, v250
    v_and_b32 v253, 4, v253
    v_xor_b32 v253, v254, v253
    v_lshlrev_b32 v253, 4, v253
    v_mul_u32_u24 v224, 9216, v251
    v_add_u32 v224, v224, v253
    v_mul_u32_u24 v225, 1152, v251
    v_add_u32 v225, v225, v253
    s_lshl_b32 s45, s40, 10
    s_add_u32 m0, s52, 49152
    s_movk_i32 s49, 384
    buffer_load_dwordx4 v244, s[24:27], s49 offen lds
    s_add_u32 m0, s52, 50176
    s_movk_i32 s49, 384
    buffer_load_dwordx4 v245, s[24:27], s49 offen lds
    s_add_u32 m0, s52, 65536
    s_movk_i32 s49, 512
    buffer_load_dwordx4 v244, s[24:27], s49 offen lds
    s_add_u32 m0, s52, 66560
    s_movk_i32 s49, 512
    buffer_load_dwordx4 v245, s[24:27], s49 offen lds
    s_add_u32 m0, s52, 81920
    s_movk_i32 s49, 640
    buffer_load_dwordx4 v244, s[24:27], s49 offen lds
    s_add_u32 m0, s52, 82944
    s_movk_i32 s49, 640
    buffer_load_dwordx4 v245, s[24:27], s49 offen lds
    s_mul_i32 s46, s43, 442368
    s_add_u32 s32, s14, s46
    s_addc_u32 s33, s15, 0
    s_and_b32 s33, s33, 0xffff
    s_sub_u32 s34, 0x510000, s46
    s_mov_b32 s35, 0x20000
    s_mul_i32 s46, s43, 2359296
    s_mul_i32 s47, s44, 147456
    s_add_u32 s46, s46, s47
    s_add_u32 s36, s20, s46
    s_addc_u32 s37, s21, 0
    s_and_b32 s37, s37, 0xffff
    s_sub_u32 s38, 0x2400000, s46
    s_mov_b32 s39, 0x20000
    v_lshrrev_b32 v252, 5, v250
    v_lshrrev_b32 v251, 2, v250
    v_and_b32 v251, 3, v251
    v_lshrrev_b32 v253, 4, v250
    v_and_b32 v253, 1, v253
    v_lshlrev_b32 v253, 1, v253
    v_lshrrev_b32 v254, 1, v250
    v_and_b32 v254, 1, v254
    v_add_u32 v253, v253, v254
    v_lshrrev_b32 v254, 1, v251
    v_lshlrev_b32 v254, 2, v254
    v_xor_b32 v253, v253, v254
    v_lshlrev_b32 v253, 4, v253
    v_and_b32 v254, 1, v250
    v_lshlrev_b32 v254, 3, v254
    v_add_u32 v253, v253, v254
    v_lshlrev_b32 v254, 2, v252
    v_add_u32 v254, v254, v251
    v_lshlrev_b32 v254, 7, v254
    v_add_u32 v227, v254, v253
    v_lshlrev_b32 v254, 3, v252
    v_add_u32 v254, v254, v251
    v_lshlrev_b32 v254, 7, v254
    v_add_u32 v226, v254, v253
    v_and_b32 v251, 31, v250
    s_lshl_b32 s46, s41, 5
    v_add_u32 v251, s46, v251
    v_lshrrev_b32 v253, 1, v250
    v_and_b32 v253, 7, v253
    v_xor_b32 v253, v253, v252
    v_lshlrev_b32 v253, 4, v253
    v_lshl_add_u32 v253, v251, 7, v253
    v_add_u32 v240, 65536, v253
    v_xor_b32 v241, 32, v240
    v_xor_b32 v242, 64, v240
    v_xor_b32 v243, 96, v240
    s_mul_i32 s46, s41, 24576
    s_add_u32 s46, s46, 65536
    s_mov_b32 s56, s46
    v_lshlrev_b32 v254, 4, v250
    v_add_u32 v229, s46, v254
    v_add_u32 v228, 0, v229
    s_mul_i32 s46, s41, 18
    s_add_u32 s46, s46, 0
    s_lshl_b32 s46, s46, 11
    v_add_u32 v230, s46, v254
    v_and_b32 v251, 31, v250
    s_lshl_b32 s46, s40, 8
    s_add_u32 s46, s46, 57344
    v_lshl_add_u32 v255, v251, 3, s46
    v_mov_b32 v246, 0
    v_mov_b32 v248, 0
    v_mov_b32 v247, 0
    v_mov_b32 v249, 0
    s_waitcnt vmcnt(6)
    s_barrier
    ds_read_b128 v[0:3], v240 offset:0
    ds_read_b128 v[4:7], v241 offset:0
    ds_read_b128 v[16:19], v240 offset:16384
    ds_read_b128 v[20:23], v241 offset:16384
    ds_read_b128 v[32:35], v240 offset:32768
    ds_read_b128 v[36:39], v241 offset:32768
    ds_read_b128 v[8:11], v242 offset:0
    ds_read_b128 v[12:15], v243 offset:0
    ds_read_b128 v[24:27], v242 offset:16384
    ds_read_b128 v[28:31], v243 offset:16384
    ds_read_b128 v[40:43], v242 offset:32768
    ds_read_b128 v[44:47], v243 offset:32768
    s_waitcnt lgkmcnt(11)
    v_dot2_f32_bf16 v246, v0, s50, v246
    v_dot2_f32_bf16 v248, v0, v0, v248
    v_dot2_f32_bf16 v247, v1, s50, v247
    v_dot2_f32_bf16 v249, v1, v1, v249
    v_dot2_f32_bf16 v246, v2, s50, v246
    v_dot2_f32_bf16 v248, v2, v2, v248
    v_dot2_f32_bf16 v247, v3, s50, v247
    v_dot2_f32_bf16 v249, v3, v3, v249
    s_waitcnt lgkmcnt(10)
    v_dot2_f32_bf16 v246, v4, s50, v246
    v_dot2_f32_bf16 v248, v4, v4, v248
    v_dot2_f32_bf16 v247, v5, s50, v247
    v_dot2_f32_bf16 v249, v5, v5, v249
    v_dot2_f32_bf16 v246, v6, s50, v246
    v_dot2_f32_bf16 v248, v6, v6, v248
    v_dot2_f32_bf16 v247, v7, s50, v247
    v_dot2_f32_bf16 v249, v7, v7, v249
    s_waitcnt lgkmcnt(9)
    v_dot2_f32_bf16 v246, v16, s50, v246
    v_dot2_f32_bf16 v248, v16, v16, v248
    v_dot2_f32_bf16 v247, v17, s50, v247
    v_dot2_f32_bf16 v249, v17, v17, v249
    v_dot2_f32_bf16 v246, v18, s50, v246
    v_dot2_f32_bf16 v248, v18, v18, v248
    v_dot2_f32_bf16 v247, v19, s50, v247
    v_dot2_f32_bf16 v249, v19, v19, v249
    s_waitcnt lgkmcnt(8)
    v_dot2_f32_bf16 v246, v20, s50, v246
    v_dot2_f32_bf16 v248, v20, v20, v248
    v_dot2_f32_bf16 v247, v21, s50, v247
    v_dot2_f32_bf16 v249, v21, v21, v249
    v_dot2_f32_bf16 v246, v22, s50, v246
    v_dot2_f32_bf16 v248, v22, v22, v248
    v_dot2_f32_bf16 v247, v23, s50, v247
    v_dot2_f32_bf16 v249, v23, v23, v249
    s_waitcnt lgkmcnt(7)
    v_dot2_f32_bf16 v246, v32, s50, v246
    v_dot2_f32_bf16 v248, v32, v32, v248
    v_dot2_f32_bf16 v247, v33, s50, v247
    v_dot2_f32_bf16 v249, v33, v33, v249
    v_dot2_f32_bf16 v246, v34, s50, v246
    v_dot2_f32_bf16 v248, v34, v34, v248
    v_dot2_f32_bf16 v247, v35, s50, v247
    v_dot2_f32_bf16 v249, v35, v35, v249
    s_waitcnt lgkmcnt(6)
    v_dot2_f32_bf16 v246, v36, s50, v246
    v_dot2_f32_bf16 v248, v36, v36, v248
    v_dot2_f32_bf16 v247, v37, s50, v247
    v_dot2_f32_bf16 v249, v37, v37, v249
    v_dot2_f32_bf16 v246, v38, s50, v246
    v_dot2_f32_bf16 v248, v38, v38, v248
    v_dot2_f32_bf16 v247, v39, s50, v247
    v_dot2_f32_bf16 v249, v39, v39, v249
    s_waitcnt lgkmcnt(0)
    s_waitcnt vmcnt(0)
    s_barrier
    s_add_u32 m0, s52, 0
    s_movk_i32 s49, 768
    buffer_load_dwordx4 v244, s[24:27], s49 offen lds
    s_add_u32 m0, s52, 1024
    s_movk_i32 s49, 768
    buffer_load_dwordx4 v245, s[24:27], s49 offen lds
    s_add_u32 m0, s52, 16384
    s_movk_i32 s49, 896
    buffer_load_dwordx4 v244, s[24:27], s49 offen lds
    s_add_u32 m0, s52, 17408
    s_movk_i32 s49, 896
    buffer_load_dwordx4 v245, s[24:27], s49 offen lds
    s_add_u32 m0, s52, 32768
    s_movk_i32 s49, 1024
    buffer_load_dwordx4 v244, s[24:27], s49 offen lds
    s_add_u32 m0, s52, 33792
    s_movk_i32 s49, 1024
    buffer_load_dwordx4 v245, s[24:27], s49 offen lds
    s_add_u32 m0, s45, 0
    s_mov_b32 s49, 0
    buffer_load_dwordx4 v224, s[28:31], s49 offen lds
    s_add_u32 m0, s45, 8192
    s_mov_b32 s49, 589824
    buffer_load_dwordx4 v224, s[28:31], s49 offen lds
    ds_read_b128 v[48:51], v240 offset:49152
    ds_read_b128 v[52:55], v241 offset:49152
    v_add_u32 v216, 0x10000, v240
    ds_read_b128 v[64:67], v216 offset:0
    v_add_u32 v217, 0x10000, v241
    ds_read_b128 v[68:71], v217 offset:0
    v_add_u32 v216, 0x10000, v240
    ds_read_b128 v[80:83], v216 offset:16384
    v_add_u32 v217, 0x10000, v241
    ds_read_b128 v[84:87], v217 offset:16384
    ds_read_b128 v[56:59], v242 offset:49152
    ds_read_b128 v[60:63], v243 offset:49152
    v_add_u32 v218, 0x10000, v242
    ds_read_b128 v[72:75], v218 offset:0
    v_add_u32 v219, 0x10000, v243
    ds_read_b128 v[76:79], v219 offset:0
    v_add_u32 v218, 0x10000, v242
    ds_read_b128 v[88:91], v218 offset:16384
    v_add_u32 v219, 0x10000, v243
    ds_read_b128 v[92:95], v219 offset:16384
    s_waitcnt lgkmcnt(11)
    v_dot2_f32_bf16 v246, v48, s50, v246
    v_dot2_f32_bf16 v248, v48, v48, v248
    v_dot2_f32_bf16 v247, v49, s50, v247
    v_dot2_f32_bf16 v249, v49, v49, v249
    v_dot2_f32_bf16 v246, v50, s50, v246
    v_dot2_f32_bf16 v248, v50, v50, v248
    v_dot2_f32_bf16 v247, v51, s50, v247
    v_dot2_f32_bf16 v249, v51, v51, v249
    s_waitcnt lgkmcnt(10)
    v_dot2_f32_bf16 v246, v52, s50, v246
    v_dot2_f32_bf16 v248, v52, v52, v248
    v_dot2_f32_bf16 v247, v53, s50, v247
    v_dot2_f32_bf16 v249, v53, v53, v249
    v_dot2_f32_bf16 v246, v54, s50, v246
    v_dot2_f32_bf16 v248, v54, v54, v248
    v_dot2_f32_bf16 v247, v55, s50, v247
    v_dot2_f32_bf16 v249, v55, v55, v249
    s_waitcnt lgkmcnt(9)
    v_dot2_f32_bf16 v246, v64, s50, v246
    v_dot2_f32_bf16 v248, v64, v64, v248
    v_dot2_f32_bf16 v247, v65, s50, v247
    v_dot2_f32_bf16 v249, v65, v65, v249
    v_dot2_f32_bf16 v246, v66, s50, v246
    v_dot2_f32_bf16 v248, v66, v66, v248
    v_dot2_f32_bf16 v247, v67, s50, v247
    v_dot2_f32_bf16 v249, v67, v67, v249
    s_waitcnt lgkmcnt(8)
    v_dot2_f32_bf16 v246, v68, s50, v246
    v_dot2_f32_bf16 v248, v68, v68, v248
    v_dot2_f32_bf16 v247, v69, s50, v247
    v_dot2_f32_bf16 v249, v69, v69, v249
    v_dot2_f32_bf16 v246, v70, s50, v246
    v_dot2_f32_bf16 v248, v70, v70, v248
    v_dot2_f32_bf16 v247, v71, s50, v247
    v_dot2_f32_bf16 v249, v71, v71, v249
    s_waitcnt lgkmcnt(7)
    v_dot2_f32_bf16 v246, v80, s50, v246
    v_dot2_f32_bf16 v248, v80, v80, v248
    v_dot2_f32_bf16 v247, v81, s50, v247
    v_dot2_f32_bf16 v249, v81, v81, v249
    v_dot2_f32_bf16 v246, v82, s50, v246
    v_dot2_f32_bf16 v248, v82, v82, v248
    v_dot2_f32_bf16 v247, v83, s50, v247
    v_dot2_f32_bf16 v249, v83, v83, v249
    s_waitcnt lgkmcnt(6)
    v_dot2_f32_bf16 v246, v84, s50, v246
    v_dot2_f32_bf16 v248, v84, v84, v248
    v_dot2_f32_bf16 v247, v85, s50, v247
    v_dot2_f32_bf16 v249, v85, v85, v249
    v_dot2_f32_bf16 v246, v86, s50, v246
    v_dot2_f32_bf16 v248, v86, v86, v248
    v_dot2_f32_bf16 v247, v87, s50, v247
    v_dot2_f32_bf16 v249, v87, v87, v249
    s_waitcnt lgkmcnt(0)
    s_waitcnt vmcnt(2)
    s_barrier
    ds_read_b128 v[96:99], v240 offset:0
    ds_read_b128 v[100:103], v241 offset:0
    ds_read_b128 v[112:115], v240 offset:16384
    ds_read_b128 v[116:119], v241 offset:16384
    ds_read_b128 v[128:131], v240 offset:32768
    ds_read_b128 v[132:135], v241 offset:32768
    ds_read_b128 v[104:107], v242 offset:0
    ds_read_b128 v[108:111], v243 offset:0
    ds_read_b128 v[120:123], v242 offset:16384
    ds_read_b128 v[124:127], v243 offset:16384
    ds_read_b128 v[136:139], v242 offset:32768
    ds_read_b128 v[140:143], v243 offset:32768
    s_waitcnt lgkmcnt(11)
    v_dot2_f32_bf16 v246, v96, s50, v246
    v_dot2_f32_bf16 v248, v96, v96, v248
    v_dot2_f32_bf16 v247, v97, s50, v247
    v_dot2_f32_bf16 v249, v97, v97, v249
    v_dot2_f32_bf16 v246, v98, s50, v246
    v_dot2_f32_bf16 v248, v98, v98, v248
    v_dot2_f32_bf16 v247, v99, s50, v247
    v_dot2_f32_bf16 v249, v99, v99, v249
    s_waitcnt lgkmcnt(10)
    v_dot2_f32_bf16 v246, v100, s50, v246
    v_dot2_f32_bf16 v248, v100, v100, v248
    v_dot2_f32_bf16 v247, v101, s50, v247
    v_dot2_f32_bf16 v249, v101, v101, v249
    v_dot2_f32_bf16 v246, v102, s50, v246
    v_dot2_f32_bf16 v248, v102, v102, v248
    v_dot2_f32_bf16 v247, v103, s50, v247
    v_dot2_f32_bf16 v249, v103, v103, v249
    s_waitcnt lgkmcnt(9)
    v_dot2_f32_bf16 v246, v112, s50, v246
    v_dot2_f32_bf16 v248, v112, v112, v248
    v_dot2_f32_bf16 v247, v113, s50, v247
    v_dot2_f32_bf16 v249, v113, v113, v249
    v_dot2_f32_bf16 v246, v114, s50, v246
    v_dot2_f32_bf16 v248, v114, v114, v248
    v_dot2_f32_bf16 v247, v115, s50, v247
    v_dot2_f32_bf16 v249, v115, v115, v249
    s_waitcnt lgkmcnt(8)
    v_dot2_f32_bf16 v246, v116, s50, v246
    v_dot2_f32_bf16 v248, v116, v116, v248
    v_dot2_f32_bf16 v247, v117, s50, v247
    v_dot2_f32_bf16 v249, v117, v117, v249
    v_dot2_f32_bf16 v246, v118, s50, v246
    v_dot2_f32_bf16 v248, v118, v118, v248
    v_dot2_f32_bf16 v247, v119, s50, v247
    v_dot2_f32_bf16 v249, v119, v119, v249
    s_waitcnt lgkmcnt(7)
    v_dot2_f32_bf16 v246, v128, s50, v246
    v_dot2_f32_bf16 v248, v128, v128, v248
    v_dot2_f32_bf16 v247, v129, s50, v247
    v_dot2_f32_bf16 v249, v129, v129, v249
    v_dot2_f32_bf16 v246, v130, s50, v246
    v_dot2_f32_bf16 v248, v130, v130, v248
    v_dot2_f32_bf16 v247, v131, s50, v247
    v_dot2_f32_bf16 v249, v131, v131, v249
    s_waitcnt lgkmcnt(6)
    v_dot2_f32_bf16 v246, v132, s50, v246
    v_dot2_f32_bf16 v248, v132, v132, v248
    v_dot2_f32_bf16 v247, v133, s50, v247
    v_dot2_f32_bf16 v249, v133, v133, v249
    v_dot2_f32_bf16 v246, v134, s50, v246
    v_dot2_f32_bf16 v248, v134, v134, v248
    v_dot2_f32_bf16 v247, v135, s50, v247
    v_dot2_f32_bf16 v249, v135, v135, v249
    s_waitcnt lgkmcnt(0)
    s_add_u32 m0, s45, 16384
    s_mov_b32 s49, 1179648
    buffer_load_dwordx4 v224, s[28:31], s49 offen lds
    s_add_u32 m0, s45, 24576
    s_mov_b32 s49, 1769472
    buffer_load_dwordx4 v224, s[28:31], s49 offen lds
    s_add_u32 m0, s45, 32768
    s_mov_b32 s49, 2359296
    buffer_load_dwordx4 v224, s[28:31], s49 offen lds
    s_add_u32 m0, s45, 40960
    s_mov_b32 s49, 2949120
    buffer_load_dwordx4 v224, s[28:31], s49 offen lds
    s_add_u32 m0, s45, 49152
    s_mov_b32 s49, 3538944
    buffer_load_dwordx4 v224, s[28:31], s49 offen lds
    s_and_b32 s46, s44, 7
    s_lshl_b32 s46, s46, 3
    s_add_u32 s46, s46, s40
    s_mul_i32 s46, s46, 6912
    v_lshl_add_u32 v251, v250, 7, s46
    v_mov_b32 v253, 0x7fffff00
    v_cmp_gt_u32 vcc, 54, v250
    s_nop 1
    v_cndmask_b32 v251, v253, v251, vcc
    buffer_load_dword v233, v251, s[32:35], 0 offen
    s_nop 1
    v_add_f32 v246, v246, v247
    v_add_f32 v248, v248, v249
    v_mov_b32 v247, v246
    s_nop 1
    v_permlane32_swap_b32 v246, v247
    s_nop 1
    v_add_f32 v246, v246, v247
    v_mov_b32 v249, v248
    s_nop 1
    v_permlane32_swap_b32 v248, v249
    s_nop 1
    v_add_f32 v248, v248, v249
    v_mov_b32 v247, v248
    ds_write_b64 v255, v[246:247]
    v_xor_b32 v251, 1024, v255
    s_waitcnt lgkmcnt(0)
    s_barrier
    ds_read_b64 v[216:217], v251
    s_waitcnt lgkmcnt(0)
    v_add_f32 v246, v246, v216
    v_add_f32 v248, v248, v217
    v_mul_f32 v246, 0x3ae38e39, v246
    v_mul_f32 v248, 0x3ae38e39, v248
    v_fma_f32 v248, -v246, v246, v248
    v_max_f32 v248, 0, v248
    v_add_f32 v248, 0x3727c5ac, v248
    v_sub_f32 v246, 0, v246
    v_rsq_f32 v231, v248
    v_sqrt_f32 v232, v248
    s_nop 0
    v_mul_f32 v231, s51, v231
    v_dot2_f32_bf16 v216, v0, s53, v246
    v_dot2_f32_bf16 v217, v0, s54, v246
    v_dot2_f32_bf16 v218, v1, s53, v246
    v_dot2_f32_bf16 v219, v1, s54, v246
    v_dot2_f32_bf16 v220, v2, s53, v246
    v_dot2_f32_bf16 v221, v2, s54, v246
    v_dot2_f32_bf16 v222, v3, s53, v246
    v_dot2_f32_bf16 v223, v3, s54, v246
    s_nop 0
    v_cvt_pk_bf16_f32 v0, v216, v217
    v_cvt_pk_bf16_f32 v1, v218, v219
    v_cvt_pk_bf16_f32 v2, v220, v221
    v_cvt_pk_bf16_f32 v3, v222, v223
    v_dot2_f32_bf16 v216, v4, s53, v246
    v_dot2_f32_bf16 v217, v4, s54, v246
    v_dot2_f32_bf16 v218, v5, s53, v246
    v_dot2_f32_bf16 v219, v5, s54, v246
    v_dot2_f32_bf16 v220, v6, s53, v246
    v_dot2_f32_bf16 v221, v6, s54, v246
    v_dot2_f32_bf16 v222, v7, s53, v246
    v_dot2_f32_bf16 v223, v7, s54, v246
    s_nop 0
    v_cvt_pk_bf16_f32 v4, v216, v217
    v_cvt_pk_bf16_f32 v5, v218, v219
    v_cvt_pk_bf16_f32 v6, v220, v221
    v_cvt_pk_bf16_f32 v7, v222, v223
    v_dot2_f32_bf16 v216, v8, s53, v246
    v_dot2_f32_bf16 v217, v8, s54, v246
    v_dot2_f32_bf16 v218, v9, s53, v246
    v_dot2_f32_bf16 v219, v9, s54, v246
    v_dot2_f32_bf16 v220, v10, s53, v246
    v_dot2_f32_bf16 v221, v10, s54, v246
    v_dot2_f32_bf16 v222, v11, s53, v246
    v_dot2_f32_bf16 v223, v11, s54, v246
    s_nop 0
    v_cvt_pk_bf16_f32 v8, v216, v217
    v_cvt_pk_bf16_f32 v9, v218, v219
    v_cvt_pk_bf16_f32 v10, v220, v221
    v_cvt_pk_bf16_f32 v11, v222, v223
    v_dot2_f32_bf16 v216, v12, s53, v246
    v_dot2_f32_bf16 v217, v12, s54, v246
    v_dot2_f32_bf16 v218, v13, s53, v246
    v_dot2_f32_bf16 v219, v13, s54, v246
    v_dot2_f32_bf16 v220, v14, s53, v246
    v_dot2_f32_bf16 v221, v14, s54, v246
    v_dot2_f32_bf16 v222, v15, s53, v246
    v_dot2_f32_bf16 v223, v15, s54, v246
    s_nop 0
    v_cvt_pk_bf16_f32 v12, v216, v217
    v_cvt_pk_bf16_f32 v13, v218, v219
    v_cvt_pk_bf16_f32 v14, v220, v221
    v_cvt_pk_bf16_f32 v15, v222, v223
    v_dot2_f32_bf16 v216, v16, s53, v246
    v_dot2_f32_bf16 v217, v16, s54, v246
    v_dot2_f32_bf16 v218, v17, s53, v246
    v_dot2_f32_bf16 v219, v17, s54, v246
    v_dot2_f32_bf16 v220, v18, s53, v246
    v_dot2_f32_bf16 v221, v18, s54, v246
    v_dot2_f32_bf16 v222, v19, s53, v246
    v_dot2_f32_bf16 v223, v19, s54, v246
    s_nop 0
    v_cvt_pk_bf16_f32 v16, v216, v217
    v_cvt_pk_bf16_f32 v17, v218, v219
    v_cvt_pk_bf16_f32 v18, v220, v221
    v_cvt_pk_bf16_f32 v19, v222, v223
    v_dot2_f32_bf16 v216, v20, s53, v246
    v_dot2_f32_bf16 v217, v20, s54, v246
    v_dot2_f32_bf16 v218, v21, s53, v246
    v_dot2_f32_bf16 v219, v21, s54, v246
    v_dot2_f32_bf16 v220, v22, s53, v246
    v_dot2_f32_bf16 v221, v22, s54, v246
    v_dot2_f32_bf16 v222, v23, s53, v246
    v_dot2_f32_bf16 v223, v23, s54, v246
    s_nop 0
    v_cvt_pk_bf16_f32 v20, v216, v217
    v_cvt_pk_bf16_f32 v21, v218, v219
    v_cvt_pk_bf16_f32 v22, v220, v221
    v_cvt_pk_bf16_f32 v23, v222, v223
    v_dot2_f32_bf16 v216, v24, s53, v246
    v_dot2_f32_bf16 v217, v24, s54, v246
    v_dot2_f32_bf16 v218, v25, s53, v246
    v_dot2_f32_bf16 v219, v25, s54, v246
    v_dot2_f32_bf16 v220, v26, s53, v246
    v_dot2_f32_bf16 v221, v26, s54, v246
    v_dot2_f32_bf16 v222, v27, s53, v246
    v_dot2_f32_bf16 v223, v27, s54, v246
    s_nop 0
    v_cvt_pk_bf16_f32 v24, v216, v217
    v_cvt_pk_bf16_f32 v25, v218, v219
    v_cvt_pk_bf16_f32 v26, v220, v221
    v_cvt_pk_bf16_f32 v27, v222, v223
    v_dot2_f32_bf16 v216, v28, s53, v246
    v_dot2_f32_bf16 v217, v28, s54, v246
    v_dot2_f32_bf16 v218, v29, s53, v246
    v_dot2_f32_bf16 v219, v29, s54, v246
    v_dot2_f32_bf16 v220, v30, s53, v246
    v_dot2_f32_bf16 v221, v30, s54, v246
    v_dot2_f32_bf16 v222, v31, s53, v246
    v_dot2_f32_bf16 v223, v31, s54, v246
    s_nop 0
    v_cvt_pk_bf16_f32 v28, v216, v217
    v_cvt_pk_bf16_f32 v29, v218, v219
    v_cvt_pk_bf16_f32 v30, v220, v221
    v_cvt_pk_bf16_f32 v31, v222, v223
    v_dot2_f32_bf16 v216, v32, s53, v246
    v_dot2_f32_bf16 v217, v32, s54, v246
    v_dot2_f32_bf16 v218, v33, s53, v246
    v_dot2_f32_bf16 v219, v33, s54, v246
    v_dot2_f32_bf16 v220, v34, s53, v246
    v_dot2_f32_bf16 v221, v34, s54, v246
    v_dot2_f32_bf16 v222, v35, s53, v246
    v_dot2_f32_bf16 v223, v35, s54, v246
    s_nop 0
    v_cvt_pk_bf16_f32 v32, v216, v217
    v_cvt_pk_bf16_f32 v33, v218, v219
    v_cvt_pk_bf16_f32 v34, v220, v221
    v_cvt_pk_bf16_f32 v35, v222, v223
    v_dot2_f32_bf16 v216, v36, s53, v246
    v_dot2_f32_bf16 v217, v36, s54, v246
    v_dot2_f32_bf16 v218, v37, s53, v246
    v_dot2_f32_bf16 v219, v37, s54, v246
    v_dot2_f32_bf16 v220, v38, s53, v246
    v_dot2_f32_bf16 v221, v38, s54, v246
    v_dot2_f32_bf16 v222, v39, s53, v246
    v_dot2_f32_bf16 v223, v39, s54, v246
    s_nop 0
    v_cvt_pk_bf16_f32 v36, v216, v217
    v_cvt_pk_bf16_f32 v37, v218, v219
    v_cvt_pk_bf16_f32 v38, v220, v221
    v_cvt_pk_bf16_f32 v39, v222, v223
    v_dot2_f32_bf16 v216, v40, s53, v246
    v_dot2_f32_bf16 v217, v40, s54, v246
    v_dot2_f32_bf16 v218, v41, s53, v246
    v_dot2_f32_bf16 v219, v41, s54, v246
    v_dot2_f32_bf16 v220, v42, s53, v246
    v_dot2_f32_bf16 v221, v42, s54, v246
    v_dot2_f32_bf16 v222, v43, s53, v246
    v_dot2_f32_bf16 v223, v43, s54, v246
    s_nop 0
    v_cvt_pk_bf16_f32 v40, v216, v217
    v_cvt_pk_bf16_f32 v41, v218, v219
    v_cvt_pk_bf16_f32 v42, v220, v221
    v_cvt_pk_bf16_f32 v43, v222, v223
    v_dot2_f32_bf16 v216, v44, s53, v246
    v_dot2_f32_bf16 v217, v44, s54, v246
    v_dot2_f32_bf16 v218, v45, s53, v246
    v_dot2_f32_bf16 v219, v45, s54, v246
    v_dot2_f32_bf16 v220, v46, s53, v246
    v_dot2_f32_bf16 v221, v46, s54, v246
    v_dot2_f32_bf16 v222, v47, s53, v246
    v_dot2_f32_bf16 v223, v47, s54, v246
    s_nop 0
    v_cvt_pk_bf16_f32 v44, v216, v217
    v_cvt_pk_bf16_f32 v45, v218, v219
    v_cvt_pk_bf16_f32 v46, v220, v221
    v_cvt_pk_bf16_f32 v47, v222, v223
    v_dot2_f32_bf16 v216, v48, s53, v246
    v_dot2_f32_bf16 v217, v48, s54, v246
    v_dot2_f32_bf16 v218, v49, s53, v246
    v_dot2_f32_bf16 v219, v49, s54, v246
    v_dot2_f32_bf16 v220, v50, s53, v246
    v_dot2_f32_bf16 v221, v50, s54, v246
    v_dot2_f32_bf16 v222, v51, s53, v246
    v_dot2_f32_bf16 v223, v51, s54, v246
    s_nop 0
    v_cvt_pk_bf16_f32 v48, v216, v217
    v_cvt_pk_bf16_f32 v49, v218, v219
    v_cvt_pk_bf16_f32 v50, v220, v221
    v_cvt_pk_bf16_f32 v51, v222, v223
    v_dot2_f32_bf16 v216, v52, s53, v246
    v_dot2_f32_bf16 v217, v52, s54, v246
    v_dot2_f32_bf16 v218, v53, s53, v246
    v_dot2_f32_bf16 v219, v53, s54, v246
    v_dot2_f32_bf16 v220, v54, s53, v246
    v_dot2_f32_bf16 v221, v54, s54, v246
    v_dot2_f32_bf16 v222, v55, s53, v246
    v_dot2_f32_bf16 v223, v55, s54, v246
    s_nop 0
    v_cvt_pk_bf16_f32 v52, v216, v217
    v_cvt_pk_bf16_f32 v53, v218, v219
    v_cvt_pk_bf16_f32 v54, v220, v221
    v_cvt_pk_bf16_f32 v55, v222, v223
    v_dot2_f32_bf16 v216, v56, s53, v246
    v_dot2_f32_bf16 v217, v56, s54, v246
    v_dot2_f32_bf16 v218, v57, s53, v246
    v_dot2_f32_bf16 v219, v57, s54, v246
    v_dot2_f32_bf16 v220, v58, s53, v246
    v_dot2_f32_bf16 v221, v58, s54, v246
    v_dot2_f32_bf16 v222, v59, s53, v246
    v_dot2_f32_bf16 v223, v59, s54, v246
    s_nop 0
    v_cvt_pk_bf16_f32 v56, v216, v217
    v_cvt_pk_bf16_f32 v57, v218, v219
    v_cvt_pk_bf16_f32 v58, v220, v221
    v_cvt_pk_bf16_f32 v59, v222, v223
    v_dot2_f32_bf16 v216, v60, s53, v246
    v_dot2_f32_bf16 v217, v60, s54, v246
    v_dot2_f32_bf16 v218, v61, s53, v246
    v_dot2_f32_bf16 v219, v61, s54, v246
    v_dot2_f32_bf16 v220, v62, s53, v246
    v_dot2_f32_bf16 v221, v62, s54, v246
    v_dot2_f32_bf16 v222, v63, s53, v246
    v_dot2_f32_bf16 v223, v63, s54, v246
    s_nop 0
    v_cvt_pk_bf16_f32 v60, v216, v217
    v_cvt_pk_bf16_f32 v61, v218, v219
    v_cvt_pk_bf16_f32 v62, v220, v221
    v_cvt_pk_bf16_f32 v63, v222, v223
    v_dot2_f32_bf16 v216, v64, s53, v246
    v_dot2_f32_bf16 v217, v64, s54, v246
    v_dot2_f32_bf16 v218, v65, s53, v246
    v_dot2_f32_bf16 v219, v65, s54, v246
    v_dot2_f32_bf16 v220, v66, s53, v246
    v_dot2_f32_bf16 v221, v66, s54, v246
    v_dot2_f32_bf16 v222, v67, s53, v246
    v_dot2_f32_bf16 v223, v67, s54, v246
    s_nop 0
    v_cvt_pk_bf16_f32 v64, v216, v217
    v_cvt_pk_bf16_f32 v65, v218, v219
    v_cvt_pk_bf16_f32 v66, v220, v221
    v_cvt_pk_bf16_f32 v67, v222, v223
    v_dot2_f32_bf16 v216, v68, s53, v246
    v_dot2_f32_bf16 v217, v68, s54, v246
    v_dot2_f32_bf16 v218, v69, s53, v246
    v_dot2_f32_bf16 v219, v69, s54, v246
    v_dot2_f32_bf16 v220, v70, s53, v246
    v_dot2_f32_bf16 v221, v70, s54, v246
    v_dot2_f32_bf16 v222, v71, s53, v246
    v_dot2_f32_bf16 v223, v71, s54, v246
    s_nop 0
    v_cvt_pk_bf16_f32 v68, v216, v217
    v_cvt_pk_bf16_f32 v69, v218, v219
    v_cvt_pk_bf16_f32 v70, v220, v221
    v_cvt_pk_bf16_f32 v71, v222, v223
    v_dot2_f32_bf16 v216, v72, s53, v246
    v_dot2_f32_bf16 v217, v72, s54, v246
    v_dot2_f32_bf16 v218, v73, s53, v246
    v_dot2_f32_bf16 v219, v73, s54, v246
    v_dot2_f32_bf16 v220, v74, s53, v246
    v_dot2_f32_bf16 v221, v74, s54, v246
    v_dot2_f32_bf16 v222, v75, s53, v246
    v_dot2_f32_bf16 v223, v75, s54, v246
    s_nop 0
    v_cvt_pk_bf16_f32 v72, v216, v217
    v_cvt_pk_bf16_f32 v73, v218, v219
    v_cvt_pk_bf16_f32 v74, v220, v221
    v_cvt_pk_bf16_f32 v75, v222, v223
    v_dot2_f32_bf16 v216, v76, s53, v246
    v_dot2_f32_bf16 v217, v76, s54, v246
    v_dot2_f32_bf16 v218, v77, s53, v246
    v_dot2_f32_bf16 v219, v77, s54, v246
    v_dot2_f32_bf16 v220, v78, s53, v246
    v_dot2_f32_bf16 v221, v78, s54, v246
    v_dot2_f32_bf16 v222, v79, s53, v246
    v_dot2_f32_bf16 v223, v79, s54, v246
    s_nop 0
    v_cvt_pk_bf16_f32 v76, v216, v217
    v_cvt_pk_bf16_f32 v77, v218, v219
    v_cvt_pk_bf16_f32 v78, v220, v221
    v_cvt_pk_bf16_f32 v79, v222, v223
    v_dot2_f32_bf16 v216, v80, s53, v246
    v_dot2_f32_bf16 v217, v80, s54, v246
    v_dot2_f32_bf16 v218, v81, s53, v246
    v_dot2_f32_bf16 v219, v81, s54, v246
    v_dot2_f32_bf16 v220, v82, s53, v246
    v_dot2_f32_bf16 v221, v82, s54, v246
    v_dot2_f32_bf16 v222, v83, s53, v246
    v_dot2_f32_bf16 v223, v83, s54, v246
    s_nop 0
    v_cvt_pk_bf16_f32 v80, v216, v217
    v_cvt_pk_bf16_f32 v81, v218, v219
    v_cvt_pk_bf16_f32 v82, v220, v221
    v_cvt_pk_bf16_f32 v83, v222, v223
    v_dot2_f32_bf16 v216, v84, s53, v246
    v_dot2_f32_bf16 v217, v84, s54, v246
    v_dot2_f32_bf16 v218, v85, s53, v246
    v_dot2_f32_bf16 v219, v85, s54, v246
    v_dot2_f32_bf16 v220, v86, s53, v246
    v_dot2_f32_bf16 v221, v86, s54, v246
    v_dot2_f32_bf16 v222, v87, s53, v246
    v_dot2_f32_bf16 v223, v87, s54, v246
    s_nop 0
    v_cvt_pk_bf16_f32 v84, v216, v217
    v_cvt_pk_bf16_f32 v85, v218, v219
    v_cvt_pk_bf16_f32 v86, v220, v221
    v_cvt_pk_bf16_f32 v87, v222, v223
    v_dot2_f32_bf16 v216, v88, s53, v246
    v_dot2_f32_bf16 v217, v88, s54, v246
    v_dot2_f32_bf16 v218, v89, s53, v246
    v_dot2_f32_bf16 v219, v89, s54, v246
    v_dot2_f32_bf16 v220, v90, s53, v246
    v_dot2_f32_bf16 v221, v90, s54, v246
    v_dot2_f32_bf16 v222, v91, s53, v246
    v_dot2_f32_bf16 v223, v91, s54, v246
    s_nop 0
    v_cvt_pk_bf16_f32 v88, v216, v217
    v_cvt_pk_bf16_f32 v89, v218, v219
    v_cvt_pk_bf16_f32 v90, v220, v221
    v_cvt_pk_bf16_f32 v91, v222, v223
    v_dot2_f32_bf16 v216, v92, s53, v246
    v_dot2_f32_bf16 v217, v92, s54, v246
    v_dot2_f32_bf16 v218, v93, s53, v246
    v_dot2_f32_bf16 v219, v93, s54, v246
    v_dot2_f32_bf16 v220, v94, s53, v246
    v_dot2_f32_bf16 v221, v94, s54, v246
    v_dot2_f32_bf16 v222, v95, s53, v246
    v_dot2_f32_bf16 v223, v95, s54, v246
    s_nop 0
    v_cvt_pk_bf16_f32 v92, v216, v217
    v_cvt_pk_bf16_f32 v93, v218, v219
    v_cvt_pk_bf16_f32 v94, v220, v221
    v_cvt_pk_bf16_f32 v95, v222, v223
    v_dot2_f32_bf16 v216, v96, s53, v246
    v_dot2_f32_bf16 v217, v96, s54, v246
    v_dot2_f32_bf16 v218, v97, s53, v246
    v_dot2_f32_bf16 v219, v97, s54, v246
    v_dot2_f32_bf16 v220, v98, s53, v246
    v_dot2_f32_bf16 v221, v98, s54, v246
    v_dot2_f32_bf16 v222, v99, s53, v246
    v_dot2_f32_bf16 v223, v99, s54, v246
    s_nop 0
    v_cvt_pk_bf16_f32 v96, v216, v217
    v_cvt_pk_bf16_f32 v97, v218, v219
    v_cvt_pk_bf16_f32 v98, v220, v221
    v_cvt_pk_bf16_f32 v99, v222, v223
    v_dot2_f32_bf16 v216, v100, s53, v246
    v_dot2_f32_bf16 v217, v100, s54, v246
    v_dot2_f32_bf16 v218, v101, s53, v246
    v_dot2_f32_bf16 v219, v101, s54, v246
    v_dot2_f32_bf16 v220, v102, s53, v246
    v_dot2_f32_bf16 v221, v102, s54, v246
    v_dot2_f32_bf16 v222, v103, s53, v246
    v_dot2_f32_bf16 v223, v103, s54, v246
    s_nop 0
    v_cvt_pk_bf16_f32 v100, v216, v217
    v_cvt_pk_bf16_f32 v101, v218, v219
    v_cvt_pk_bf16_f32 v102, v220, v221
    v_cvt_pk_bf16_f32 v103, v222, v223
    v_dot2_f32_bf16 v216, v104, s53, v246
    v_dot2_f32_bf16 v217, v104, s54, v246
    v_dot2_f32_bf16 v218, v105, s53, v246
    v_dot2_f32_bf16 v219, v105, s54, v246
    v_dot2_f32_bf16 v220, v106, s53, v246
    v_dot2_f32_bf16 v221, v106, s54, v246
    v_dot2_f32_bf16 v222, v107, s53, v246
    v_dot2_f32_bf16 v223, v107, s54, v246
    s_nop 0
    v_cvt_pk_bf16_f32 v104, v216, v217
    v_cvt_pk_bf16_f32 v105, v218, v219
    v_cvt_pk_bf16_f32 v106, v220, v221
    v_cvt_pk_bf16_f32 v107, v222, v223
    v_dot2_f32_bf16 v216, v108, s53, v246
    v_dot2_f32_bf16 v217, v108, s54, v246
    v_dot2_f32_bf16 v218, v109, s53, v246
    v_dot2_f32_bf16 v219, v109, s54, v246
    v_dot2_f32_bf16 v220, v110, s53, v246
    v_dot2_f32_bf16 v221, v110, s54, v246
    v_dot2_f32_bf16 v222, v111, s53, v246
    v_dot2_f32_bf16 v223, v111, s54, v246
    s_nop 0
    v_cvt_pk_bf16_f32 v108, v216, v217
    v_cvt_pk_bf16_f32 v109, v218, v219
    v_cvt_pk_bf16_f32 v110, v220, v221
    v_cvt_pk_bf16_f32 v111, v222, v223
    v_dot2_f32_bf16 v216, v112, s53, v246
    v_dot2_f32_bf16 v217, v112, s54, v246
    v_dot2_f32_bf16 v218, v113, s53, v246
    v_dot2_f32_bf16 v219, v113, s54, v246
    v_dot2_f32_bf16 v220, v114, s53, v246
    v_dot2_f32_bf16 v221, v114, s54, v246
    v_dot2_f32_bf16 v222, v115, s53, v246
    v_dot2_f32_bf16 v223, v115, s54, v246
    s_nop 0
    v_cvt_pk_bf16_f32 v112, v216, v217
    v_cvt_pk_bf16_f32 v113, v218, v219
    v_cvt_pk_bf16_f32 v114, v220, v221
    v_cvt_pk_bf16_f32 v115, v222, v223
    v_dot2_f32_bf16 v216, v116, s53, v246
    v_dot2_f32_bf16 v217, v116, s54, v246
    v_dot2_f32_bf16 v218, v117, s53, v246
    v_dot2_f32_bf16 v219, v117, s54, v246
    v_dot2_f32_bf16 v220, v118, s53, v246
    v_dot2_f32_bf16 v221, v118, s54, v246
    v_dot2_f32_bf16 v222, v119, s53, v246
    v_dot2_f32_bf16 v223, v119, s54, v246
    s_nop 0
    v_cvt_pk_bf16_f32 v116, v216, v217
    v_cvt_pk_bf16_f32 v117, v218, v219
    v_cvt_pk_bf16_f32 v118, v220, v221
    v_cvt_pk_bf16_f32 v119, v222, v223
    v_dot2_f32_bf16 v216, v120, s53, v246
    v_dot2_f32_bf16 v217, v120, s54, v246
    v_dot2_f32_bf16 v218, v121, s53, v246
    v_dot2_f32_bf16 v219, v121, s54, v246
    v_dot2_f32_bf16 v220, v122, s53, v246
    v_dot2_f32_bf16 v221, v122, s54, v246
    v_dot2_f32_bf16 v222, v123, s53, v246
    v_dot2_f32_bf16 v223, v123, s54, v246
    s_nop 0
    v_cvt_pk_bf16_f32 v120, v216, v217
    v_cvt_pk_bf16_f32 v121, v218, v219
    v_cvt_pk_bf16_f32 v122, v220, v221
    v_cvt_pk_bf16_f32 v123, v222, v223
    v_dot2_f32_bf16 v216, v124, s53, v246
    v_dot2_f32_bf16 v217, v124, s54, v246
    v_dot2_f32_bf16 v218, v125, s53, v246
    v_dot2_f32_bf16 v219, v125, s54, v246
    v_dot2_f32_bf16 v220, v126, s53, v246
    v_dot2_f32_bf16 v221, v126, s54, v246
    v_dot2_f32_bf16 v222, v127, s53, v246
    v_dot2_f32_bf16 v223, v127, s54, v246
    s_nop 0
    v_cvt_pk_bf16_f32 v124, v216, v217
    v_cvt_pk_bf16_f32 v125, v218, v219
    v_cvt_pk_bf16_f32 v126, v220, v221
    v_cvt_pk_bf16_f32 v127, v222, v223
    v_dot2_f32_bf16 v216, v128, s53, v246
    v_dot2_f32_bf16 v217, v128, s54, v246
    v_dot2_f32_bf16 v218, v129, s53, v246
    v_dot2_f32_bf16 v219, v129, s54, v246
    v_dot2_f32_bf16 v220, v130, s53, v246
    v_dot2_f32_bf16 v221, v130, s54, v246
    v_dot2_f32_bf16 v222, v131, s53, v246
    v_dot2_f32_bf16 v223, v131, s54, v246
    s_nop 0
    v_cvt_pk_bf16_f32 v128, v216, v217
    v_cvt_pk_bf16_f32 v129, v218, v219
    v_cvt_pk_bf16_f32 v130, v220, v221
    v_cvt_pk_bf16_f32 v131, v222, v223
    v_dot2_f32_bf16 v216, v132, s53, v246
    v_dot2_f32_bf16 v217, v132, s54, v246
    v_dot2_f32_bf16 v218, v133, s53, v246
    v_dot2_f32_bf16 v219, v133, s54, v246
    v_dot2_f32_bf16 v220, v134, s53, v246
    v_dot2_f32_bf16 v221, v134, s54, v246
    v_dot2_f32_bf16 v222, v135, s53, v246
    v_dot2_f32_bf16 v223, v135, s54, v246
    s_nop 0
    v_cvt_pk_bf16_f32 v132, v216, v217
    v_cvt_pk_bf16_f32 v133, v218, v219
    v_cvt_pk_bf16_f32 v134, v220, v221
    v_cvt_pk_bf16_f32 v135, v222, v223
    v_dot2_f32_bf16 v216, v136, s53, v246
    v_dot2_f32_bf16 v217, v136, s54, v246
    v_dot2_f32_bf16 v218, v137, s53, v246
    v_dot2_f32_bf16 v219, v137, s54, v246
    v_dot2_f32_bf16 v220, v138, s53, v246
    v_dot2_f32_bf16 v221, v138, s54, v246
    v_dot2_f32_bf16 v222, v139, s53, v246
    v_dot2_f32_bf16 v223, v139, s54, v246
    s_nop 0
    v_cvt_pk_bf16_f32 v136, v216, v217
    v_cvt_pk_bf16_f32 v137, v218, v219
    v_cvt_pk_bf16_f32 v138, v220, v221
    v_cvt_pk_bf16_f32 v139, v222, v223
    v_dot2_f32_bf16 v216, v140, s53, v246
    v_dot2_f32_bf16 v217, v140, s54, v246
    v_dot2_f32_bf16 v218, v141, s53, v246
    v_dot2_f32_bf16 v219, v141, s54, v246
    v_dot2_f32_bf16 v220, v142, s53, v246
    v_dot2_f32_bf16 v221, v142, s54, v246
    v_dot2_f32_bf16 v222, v143, s53, v246
    v_dot2_f32_bf16 v223, v143, s54, v246
    s_nop 0
    v_cvt_pk_bf16_f32 v140, v216, v217
    v_cvt_pk_bf16_f32 v141, v218, v219
    v_cvt_pk_bf16_f32 v142, v220, v221
    v_cvt_pk_bf16_f32 v143, v222, v223
    s_waitcnt vmcnt(7)
    s_barrier
    ds_read_b64_tr_b16 v[176:177], v226 offset:0
    ds_read_b64_tr_b16 v[178:179], v226 offset:512
    ds_read_b64_tr_b16 v[180:181], v226 offset:2048
    ds_read_b64_tr_b16 v[182:183], v226 offset:2560
    ds_read_b64_tr_b16 v[184:185], v226 offset:4096
    ds_read_b64_tr_b16 v[186:187], v226 offset:4608
    ds_read_b64_tr_b16 v[188:189], v226 offset:6144
    ds_read_b64_tr_b16 v[190:191], v226 offset:6656
    s_waitcnt vmcnt(6)
    s_barrier
    s_waitcnt lgkmcnt(6)
    v_mfma_f32_32x32x16_bf16 v[144:159], v[176:179], v[0:3], 0
    ds_read_b64_tr_b16 v[192:193], v226 offset:8192
    ds_read_b64_tr_b16 v[194:195], v226 offset:8704
    s_waitcnt lgkmcnt(6)
    v_mfma_f32_32x32x16_bf16 v[144:159], v[180:183], v[4:7], v[144:159]
    ds_read_b64_tr_b16 v[196:197], v226 offset:10240
    ds_read_b64_tr_b16 v[198:199], v226 offset:10752
    s_waitcnt lgkmcnt(6)
    v_mfma_f32_32x32x16_bf16 v[144:159], v[184:187], v[8:11], v[144:159]
    ds_read_b64_tr_b16 v[200:201], v226 offset:12288
    ds_read_b64_tr_b16 v[202:203], v226 offset:12800
    s_waitcnt lgkmcnt(6)
    v_mfma_f32_32x32x16_bf16 v[144:159], v[188:191], v[12:15], v[144:159]
    ds_read_b64_tr_b16 v[204:205], v226 offset:14336
    ds_read_b64_tr_b16 v[206:207], v226 offset:14848
    s_add_u32 m0, s45, 57344
    s_mov_b32 s49, 4128768
    buffer_load_dwordx4 v224, s[28:31], s49 offen lds
    s_waitcnt vmcnt(6)
    s_barrier
    s_waitcnt lgkmcnt(6)
    v_mfma_f32_32x32x16_bf16 v[144:159], v[192:195], v[16:19], v[144:159]
    ds_read_b64_tr_b16 v[176:177], v226 offset:16384
    ds_read_b64_tr_b16 v[178:179], v226 offset:16896
    s_waitcnt lgkmcnt(6)
    v_mfma_f32_32x32x16_bf16 v[144:159], v[196:199], v[20:23], v[144:159]
    ds_read_b64_tr_b16 v[180:181], v226 offset:18432
    ds_read_b64_tr_b16 v[182:183], v226 offset:18944
    s_waitcnt lgkmcnt(6)
    v_mfma_f32_32x32x16_bf16 v[144:159], v[200:203], v[24:27], v[144:159]
    ds_read_b64_tr_b16 v[184:185], v226 offset:20480
    ds_read_b64_tr_b16 v[186:187], v226 offset:20992
    s_waitcnt lgkmcnt(6)
    v_mfma_f32_32x32x16_bf16 v[144:159], v[204:207], v[28:31], v[144:159]
    ds_read_b64_tr_b16 v[188:189], v226 offset:22528
    ds_read_b64_tr_b16 v[190:191], v226 offset:23040
    s_add_u32 m0, s45, 0
    s_mov_b32 s49, 4718592
    buffer_load_dwordx4 v224, s[28:31], s49 offen lds
    s_waitcnt vmcnt(6)
    s_barrier
    s_waitcnt lgkmcnt(6)
    v_mfma_f32_32x32x16_bf16 v[144:159], v[176:179], v[32:35], v[144:159]
    ds_read_b64_tr_b16 v[192:193], v226 offset:24576
    ds_read_b64_tr_b16 v[194:195], v226 offset:25088
    s_waitcnt lgkmcnt(6)
    v_mfma_f32_32x32x16_bf16 v[144:159], v[180:183], v[36:39], v[144:159]
    ds_read_b64_tr_b16 v[196:197], v226 offset:26624
    ds_read_b64_tr_b16 v[198:199], v226 offset:27136
    s_waitcnt lgkmcnt(6)
    v_mfma_f32_32x32x16_bf16 v[144:159], v[184:187], v[40:43], v[144:159]
    ds_read_b64_tr_b16 v[200:201], v226 offset:28672
    ds_read_b64_tr_b16 v[202:203], v226 offset:29184
    s_waitcnt lgkmcnt(6)
    v_mfma_f32_32x32x16_bf16 v[144:159], v[188:191], v[44:47], v[144:159]
    ds_read_b64_tr_b16 v[204:205], v226 offset:30720
    ds_read_b64_tr_b16 v[206:207], v226 offset:31232
    s_add_u32 m0, s45, 8192
    s_mov_b32 s49, 128
    buffer_load_dwordx4 v224, s[28:31], s49 offen lds
    s_waitcnt vmcnt(6)
    s_barrier
    s_waitcnt lgkmcnt(6)
    v_mfma_f32_32x32x16_bf16 v[144:159], v[192:195], v[48:51], v[144:159]
    ds_read_b64_tr_b16 v[176:177], v226 offset:32768
    ds_read_b64_tr_b16 v[178:179], v226 offset:33280
    s_waitcnt lgkmcnt(6)
    v_mfma_f32_32x32x16_bf16 v[144:159], v[196:199], v[52:55], v[144:159]
    ds_read_b64_tr_b16 v[180:181], v226 offset:34816
    ds_read_b64_tr_b16 v[182:183], v226 offset:35328
    s_waitcnt lgkmcnt(6)
    v_mfma_f32_32x32x16_bf16 v[144:159], v[200:203], v[56:59], v[144:159]
    ds_read_b64_tr_b16 v[184:185], v226 offset:36864
    ds_read_b64_tr_b16 v[186:187], v226 offset:37376
    s_waitcnt lgkmcnt(6)
    v_mfma_f32_32x32x16_bf16 v[144:159], v[204:207], v[60:63], v[144:159]
    ds_read_b64_tr_b16 v[188:189], v226 offset:38912
    ds_read_b64_tr_b16 v[190:191], v226 offset:39424
    s_add_u32 m0, s45, 16384
    s_mov_b32 s49, 589952
    buffer_load_dwordx4 v224, s[28:31], s49 offen lds
    s_waitcnt vmcnt(6)
    s_barrier
    s_waitcnt lgkmcnt(6)
    v_mfma_f32_32x32x16_bf16 v[144:159], v[176:179], v[64:67], v[144:159]
    ds_read_b64_tr_b16 v[192:193], v226 offset:40960
    ds_read_b64_tr_b16 v[194:195], v226 offset:41472
    s_waitcnt lgkmcnt(6)
    v_mfma_f32_32x32x16_bf16 v[144:159], v[180:183], v[68:71], v[144:159]
    ds_read_b64_tr_b16 v[196:197], v226 offset:43008
    ds_read_b64_tr_b16 v[198:199], v226 offset:43520
    s_waitcnt lgkmcnt(6)
    v_mfma_f32_32x32x16_bf16 v[144:159], v[184:187], v[72:75], v[144:159]
    ds_read_b64_tr_b16 v[200:201], v226 offset:45056
    ds_read_b64_tr_b16 v[202:203], v226 offset:45568
    s_waitcnt lgkmcnt(6)
    v_mfma_f32_32x32x16_bf16 v[144:159], v[188:191], v[76:79], v[144:159]
    ds_read_b64_tr_b16 v[204:205], v226 offset:47104
    ds_read_b64_tr_b16 v[206:207], v226 offset:47616
    s_add_u32 m0, s45, 24576
    s_mov_b32 s49, 1179776
    buffer_load_dwordx4 v224, s[28:31], s49 offen lds
    s_waitcnt vmcnt(6)
    s_barrier
    s_waitcnt lgkmcnt(6)
    v_mfma_f32_32x32x16_bf16 v[144:159], v[192:195], v[80:83], v[144:159]
    ds_read_b64_tr_b16 v[176:177], v226 offset:49152
    ds_read_b64_tr_b16 v[178:179], v226 offset:49664
    s_waitcnt lgkmcnt(6)
    v_mfma_f32_32x32x16_bf16 v[144:159], v[196:199], v[84:87], v[144:159]
    ds_read_b64_tr_b16 v[180:181], v226 offset:51200
    ds_read_b64_tr_b16 v[182:183], v226 offset:51712
    s_waitcnt lgkmcnt(6)
    v_mfma_f32_32x32x16_bf16 v[144:159], v[200:203], v[88:91], v[144:159]
    ds_read_b64_tr_b16 v[184:185], v226 offset:53248
    ds_read_b64_tr_b16 v[186:187], v226 offset:53760
    s_waitcnt lgkmcnt(6)
    v_mfma_f32_32x32x16_bf16 v[144:159], v[204:207], v[92:95], v[144:159]
    ds_read_b64_tr_b16 v[188:189], v226 offset:55296
    ds_read_b64_tr_b16 v[190:191], v226 offset:55808
    s_add_u32 m0, s45, 32768
    s_mov_b32 s49, 1769600
    buffer_load_dwordx4 v224, s[28:31], s49 offen lds
    s_waitcnt vmcnt(5)
    s_barrier
    s_waitcnt lgkmcnt(6)
    v_mfma_f32_32x32x16_bf16 v[144:159], v[176:179], v[96:99], v[144:159]
    ds_read_b64_tr_b16 v[192:193], v226 offset:57344
    ds_read_b64_tr_b16 v[194:195], v226 offset:57856
    s_waitcnt lgkmcnt(6)
    v_mfma_f32_32x32x16_bf16 v[144:159], v[180:183], v[100:103], v[144:159]
    ds_read_b64_tr_b16 v[196:197], v226 offset:59392
    ds_read_b64_tr_b16 v[198:199], v226 offset:59904
    s_waitcnt lgkmcnt(6)
    v_mfma_f32_32x32x16_bf16 v[144:159], v[184:187], v[104:107], v[144:159]
    ds_read_b64_tr_b16 v[200:201], v226 offset:61440
    ds_read_b64_tr_b16 v[202:203], v226 offset:61952
    s_waitcnt lgkmcnt(6)
    v_mfma_f32_32x32x16_bf16 v[144:159], v[188:191], v[108:111], v[144:159]
    ds_read_b64_tr_b16 v[204:205], v226 offset:63488
    ds_read_b64_tr_b16 v[206:207], v226 offset:64000
    s_add_u32 m0, s45, 40960
    s_mov_b32 s49, 2359424
    buffer_load_dwordx4 v224, s[28:31], s49 offen lds
    s_waitcnt vmcnt(5)
    s_barrier
    s_waitcnt lgkmcnt(6)
    v_mfma_f32_32x32x16_bf16 v[144:159], v[192:195], v[112:115], v[144:159]
    ds_read_b64_tr_b16 v[176:177], v226 offset:0
    ds_read_b64_tr_b16 v[178:179], v226 offset:512
    s_waitcnt lgkmcnt(6)
    v_mfma_f32_32x32x16_bf16 v[144:159], v[196:199], v[116:119], v[144:159]
    ds_read_b64_tr_b16 v[180:181], v226 offset:2048
    ds_read_b64_tr_b16 v[182:183], v226 offset:2560
    s_waitcnt lgkmcnt(6)
    v_mfma_f32_32x32x16_bf16 v[144:159], v[200:203], v[120:123], v[144:159]
    ds_read_b64_tr_b16 v[184:185], v226 offset:4096
    ds_read_b64_tr_b16 v[186:187], v226 offset:4608
    s_waitcnt lgkmcnt(6)
    v_mfma_f32_32x32x16_bf16 v[144:159], v[204:207], v[124:127], v[144:159]
    ds_read_b64_tr_b16 v[188:189], v226 offset:6144
    ds_read_b64_tr_b16 v[190:191], v226 offset:6656
    s_add_u32 m0, s45, 49152
    s_mov_b32 s49, 2949248
    buffer_load_dwordx4 v224, s[28:31], s49 offen lds
    s_waitcnt vmcnt(5)
    s_barrier
    s_waitcnt lgkmcnt(6)
    v_mfma_f32_32x32x16_bf16 v[144:159], v[176:179], v[128:131], v[144:159]
    ds_read_b64_tr_b16 v[192:193], v226 offset:8192
    ds_read_b64_tr_b16 v[194:195], v226 offset:8704
    s_waitcnt lgkmcnt(6)
    v_mfma_f32_32x32x16_bf16 v[144:159], v[180:183], v[132:135], v[144:159]
    ds_read_b64_tr_b16 v[196:197], v226 offset:10240
    ds_read_b64_tr_b16 v[198:199], v226 offset:10752
    s_waitcnt lgkmcnt(6)
    v_mfma_f32_32x32x16_bf16 v[144:159], v[184:187], v[136:139], v[144:159]
    ds_read_b64_tr_b16 v[200:201], v226 offset:12288
    ds_read_b64_tr_b16 v[202:203], v226 offset:12800
    s_waitcnt lgkmcnt(6)
    v_mfma_f32_32x32x16_bf16 v[144:159], v[188:191], v[140:143], v[144:159]
    ds_read_b64_tr_b16 v[204:205], v226 offset:14336
    ds_read_b64_tr_b16 v[206:207], v226 offset:14848
    s_add_u32 m0, s45, 57344
    s_mov_b32 s49, 3539072
    buffer_load_dwordx4 v224, s[28:31], s49 offen lds
    s_waitcnt vmcnt(5)
    s_barrier
    s_waitcnt lgkmcnt(6)
    v_mfma_f32_32x32x16_bf16 v[160:175], v[192:195], v[0:3], 0
    ds_read_b64_tr_b16 v[176:177], v226 offset:16384
    ds_read_b64_tr_b16 v[178:179], v226 offset:16896
    s_waitcnt lgkmcnt(6)
    v_mfma_f32_32x32x16_bf16 v[160:175], v[196:199], v[4:7], v[160:175]
    ds_read_b64_tr_b16 v[180:181], v226 offset:18432
    ds_read_b64_tr_b16 v[182:183], v226 offset:18944
    s_waitcnt lgkmcnt(6)
    v_mfma_f32_32x32x16_bf16 v[160:175], v[200:203], v[8:11], v[160:175]
    ds_read_b64_tr_b16 v[184:185], v226 offset:20480
    ds_read_b64_tr_b16 v[186:187], v226 offset:20992
    s_waitcnt lgkmcnt(6)
    v_mfma_f32_32x32x16_bf16 v[160:175], v[204:207], v[12:15], v[160:175]
    ds_read_b64_tr_b16 v[188:189], v226 offset:22528
    ds_read_b64_tr_b16 v[190:191], v226 offset:23040
    s_add_u32 m0, s45, 0
    s_mov_b32 s49, 4128896
    buffer_load_dwordx4 v224, s[28:31], s49 offen lds
    s_waitcnt vmcnt(5)
    s_barrier
    s_waitcnt lgkmcnt(6)
    v_mfma_f32_32x32x16_bf16 v[160:175], v[176:179], v[16:19], v[160:175]
    ds_read_b64_tr_b16 v[192:193], v226 offset:24576
    ds_read_b64_tr_b16 v[194:195], v226 offset:25088
    v_mul_f32 v216, v144, v231
    v_mul_f32 v217, v145, v231
    v_exp_f32_e64 v216, -v216
    s_waitcnt lgkmcnt(6)
    v_mfma_f32_32x32x16_bf16 v[160:175], v[180:183], v[20:23], v[160:175]
    ds_read_b64_tr_b16 v[196:197], v226 offset:26624
    ds_read_b64_tr_b16 v[198:199], v226 offset:27136
    v_exp_f32_e64 v217, -v217
    v_fma_f32 v216, v216, v232, v232
    s_waitcnt lgkmcnt(6)
    v_mfma_f32_32x32x16_bf16 v[160:175], v[184:187], v[24:27], v[160:175]
    ds_read_b64_tr_b16 v[200:201], v226 offset:28672
    ds_read_b64_tr_b16 v[202:203], v226 offset:29184
    v_fma_f32 v217, v217, v232, v232
    v_rcp_f32 v216, v216
    s_waitcnt lgkmcnt(6)
    v_mfma_f32_32x32x16_bf16 v[160:175], v[188:191], v[28:31], v[160:175]
    ds_read_b64_tr_b16 v[204:205], v226 offset:30720
    ds_read_b64_tr_b16 v[206:207], v226 offset:31232
    v_rcp_f32 v217, v217
    v_mul_f32 v216, v144, v216
    v_mul_f32 v217, v145, v217
    v_cvt_pk_bf16_f32 v208, v216, v217
    s_add_u32 m0, s45, 8192
    s_mov_b32 s49, 4718720
    buffer_load_dwordx4 v224, s[28:31], s49 offen lds
    s_waitcnt vmcnt(5)
    s_barrier
    s_waitcnt lgkmcnt(6)
    v_mfma_f32_32x32x16_bf16 v[160:175], v[192:195], v[32:35], v[160:175]
    ds_read_b64_tr_b16 v[176:177], v226 offset:32768
    ds_read_b64_tr_b16 v[178:179], v226 offset:33280
    v_mul_f32 v216, v146, v231
    v_mul_f32 v217, v147, v231
    v_exp_f32_e64 v216, -v216
    s_waitcnt lgkmcnt(6)
    v_mfma_f32_32x32x16_bf16 v[160:175], v[196:199], v[36:39], v[160:175]
    ds_read_b64_tr_b16 v[180:181], v226 offset:34816
    ds_read_b64_tr_b16 v[182:183], v226 offset:35328
    v_exp_f32_e64 v217, -v217
    v_fma_f32 v216, v216, v232, v232
    s_waitcnt lgkmcnt(6)
    v_mfma_f32_32x32x16_bf16 v[160:175], v[200:203], v[40:43], v[160:175]
    ds_read_b64_tr_b16 v[184:185], v226 offset:36864
    ds_read_b64_tr_b16 v[186:187], v226 offset:37376
    v_fma_f32 v217, v217, v232, v232
    v_rcp_f32 v216, v216
    s_waitcnt lgkmcnt(6)
    v_mfma_f32_32x32x16_bf16 v[160:175], v[204:207], v[44:47], v[160:175]
    ds_read_b64_tr_b16 v[188:189], v226 offset:38912
    ds_read_b64_tr_b16 v[190:191], v226 offset:39424
    v_rcp_f32 v217, v217
    v_mul_f32 v216, v146, v216
    v_mul_f32 v217, v147, v217
    v_cvt_pk_bf16_f32 v209, v216, v217
    s_add_u32 m0, s45, 16384
    s_mov_b32 s49, 256
    buffer_load_dwordx4 v224, s[28:31], s49 offen lds
    s_waitcnt vmcnt(5)
    s_barrier
    s_waitcnt lgkmcnt(6)
    v_mfma_f32_32x32x16_bf16 v[160:175], v[176:179], v[48:51], v[160:175]
    ds_read_b64_tr_b16 v[192:193], v226 offset:40960
    ds_read_b64_tr_b16 v[194:195], v226 offset:41472
    v_mul_f32 v216, v148, v231
    v_mul_f32 v217, v149, v231
    v_exp_f32_e64 v216, -v216
    s_waitcnt lgkmcnt(6)
    v_mfma_f32_32x32x16_bf16 v[160:175], v[180:183], v[52:55], v[160:175]
    ds_read_b64_tr_b16 v[196:197], v226 offset:43008
    ds_read_b64_tr_b16 v[198:199], v226 offset:43520
    v_exp_f32_e64 v217, -v217
    v_fma_f32 v216, v216, v232, v232
    s_waitcnt lgkmcnt(6)
    v_mfma_f32_32x32x16_bf16 v[160:175], v[184:187], v[56:59], v[160:175]
    ds_read_b64_tr_b16 v[200:201], v226 offset:45056
    ds_read_b64_tr_b16 v[202:203], v226 offset:45568
    v_fma_f32 v217, v217, v232, v232
    v_rcp_f32 v216, v216
    s_waitcnt lgkmcnt(6)
    v_mfma_f32_32x32x16_bf16 v[160:175], v[188:191], v[60:63], v[160:175]
    ds_read_b64_tr_b16 v[204:205], v226 offset:47104
    ds_read_b64_tr_b16 v[206:207], v226 offset:47616
    v_rcp_f32 v217, v217
    v_mul_f32 v216, v148, v216
    v_mul_f32 v217, v149, v217
    v_cvt_pk_bf16_f32 v210, v216, v217
    s_add_u32 m0, s45, 24576
    s_mov_b32 s49, 590080
    buffer_load_dwordx4 v224, s[28:31], s49 offen lds
    s_waitcnt vmcnt(5)
    s_barrier
    s_waitcnt lgkmcnt(6)
    v_mfma_f32_32x32x16_bf16 v[160:175], v[192:195], v[64:67], v[160:175]
    ds_read_b64_tr_b16 v[176:177], v226 offset:49152
    ds_read_b64_tr_b16 v[178:179], v226 offset:49664
    v_mul_f32 v216, v150, v231
    v_mul_f32 v217, v151, v231
    v_exp_f32_e64 v216, -v216
    s_waitcnt lgkmcnt(6)
    v_mfma_f32_32x32x16_bf16 v[160:175], v[196:199], v[68:71], v[160:175]
    ds_read_b64_tr_b16 v[180:181], v226 offset:51200
    ds_read_b64_tr_b16 v[182:183], v226 offset:51712
    v_exp_f32_e64 v217, -v217
    v_fma_f32 v216, v216, v232, v232
    s_waitcnt lgkmcnt(6)
    v_mfma_f32_32x32x16_bf16 v[160:175], v[200:203], v[72:75], v[160:175]
    ds_read_b64_tr_b16 v[184:185], v226 offset:53248
    ds_read_b64_tr_b16 v[186:187], v226 offset:53760
    v_fma_f32 v217, v217, v232, v232
    v_rcp_f32 v216, v216
    s_waitcnt lgkmcnt(6)
    v_mfma_f32_32x32x16_bf16 v[160:175], v[204:207], v[76:79], v[160:175]
    ds_read_b64_tr_b16 v[188:189], v226 offset:55296
    ds_read_b64_tr_b16 v[190:191], v226 offset:55808
    v_rcp_f32 v217, v217
    v_mul_f32 v216, v150, v216
    v_mul_f32 v217, v151, v217
    v_cvt_pk_bf16_f32 v211, v216, v217
    ds_write_b128 v228, v[208:211] offset:0
    s_add_u32 m0, s45, 32768
    s_mov_b32 s49, 1179904
    buffer_load_dwordx4 v224, s[28:31], s49 offen lds
    s_waitcnt vmcnt(5) lgkmcnt(0)
    s_barrier
    v_mfma_f32_32x32x16_bf16 v[160:175], v[176:179], v[80:83], v[160:175]
    ds_read_b64_tr_b16 v[192:193], v226 offset:57344
    ds_read_b64_tr_b16 v[194:195], v226 offset:57856
    v_mul_f32 v216, v152, v231
    v_mul_f32 v217, v153, v231
    v_exp_f32_e64 v216, -v216
    v_mfma_f32_32x32x16_bf16 v[160:175], v[180:183], v[84:87], v[160:175]
    ds_read_b64_tr_b16 v[196:197], v226 offset:59392
    ds_read_b64_tr_b16 v[198:199], v226 offset:59904
    v_exp_f32_e64 v217, -v217
    v_fma_f32 v216, v216, v232, v232
    v_mfma_f32_32x32x16_bf16 v[160:175], v[184:187], v[88:91], v[160:175]
    ds_read_b64_tr_b16 v[200:201], v226 offset:61440
    ds_read_b64_tr_b16 v[202:203], v226 offset:61952
    v_fma_f32 v217, v217, v232, v232
    v_rcp_f32 v216, v216
    v_mfma_f32_32x32x16_bf16 v[160:175], v[188:191], v[92:95], v[160:175]
    ds_read_b64_tr_b16 v[204:205], v226 offset:63488
    ds_read_b64_tr_b16 v[206:207], v226 offset:64000
    v_rcp_f32 v217, v217
    v_mul_f32 v216, v152, v216
    v_mul_f32 v217, v153, v217
    v_cvt_pk_bf16_f32 v212, v216, v217
    s_add_u32 m0, s45, 40960
    s_mov_b32 s49, 1769728
    buffer_load_dwordx4 v224, s[28:31], s49 offen lds
    s_waitcnt vmcnt(5)
    s_barrier
    s_waitcnt lgkmcnt(6)
    v_mfma_f32_32x32x16_bf16 v[160:175], v[192:195], v[96:99], v[160:175]
    ds_read_b64_tr_b16 v[176:177], v226 offset:0
    ds_read_b64_tr_b16 v[178:179], v226 offset:512
    v_mul_f32 v216, v154, v231
    v_mul_f32 v217, v155, v231
    v_exp_f32_e64 v216, -v216
    s_waitcnt lgkmcnt(6)
    v_mfma_f32_32x32x16_bf16 v[160:175], v[196:199], v[100:103], v[160:175]
    ds_read_b64_tr_b16 v[180:181], v226 offset:2048
    ds_read_b64_tr_b16 v[182:183], v226 offset:2560
    v_exp_f32_e64 v217, -v217
    v_fma_f32 v216, v216, v232, v232
    s_waitcnt lgkmcnt(6)
    v_mfma_f32_32x32x16_bf16 v[160:175], v[200:203], v[104:107], v[160:175]
    ds_read_b64_tr_b16 v[184:185], v226 offset:4096
    ds_read_b64_tr_b16 v[186:187], v226 offset:4608
    v_fma_f32 v217, v217, v232, v232
    v_rcp_f32 v216, v216
    s_waitcnt lgkmcnt(6)
    v_mfma_f32_32x32x16_bf16 v[160:175], v[204:207], v[108:111], v[160:175]
    ds_read_b64_tr_b16 v[188:189], v226 offset:6144
    ds_read_b64_tr_b16 v[190:191], v226 offset:6656
    v_rcp_f32 v217, v217
    v_mul_f32 v216, v154, v216
    v_mul_f32 v217, v155, v217
    v_cvt_pk_bf16_f32 v213, v216, v217
    s_add_u32 m0, s45, 49152
    s_mov_b32 s49, 2359552
    buffer_load_dwordx4 v224, s[28:31], s49 offen lds
    s_waitcnt vmcnt(5)
    s_barrier
    s_waitcnt lgkmcnt(6)
    v_mfma_f32_32x32x16_bf16 v[160:175], v[176:179], v[112:115], v[160:175]
    ds_read_b64_tr_b16 v[192:193], v226 offset:8192
    ds_read_b64_tr_b16 v[194:195], v226 offset:8704
    v_mul_f32 v216, v156, v231
    v_mul_f32 v217, v157, v231
    v_exp_f32_e64 v216, -v216
    s_waitcnt lgkmcnt(6)
    v_mfma_f32_32x32x16_bf16 v[160:175], v[180:183], v[116:119], v[160:175]
    ds_read_b64_tr_b16 v[196:197], v226 offset:10240
    ds_read_b64_tr_b16 v[198:199], v226 offset:10752
    v_exp_f32_e64 v217, -v217
    v_fma_f32 v216, v216, v232, v232
    s_waitcnt lgkmcnt(6)
    v_mfma_f32_32x32x16_bf16 v[160:175], v[184:187], v[120:123], v[160:175]
    ds_read_b64_tr_b16 v[200:201], v226 offset:12288
    ds_read_b64_tr_b16 v[202:203], v226 offset:12800
    v_fma_f32 v217, v217, v232, v232
    v_rcp_f32 v216, v216
    s_waitcnt lgkmcnt(6)
    v_mfma_f32_32x32x16_bf16 v[160:175], v[188:191], v[124:127], v[160:175]
    ds_read_b64_tr_b16 v[204:205], v226 offset:14336
    ds_read_b64_tr_b16 v[206:207], v226 offset:14848
    v_rcp_f32 v217, v217
    v_mul_f32 v216, v156, v216
    v_mul_f32 v217, v157, v217
    v_cvt_pk_bf16_f32 v214, v216, v217
    s_add_u32 m0, s45, 57344
    s_mov_b32 s49, 2949376
    buffer_load_dwordx4 v224, s[28:31], s49 offen lds
    s_waitcnt vmcnt(5)
    s_barrier
    s_waitcnt lgkmcnt(6)
    v_mfma_f32_32x32x16_bf16 v[160:175], v[192:195], v[128:131], v[160:175]
    ds_read_b64_tr_b16 v[176:177], v226 offset:16384
    ds_read_b64_tr_b16 v[178:179], v226 offset:16896
    v_mul_f32 v216, v158, v231
    v_mul_f32 v217, v159, v231
    v_exp_f32_e64 v216, -v216
    s_waitcnt lgkmcnt(6)
    v_mfma_f32_32x32x16_bf16 v[160:175], v[196:199], v[132:135], v[160:175]
    ds_read_b64_tr_b16 v[180:181], v226 offset:18432
    ds_read_b64_tr_b16 v[182:183], v226 offset:18944
    v_exp_f32_e64 v217, -v217
    v_fma_f32 v216, v216, v232, v232
    s_waitcnt lgkmcnt(6)
    v_mfma_f32_32x32x16_bf16 v[160:175], v[200:203], v[136:139], v[160:175]
    ds_read_b64_tr_b16 v[184:185], v226 offset:20480
    ds_read_b64_tr_b16 v[186:187], v226 offset:20992
    v_fma_f32 v217, v217, v232, v232
    v_rcp_f32 v216, v216
    s_waitcnt lgkmcnt(6)
    v_mfma_f32_32x32x16_bf16 v[160:175], v[204:207], v[140:143], v[160:175]
    ds_read_b64_tr_b16 v[188:189], v226 offset:22528
    ds_read_b64_tr_b16 v[190:191], v226 offset:23040
    v_rcp_f32 v217, v217
    v_mul_f32 v216, v158, v216
    v_mul_f32 v217, v159, v217
    v_cvt_pk_bf16_f32 v215, v216, v217
    ds_write_b128 v228, v[212:215] offset:1024
    s_add_u32 m0, s45, 0
    s_mov_b32 s49, 3539200
    buffer_load_dwordx4 v224, s[28:31], s49 offen lds
    s_waitcnt vmcnt(5) lgkmcnt(0)
    s_barrier
    v_mfma_f32_32x32x16_bf16 v[144:159], v[176:179], v[0:3], 0
    ds_read_b64_tr_b16 v[192:193], v226 offset:24576
    ds_read_b64_tr_b16 v[194:195], v226 offset:25088
    v_mfma_f32_32x32x16_bf16 v[144:159], v[180:183], v[4:7], v[144:159]
    ds_read_b64_tr_b16 v[196:197], v226 offset:26624
    ds_read_b64_tr_b16 v[198:199], v226 offset:27136
    v_mfma_f32_32x32x16_bf16 v[144:159], v[184:187], v[8:11], v[144:159]
    ds_read_b64_tr_b16 v[200:201], v226 offset:28672
    ds_read_b64_tr_b16 v[202:203], v226 offset:29184
    v_mfma_f32_32x32x16_bf16 v[144:159], v[188:191], v[12:15], v[144:159]
    ds_read_b64_tr_b16 v[204:205], v226 offset:30720
    ds_read_b64_tr_b16 v[206:207], v226 offset:31232
    s_add_u32 m0, s45, 8192
    s_mov_b32 s49, 4129024
    buffer_load_dwordx4 v224, s[28:31], s49 offen lds
    s_waitcnt vmcnt(5)
    s_barrier
    s_waitcnt lgkmcnt(6)
    v_mfma_f32_32x32x16_bf16 v[144:159], v[192:195], v[16:19], v[144:159]
    ds_read_b64_tr_b16 v[176:177], v226 offset:32768
    ds_read_b64_tr_b16 v[178:179], v226 offset:33280
    v_mul_f32 v216, v160, v231
    v_mul_f32 v217, v161, v231
    v_exp_f32_e64 v216, -v216
    s_waitcnt lgkmcnt(6)
    v_mfma_f32_32x32x16_bf16 v[144:159], v[196:199], v[20:23], v[144:159]
    ds_read_b64_tr_b16 v[180:181], v226 offset:34816
    ds_read_b64_tr_b16 v[182:183], v226 offset:35328
    v_exp_f32_e64 v217, -v217
    v_fma_f32 v216, v216, v232, v232
    s_waitcnt lgkmcnt(6)
    v_mfma_f32_32x32x16_bf16 v[144:159], v[200:203], v[24:27], v[144:159]
    ds_read_b64_tr_b16 v[184:185], v226 offset:36864
    ds_read_b64_tr_b16 v[186:187], v226 offset:37376
    v_fma_f32 v217, v217, v232, v232
    v_rcp_f32 v216, v216
    s_waitcnt lgkmcnt(6)
    v_mfma_f32_32x32x16_bf16 v[144:159], v[204:207], v[28:31], v[144:159]
    ds_read_b64_tr_b16 v[188:189], v226 offset:38912
    ds_read_b64_tr_b16 v[190:191], v226 offset:39424
    v_rcp_f32 v217, v217
    v_mul_f32 v216, v160, v216
    v_mul_f32 v217, v161, v217
    v_cvt_pk_bf16_f32 v208, v216, v217
    s_add_u32 m0, s45, 16384
    s_mov_b32 s49, 4718848
    buffer_load_dwordx4 v224, s[28:31], s49 offen lds
    s_waitcnt vmcnt(5)
    s_barrier
    s_waitcnt lgkmcnt(6)
    v_mfma_f32_32x32x16_bf16 v[144:159], v[176:179], v[32:35], v[144:159]
    ds_read_b64_tr_b16 v[192:193], v226 offset:40960
    ds_read_b64_tr_b16 v[194:195], v226 offset:41472
    v_mul_f32 v216, v162, v231
    v_mul_f32 v217, v163, v231
    v_exp_f32_e64 v216, -v216
    s_waitcnt lgkmcnt(6)
    v_mfma_f32_32x32x16_bf16 v[144:159], v[180:183], v[36:39], v[144:159]
    ds_read_b64_tr_b16 v[196:197], v226 offset:43008
    ds_read_b64_tr_b16 v[198:199], v226 offset:43520
    v_exp_f32_e64 v217, -v217
    v_fma_f32 v216, v216, v232, v232
    s_waitcnt lgkmcnt(6)
    v_mfma_f32_32x32x16_bf16 v[144:159], v[184:187], v[40:43], v[144:159]
    ds_read_b64_tr_b16 v[200:201], v226 offset:45056
    ds_read_b64_tr_b16 v[202:203], v226 offset:45568
    v_fma_f32 v217, v217, v232, v232
    v_rcp_f32 v216, v216
    s_waitcnt lgkmcnt(6)
    v_mfma_f32_32x32x16_bf16 v[144:159], v[188:191], v[44:47], v[144:159]
    ds_read_b64_tr_b16 v[204:205], v226 offset:47104
    ds_read_b64_tr_b16 v[206:207], v226 offset:47616
    v_rcp_f32 v217, v217
    v_mul_f32 v216, v162, v216
    v_mul_f32 v217, v163, v217
    v_cvt_pk_bf16_f32 v209, v216, v217
    s_add_u32 m0, s45, 24576
    s_mov_b32 s49, 384
    buffer_load_dwordx4 v224, s[28:31], s49 offen lds
    s_waitcnt vmcnt(5)
    s_barrier
    s_waitcnt lgkmcnt(6)
    v_mfma_f32_32x32x16_bf16 v[144:159], v[192:195], v[48:51], v[144:159]
    ds_read_b64_tr_b16 v[176:177], v226 offset:49152
    ds_read_b64_tr_b16 v[178:179], v226 offset:49664
    v_mul_f32 v216, v164, v231
    v_mul_f32 v217, v165, v231
    v_exp_f32_e64 v216, -v216
    s_waitcnt lgkmcnt(6)
    v_mfma_f32_32x32x16_bf16 v[144:159], v[196:199], v[52:55], v[144:159]
    ds_read_b64_tr_b16 v[180:181], v226 offset:51200
    ds_read_b64_tr_b16 v[182:183], v226 offset:51712
    v_exp_f32_e64 v217, -v217
    v_fma_f32 v216, v216, v232, v232
    s_waitcnt lgkmcnt(6)
    v_mfma_f32_32x32x16_bf16 v[144:159], v[200:203], v[56:59], v[144:159]
    ds_read_b64_tr_b16 v[184:185], v226 offset:53248
    ds_read_b64_tr_b16 v[186:187], v226 offset:53760
    v_fma_f32 v217, v217, v232, v232
    v_rcp_f32 v216, v216
    s_waitcnt lgkmcnt(6)
    v_mfma_f32_32x32x16_bf16 v[144:159], v[204:207], v[60:63], v[144:159]
    ds_read_b64_tr_b16 v[188:189], v226 offset:55296
    ds_read_b64_tr_b16 v[190:191], v226 offset:55808
    v_rcp_f32 v217, v217
    v_mul_f32 v216, v164, v216
    v_mul_f32 v217, v165, v217
    v_cvt_pk_bf16_f32 v210, v216, v217
    s_add_u32 m0, s45, 32768
    s_mov_b32 s49, 590208
    buffer_load_dwordx4 v224, s[28:31], s49 offen lds
    s_waitcnt vmcnt(5)
    s_barrier
    s_waitcnt lgkmcnt(6)
    v_mfma_f32_32x32x16_bf16 v[144:159], v[176:179], v[64:67], v[144:159]
    ds_read_b64_tr_b16 v[192:193], v226 offset:57344
    ds_read_b64_tr_b16 v[194:195], v226 offset:57856
    v_mul_f32 v216, v166, v231
    v_mul_f32 v217, v167, v231
    v_exp_f32_e64 v216, -v216
    s_waitcnt lgkmcnt(6)
    v_mfma_f32_32x32x16_bf16 v[144:159], v[180:183], v[68:71], v[144:159]
    ds_read_b64_tr_b16 v[196:197], v226 offset:59392
    ds_read_b64_tr_b16 v[198:199], v226 offset:59904
    v_exp_f32_e64 v217, -v217
    v_fma_f32 v216, v216, v232, v232
    s_waitcnt lgkmcnt(6)
    v_mfma_f32_32x32x16_bf16 v[144:159], v[184:187], v[72:75], v[144:159]
    ds_read_b64_tr_b16 v[200:201], v226 offset:61440
    ds_read_b64_tr_b16 v[202:203], v226 offset:61952
    v_fma_f32 v217, v217, v232, v232
    v_rcp_f32 v216, v216
    s_waitcnt lgkmcnt(6)
    v_mfma_f32_32x32x16_bf16 v[144:159], v[188:191], v[76:79], v[144:159]
    ds_read_b64_tr_b16 v[204:205], v226 offset:63488
    ds_read_b64_tr_b16 v[206:207], v226 offset:64000
    v_rcp_f32 v217, v217
    v_mul_f32 v216, v166, v216
    v_mul_f32 v217, v167, v217
    v_cvt_pk_bf16_f32 v211, v216, v217
    ds_write_b128 v228, v[208:211] offset:4096
    s_add_u32 m0, s45, 40960
    s_mov_b32 s49, 1180032
    buffer_load_dwordx4 v224, s[28:31], s49 offen lds
    s_waitcnt vmcnt(5) lgkmcnt(0)
    s_barrier
    v_mfma_f32_32x32x16_bf16 v[144:159], v[192:195], v[80:83], v[144:159]
    ds_read_b64_tr_b16 v[176:177], v226 offset:0
    ds_read_b64_tr_b16 v[178:179], v226 offset:512
    v_mul_f32 v216, v168, v231
    v_mul_f32 v217, v169, v231
    v_exp_f32_e64 v216, -v216
    v_mfma_f32_32x32x16_bf16 v[144:159], v[196:199], v[84:87], v[144:159]
    ds_read_b64_tr_b16 v[180:181], v226 offset:2048
    ds_read_b64_tr_b16 v[182:183], v226 offset:2560
    v_exp_f32_e64 v217, -v217
    v_fma_f32 v216, v216, v232, v232
    v_mfma_f32_32x32x16_bf16 v[144:159], v[200:203], v[88:91], v[144:159]
    ds_read_b64_tr_b16 v[184:185], v226 offset:4096
    ds_read_b64_tr_b16 v[186:187], v226 offset:4608
    v_fma_f32 v217, v217, v232, v232
    v_rcp_f32 v216, v216
    v_mfma_f32_32x32x16_bf16 v[144:159], v[204:207], v[92:95], v[144:159]
    ds_read_b64_tr_b16 v[188:189], v226 offset:6144
    ds_read_b64_tr_b16 v[190:191], v226 offset:6656
    v_rcp_f32 v217, v217
    v_mul_f32 v216, v168, v216
    v_mul_f32 v217, v169, v217
    v_cvt_pk_bf16_f32 v212, v216, v217
    s_add_u32 m0, s45, 49152
    s_mov_b32 s49, 1769856
    buffer_load_dwordx4 v224, s[28:31], s49 offen lds
    s_waitcnt vmcnt(5)
    s_barrier
    s_waitcnt lgkmcnt(6)
    v_mfma_f32_32x32x16_bf16 v[144:159], v[176:179], v[96:99], v[144:159]
    ds_read_b64_tr_b16 v[192:193], v226 offset:8192
    ds_read_b64_tr_b16 v[194:195], v226 offset:8704
    v_mul_f32 v216, v170, v231
    v_mul_f32 v217, v171, v231
    v_exp_f32_e64 v216, -v216
    s_waitcnt lgkmcnt(6)
    v_mfma_f32_32x32x16_bf16 v[144:159], v[180:183], v[100:103], v[144:159]
    ds_read_b64_tr_b16 v[196:197], v226 offset:10240
    ds_read_b64_tr_b16 v[198:199], v226 offset:10752
    v_exp_f32_e64 v217, -v217
    v_fma_f32 v216, v216, v232, v232
    s_waitcnt lgkmcnt(6)
    v_mfma_f32_32x32x16_bf16 v[144:159], v[184:187], v[104:107], v[144:159]
    ds_read_b64_tr_b16 v[200:201], v226 offset:12288
    ds_read_b64_tr_b16 v[202:203], v226 offset:12800
    v_fma_f32 v217, v217, v232, v232
    v_rcp_f32 v216, v216
    s_waitcnt lgkmcnt(6)
    v_mfma_f32_32x32x16_bf16 v[144:159], v[188:191], v[108:111], v[144:159]
    ds_read_b64_tr_b16 v[204:205], v226 offset:14336
    ds_read_b64_tr_b16 v[206:207], v226 offset:14848
    v_rcp_f32 v217, v217
    v_mul_f32 v216, v170, v216
    v_mul_f32 v217, v171, v217
    v_cvt_pk_bf16_f32 v213, v216, v217
    s_add_u32 m0, s45, 57344
    s_mov_b32 s49, 2359680
    buffer_load_dwordx4 v224, s[28:31], s49 offen lds
    s_waitcnt vmcnt(5)
    s_barrier
    s_waitcnt lgkmcnt(6)
    v_mfma_f32_32x32x16_bf16 v[144:159], v[192:195], v[112:115], v[144:159]
    ds_read_b64_tr_b16 v[176:177], v226 offset:16384
    ds_read_b64_tr_b16 v[178:179], v226 offset:16896
    v_mul_f32 v216, v172, v231
    v_mul_f32 v217, v173, v231
    v_exp_f32_e64 v216, -v216
    s_waitcnt lgkmcnt(6)
    v_mfma_f32_32x32x16_bf16 v[144:159], v[196:199], v[116:119], v[144:159]
    ds_read_b64_tr_b16 v[180:181], v226 offset:18432
    ds_read_b64_tr_b16 v[182:183], v226 offset:18944
    v_exp_f32_e64 v217, -v217
    v_fma_f32 v216, v216, v232, v232
    s_waitcnt lgkmcnt(6)
    v_mfma_f32_32x32x16_bf16 v[144:159], v[200:203], v[120:123], v[144:159]
    ds_read_b64_tr_b16 v[184:185], v226 offset:20480
    ds_read_b64_tr_b16 v[186:187], v226 offset:20992
    v_fma_f32 v217, v217, v232, v232
    v_rcp_f32 v216, v216
    s_waitcnt lgkmcnt(6)
    v_mfma_f32_32x32x16_bf16 v[144:159], v[204:207], v[124:127], v[144:159]
    ds_read_b64_tr_b16 v[188:189], v226 offset:22528
    ds_read_b64_tr_b16 v[190:191], v226 offset:23040
    v_rcp_f32 v217, v217
    v_mul_f32 v216, v172, v216
    v_mul_f32 v217, v173, v217
    v_cvt_pk_bf16_f32 v214, v216, v217
    s_add_u32 m0, s45, 0
    s_mov_b32 s49, 2949504
    buffer_load_dwordx4 v224, s[28:31], s49 offen lds
    s_waitcnt vmcnt(5)
    s_barrier
    s_waitcnt lgkmcnt(6)
    v_mfma_f32_32x32x16_bf16 v[144:159], v[176:179], v[128:131], v[144:159]
    ds_read_b64_tr_b16 v[192:193], v226 offset:24576
    ds_read_b64_tr_b16 v[194:195], v226 offset:25088
    v_mul_f32 v216, v174, v231
    v_mul_f32 v217, v175, v231
    v_exp_f32_e64 v216, -v216
    s_waitcnt lgkmcnt(6)
    v_mfma_f32_32x32x16_bf16 v[144:159], v[180:183], v[132:135], v[144:159]
    ds_read_b64_tr_b16 v[196:197], v226 offset:26624
    ds_read_b64_tr_b16 v[198:199], v226 offset:27136
    v_exp_f32_e64 v217, -v217
    v_fma_f32 v216, v216, v232, v232
    s_waitcnt lgkmcnt(6)
    v_mfma_f32_32x32x16_bf16 v[144:159], v[184:187], v[136:139], v[144:159]
    ds_read_b64_tr_b16 v[200:201], v226 offset:28672
    ds_read_b64_tr_b16 v[202:203], v226 offset:29184
    v_fma_f32 v217, v217, v232, v232
    v_rcp_f32 v216, v216
    s_waitcnt lgkmcnt(6)
    v_mfma_f32_32x32x16_bf16 v[144:159], v[188:191], v[140:143], v[144:159]
    ds_read_b64_tr_b16 v[204:205], v226 offset:30720
    ds_read_b64_tr_b16 v[206:207], v226 offset:31232
    v_rcp_f32 v217, v217
    v_mul_f32 v216, v174, v216
    v_mul_f32 v217, v175, v217
    v_cvt_pk_bf16_f32 v215, v216, v217
    ds_write_b128 v228, v[212:215] offset:5120
    s_add_u32 m0, s45, 8192
    s_mov_b32 s49, 3539328
    buffer_load_dwordx4 v224, s[28:31], s49 offen lds
    s_waitcnt vmcnt(5) lgkmcnt(0)
    s_barrier
    v_mfma_f32_32x32x16_bf16 v[160:175], v[192:195], v[0:3], 0
    ds_read_b64_tr_b16 v[176:177], v226 offset:32768
    ds_read_b64_tr_b16 v[178:179], v226 offset:33280
    v_mfma_f32_32x32x16_bf16 v[160:175], v[196:199], v[4:7], v[160:175]
    ds_read_b64_tr_b16 v[180:181], v226 offset:34816
    ds_read_b64_tr_b16 v[182:183], v226 offset:35328
    v_mfma_f32_32x32x16_bf16 v[160:175], v[200:203], v[8:11], v[160:175]
    ds_read_b64_tr_b16 v[184:185], v226 offset:36864
    ds_read_b64_tr_b16 v[186:187], v226 offset:37376
    v_mfma_f32_32x32x16_bf16 v[160:175], v[204:207], v[12:15], v[160:175]
    ds_read_b64_tr_b16 v[188:189], v226 offset:38912
    ds_read_b64_tr_b16 v[190:191], v226 offset:39424
    s_add_u32 m0, s45, 16384
    s_mov_b32 s49, 4129152
    buffer_load_dwordx4 v224, s[28:31], s49 offen lds
    s_waitcnt vmcnt(5)
    s_barrier
    s_waitcnt lgkmcnt(6)
    v_mfma_f32_32x32x16_bf16 v[160:175], v[176:179], v[16:19], v[160:175]
    ds_read_b64_tr_b16 v[192:193], v226 offset:40960
    ds_read_b64_tr_b16 v[194:195], v226 offset:41472
    v_mul_f32 v216, v144, v231
    v_mul_f32 v217, v145, v231
    v_exp_f32_e64 v216, -v216
    s_waitcnt lgkmcnt(6)
    v_mfma_f32_32x32x16_bf16 v[160:175], v[180:183], v[20:23], v[160:175]
    ds_read_b64_tr_b16 v[196:197], v226 offset:43008
    ds_read_b64_tr_b16 v[198:199], v226 offset:43520
    v_exp_f32_e64 v217, -v217
    v_fma_f32 v216, v216, v232, v232
    s_waitcnt lgkmcnt(6)
    v_mfma_f32_32x32x16_bf16 v[160:175], v[184:187], v[24:27], v[160:175]
    ds_read_b64_tr_b16 v[200:201], v226 offset:45056
    ds_read_b64_tr_b16 v[202:203], v226 offset:45568
    v_fma_f32 v217, v217, v232, v232
    v_rcp_f32 v216, v216
    s_waitcnt lgkmcnt(6)
    v_mfma_f32_32x32x16_bf16 v[160:175], v[188:191], v[28:31], v[160:175]
    ds_read_b64_tr_b16 v[204:205], v226 offset:47104
    ds_read_b64_tr_b16 v[206:207], v226 offset:47616
    v_rcp_f32 v217, v217
    v_mul_f32 v216, v144, v216
    v_mul_f32 v217, v145, v217
    v_cvt_pk_bf16_f32 v208, v216, v217
    s_add_u32 m0, s45, 24576
    s_mov_b32 s49, 4718976
    buffer_load_dwordx4 v224, s[28:31], s49 offen lds
    s_waitcnt vmcnt(5)
    s_barrier
    s_waitcnt lgkmcnt(6)
    v_mfma_f32_32x32x16_bf16 v[160:175], v[192:195], v[32:35], v[160:175]
    ds_read_b64_tr_b16 v[176:177], v226 offset:49152
    ds_read_b64_tr_b16 v[178:179], v226 offset:49664
    v_mul_f32 v216, v146, v231
    v_mul_f32 v217, v147, v231
    v_exp_f32_e64 v216, -v216
    s_waitcnt lgkmcnt(6)
    v_mfma_f32_32x32x16_bf16 v[160:175], v[196:199], v[36:39], v[160:175]
    ds_read_b64_tr_b16 v[180:181], v226 offset:51200
    ds_read_b64_tr_b16 v[182:183], v226 offset:51712
    v_exp_f32_e64 v217, -v217
    v_fma_f32 v216, v216, v232, v232
    s_waitcnt lgkmcnt(6)
    v_mfma_f32_32x32x16_bf16 v[160:175], v[200:203], v[40:43], v[160:175]
    ds_read_b64_tr_b16 v[184:185], v226 offset:53248
    ds_read_b64_tr_b16 v[186:187], v226 offset:53760
    v_fma_f32 v217, v217, v232, v232
    v_rcp_f32 v216, v216
    s_waitcnt lgkmcnt(6)
    v_mfma_f32_32x32x16_bf16 v[160:175], v[204:207], v[44:47], v[160:175]
    ds_read_b64_tr_b16 v[188:189], v226 offset:55296
    ds_read_b64_tr_b16 v[190:191], v226 offset:55808
    v_rcp_f32 v217, v217
    v_mul_f32 v216, v146, v216
    v_mul_f32 v217, v147, v217
    v_cvt_pk_bf16_f32 v209, v216, v217
    s_add_u32 m0, s45, 32768
    s_mov_b32 s49, 512
    buffer_load_dwordx4 v224, s[28:31], s49 offen lds
    s_waitcnt vmcnt(5)
    s_barrier
    s_waitcnt lgkmcnt(6)
    v_mfma_f32_32x32x16_bf16 v[160:175], v[176:179], v[48:51], v[160:175]
    ds_read_b64_tr_b16 v[192:193], v226 offset:57344
    ds_read_b64_tr_b16 v[194:195], v226 offset:57856
    v_mul_f32 v216, v148, v231
    v_mul_f32 v217, v149, v231
    v_exp_f32_e64 v216, -v216
    s_waitcnt lgkmcnt(6)
    v_mfma_f32_32x32x16_bf16 v[160:175], v[180:183], v[52:55], v[160:175]
    ds_read_b64_tr_b16 v[196:197], v226 offset:59392
    ds_read_b64_tr_b16 v[198:199], v226 offset:59904
    v_exp_f32_e64 v217, -v217
    v_fma_f32 v216, v216, v232, v232
    s_waitcnt lgkmcnt(6)
    v_mfma_f32_32x32x16_bf16 v[160:175], v[184:187], v[56:59], v[160:175]
    ds_read_b64_tr_b16 v[200:201], v226 offset:61440
    ds_read_b64_tr_b16 v[202:203], v226 offset:61952
    v_fma_f32 v217, v217, v232, v232
    v_rcp_f32 v216, v216
    s_waitcnt lgkmcnt(6)
    v_mfma_f32_32x32x16_bf16 v[160:175], v[188:191], v[60:63], v[160:175]
    ds_read_b64_tr_b16 v[204:205], v226 offset:63488
    ds_read_b64_tr_b16 v[206:207], v226 offset:64000
    v_rcp_f32 v217, v217
    v_mul_f32 v216, v148, v216
    v_mul_f32 v217, v149, v217
    v_cvt_pk_bf16_f32 v210, v216, v217
    s_add_u32 m0, s45, 40960
    s_mov_b32 s49, 590336
    buffer_load_dwordx4 v224, s[28:31], s49 offen lds
    s_waitcnt vmcnt(5)
    s_barrier
    s_waitcnt lgkmcnt(6)
    v_mfma_f32_32x32x16_bf16 v[160:175], v[192:195], v[64:67], v[160:175]
    ds_read_b64_tr_b16 v[176:177], v226 offset:0
    ds_read_b64_tr_b16 v[178:179], v226 offset:512
    v_mul_f32 v216, v150, v231
    v_mul_f32 v217, v151, v231
    v_exp_f32_e64 v216, -v216
    s_waitcnt lgkmcnt(6)
    v_mfma_f32_32x32x16_bf16 v[160:175], v[196:199], v[68:71], v[160:175]
    ds_read_b64_tr_b16 v[180:181], v226 offset:2048
    ds_read_b64_tr_b16 v[182:183], v226 offset:2560
    v_exp_f32_e64 v217, -v217
    v_fma_f32 v216, v216, v232, v232
    s_waitcnt lgkmcnt(6)
    v_mfma_f32_32x32x16_bf16 v[160:175], v[200:203], v[72:75], v[160:175]
    ds_read_b64_tr_b16 v[184:185], v226 offset:4096
    ds_read_b64_tr_b16 v[186:187], v226 offset:4608
    v_fma_f32 v217, v217, v232, v232
    v_rcp_f32 v216, v216
    s_waitcnt lgkmcnt(6)
    v_mfma_f32_32x32x16_bf16 v[160:175], v[204:207], v[76:79], v[160:175]
    ds_read_b64_tr_b16 v[188:189], v226 offset:6144
    ds_read_b64_tr_b16 v[190:191], v226 offset:6656
    v_rcp_f32 v217, v217
    v_mul_f32 v216, v150, v216
    v_mul_f32 v217, v151, v217
    v_cvt_pk_bf16_f32 v211, v216, v217
    ds_write_b128 v228, v[208:211] offset:8192
    s_add_u32 m0, s45, 49152
    s_mov_b32 s49, 1180160
    buffer_load_dwordx4 v224, s[28:31], s49 offen lds
    s_waitcnt vmcnt(5) lgkmcnt(0)
    s_barrier
    v_mfma_f32_32x32x16_bf16 v[160:175], v[176:179], v[80:83], v[160:175]
    ds_read_b64_tr_b16 v[192:193], v226 offset:8192
    ds_read_b64_tr_b16 v[194:195], v226 offset:8704
    v_mul_f32 v216, v152, v231
    v_mul_f32 v217, v153, v231
    v_exp_f32_e64 v216, -v216
    v_mfma_f32_32x32x16_bf16 v[160:175], v[180:183], v[84:87], v[160:175]
    ds_read_b64_tr_b16 v[196:197], v226 offset:10240
    ds_read_b64_tr_b16 v[198:199], v226 offset:10752
    v_exp_f32_e64 v217, -v217
    v_fma_f32 v216, v216, v232, v232
    v_mfma_f32_32x32x16_bf16 v[160:175], v[184:187], v[88:91], v[160:175]
    ds_read_b64_tr_b16 v[200:201], v226 offset:12288
    ds_read_b64_tr_b16 v[202:203], v226 offset:12800
    v_fma_f32 v217, v217, v232, v232
    v_rcp_f32 v216, v216
    v_mfma_f32_32x32x16_bf16 v[160:175], v[188:191], v[92:95], v[160:175]
    ds_read_b64_tr_b16 v[204:205], v226 offset:14336
    ds_read_b64_tr_b16 v[206:207], v226 offset:14848
    v_rcp_f32 v217, v217
    v_mul_f32 v216, v152, v216
    v_mul_f32 v217, v153, v217
    v_cvt_pk_bf16_f32 v212, v216, v217
    s_add_u32 m0, s45, 57344
    s_mov_b32 s49, 1769984
    buffer_load_dwordx4 v224, s[28:31], s49 offen lds
    s_waitcnt vmcnt(5)
    s_barrier
    s_waitcnt lgkmcnt(6)
    v_mfma_f32_32x32x16_bf16 v[160:175], v[192:195], v[96:99], v[160:175]
    ds_read_b64_tr_b16 v[176:177], v226 offset:16384
    ds_read_b64_tr_b16 v[178:179], v226 offset:16896
    v_mul_f32 v216, v154, v231
    v_mul_f32 v217, v155, v231
    v_exp_f32_e64 v216, -v216
    s_waitcnt lgkmcnt(6)
    v_mfma_f32_32x32x16_bf16 v[160:175], v[196:199], v[100:103], v[160:175]
    ds_read_b64_tr_b16 v[180:181], v226 offset:18432
    ds_read_b64_tr_b16 v[182:183], v226 offset:18944
    v_exp_f32_e64 v217, -v217
    v_fma_f32 v216, v216, v232, v232
    s_waitcnt lgkmcnt(6)
    v_mfma_f32_32x32x16_bf16 v[160:175], v[200:203], v[104:107], v[160:175]
    ds_read_b64_tr_b16 v[184:185], v226 offset:20480
    ds_read_b64_tr_b16 v[186:187], v226 offset:20992
    v_fma_f32 v217, v217, v232, v232
    v_rcp_f32 v216, v216
    s_waitcnt lgkmcnt(6)
    v_mfma_f32_32x32x16_bf16 v[160:175], v[204:207], v[108:111], v[160:175]
    ds_read_b64_tr_b16 v[188:189], v226 offset:22528
    ds_read_b64_tr_b16 v[190:191], v226 offset:23040
    v_rcp_f32 v217, v217
    v_mul_f32 v216, v154, v216
    v_mul_f32 v217, v155, v217
    v_cvt_pk_bf16_f32 v213, v216, v217
    s_add_u32 m0, s45, 0
    s_mov_b32 s49, 2359808
    buffer_load_dwordx4 v224, s[28:31], s49 offen lds
    s_waitcnt vmcnt(5)
    s_barrier
    s_waitcnt lgkmcnt(6)
    v_mfma_f32_32x32x16_bf16 v[160:175], v[176:179], v[112:115], v[160:175]
    ds_read_b64_tr_b16 v[192:193], v226 offset:24576
    ds_read_b64_tr_b16 v[194:195], v226 offset:25088
    v_mul_f32 v216, v156, v231
    v_mul_f32 v217, v157, v231
    v_exp_f32_e64 v216, -v216
    s_waitcnt lgkmcnt(6)
    v_mfma_f32_32x32x16_bf16 v[160:175], v[180:183], v[116:119], v[160:175]
    ds_read_b64_tr_b16 v[196:197], v226 offset:26624
    ds_read_b64_tr_b16 v[198:199], v226 offset:27136
    v_exp_f32_e64 v217, -v217
    v_fma_f32 v216, v216, v232, v232
    s_waitcnt lgkmcnt(6)
    v_mfma_f32_32x32x16_bf16 v[160:175], v[184:187], v[120:123], v[160:175]
    ds_read_b64_tr_b16 v[200:201], v226 offset:28672
    ds_read_b64_tr_b16 v[202:203], v226 offset:29184
    v_fma_f32 v217, v217, v232, v232
    v_rcp_f32 v216, v216
    s_waitcnt lgkmcnt(6)
    v_mfma_f32_32x32x16_bf16 v[160:175], v[188:191], v[124:127], v[160:175]
    ds_read_b64_tr_b16 v[204:205], v226 offset:30720
    ds_read_b64_tr_b16 v[206:207], v226 offset:31232
    v_rcp_f32 v217, v217
    v_mul_f32 v216, v156, v216
    v_mul_f32 v217, v157, v217
    v_cvt_pk_bf16_f32 v214, v216, v217
    s_add_u32 m0, s45, 8192
    s_mov_b32 s49, 2949632
    buffer_load_dwordx4 v224, s[28:31], s49 offen lds
    s_waitcnt vmcnt(5)
    s_barrier
    s_waitcnt lgkmcnt(6)
    v_mfma_f32_32x32x16_bf16 v[160:175], v[192:195], v[128:131], v[160:175]
    ds_read_b64_tr_b16 v[176:177], v226 offset:32768
    ds_read_b64_tr_b16 v[178:179], v226 offset:33280
    v_mul_f32 v216, v158, v231
    v_mul_f32 v217, v159, v231
    v_exp_f32_e64 v216, -v216
    s_waitcnt lgkmcnt(6)
    v_mfma_f32_32x32x16_bf16 v[160:175], v[196:199], v[132:135], v[160:175]
    ds_read_b64_tr_b16 v[180:181], v226 offset:34816
    ds_read_b64_tr_b16 v[182:183], v226 offset:35328
    v_exp_f32_e64 v217, -v217
    v_fma_f32 v216, v216, v232, v232
    s_waitcnt lgkmcnt(6)
    v_mfma_f32_32x32x16_bf16 v[160:175], v[200:203], v[136:139], v[160:175]
    ds_read_b64_tr_b16 v[184:185], v226 offset:36864
    ds_read_b64_tr_b16 v[186:187], v226 offset:37376
    v_fma_f32 v217, v217, v232, v232
    v_rcp_f32 v216, v216
    s_waitcnt lgkmcnt(6)
    v_mfma_f32_32x32x16_bf16 v[160:175], v[204:207], v[140:143], v[160:175]
    ds_read_b64_tr_b16 v[188:189], v226 offset:38912
    ds_read_b64_tr_b16 v[190:191], v226 offset:39424
    v_rcp_f32 v217, v217
    v_mul_f32 v216, v158, v216
    v_mul_f32 v217, v159, v217
    v_cvt_pk_bf16_f32 v215, v216, v217
    ds_write_b128 v228, v[212:215] offset:9216
    s_add_u32 m0, s45, 16384
    s_mov_b32 s49, 3539456
    buffer_load_dwordx4 v224, s[28:31], s49 offen lds
    s_waitcnt vmcnt(5) lgkmcnt(0)
    s_barrier
    v_mfma_f32_32x32x16_bf16 v[144:159], v[176:179], v[0:3], 0
    ds_read_b64_tr_b16 v[192:193], v226 offset:40960
    ds_read_b64_tr_b16 v[194:195], v226 offset:41472
    v_mfma_f32_32x32x16_bf16 v[144:159], v[180:183], v[4:7], v[144:159]
    ds_read_b64_tr_b16 v[196:197], v226 offset:43008
    ds_read_b64_tr_b16 v[198:199], v226 offset:43520
    v_mfma_f32_32x32x16_bf16 v[144:159], v[184:187], v[8:11], v[144:159]
    ds_read_b64_tr_b16 v[200:201], v226 offset:45056
    ds_read_b64_tr_b16 v[202:203], v226 offset:45568
    v_mfma_f32_32x32x16_bf16 v[144:159], v[188:191], v[12:15], v[144:159]
    ds_read_b64_tr_b16 v[204:205], v226 offset:47104
    ds_read_b64_tr_b16 v[206:207], v226 offset:47616
    s_add_u32 m0, s45, 24576
    s_mov_b32 s49, 4129280
    buffer_load_dwordx4 v224, s[28:31], s49 offen lds
    s_waitcnt vmcnt(5)
    s_barrier
    s_waitcnt lgkmcnt(6)
    v_mfma_f32_32x32x16_bf16 v[144:159], v[192:195], v[16:19], v[144:159]
    ds_read_b64_tr_b16 v[176:177], v226 offset:49152
    ds_read_b64_tr_b16 v[178:179], v226 offset:49664
    v_mul_f32 v216, v160, v231
    v_mul_f32 v217, v161, v231
    v_exp_f32_e64 v216, -v216
    s_waitcnt lgkmcnt(6)
    v_mfma_f32_32x32x16_bf16 v[144:159], v[196:199], v[20:23], v[144:159]
    ds_read_b64_tr_b16 v[180:181], v226 offset:51200
    ds_read_b64_tr_b16 v[182:183], v226 offset:51712
    v_exp_f32_e64 v217, -v217
    v_fma_f32 v216, v216, v232, v232
    s_waitcnt lgkmcnt(6)
    v_mfma_f32_32x32x16_bf16 v[144:159], v[200:203], v[24:27], v[144:159]
    ds_read_b64_tr_b16 v[184:185], v226 offset:53248
    ds_read_b64_tr_b16 v[186:187], v226 offset:53760
    v_fma_f32 v217, v217, v232, v232
    v_rcp_f32 v216, v216
    s_waitcnt lgkmcnt(6)
    v_mfma_f32_32x32x16_bf16 v[144:159], v[204:207], v[28:31], v[144:159]
    ds_read_b64_tr_b16 v[188:189], v226 offset:55296
    ds_read_b64_tr_b16 v[190:191], v226 offset:55808
    v_rcp_f32 v217, v217
    v_mul_f32 v216, v160, v216
    v_mul_f32 v217, v161, v217
    v_cvt_pk_bf16_f32 v208, v216, v217
    s_add_u32 m0, s45, 32768
    s_mov_b32 s49, 4719104
    buffer_load_dwordx4 v224, s[28:31], s49 offen lds
    s_waitcnt vmcnt(5)
    s_barrier
    s_waitcnt lgkmcnt(6)
    v_mfma_f32_32x32x16_bf16 v[144:159], v[176:179], v[32:35], v[144:159]
    ds_read_b64_tr_b16 v[192:193], v226 offset:57344
    ds_read_b64_tr_b16 v[194:195], v226 offset:57856
    v_mul_f32 v216, v162, v231
    v_mul_f32 v217, v163, v231
    v_exp_f32_e64 v216, -v216
    s_waitcnt lgkmcnt(6)
    v_mfma_f32_32x32x16_bf16 v[144:159], v[180:183], v[36:39], v[144:159]
    ds_read_b64_tr_b16 v[196:197], v226 offset:59392
    ds_read_b64_tr_b16 v[198:199], v226 offset:59904
    v_exp_f32_e64 v217, -v217
    v_fma_f32 v216, v216, v232, v232
    s_waitcnt lgkmcnt(6)
    v_mfma_f32_32x32x16_bf16 v[144:159], v[184:187], v[40:43], v[144:159]
    ds_read_b64_tr_b16 v[200:201], v226 offset:61440
    ds_read_b64_tr_b16 v[202:203], v226 offset:61952
    v_fma_f32 v217, v217, v232, v232
    v_rcp_f32 v216, v216
    s_waitcnt lgkmcnt(6)
    v_mfma_f32_32x32x16_bf16 v[144:159], v[188:191], v[44:47], v[144:159]
    ds_read_b64_tr_b16 v[204:205], v226 offset:63488
    ds_read_b64_tr_b16 v[206:207], v226 offset:64000
    v_rcp_f32 v217, v217
    v_mul_f32 v216, v162, v216
    v_mul_f32 v217, v163, v217
    v_cvt_pk_bf16_f32 v209, v216, v217
    s_add_u32 m0, s45, 40960
    s_mov_b32 s49, 640
    buffer_load_dwordx4 v224, s[28:31], s49 offen lds
    s_waitcnt vmcnt(5)
    s_barrier
    s_waitcnt lgkmcnt(6)
    v_mfma_f32_32x32x16_bf16 v[144:159], v[192:195], v[48:51], v[144:159]
    ds_read_b64_tr_b16 v[176:177], v226 offset:0
    ds_read_b64_tr_b16 v[178:179], v226 offset:512
    v_mul_f32 v216, v164, v231
    v_mul_f32 v217, v165, v231
    v_exp_f32_e64 v216, -v216
    s_waitcnt lgkmcnt(6)
    v_mfma_f32_32x32x16_bf16 v[144:159], v[196:199], v[52:55], v[144:159]
    ds_read_b64_tr_b16 v[180:181], v226 offset:2048
    ds_read_b64_tr_b16 v[182:183], v226 offset:2560
    v_exp_f32_e64 v217, -v217
    v_fma_f32 v216, v216, v232, v232
    s_waitcnt lgkmcnt(6)
    v_mfma_f32_32x32x16_bf16 v[144:159], v[200:203], v[56:59], v[144:159]
    ds_read_b64_tr_b16 v[184:185], v226 offset:4096
    ds_read_b64_tr_b16 v[186:187], v226 offset:4608
    v_fma_f32 v217, v217, v232, v232
    v_rcp_f32 v216, v216
    s_waitcnt lgkmcnt(6)
    v_mfma_f32_32x32x16_bf16 v[144:159], v[204:207], v[60:63], v[144:159]
    ds_read_b64_tr_b16 v[188:189], v226 offset:6144
    ds_read_b64_tr_b16 v[190:191], v226 offset:6656
    v_rcp_f32 v217, v217
    v_mul_f32 v216, v164, v216
    v_mul_f32 v217, v165, v217
    v_cvt_pk_bf16_f32 v210, v216, v217
    s_add_u32 m0, s45, 49152
    s_mov_b32 s49, 590464
    buffer_load_dwordx4 v224, s[28:31], s49 offen lds
    s_waitcnt vmcnt(5)
    s_barrier
    s_waitcnt lgkmcnt(6)
    v_mfma_f32_32x32x16_bf16 v[144:159], v[176:179], v[64:67], v[144:159]
    ds_read_b64_tr_b16 v[192:193], v226 offset:8192
    ds_read_b64_tr_b16 v[194:195], v226 offset:8704
    v_mul_f32 v216, v166, v231
    v_mul_f32 v217, v167, v231
    v_exp_f32_e64 v216, -v216
    s_waitcnt lgkmcnt(6)
    v_mfma_f32_32x32x16_bf16 v[144:159], v[180:183], v[68:71], v[144:159]
    ds_read_b64_tr_b16 v[196:197], v226 offset:10240
    ds_read_b64_tr_b16 v[198:199], v226 offset:10752
    v_exp_f32_e64 v217, -v217
    v_fma_f32 v216, v216, v232, v232
    s_waitcnt lgkmcnt(6)
    v_mfma_f32_32x32x16_bf16 v[144:159], v[184:187], v[72:75], v[144:159]
    ds_read_b64_tr_b16 v[200:201], v226 offset:12288
    ds_read_b64_tr_b16 v[202:203], v226 offset:12800
    v_fma_f32 v217, v217, v232, v232
    v_rcp_f32 v216, v216
    s_waitcnt lgkmcnt(6)
    v_mfma_f32_32x32x16_bf16 v[144:159], v[188:191], v[76:79], v[144:159]
    ds_read_b64_tr_b16 v[204:205], v226 offset:14336
    ds_read_b64_tr_b16 v[206:207], v226 offset:14848
    v_rcp_f32 v217, v217
    v_mul_f32 v216, v166, v216
    v_mul_f32 v217, v167, v217
    v_cvt_pk_bf16_f32 v211, v216, v217
    ds_write_b128 v228, v[208:211] offset:12288
    s_add_u32 m0, s45, 57344
    s_mov_b32 s49, 1180288
    buffer_load_dwordx4 v224, s[28:31], s49 offen lds
    s_waitcnt vmcnt(5) lgkmcnt(0)
    s_barrier
    v_mfma_f32_32x32x16_bf16 v[144:159], v[192:195], v[80:83], v[144:159]
    ds_read_b64_tr_b16 v[176:177], v226 offset:16384
    ds_read_b64_tr_b16 v[178:179], v226 offset:16896
    v_mul_f32 v216, v168, v231
    v_mul_f32 v217, v169, v231
    v_exp_f32_e64 v216, -v216
    v_mfma_f32_32x32x16_bf16 v[144:159], v[196:199], v[84:87], v[144:159]
    ds_read_b64_tr_b16 v[180:181], v226 offset:18432
    ds_read_b64_tr_b16 v[182:183], v226 offset:18944
    v_exp_f32_e64 v217, -v217
    v_fma_f32 v216, v216, v232, v232
    v_mfma_f32_32x32x16_bf16 v[144:159], v[200:203], v[88:91], v[144:159]
    ds_read_b64_tr_b16 v[184:185], v226 offset:20480
    ds_read_b64_tr_b16 v[186:187], v226 offset:20992
    v_fma_f32 v217, v217, v232, v232
    v_rcp_f32 v216, v216
    v_mfma_f32_32x32x16_bf16 v[144:159], v[204:207], v[92:95], v[144:159]
    ds_read_b64_tr_b16 v[188:189], v226 offset:22528
    ds_read_b64_tr_b16 v[190:191], v226 offset:23040
    v_rcp_f32 v217, v217
    v_mul_f32 v216, v168, v216
    v_mul_f32 v217, v169, v217
    v_cvt_pk_bf16_f32 v212, v216, v217
    s_add_u32 m0, s45, 0
    s_mov_b32 s49, 1770112
    buffer_load_dwordx4 v224, s[28:31], s49 offen lds
    s_waitcnt vmcnt(5)
    s_barrier
    s_waitcnt lgkmcnt(6)
    v_mfma_f32_32x32x16_bf16 v[144:159], v[176:179], v[96:99], v[144:159]
    ds_read_b64_tr_b16 v[192:193], v226 offset:24576
    ds_read_b64_tr_b16 v[194:195], v226 offset:25088
    v_mul_f32 v216, v170, v231
    v_mul_f32 v217, v171, v231
    v_exp_f32_e64 v216, -v216
    s_waitcnt lgkmcnt(6)
    v_mfma_f32_32x32x16_bf16 v[144:159], v[180:183], v[100:103], v[144:159]
    ds_read_b64_tr_b16 v[196:197], v226 offset:26624
    ds_read_b64_tr_b16 v[198:199], v226 offset:27136
    v_exp_f32_e64 v217, -v217
    v_fma_f32 v216, v216, v232, v232
    s_waitcnt lgkmcnt(6)
    v_mfma_f32_32x32x16_bf16 v[144:159], v[184:187], v[104:107], v[144:159]
    ds_read_b64_tr_b16 v[200:201], v226 offset:28672
    ds_read_b64_tr_b16 v[202:203], v226 offset:29184
    v_fma_f32 v217, v217, v232, v232
    v_rcp_f32 v216, v216
    s_waitcnt lgkmcnt(6)
    v_mfma_f32_32x32x16_bf16 v[144:159], v[188:191], v[108:111], v[144:159]
    ds_read_b64_tr_b16 v[204:205], v226 offset:30720
    ds_read_b64_tr_b16 v[206:207], v226 offset:31232
    v_rcp_f32 v217, v217
    v_mul_f32 v216, v170, v216
    v_mul_f32 v217, v171, v217
    v_cvt_pk_bf16_f32 v213, v216, v217
    s_add_u32 m0, s45, 8192
    s_mov_b32 s49, 2359936
    buffer_load_dwordx4 v224, s[28:31], s49 offen lds
    s_waitcnt vmcnt(5)
    s_barrier
    s_waitcnt lgkmcnt(6)
    v_mfma_f32_32x32x16_bf16 v[144:159], v[192:195], v[112:115], v[144:159]
    ds_read_b64_tr_b16 v[176:177], v226 offset:32768
    ds_read_b64_tr_b16 v[178:179], v226 offset:33280
    v_mul_f32 v216, v172, v231
    v_mul_f32 v217, v173, v231
    v_exp_f32_e64 v216, -v216
    s_waitcnt lgkmcnt(6)
    v_mfma_f32_32x32x16_bf16 v[144:159], v[196:199], v[116:119], v[144:159]
    ds_read_b64_tr_b16 v[180:181], v226 offset:34816
    ds_read_b64_tr_b16 v[182:183], v226 offset:35328
    v_exp_f32_e64 v217, -v217
    v_fma_f32 v216, v216, v232, v232
    s_waitcnt lgkmcnt(6)
    v_mfma_f32_32x32x16_bf16 v[144:159], v[200:203], v[120:123], v[144:159]
    ds_read_b64_tr_b16 v[184:185], v226 offset:36864
    ds_read_b64_tr_b16 v[186:187], v226 offset:37376
    v_fma_f32 v217, v217, v232, v232
    v_rcp_f32 v216, v216
    s_waitcnt lgkmcnt(6)
    v_mfma_f32_32x32x16_bf16 v[144:159], v[204:207], v[124:127], v[144:159]
    ds_read_b64_tr_b16 v[188:189], v226 offset:38912
    ds_read_b64_tr_b16 v[190:191], v226 offset:39424
    v_rcp_f32 v217, v217
    v_mul_f32 v216, v172, v216
    v_mul_f32 v217, v173, v217
    v_cvt_pk_bf16_f32 v214, v216, v217
    s_add_u32 m0, s45, 16384
    s_mov_b32 s49, 2949760
    buffer_load_dwordx4 v224, s[28:31], s49 offen lds
    s_waitcnt vmcnt(5)
    s_barrier
    s_waitcnt lgkmcnt(6)
    v_mfma_f32_32x32x16_bf16 v[144:159], v[176:179], v[128:131], v[144:159]
    ds_read_b64_tr_b16 v[192:193], v226 offset:40960
    ds_read_b64_tr_b16 v[194:195], v226 offset:41472
    v_mul_f32 v216, v174, v231
    v_mul_f32 v217, v175, v231
    v_exp_f32_e64 v216, -v216
    s_waitcnt lgkmcnt(6)
    v_mfma_f32_32x32x16_bf16 v[144:159], v[180:183], v[132:135], v[144:159]
    ds_read_b64_tr_b16 v[196:197], v226 offset:43008
    ds_read_b64_tr_b16 v[198:199], v226 offset:43520
    v_exp_f32_e64 v217, -v217
    v_fma_f32 v216, v216, v232, v232
    s_waitcnt lgkmcnt(6)
    v_mfma_f32_32x32x16_bf16 v[144:159], v[184:187], v[136:139], v[144:159]
    ds_read_b64_tr_b16 v[200:201], v226 offset:45056
    ds_read_b64_tr_b16 v[202:203], v226 offset:45568
    v_fma_f32 v217, v217, v232, v232
    v_rcp_f32 v216, v216
    s_waitcnt lgkmcnt(6)
    v_mfma_f32_32x32x16_bf16 v[144:159], v[188:191], v[140:143], v[144:159]
    ds_read_b64_tr_b16 v[204:205], v226 offset:47104
    ds_read_b64_tr_b16 v[206:207], v226 offset:47616
    v_rcp_f32 v217, v217
    v_mul_f32 v216, v174, v216
    v_mul_f32 v217, v175, v217
    v_cvt_pk_bf16_f32 v215, v216, v217
    ds_write_b128 v228, v[212:215] offset:13312
    s_add_u32 m0, s45, 24576
    s_mov_b32 s49, 3539584
    buffer_load_dwordx4 v224, s[28:31], s49 offen lds
    s_waitcnt vmcnt(5) lgkmcnt(0)
    s_barrier
    v_mfma_f32_32x32x16_bf16 v[160:175], v[192:195], v[0:3], 0
    ds_read_b64_tr_b16 v[176:177], v226 offset:49152
    ds_read_b64_tr_b16 v[178:179], v226 offset:49664
    v_mfma_f32_32x32x16_bf16 v[160:175], v[196:199], v[4:7], v[160:175]
    ds_read_b64_tr_b16 v[180:181], v226 offset:51200
    ds_read_b64_tr_b16 v[182:183], v226 offset:51712
    v_mfma_f32_32x32x16_bf16 v[160:175], v[200:203], v[8:11], v[160:175]
    ds_read_b64_tr_b16 v[184:185], v226 offset:53248
    ds_read_b64_tr_b16 v[186:187], v226 offset:53760
    v_mfma_f32_32x32x16_bf16 v[160:175], v[204:207], v[12:15], v[160:175]
    ds_read_b64_tr_b16 v[188:189], v226 offset:55296
    ds_read_b64_tr_b16 v[190:191], v226 offset:55808
    s_add_u32 m0, s45, 32768
    s_mov_b32 s49, 4129408
    buffer_load_dwordx4 v224, s[28:31], s49 offen lds
    s_waitcnt vmcnt(5)
    s_barrier
    s_waitcnt lgkmcnt(6)
    v_mfma_f32_32x32x16_bf16 v[160:175], v[176:179], v[16:19], v[160:175]
    ds_read_b64_tr_b16 v[192:193], v226 offset:57344
    ds_read_b64_tr_b16 v[194:195], v226 offset:57856
    v_mul_f32 v216, v144, v231
    v_mul_f32 v217, v145, v231
    v_exp_f32_e64 v216, -v216
    ds_read_b128 v[0:3], v229 offset:0
    s_waitcnt lgkmcnt(7)
    v_mfma_f32_32x32x16_bf16 v[160:175], v[180:183], v[20:23], v[160:175]
    ds_read_b64_tr_b16 v[196:197], v226 offset:59392
    ds_read_b64_tr_b16 v[198:199], v226 offset:59904
    v_exp_f32_e64 v217, -v217
    v_fma_f32 v216, v216, v232, v232
    ds_read_b128 v[4:7], v229 offset:1024
    s_waitcnt lgkmcnt(8)
    v_mfma_f32_32x32x16_bf16 v[160:175], v[184:187], v[24:27], v[160:175]
    ds_read_b64_tr_b16 v[200:201], v226 offset:61440
    ds_read_b64_tr_b16 v[202:203], v226 offset:61952
    v_fma_f32 v217, v217, v232, v232
    v_rcp_f32 v216, v216
    ds_read_b128 v[8:11], v229 offset:2048
    s_waitcnt lgkmcnt(9)
    v_mfma_f32_32x32x16_bf16 v[160:175], v[188:191], v[28:31], v[160:175]
    ds_read_b64_tr_b16 v[204:205], v226 offset:63488
    ds_read_b64_tr_b16 v[206:207], v226 offset:64000
    v_rcp_f32 v217, v217
    ds_read_b128 v[12:15], v229 offset:3072
    v_mul_f32 v216, v144, v216
    v_mul_f32 v217, v145, v217
    v_cvt_pk_bf16_f32 v208, v216, v217
    s_add_u32 m0, s45, 40960
    s_mov_b32 s49, 4719232
    buffer_load_dwordx4 v224, s[28:31], s49 offen lds
    s_waitcnt vmcnt(5)
    s_barrier
    s_waitcnt lgkmcnt(10)
    v_mfma_f32_32x32x16_bf16 v[160:175], v[192:195], v[32:35], v[160:175]
    ds_read_b64_tr_b16 v[176:177], v226 offset:0
    ds_read_b64_tr_b16 v[178:179], v226 offset:512
    v_mul_f32 v216, v146, v231
    v_mul_f32 v217, v147, v231
    v_exp_f32_e64 v216, -v216
    ds_read_b128 v[16:19], v229 offset:4096
    s_waitcnt lgkmcnt(10)
    v_mfma_f32_32x32x16_bf16 v[160:175], v[196:199], v[36:39], v[160:175]
    ds_read_b64_tr_b16 v[180:181], v226 offset:2048
    ds_read_b64_tr_b16 v[182:183], v226 offset:2560
    v_exp_f32_e64 v217, -v217
    v_fma_f32 v216, v216, v232, v232
    ds_read_b128 v[20:23], v229 offset:5120
    s_waitcnt lgkmcnt(10)
    v_mfma_f32_32x32x16_bf16 v[160:175], v[200:203], v[40:43], v[160:175]
    ds_read_b64_tr_b16 v[184:185], v226 offset:4096
    ds_read_b64_tr_b16 v[186:187], v226 offset:4608
    v_fma_f32 v217, v217, v232, v232
    v_rcp_f32 v216, v216
    ds_read_b128 v[24:27], v229 offset:6144
    s_waitcnt lgkmcnt(10)
    v_mfma_f32_32x32x16_bf16 v[160:175], v[204:207], v[44:47], v[160:175]
    ds_read_b64_tr_b16 v[188:189], v226 offset:6144
    ds_read_b64_tr_b16 v[190:191], v226 offset:6656
    v_rcp_f32 v217, v217
    ds_read_b128 v[28:31], v229 offset:7168
    v_mul_f32 v216, v146, v216
    v_mul_f32 v217, v147, v217
    v_cvt_pk_bf16_f32 v209, v216, v217
    s_add_u32 m0, s45, 49152
    s_mov_b32 s49, 0
    buffer_load_dwordx4 v225, s[32:35], s49 offen lds
    s_waitcnt vmcnt(5)
    s_barrier
    s_waitcnt lgkmcnt(10)
    v_mfma_f32_32x32x16_bf16 v[160:175], v[176:179], v[48:51], v[160:175]
    ds_read_b64_tr_b16 v[192:193], v226 offset:8192
    ds_read_b64_tr_b16 v[194:195], v226 offset:8704
    v_mul_f32 v216, v148, v231
    v_mul_f32 v217, v149, v231
    v_exp_f32_e64 v216, -v216
    ds_read_b128 v[32:35], v229 offset:8192
    s_waitcnt lgkmcnt(10)
    v_mfma_f32_32x32x16_bf16 v[160:175], v[180:183], v[52:55], v[160:175]
    ds_read_b64_tr_b16 v[196:197], v226 offset:10240
    ds_read_b64_tr_b16 v[198:199], v226 offset:10752
    v_exp_f32_e64 v217, -v217
    v_fma_f32 v216, v216, v232, v232
    ds_read_b128 v[36:39], v229 offset:9216
    s_waitcnt lgkmcnt(10)
    v_mfma_f32_32x32x16_bf16 v[160:175], v[184:187], v[56:59], v[160:175]
    ds_read_b64_tr_b16 v[200:201], v226 offset:12288
    ds_read_b64_tr_b16 v[202:203], v226 offset:12800
    v_fma_f32 v217, v217, v232, v232
    v_rcp_f32 v216, v216
    ds_read_b128 v[40:43], v229 offset:10240
    s_waitcnt lgkmcnt(10)
    v_mfma_f32_32x32x16_bf16 v[160:175], v[188:191], v[60:63], v[160:175]
    ds_read_b64_tr_b16 v[204:205], v226 offset:14336
    ds_read_b64_tr_b16 v[206:207], v226 offset:14848
    v_rcp_f32 v217, v217
    ds_read_b128 v[44:47], v229 offset:11264
    v_mul_f32 v216, v148, v216
    v_mul_f32 v217, v149, v217
    v_cvt_pk_bf16_f32 v210, v216, v217
    s_add_u32 m0, s45, 57344
    s_mov_b32 s49, 73728
    buffer_load_dwordx4 v225, s[32:35], s49 offen lds
    s_waitcnt vmcnt(5)
    s_barrier
    s_waitcnt lgkmcnt(10)
    v_mfma_f32_32x32x16_bf16 v[160:175], v[192:195], v[64:67], v[160:175]
    ds_read_b64_tr_b16 v[176:177], v226 offset:16384
    ds_read_b64_tr_b16 v[178:179], v226 offset:16896
    v_mul_f32 v216, v150, v231
    v_mul_f32 v217, v151, v231
    v_exp_f32_e64 v216, -v216
    ds_read_b128 v[48:51], v229 offset:12288
    s_waitcnt lgkmcnt(10)
    v_mfma_f32_32x32x16_bf16 v[160:175], v[196:199], v[68:71], v[160:175]
    ds_read_b64_tr_b16 v[180:181], v226 offset:18432
    ds_read_b64_tr_b16 v[182:183], v226 offset:18944
    v_exp_f32_e64 v217, -v217
    v_fma_f32 v216, v216, v232, v232
    ds_read_b128 v[52:55], v229 offset:13312
    s_waitcnt lgkmcnt(10)
    v_mfma_f32_32x32x16_bf16 v[160:175], v[200:203], v[72:75], v[160:175]
    ds_read_b64_tr_b16 v[184:185], v226 offset:20480
    ds_read_b64_tr_b16 v[186:187], v226 offset:20992
    v_fma_f32 v217, v217, v232, v232
    v_rcp_f32 v216, v216
    ds_read_b128 v[56:59], v229 offset:14336
    s_waitcnt lgkmcnt(10)
    v_mfma_f32_32x32x16_bf16 v[160:175], v[204:207], v[76:79], v[160:175]
    ds_read_b64_tr_b16 v[188:189], v226 offset:22528
    ds_read_b64_tr_b16 v[190:191], v226 offset:23040
    v_rcp_f32 v217, v217
    ds_read_b128 v[60:63], v229 offset:15360
    v_mul_f32 v216, v150, v216
    v_mul_f32 v217, v151, v217
    v_cvt_pk_bf16_f32 v211, v216, v217
    ds_write_b128 v228, v[208:211] offset:16384
    s_add_u32 m0, s45, 0
    s_mov_b32 s49, 147456
    buffer_load_dwordx4 v225, s[32:35], s49 offen lds
    s_waitcnt vmcnt(5) lgkmcnt(0)
    s_barrier
    v_mfma_f32_32x32x16_bf16 v[160:175], v[176:179], v[80:83], v[160:175]
    ds_read_b64_tr_b16 v[192:193], v226 offset:24576
    ds_read_b64_tr_b16 v[194:195], v226 offset:25088
    v_mul_f32 v216, v152, v231
    v_mul_f32 v217, v153, v231
    v_exp_f32_e64 v216, -v216
    v_mfma_f32_32x32x16_bf16 v[160:175], v[180:183], v[84:87], v[160:175]
    ds_read_b64_tr_b16 v[196:197], v226 offset:26624
    ds_read_b64_tr_b16 v[198:199], v226 offset:27136
    v_exp_f32_e64 v217, -v217
    v_fma_f32 v216, v216, v232, v232
    v_mfma_f32_32x32x16_bf16 v[160:175], v[184:187], v[88:91], v[160:175]
    ds_read_b64_tr_b16 v[200:201], v226 offset:28672
    ds_read_b64_tr_b16 v[202:203], v226 offset:29184
    v_fma_f32 v217, v217, v232, v232
    v_rcp_f32 v216, v216
    v_mfma_f32_32x32x16_bf16 v[160:175], v[188:191], v[92:95], v[160:175]
    ds_read_b64_tr_b16 v[204:205], v226 offset:30720
    ds_read_b64_tr_b16 v[206:207], v226 offset:31232
    v_rcp_f32 v217, v217
    v_mul_f32 v216, v152, v216
    v_mul_f32 v217, v153, v217
    v_cvt_pk_bf16_f32 v212, v216, v217
    s_add_u32 m0, s45, 8192
    s_mov_b32 s49, 221184
    buffer_load_dwordx4 v225, s[32:35], s49 offen lds
    s_waitcnt vmcnt(5)
    s_barrier
    s_waitcnt lgkmcnt(6)
    v_mfma_f32_32x32x16_bf16 v[160:175], v[192:195], v[96:99], v[160:175]
    ds_read_b64_tr_b16 v[176:177], v226 offset:32768
    ds_read_b64_tr_b16 v[178:179], v226 offset:33280
    v_mul_f32 v216, v154, v231
    v_mul_f32 v217, v155, v231
    v_exp_f32_e64 v216, -v216
    s_waitcnt lgkmcnt(6)
    v_mfma_f32_32x32x16_bf16 v[160:175], v[196:199], v[100:103], v[160:175]
    ds_read_b64_tr_b16 v[180:181], v226 offset:34816
    ds_read_b64_tr_b16 v[182:183], v226 offset:35328
    v_exp_f32_e64 v217, -v217
    v_fma_f32 v216, v216, v232, v232
    s_waitcnt lgkmcnt(6)
    v_mfma_f32_32x32x16_bf16 v[160:175], v[200:203], v[104:107], v[160:175]
    ds_read_b64_tr_b16 v[184:185], v226 offset:36864
    ds_read_b64_tr_b16 v[186:187], v226 offset:37376
    v_fma_f32 v217, v217, v232, v232
    v_rcp_f32 v216, v216
    s_waitcnt lgkmcnt(6)
    v_mfma_f32_32x32x16_bf16 v[160:175], v[204:207], v[108:111], v[160:175]
    ds_read_b64_tr_b16 v[188:189], v226 offset:38912
    ds_read_b64_tr_b16 v[190:191], v226 offset:39424
    v_rcp_f32 v217, v217
    v_mul_f32 v216, v154, v216
    v_mul_f32 v217, v155, v217
    v_cvt_pk_bf16_f32 v213, v216, v217
    s_add_u32 m0, s45, 16384
    s_mov_b32 s49, 294912
    buffer_load_dwordx4 v225, s[32:35], s49 offen lds
    s_waitcnt vmcnt(5)
    s_barrier
    s_waitcnt lgkmcnt(6)
    v_mfma_f32_32x32x16_bf16 v[160:175], v[176:179], v[112:115], v[160:175]
    ds_read_b64_tr_b16 v[192:193], v226 offset:40960
    ds_read_b64_tr_b16 v[194:195], v226 offset:41472
    v_mul_f32 v216, v156, v231
    v_mul_f32 v217, v157, v231
    v_exp_f32_e64 v216, -v216
    s_waitcnt lgkmcnt(6)
    v_mfma_f32_32x32x16_bf16 v[160:175], v[180:183], v[116:119], v[160:175]
    ds_read_b64_tr_b16 v[196:197], v226 offset:43008
    ds_read_b64_tr_b16 v[198:199], v226 offset:43520
    v_exp_f32_e64 v217, -v217
    v_fma_f32 v216, v216, v232, v232
    s_waitcnt lgkmcnt(6)
    v_mfma_f32_32x32x16_bf16 v[160:175], v[184:187], v[120:123], v[160:175]
    ds_read_b64_tr_b16 v[200:201], v226 offset:45056
    ds_read_b64_tr_b16 v[202:203], v226 offset:45568
    v_fma_f32 v217, v217, v232, v232
    v_rcp_f32 v216, v216
    s_waitcnt lgkmcnt(6)
    v_mfma_f32_32x32x16_bf16 v[160:175], v[188:191], v[124:127], v[160:175]
    ds_read_b64_tr_b16 v[204:205], v226 offset:47104
    ds_read_b64_tr_b16 v[206:207], v226 offset:47616
    v_rcp_f32 v217, v217
    v_mul_f32 v216, v156, v216
    v_mul_f32 v217, v157, v217
    v_cvt_pk_bf16_f32 v214, v216, v217
    s_add_u32 m0, s45, 24576
    s_mov_b32 s49, 368640
    buffer_load_dwordx4 v225, s[32:35], s49 offen lds
    s_waitcnt vmcnt(5)
    s_barrier
    s_waitcnt lgkmcnt(6)
    v_mfma_f32_32x32x16_bf16 v[160:175], v[192:195], v[128:131], v[160:175]
    ds_read_b64_tr_b16 v[176:177], v227 offset:49152
    ds_read_b64_tr_b16 v[178:179], v227 offset:50176
    v_mul_f32 v216, v158, v231
    v_mul_f32 v217, v159, v231
    v_exp_f32_e64 v216, -v216
    s_waitcnt lgkmcnt(6)
    v_mfma_f32_32x32x16_bf16 v[160:175], v[196:199], v[132:135], v[160:175]
    ds_read_b64_tr_b16 v[180:181], v227 offset:51200
    ds_read_b64_tr_b16 v[182:183], v227 offset:52224
    v_exp_f32_e64 v217, -v217
    v_fma_f32 v216, v216, v232, v232
    s_waitcnt lgkmcnt(6)
    v_mfma_f32_32x32x16_bf16 v[160:175], v[200:203], v[136:139], v[160:175]
    ds_read_b64_tr_b16 v[184:185], v227 offset:53248
    ds_read_b64_tr_b16 v[186:187], v227 offset:54272
    v_fma_f32 v217, v217, v232, v232
    v_rcp_f32 v216, v216
    s_waitcnt lgkmcnt(6)
    v_mfma_f32_32x32x16_bf16 v[160:175], v[204:207], v[140:143], v[160:175]
    ds_read_b64_tr_b16 v[188:189], v227 offset:55296
    ds_read_b64_tr_b16 v[190:191], v227 offset:56320
    v_rcp_f32 v217, v217
    v_mul_f32 v216, v158, v216
    v_mul_f32 v217, v159, v217
    v_cvt_pk_bf16_f32 v215, v216, v217
    ds_write_b128 v228, v[212:215] offset:17408
    s_add_u32 m0, s45, 32768
    s_mov_b32 s49, 128
    buffer_load_dwordx4 v225, s[32:35], s49 offen lds
    s_waitcnt vmcnt(5) lgkmcnt(0)
    s_barrier
    v_mfma_f32_32x32x16_bf16 v[144:159], v[176:179], v[0:3], 0
    ds_read_b64_tr_b16 v[192:193], v227 offset:57344
    ds_read_b64_tr_b16 v[194:195], v227 offset:58368
    s_nop 7
    s_nop 3
    v_mul_f32 v216, v160, v231
    v_mul_f32 v217, v161, v231
    v_exp_f32_e64 v216, -v216
    v_mul_f32 v218, v162, v231
    v_mul_f32 v219, v163, v231
    v_exp_f32_e64 v218, -v218
    v_mul_f32 v220, v164, v231
    v_mul_f32 v221, v165, v231
    v_exp_f32_e64 v220, -v220
    v_mul_f32 v222, v166, v231
    v_mul_f32 v223, v167, v231
    v_exp_f32_e64 v222, -v222
    v_mfma_f32_32x32x16_bf16 v[144:159], v[180:183], v[4:7], v[144:159]
    ds_read_b64_tr_b16 v[196:197], v227 offset:59392
    ds_read_b64_tr_b16 v[198:199], v227 offset:60416
    v_exp_f32_e64 v217, -v217
    v_fma_f32 v216, v216, v232, v232
    v_exp_f32_e64 v219, -v219
    v_fma_f32 v218, v218, v232, v232
    v_exp_f32_e64 v221, -v221
    v_fma_f32 v220, v220, v232, v232
    v_exp_f32_e64 v223, -v223
    v_fma_f32 v222, v222, v232, v232
    v_mfma_f32_32x32x16_bf16 v[144:159], v[184:187], v[8:11], v[144:159]
    ds_read_b64_tr_b16 v[200:201], v227 offset:61440
    ds_read_b64_tr_b16 v[202:203], v227 offset:62464
    v_fma_f32 v217, v217, v232, v232
    v_rcp_f32 v216, v216
    v_fma_f32 v219, v219, v232, v232
    v_rcp_f32 v218, v218
    v_fma_f32 v221, v221, v232, v232
    v_rcp_f32 v220, v220
    v_fma_f32 v223, v223, v232, v232
    v_rcp_f32 v222, v222
    v_mfma_f32_32x32x16_bf16 v[144:159], v[188:191], v[12:15], v[144:159]
    ds_read_b64_tr_b16 v[204:205], v227 offset:63488
    ds_read_b64_tr_b16 v[206:207], v227 offset:64512
    v_rcp_f32 v217, v217
    v_rcp_f32 v219, v219
    v_rcp_f32 v221, v221
    v_rcp_f32 v223, v223
    v_mul_f32 v216, v160, v216
    v_mul_f32 v217, v161, v217
    v_cvt_pk_bf16_f32 v208, v216, v217
    v_mul_f32 v218, v162, v218
    v_mul_f32 v219, v163, v219
    v_cvt_pk_bf16_f32 v209, v218, v219
    v_mul_f32 v220, v164, v220
    v_mul_f32 v221, v165, v221
    v_cvt_pk_bf16_f32 v210, v220, v221
    v_mul_f32 v222, v166, v222
    v_mul_f32 v223, v167, v223
    v_cvt_pk_bf16_f32 v211, v222, v223
    ds_write_b128 v228, v[208:211] offset:20480
    s_add_u32 m0, s45, 40960
    s_mov_b32 s49, 73856
    buffer_load_dwordx4 v225, s[32:35], s49 offen lds
    s_waitcnt vmcnt(5) lgkmcnt(0)
    s_barrier
    v_mfma_f32_32x32x16_bf16 v[144:159], v[192:195], v[16:19], v[144:159]
    ds_read_b64_tr_b16 v[176:177], v227 offset:0
    ds_read_b64_tr_b16 v[178:179], v227 offset:1024
    v_mul_f32 v216, v168, v231
    v_mul_f32 v217, v169, v231
    v_exp_f32_e64 v216, -v216
    v_mul_f32 v218, v170, v231
    v_mul_f32 v219, v171, v231
    v_exp_f32_e64 v218, -v218
    v_mul_f32 v220, v172, v231
    v_mul_f32 v221, v173, v231
    v_exp_f32_e64 v220, -v220
    v_mul_f32 v222, v174, v231
    v_mul_f32 v223, v175, v231
    v_exp_f32_e64 v222, -v222
    v_mfma_f32_32x32x16_bf16 v[144:159], v[196:199], v[20:23], v[144:159]
    ds_read_b64_tr_b16 v[180:181], v227 offset:2048
    ds_read_b64_tr_b16 v[182:183], v227 offset:3072
    v_exp_f32_e64 v217, -v217
    v_fma_f32 v216, v216, v232, v232
    v_exp_f32_e64 v219, -v219
    v_fma_f32 v218, v218, v232, v232
    v_exp_f32_e64 v221, -v221
    v_fma_f32 v220, v220, v232, v232
    v_exp_f32_e64 v223, -v223
    v_fma_f32 v222, v222, v232, v232
    v_mfma_f32_32x32x16_bf16 v[144:159], v[200:203], v[24:27], v[144:159]
    ds_read_b64_tr_b16 v[184:185], v227 offset:4096
    ds_read_b64_tr_b16 v[186:187], v227 offset:5120
    v_fma_f32 v217, v217, v232, v232
    v_rcp_f32 v216, v216
    v_fma_f32 v219, v219, v232, v232
    v_rcp_f32 v218, v218
    v_fma_f32 v221, v221, v232, v232
    v_rcp_f32 v220, v220
    v_fma_f32 v223, v223, v232, v232
    v_rcp_f32 v222, v222
    v_mfma_f32_32x32x16_bf16 v[144:159], v[204:207], v[28:31], v[144:159]
    ds_read_b64_tr_b16 v[188:189], v227 offset:6144
    ds_read_b64_tr_b16 v[190:191], v227 offset:7168
    v_rcp_f32 v217, v217
    v_rcp_f32 v219, v219
    v_rcp_f32 v221, v221
    v_rcp_f32 v223, v223
    v_mul_f32 v216, v168, v216
    v_mul_f32 v217, v169, v217
    v_cvt_pk_bf16_f32 v212, v216, v217
    v_mul_f32 v218, v170, v218
    v_mul_f32 v219, v171, v219
    v_cvt_pk_bf16_f32 v213, v218, v219
    v_mul_f32 v220, v172, v220
    v_mul_f32 v221, v173, v221
    v_cvt_pk_bf16_f32 v214, v220, v221
    v_mul_f32 v222, v174, v222
    v_mul_f32 v223, v175, v223
    v_cvt_pk_bf16_f32 v215, v222, v223
    ds_write_b128 v228, v[212:215] offset:21504
    s_add_u32 m0, s45, 49152
    s_mov_b32 s49, 147584
    buffer_load_dwordx4 v225, s[32:35], s49 offen lds
    s_waitcnt vmcnt(5) lgkmcnt(0)
    s_barrier
    v_mfma_f32_32x32x16_bf16 v[144:159], v[176:179], v[32:35], v[144:159]
    ds_read_b64_tr_b16 v[192:193], v227 offset:8192
    ds_read_b64_tr_b16 v[194:195], v227 offset:9216
    ds_read_b128 v[64:67], v229 offset:16384
    v_mfma_f32_32x32x16_bf16 v[144:159], v[180:183], v[36:39], v[144:159]
    ds_read_b64_tr_b16 v[196:197], v227 offset:10240
    ds_read_b64_tr_b16 v[198:199], v227 offset:11264
    ds_read_b128 v[68:71], v229 offset:17408
    v_mfma_f32_32x32x16_bf16 v[144:159], v[184:187], v[40:43], v[144:159]
    ds_read_b64_tr_b16 v[200:201], v227 offset:12288
    ds_read_b64_tr_b16 v[202:203], v227 offset:13312
    ds_read_b128 v[72:75], v229 offset:18432
    v_mfma_f32_32x32x16_bf16 v[144:159], v[188:191], v[44:47], v[144:159]
    ds_read_b64_tr_b16 v[204:205], v227 offset:14336
    ds_read_b64_tr_b16 v[206:207], v227 offset:15360
    ds_read_b128 v[76:79], v229 offset:19456
    s_add_u32 m0, s45, 57344
    s_mov_b32 s49, 221312
    buffer_load_dwordx4 v225, s[32:35], s49 offen lds
    s_waitcnt vmcnt(5)
    s_barrier
    s_waitcnt lgkmcnt(10)
    v_mfma_f32_32x32x16_bf16 v[144:159], v[192:195], v[48:51], v[144:159]
    ds_read_b64_tr_b16 v[176:177], v227 offset:16384
    ds_read_b64_tr_b16 v[178:179], v227 offset:17408
    s_waitcnt lgkmcnt(9)
    v_mfma_f32_32x32x16_bf16 v[144:159], v[196:199], v[52:55], v[144:159]
    ds_read_b64_tr_b16 v[180:181], v227 offset:18432
    ds_read_b64_tr_b16 v[182:183], v227 offset:19456
    s_waitcnt lgkmcnt(8)
    v_mfma_f32_32x32x16_bf16 v[144:159], v[200:203], v[56:59], v[144:159]
    ds_read_b64_tr_b16 v[184:185], v227 offset:20480
    ds_read_b64_tr_b16 v[186:187], v227 offset:21504
    s_waitcnt lgkmcnt(7)
    v_mfma_f32_32x32x16_bf16 v[144:159], v[204:207], v[60:63], v[144:159]
    ds_read_b64_tr_b16 v[188:189], v227 offset:22528
    ds_read_b64_tr_b16 v[190:191], v227 offset:23552
    s_add_u32 m0, s45, 0
    s_mov_b32 s49, 295040
    buffer_load_dwordx4 v225, s[32:35], s49 offen lds
    s_waitcnt vmcnt(5)
    s_barrier
    s_waitcnt lgkmcnt(6)
    v_mfma_f32_32x32x16_bf16 v[144:159], v[176:179], v[64:67], v[144:159]
    ds_read_b64_tr_b16 v[192:193], v227 offset:24576
    ds_read_b64_tr_b16 v[194:195], v227 offset:25600
    ds_read_b128 v[80:83], v229 offset:20480
    s_waitcnt lgkmcnt(7)
    v_mfma_f32_32x32x16_bf16 v[144:159], v[180:183], v[68:71], v[144:159]
    ds_read_b64_tr_b16 v[196:197], v227 offset:26624
    ds_read_b64_tr_b16 v[198:199], v227 offset:27648
    ds_read_b128 v[84:87], v229 offset:21504
    s_waitcnt lgkmcnt(8)
    v_mfma_f32_32x32x16_bf16 v[144:159], v[184:187], v[72:75], v[144:159]
    ds_read_b64_tr_b16 v[200:201], v227 offset:28672
    ds_read_b64_tr_b16 v[202:203], v227 offset:29696
    ds_read_b128 v[88:91], v229 offset:22528
    s_waitcnt lgkmcnt(9)
    v_mfma_f32_32x32x16_bf16 v[144:159], v[188:191], v[76:79], v[144:159]
    ds_read_b64_tr_b16 v[204:205], v227 offset:30720
    ds_read_b64_tr_b16 v[206:207], v227 offset:31744
    ds_read_b128 v[92:95], v229 offset:23552
    s_add_u32 m0, s45, 8192
    s_mov_b32 s49, 368768
    buffer_load_dwordx4 v225, s[32:35], s49 offen lds
    s_waitcnt vmcnt(5)
    s_barrier
    s_waitcnt lgkmcnt(9)
    v_mfma_f32_32x32x16_bf16 v[144:159], v[192:195], v[80:83], v[144:159]
    ds_read_b64_tr_b16 v[176:177], v227 offset:32768
    ds_read_b64_tr_b16 v[178:179], v227 offset:33792
    s_waitcnt lgkmcnt(8)
    v_mfma_f32_32x32x16_bf16 v[144:159], v[196:199], v[84:87], v[144:159]
    ds_read_b64_tr_b16 v[180:181], v227 offset:34816
    ds_read_b64_tr_b16 v[182:183], v227 offset:35840
    s_waitcnt lgkmcnt(7)
    v_mfma_f32_32x32x16_bf16 v[144:159], v[200:203], v[88:91], v[144:159]
    ds_read_b64_tr_b16 v[184:185], v227 offset:36864
    ds_read_b64_tr_b16 v[186:187], v227 offset:37888
    s_waitcnt lgkmcnt(6)
    v_mfma_f32_32x32x16_bf16 v[144:159], v[204:207], v[92:95], v[144:159]
    ds_read_b64_tr_b16 v[188:189], v227 offset:38912
    ds_read_b64_tr_b16 v[190:191], v227 offset:39936
    s_add_u32 m0, s45, 16384
    s_mov_b32 s49, 256
    buffer_load_dwordx4 v225, s[32:35], s49 offen lds
    s_waitcnt vmcnt(5)
    s_barrier
    s_waitcnt lgkmcnt(6)
    v_mfma_f32_32x32x16_bf16 v[160:175], v[176:179], v[0:3], 0
    ds_read_b64_tr_b16 v[192:193], v227 offset:40960
    ds_read_b64_tr_b16 v[194:195], v227 offset:41984
    s_waitcnt lgkmcnt(6)
    v_mfma_f32_32x32x16_bf16 v[160:175], v[180:183], v[4:7], v[160:175]
    ds_read_b64_tr_b16 v[196:197], v227 offset:43008
    ds_read_b64_tr_b16 v[198:199], v227 offset:44032
    s_waitcnt lgkmcnt(6)
    v_mfma_f32_32x32x16_bf16 v[160:175], v[184:187], v[8:11], v[160:175]
    ds_read_b64_tr_b16 v[200:201], v227 offset:45056
    ds_read_b64_tr_b16 v[202:203], v227 offset:46080
    s_waitcnt lgkmcnt(6)
    v_mfma_f32_32x32x16_bf16 v[160:175], v[188:191], v[12:15], v[160:175]
    ds_read_b64_tr_b16 v[204:205], v227 offset:47104
    ds_read_b64_tr_b16 v[206:207], v227 offset:48128
    s_add_u32 m0, s45, 24576
    s_mov_b32 s49, 73984
    buffer_load_dwordx4 v225, s[32:35], s49 offen lds
    s_waitcnt vmcnt(5)
    s_barrier
    s_waitcnt lgkmcnt(6)
    v_mfma_f32_32x32x16_bf16 v[160:175], v[192:195], v[16:19], v[160:175]
    ds_read_b64_tr_b16 v[176:177], v227 offset:49152
    ds_read_b64_tr_b16 v[178:179], v227 offset:50176
    s_waitcnt lgkmcnt(6)
    v_mfma_f32_32x32x16_bf16 v[160:175], v[196:199], v[20:23], v[160:175]
    ds_read_b64_tr_b16 v[180:181], v227 offset:51200
    ds_read_b64_tr_b16 v[182:183], v227 offset:52224
    s_waitcnt lgkmcnt(6)
    v_mfma_f32_32x32x16_bf16 v[160:175], v[200:203], v[24:27], v[160:175]
    ds_read_b64_tr_b16 v[184:185], v227 offset:53248
    ds_read_b64_tr_b16 v[186:187], v227 offset:54272
    s_waitcnt lgkmcnt(6)
    v_mfma_f32_32x32x16_bf16 v[160:175], v[204:207], v[28:31], v[160:175]
    ds_read_b64_tr_b16 v[188:189], v227 offset:55296
    ds_read_b64_tr_b16 v[190:191], v227 offset:56320
    s_add_u32 m0, s45, 32768
    s_mov_b32 s49, 147712
    buffer_load_dwordx4 v225, s[32:35], s49 offen lds
    v_cvt_pk_bf16_f32 v208, v144, v145
    v_cvt_pk_bf16_f32 v209, v146, v147
    v_cvt_pk_bf16_f32 v210, v148, v149
    v_cvt_pk_bf16_f32 v211, v150, v151
    s_mov_b32 s48, 0
    buffer_store_dwordx4 v[208:211], v230, s[36:39], s48 offen offset:0 sc0 sc1
    s_waitcnt vmcnt(6)
    s_barrier
    s_waitcnt lgkmcnt(6)
    v_mfma_f32_32x32x16_bf16 v[160:175], v[176:179], v[32:35], v[160:175]
    ds_read_b64_tr_b16 v[192:193], v227 offset:57344
    ds_read_b64_tr_b16 v[194:195], v227 offset:58368
    s_waitcnt lgkmcnt(6)
    v_mfma_f32_32x32x16_bf16 v[160:175], v[180:183], v[36:39], v[160:175]
    ds_read_b64_tr_b16 v[196:197], v227 offset:59392
    ds_read_b64_tr_b16 v[198:199], v227 offset:60416
    s_waitcnt lgkmcnt(6)
    v_mfma_f32_32x32x16_bf16 v[160:175], v[184:187], v[40:43], v[160:175]
    ds_read_b64_tr_b16 v[200:201], v227 offset:61440
    ds_read_b64_tr_b16 v[202:203], v227 offset:62464
    s_waitcnt lgkmcnt(6)
    v_mfma_f32_32x32x16_bf16 v[160:175], v[188:191], v[44:47], v[160:175]
    ds_read_b64_tr_b16 v[204:205], v227 offset:63488
    ds_read_b64_tr_b16 v[206:207], v227 offset:64512
    s_add_u32 m0, s45, 40960
    s_mov_b32 s49, 221440
    buffer_load_dwordx4 v225, s[32:35], s49 offen lds
    s_waitcnt vmcnt(6)
    s_barrier
    s_waitcnt lgkmcnt(6)
    v_mfma_f32_32x32x16_bf16 v[160:175], v[192:195], v[48:51], v[160:175]
    ds_read_b64_tr_b16 v[176:177], v227 offset:0
    ds_read_b64_tr_b16 v[178:179], v227 offset:1024
    s_waitcnt lgkmcnt(6)
    v_mfma_f32_32x32x16_bf16 v[160:175], v[196:199], v[52:55], v[160:175]
    ds_read_b64_tr_b16 v[180:181], v227 offset:2048
    ds_read_b64_tr_b16 v[182:183], v227 offset:3072
    s_waitcnt lgkmcnt(6)
    v_mfma_f32_32x32x16_bf16 v[160:175], v[200:203], v[56:59], v[160:175]
    ds_read_b64_tr_b16 v[184:185], v227 offset:4096
    ds_read_b64_tr_b16 v[186:187], v227 offset:5120
    s_waitcnt lgkmcnt(6)
    v_mfma_f32_32x32x16_bf16 v[160:175], v[204:207], v[60:63], v[160:175]
    ds_read_b64_tr_b16 v[188:189], v227 offset:6144
    ds_read_b64_tr_b16 v[190:191], v227 offset:7168
    s_add_u32 m0, s45, 49152
    s_mov_b32 s49, 295168
    buffer_load_dwordx4 v225, s[32:35], s49 offen lds
    v_cvt_pk_bf16_f32 v212, v152, v153
    v_cvt_pk_bf16_f32 v213, v154, v155
    v_cvt_pk_bf16_f32 v214, v156, v157
    v_cvt_pk_bf16_f32 v215, v158, v159
    s_mov_b32 s48, 0
    buffer_store_dwordx4 v[212:215], v230, s[36:39], s48 offen offset:1024 sc0 sc1
    s_waitcnt vmcnt(7)
    s_barrier
    s_waitcnt lgkmcnt(6)
    v_mfma_f32_32x32x16_bf16 v[160:175], v[176:179], v[64:67], v[160:175]
    ds_read_b64_tr_b16 v[192:193], v227 offset:8192
    ds_read_b64_tr_b16 v[194:195], v227 offset:9216
    s_waitcnt lgkmcnt(6)
    v_mfma_f32_32x32x16_bf16 v[160:175], v[180:183], v[68:71], v[160:175]
    ds_read_b64_tr_b16 v[196:197], v227 offset:10240
    ds_read_b64_tr_b16 v[198:199], v227 offset:11264
    s_waitcnt lgkmcnt(6)
    v_mfma_f32_32x32x16_bf16 v[160:175], v[184:187], v[72:75], v[160:175]
    ds_read_b64_tr_b16 v[200:201], v227 offset:12288
    ds_read_b64_tr_b16 v[202:203], v227 offset:13312
    s_waitcnt lgkmcnt(6)
    v_mfma_f32_32x32x16_bf16 v[160:175], v[188:191], v[76:79], v[160:175]
    ds_read_b64_tr_b16 v[204:205], v227 offset:14336
    ds_read_b64_tr_b16 v[206:207], v227 offset:15360
    s_add_u32 m0, s45, 57344
    s_mov_b32 s49, 368896
    buffer_load_dwordx4 v225, s[32:35], s49 offen lds
    s_waitcnt vmcnt(7)
    s_barrier
    s_waitcnt lgkmcnt(6)
    v_mfma_f32_32x32x16_bf16 v[160:175], v[192:195], v[80:83], v[160:175]
    ds_read_b64_tr_b16 v[176:177], v227 offset:16384
    ds_read_b64_tr_b16 v[178:179], v227 offset:17408
    s_waitcnt lgkmcnt(6)
    v_mfma_f32_32x32x16_bf16 v[160:175], v[196:199], v[84:87], v[160:175]
    ds_read_b64_tr_b16 v[180:181], v227 offset:18432
    ds_read_b64_tr_b16 v[182:183], v227 offset:19456
    s_waitcnt lgkmcnt(6)
    v_mfma_f32_32x32x16_bf16 v[160:175], v[200:203], v[88:91], v[160:175]
    ds_read_b64_tr_b16 v[184:185], v227 offset:20480
    ds_read_b64_tr_b16 v[186:187], v227 offset:21504
    s_waitcnt lgkmcnt(6)
    v_mfma_f32_32x32x16_bf16 v[160:175], v[204:207], v[92:95], v[160:175]
    ds_read_b64_tr_b16 v[188:189], v227 offset:22528
    ds_read_b64_tr_b16 v[190:191], v227 offset:23552
    s_add_u32 m0, s45, 0
    s_mov_b32 s49, 384
    buffer_load_dwordx4 v225, s[32:35], s49 offen lds
    s_waitcnt vmcnt(7)
    s_barrier
    s_waitcnt lgkmcnt(6)
    v_mfma_f32_32x32x16_bf16 v[144:159], v[176:179], v[0:3], 0
    ds_read_b64_tr_b16 v[192:193], v227 offset:24576
    ds_read_b64_tr_b16 v[194:195], v227 offset:25600
    s_waitcnt lgkmcnt(6)
    v_mfma_f32_32x32x16_bf16 v[144:159], v[180:183], v[4:7], v[144:159]
    ds_read_b64_tr_b16 v[196:197], v227 offset:26624
    ds_read_b64_tr_b16 v[198:199], v227 offset:27648
    s_waitcnt lgkmcnt(6)
    v_mfma_f32_32x32x16_bf16 v[144:159], v[184:187], v[8:11], v[144:159]
    ds_read_b64_tr_b16 v[200:201], v227 offset:28672
    ds_read_b64_tr_b16 v[202:203], v227 offset:29696
    s_waitcnt lgkmcnt(6)
    v_mfma_f32_32x32x16_bf16 v[144:159], v[188:191], v[12:15], v[144:159]
    ds_read_b64_tr_b16 v[204:205], v227 offset:30720
    ds_read_b64_tr_b16 v[206:207], v227 offset:31744
    s_add_u32 m0, s45, 8192
    s_mov_b32 s49, 74112
    buffer_load_dwordx4 v225, s[32:35], s49 offen lds
    s_waitcnt vmcnt(7)
    s_barrier
    s_waitcnt lgkmcnt(6)
    v_mfma_f32_32x32x16_bf16 v[144:159], v[192:195], v[16:19], v[144:159]
    ds_read_b64_tr_b16 v[176:177], v227 offset:32768
    ds_read_b64_tr_b16 v[178:179], v227 offset:33792
    s_waitcnt lgkmcnt(6)
    v_mfma_f32_32x32x16_bf16 v[144:159], v[196:199], v[20:23], v[144:159]
    ds_read_b64_tr_b16 v[180:181], v227 offset:34816
    ds_read_b64_tr_b16 v[182:183], v227 offset:35840
    s_waitcnt lgkmcnt(6)
    v_mfma_f32_32x32x16_bf16 v[144:159], v[200:203], v[24:27], v[144:159]
    ds_read_b64_tr_b16 v[184:185], v227 offset:36864
    ds_read_b64_tr_b16 v[186:187], v227 offset:37888
    s_waitcnt lgkmcnt(6)
    v_mfma_f32_32x32x16_bf16 v[144:159], v[204:207], v[28:31], v[144:159]
    ds_read_b64_tr_b16 v[188:189], v227 offset:38912
    ds_read_b64_tr_b16 v[190:191], v227 offset:39936
    s_add_u32 m0, s45, 16384
    s_mov_b32 s49, 147840
    buffer_load_dwordx4 v225, s[32:35], s49 offen lds
    v_cvt_pk_bf16_f32 v208, v160, v161
    v_cvt_pk_bf16_f32 v209, v162, v163
    v_cvt_pk_bf16_f32 v210, v164, v165
    v_cvt_pk_bf16_f32 v211, v166, v167
    s_mov_b32 s48, 4096
    buffer_store_dwordx4 v[208:211], v230, s[36:39], s48 offen offset:0 sc0 sc1
    s_waitcnt vmcnt(7)
    s_barrier
    s_waitcnt lgkmcnt(6)
    v_mfma_f32_32x32x16_bf16 v[144:159], v[176:179], v[32:35], v[144:159]
    ds_read_b64_tr_b16 v[192:193], v227 offset:40960
    ds_read_b64_tr_b16 v[194:195], v227 offset:41984
    s_waitcnt lgkmcnt(6)
    v_mfma_f32_32x32x16_bf16 v[144:159], v[180:183], v[36:39], v[144:159]
    ds_read_b64_tr_b16 v[196:197], v227 offset:43008
    ds_read_b64_tr_b16 v[198:199], v227 offset:44032
    s_waitcnt lgkmcnt(6)
    v_mfma_f32_32x32x16_bf16 v[144:159], v[184:187], v[40:43], v[144:159]
    ds_read_b64_tr_b16 v[200:201], v227 offset:45056
    ds_read_b64_tr_b16 v[202:203], v227 offset:46080
    s_waitcnt lgkmcnt(6)
    v_mfma_f32_32x32x16_bf16 v[144:159], v[188:191], v[44:47], v[144:159]
    ds_read_b64_tr_b16 v[204:205], v227 offset:47104
    ds_read_b64_tr_b16 v[206:207], v227 offset:48128
    s_add_u32 m0, s45, 24576
    s_mov_b32 s49, 221568
    buffer_load_dwordx4 v225, s[32:35], s49 offen lds
    s_waitcnt vmcnt(7)
    s_barrier
    s_waitcnt lgkmcnt(6)
    v_mfma_f32_32x32x16_bf16 v[144:159], v[192:195], v[48:51], v[144:159]
    ds_read_b64_tr_b16 v[176:177], v227 offset:49152
    ds_read_b64_tr_b16 v[178:179], v227 offset:50176
    s_waitcnt lgkmcnt(6)
    v_mfma_f32_32x32x16_bf16 v[144:159], v[196:199], v[52:55], v[144:159]
    ds_read_b64_tr_b16 v[180:181], v227 offset:51200
    ds_read_b64_tr_b16 v[182:183], v227 offset:52224
    s_waitcnt lgkmcnt(6)
    v_mfma_f32_32x32x16_bf16 v[144:159], v[200:203], v[56:59], v[144:159]
    ds_read_b64_tr_b16 v[184:185], v227 offset:53248
    ds_read_b64_tr_b16 v[186:187], v227 offset:54272
    s_waitcnt lgkmcnt(6)
    v_mfma_f32_32x32x16_bf16 v[144:159], v[204:207], v[60:63], v[144:159]
    ds_read_b64_tr_b16 v[188:189], v227 offset:55296
    ds_read_b64_tr_b16 v[190:191], v227 offset:56320
    s_add_u32 m0, s45, 32768
    s_mov_b32 s49, 295296
    buffer_load_dwordx4 v225, s[32:35], s49 offen lds
    v_cvt_pk_bf16_f32 v212, v168, v169
    v_cvt_pk_bf16_f32 v213, v170, v171
    v_cvt_pk_bf16_f32 v214, v172, v173
    v_cvt_pk_bf16_f32 v215, v174, v175
    s_mov_b32 s48, 4096
    buffer_store_dwordx4 v[212:215], v230, s[36:39], s48 offen offset:1024 sc0 sc1
    s_waitcnt vmcnt(7)
    s_barrier
    s_waitcnt lgkmcnt(6)
    v_mfma_f32_32x32x16_bf16 v[144:159], v[176:179], v[64:67], v[144:159]
    ds_read_b64_tr_b16 v[192:193], v227 offset:57344
    ds_read_b64_tr_b16 v[194:195], v227 offset:58368
    s_waitcnt lgkmcnt(6)
    v_mfma_f32_32x32x16_bf16 v[144:159], v[180:183], v[68:71], v[144:159]
    ds_read_b64_tr_b16 v[196:197], v227 offset:59392
    ds_read_b64_tr_b16 v[198:199], v227 offset:60416
    s_waitcnt lgkmcnt(6)
    v_mfma_f32_32x32x16_bf16 v[144:159], v[184:187], v[72:75], v[144:159]
    ds_read_b64_tr_b16 v[200:201], v227 offset:61440
    ds_read_b64_tr_b16 v[202:203], v227 offset:62464
    s_waitcnt lgkmcnt(6)
    v_mfma_f32_32x32x16_bf16 v[144:159], v[188:191], v[76:79], v[144:159]
    ds_read_b64_tr_b16 v[204:205], v227 offset:63488
    ds_read_b64_tr_b16 v[206:207], v227 offset:64512
    s_add_u32 m0, s45, 40960
    s_mov_b32 s49, 369024
    buffer_load_dwordx4 v225, s[32:35], s49 offen lds
    s_waitcnt vmcnt(7)
    s_barrier
    s_waitcnt lgkmcnt(6)
    v_mfma_f32_32x32x16_bf16 v[144:159], v[192:195], v[80:83], v[144:159]
    ds_read_b64_tr_b16 v[176:177], v227 offset:0
    ds_read_b64_tr_b16 v[178:179], v227 offset:1024
    s_waitcnt lgkmcnt(6)
    v_mfma_f32_32x32x16_bf16 v[144:159], v[196:199], v[84:87], v[144:159]
    ds_read_b64_tr_b16 v[180:181], v227 offset:2048
    ds_read_b64_tr_b16 v[182:183], v227 offset:3072
    s_waitcnt lgkmcnt(6)
    v_mfma_f32_32x32x16_bf16 v[144:159], v[200:203], v[88:91], v[144:159]
    ds_read_b64_tr_b16 v[184:185], v227 offset:4096
    ds_read_b64_tr_b16 v[186:187], v227 offset:5120
    s_waitcnt lgkmcnt(6)
    v_mfma_f32_32x32x16_bf16 v[144:159], v[204:207], v[92:95], v[144:159]
    ds_read_b64_tr_b16 v[188:189], v227 offset:6144
    ds_read_b64_tr_b16 v[190:191], v227 offset:7168
    s_add_u32 m0, s45, 49152
    s_mov_b32 s49, 512
    buffer_load_dwordx4 v225, s[32:35], s49 offen lds
    s_waitcnt vmcnt(7)
    s_barrier
    s_waitcnt lgkmcnt(6)
    v_mfma_f32_32x32x16_bf16 v[160:175], v[176:179], v[0:3], 0
    ds_read_b64_tr_b16 v[192:193], v227 offset:8192
    ds_read_b64_tr_b16 v[194:195], v227 offset:9216
    s_waitcnt lgkmcnt(6)
    v_mfma_f32_32x32x16_bf16 v[160:175], v[180:183], v[4:7], v[160:175]
    ds_read_b64_tr_b16 v[196:197], v227 offset:10240
    ds_read_b64_tr_b16 v[198:199], v227 offset:11264
    s_waitcnt lgkmcnt(6)
    v_mfma_f32_32x32x16_bf16 v[160:175], v[184:187], v[8:11], v[160:175]
    ds_read_b64_tr_b16 v[200:201], v227 offset:12288
    ds_read_b64_tr_b16 v[202:203], v227 offset:13312
    s_waitcnt lgkmcnt(6)
    v_mfma_f32_32x32x16_bf16 v[160:175], v[188:191], v[12:15], v[160:175]
    ds_read_b64_tr_b16 v[204:205], v227 offset:14336
    ds_read_b64_tr_b16 v[206:207], v227 offset:15360
    s_add_u32 m0, s45, 57344
    s_mov_b32 s49, 74240
    buffer_load_dwordx4 v225, s[32:35], s49 offen lds
    s_waitcnt vmcnt(7)
    s_barrier
    s_waitcnt lgkmcnt(6)
    v_mfma_f32_32x32x16_bf16 v[160:175], v[192:195], v[16:19], v[160:175]
    ds_read_b64_tr_b16 v[176:177], v227 offset:16384
    ds_read_b64_tr_b16 v[178:179], v227 offset:17408
    s_waitcnt lgkmcnt(6)
    v_mfma_f32_32x32x16_bf16 v[160:175], v[196:199], v[20:23], v[160:175]
    ds_read_b64_tr_b16 v[180:181], v227 offset:18432
    ds_read_b64_tr_b16 v[182:183], v227 offset:19456
    s_waitcnt lgkmcnt(6)
    v_mfma_f32_32x32x16_bf16 v[160:175], v[200:203], v[24:27], v[160:175]
    ds_read_b64_tr_b16 v[184:185], v227 offset:20480
    ds_read_b64_tr_b16 v[186:187], v227 offset:21504
    s_waitcnt lgkmcnt(6)
    v_mfma_f32_32x32x16_bf16 v[160:175], v[204:207], v[28:31], v[160:175]
    ds_read_b64_tr_b16 v[188:189], v227 offset:22528
    ds_read_b64_tr_b16 v[190:191], v227 offset:23552
    s_add_u32 m0, s45, 0
    s_mov_b32 s49, 147968
    buffer_load_dwordx4 v225, s[32:35], s49 offen lds
    v_cvt_pk_bf16_f32 v208, v144, v145
    v_cvt_pk_bf16_f32 v209, v146, v147
    v_cvt_pk_bf16_f32 v210, v148, v149
    v_cvt_pk_bf16_f32 v211, v150, v151
    s_mov_b32 s48, 8192
    buffer_store_dwordx4 v[208:211], v230, s[36:39], s48 offen offset:0 sc0 sc1
    s_waitcnt vmcnt(7)
    s_barrier
    s_waitcnt lgkmcnt(6)
    v_mfma_f32_32x32x16_bf16 v[160:175], v[176:179], v[32:35], v[160:175]
    ds_read_b64_tr_b16 v[192:193], v227 offset:24576
    ds_read_b64_tr_b16 v[194:195], v227 offset:25600
    s_waitcnt lgkmcnt(6)
    v_mfma_f32_32x32x16_bf16 v[160:175], v[180:183], v[36:39], v[160:175]
    ds_read_b64_tr_b16 v[196:197], v227 offset:26624
    ds_read_b64_tr_b16 v[198:199], v227 offset:27648
    s_waitcnt lgkmcnt(6)
    v_mfma_f32_32x32x16_bf16 v[160:175], v[184:187], v[40:43], v[160:175]
    ds_read_b64_tr_b16 v[200:201], v227 offset:28672
    ds_read_b64_tr_b16 v[202:203], v227 offset:29696
    s_waitcnt lgkmcnt(6)
    v_mfma_f32_32x32x16_bf16 v[160:175], v[188:191], v[44:47], v[160:175]
    ds_read_b64_tr_b16 v[204:205], v227 offset:30720
    ds_read_b64_tr_b16 v[206:207], v227 offset:31744
    s_add_u32 m0, s45, 8192
    s_mov_b32 s49, 221696
    buffer_load_dwordx4 v225, s[32:35], s49 offen lds
    s_waitcnt vmcnt(7)
    s_barrier
    s_waitcnt lgkmcnt(6)
    v_mfma_f32_32x32x16_bf16 v[160:175], v[192:195], v[48:51], v[160:175]
    ds_read_b64_tr_b16 v[176:177], v227 offset:32768
    ds_read_b64_tr_b16 v[178:179], v227 offset:33792
    s_waitcnt lgkmcnt(6)
    v_mfma_f32_32x32x16_bf16 v[160:175], v[196:199], v[52:55], v[160:175]
    ds_read_b64_tr_b16 v[180:181], v227 offset:34816
    ds_read_b64_tr_b16 v[182:183], v227 offset:35840
    s_waitcnt lgkmcnt(6)
    v_mfma_f32_32x32x16_bf16 v[160:175], v[200:203], v[56:59], v[160:175]
    ds_read_b64_tr_b16 v[184:185], v227 offset:36864
    ds_read_b64_tr_b16 v[186:187], v227 offset:37888
    s_waitcnt lgkmcnt(6)
    v_mfma_f32_32x32x16_bf16 v[160:175], v[204:207], v[60:63], v[160:175]
    ds_read_b64_tr_b16 v[188:189], v227 offset:38912
    ds_read_b64_tr_b16 v[190:191], v227 offset:39936
    s_add_u32 m0, s45, 16384
    s_mov_b32 s49, 295424
    buffer_load_dwordx4 v225, s[32:35], s49 offen lds
    v_cvt_pk_bf16_f32 v212, v152, v153
    v_cvt_pk_bf16_f32 v213, v154, v155
    v_cvt_pk_bf16_f32 v214, v156, v157
    v_cvt_pk_bf16_f32 v215, v158, v159
    s_mov_b32 s48, 8192
    buffer_store_dwordx4 v[212:215], v230, s[36:39], s48 offen offset:1024 sc0 sc1
    s_waitcnt vmcnt(7)
    s_barrier
    s_waitcnt lgkmcnt(6)
    v_mfma_f32_32x32x16_bf16 v[160:175], v[176:179], v[64:67], v[160:175]
    ds_read_b64_tr_b16 v[192:193], v227 offset:40960
    ds_read_b64_tr_b16 v[194:195], v227 offset:41984
    s_waitcnt lgkmcnt(6)
    v_mfma_f32_32x32x16_bf16 v[160:175], v[180:183], v[68:71], v[160:175]
    ds_read_b64_tr_b16 v[196:197], v227 offset:43008
    ds_read_b64_tr_b16 v[198:199], v227 offset:44032
    s_waitcnt lgkmcnt(6)
    v_mfma_f32_32x32x16_bf16 v[160:175], v[184:187], v[72:75], v[160:175]
    ds_read_b64_tr_b16 v[200:201], v227 offset:45056
    ds_read_b64_tr_b16 v[202:203], v227 offset:46080
    s_waitcnt lgkmcnt(6)
    v_mfma_f32_32x32x16_bf16 v[160:175], v[188:191], v[76:79], v[160:175]
    ds_read_b64_tr_b16 v[204:205], v227 offset:47104
    ds_read_b64_tr_b16 v[206:207], v227 offset:48128
    s_add_u32 m0, s45, 24576
    s_mov_b32 s49, 369152
    buffer_load_dwordx4 v225, s[32:35], s49 offen lds
    s_waitcnt vmcnt(7)
    s_barrier
    s_waitcnt lgkmcnt(6)
    v_mfma_f32_32x32x16_bf16 v[160:175], v[192:195], v[80:83], v[160:175]
    ds_read_b64_tr_b16 v[176:177], v227 offset:49152
    ds_read_b64_tr_b16 v[178:179], v227 offset:50176
    s_waitcnt lgkmcnt(6)
    v_mfma_f32_32x32x16_bf16 v[160:175], v[196:199], v[84:87], v[160:175]
    ds_read_b64_tr_b16 v[180:181], v227 offset:51200
    ds_read_b64_tr_b16 v[182:183], v227 offset:52224
    s_waitcnt lgkmcnt(6)
    v_mfma_f32_32x32x16_bf16 v[160:175], v[200:203], v[88:91], v[160:175]
    ds_read_b64_tr_b16 v[184:185], v227 offset:53248
    ds_read_b64_tr_b16 v[186:187], v227 offset:54272
    s_waitcnt lgkmcnt(6)
    v_mfma_f32_32x32x16_bf16 v[160:175], v[204:207], v[92:95], v[160:175]
    ds_read_b64_tr_b16 v[188:189], v227 offset:55296
    ds_read_b64_tr_b16 v[190:191], v227 offset:56320
    s_add_u32 m0, s45, 32768
    s_mov_b32 s49, 640
    buffer_load_dwordx4 v225, s[32:35], s49 offen lds
    s_waitcnt vmcnt(7)
    s_barrier
    s_waitcnt lgkmcnt(6)
    v_mfma_f32_32x32x16_bf16 v[144:159], v[176:179], v[0:3], 0
    ds_read_b64_tr_b16 v[192:193], v227 offset:57344
    ds_read_b64_tr_b16 v[194:195], v227 offset:58368
    s_waitcnt lgkmcnt(6)
    v_mfma_f32_32x32x16_bf16 v[144:159], v[180:183], v[4:7], v[144:159]
    ds_read_b64_tr_b16 v[196:197], v227 offset:59392
    ds_read_b64_tr_b16 v[198:199], v227 offset:60416
    s_waitcnt lgkmcnt(6)
    v_mfma_f32_32x32x16_bf16 v[144:159], v[184:187], v[8:11], v[144:159]
    ds_read_b64_tr_b16 v[200:201], v227 offset:61440
    ds_read_b64_tr_b16 v[202:203], v227 offset:62464
    s_waitcnt lgkmcnt(6)
    v_mfma_f32_32x32x16_bf16 v[144:159], v[188:191], v[12:15], v[144:159]
    ds_read_b64_tr_b16 v[204:205], v227 offset:63488
    ds_read_b64_tr_b16 v[206:207], v227 offset:64512
    s_add_u32 m0, s45, 40960
    s_mov_b32 s49, 74368
    buffer_load_dwordx4 v225, s[32:35], s49 offen lds
    s_waitcnt vmcnt(7)
    s_barrier
    s_waitcnt lgkmcnt(6)
    v_mfma_f32_32x32x16_bf16 v[144:159], v[192:195], v[16:19], v[144:159]
    ds_read_b64_tr_b16 v[176:177], v227 offset:0
    ds_read_b64_tr_b16 v[178:179], v227 offset:1024
    s_waitcnt lgkmcnt(6)
    v_mfma_f32_32x32x16_bf16 v[144:159], v[196:199], v[20:23], v[144:159]
    ds_read_b64_tr_b16 v[180:181], v227 offset:2048
    ds_read_b64_tr_b16 v[182:183], v227 offset:3072
    s_waitcnt lgkmcnt(6)
    v_mfma_f32_32x32x16_bf16 v[144:159], v[200:203], v[24:27], v[144:159]
    ds_read_b64_tr_b16 v[184:185], v227 offset:4096
    ds_read_b64_tr_b16 v[186:187], v227 offset:5120
    s_waitcnt lgkmcnt(6)
    v_mfma_f32_32x32x16_bf16 v[144:159], v[204:207], v[28:31], v[144:159]
    ds_read_b64_tr_b16 v[188:189], v227 offset:6144
    ds_read_b64_tr_b16 v[190:191], v227 offset:7168
    s_add_u32 m0, s45, 49152
    s_mov_b32 s49, 148096
    buffer_load_dwordx4 v225, s[32:35], s49 offen lds
    v_cvt_pk_bf16_f32 v208, v160, v161
    v_cvt_pk_bf16_f32 v209, v162, v163
    v_cvt_pk_bf16_f32 v210, v164, v165
    v_cvt_pk_bf16_f32 v211, v166, v167
    s_mov_b32 s48, 12288
    buffer_store_dwordx4 v[208:211], v230, s[36:39], s48 offen offset:0 sc0 sc1
    s_waitcnt vmcnt(7)
    s_barrier
    s_waitcnt lgkmcnt(6)
    v_mfma_f32_32x32x16_bf16 v[144:159], v[176:179], v[32:35], v[144:159]
    ds_read_b64_tr_b16 v[192:193], v227 offset:8192
    ds_read_b64_tr_b16 v[194:195], v227 offset:9216
    s_waitcnt lgkmcnt(6)
    v_mfma_f32_32x32x16_bf16 v[144:159], v[180:183], v[36:39], v[144:159]
    ds_read_b64_tr_b16 v[196:197], v227 offset:10240
    ds_read_b64_tr_b16 v[198:199], v227 offset:11264
    s_waitcnt lgkmcnt(6)
    v_mfma_f32_32x32x16_bf16 v[144:159], v[184:187], v[40:43], v[144:159]
    ds_read_b64_tr_b16 v[200:201], v227 offset:12288
    ds_read_b64_tr_b16 v[202:203], v227 offset:13312
    s_waitcnt lgkmcnt(6)
    v_mfma_f32_32x32x16_bf16 v[144:159], v[188:191], v[44:47], v[144:159]
    ds_read_b64_tr_b16 v[204:205], v227 offset:14336
    ds_read_b64_tr_b16 v[206:207], v227 offset:15360
    s_add_u32 m0, s45, 57344
    s_mov_b32 s49, 221824
    buffer_load_dwordx4 v225, s[32:35], s49 offen lds
    s_waitcnt vmcnt(7)
    s_barrier
    s_waitcnt lgkmcnt(6)
    v_mfma_f32_32x32x16_bf16 v[144:159], v[192:195], v[48:51], v[144:159]
    ds_read_b64_tr_b16 v[176:177], v227 offset:16384
    ds_read_b64_tr_b16 v[178:179], v227 offset:17408
    s_waitcnt lgkmcnt(6)
    v_mfma_f32_32x32x16_bf16 v[144:159], v[196:199], v[52:55], v[144:159]
    ds_read_b64_tr_b16 v[180:181], v227 offset:18432
    ds_read_b64_tr_b16 v[182:183], v227 offset:19456
    s_waitcnt lgkmcnt(6)
    v_mfma_f32_32x32x16_bf16 v[144:159], v[200:203], v[56:59], v[144:159]
    ds_read_b64_tr_b16 v[184:185], v227 offset:20480
    ds_read_b64_tr_b16 v[186:187], v227 offset:21504
    s_waitcnt lgkmcnt(6)
    v_mfma_f32_32x32x16_bf16 v[144:159], v[204:207], v[60:63], v[144:159]
    ds_read_b64_tr_b16 v[188:189], v227 offset:22528
    ds_read_b64_tr_b16 v[190:191], v227 offset:23552
    s_add_u32 m0, s45, 0
    s_mov_b32 s49, 295552
    buffer_load_dwordx4 v225, s[32:35], s49 offen lds
    v_cvt_pk_bf16_f32 v212, v168, v169
    v_cvt_pk_bf16_f32 v213, v170, v171
    v_cvt_pk_bf16_f32 v214, v172, v173
    v_cvt_pk_bf16_f32 v215, v174, v175
    s_mov_b32 s48, 12288
    buffer_store_dwordx4 v[212:215], v230, s[36:39], s48 offen offset:1024 sc0 sc1
    s_waitcnt vmcnt(7)
    s_barrier
    s_waitcnt lgkmcnt(6)
    v_mfma_f32_32x32x16_bf16 v[144:159], v[176:179], v[64:67], v[144:159]
    ds_read_b64_tr_b16 v[192:193], v227 offset:24576
    ds_read_b64_tr_b16 v[194:195], v227 offset:25600
    s_waitcnt lgkmcnt(6)
    v_mfma_f32_32x32x16_bf16 v[144:159], v[180:183], v[68:71], v[144:159]
    ds_read_b64_tr_b16 v[196:197], v227 offset:26624
    ds_read_b64_tr_b16 v[198:199], v227 offset:27648
    s_waitcnt lgkmcnt(6)
    v_mfma_f32_32x32x16_bf16 v[144:159], v[184:187], v[72:75], v[144:159]
    ds_read_b64_tr_b16 v[200:201], v227 offset:28672
    ds_read_b64_tr_b16 v[202:203], v227 offset:29696
    s_waitcnt lgkmcnt(6)
    v_mfma_f32_32x32x16_bf16 v[144:159], v[188:191], v[76:79], v[144:159]
    ds_read_b64_tr_b16 v[204:205], v227 offset:30720
    ds_read_b64_tr_b16 v[206:207], v227 offset:31744
    s_add_u32 m0, s45, 8192
    s_mov_b32 s49, 369280
    buffer_load_dwordx4 v225, s[32:35], s49 offen lds
    s_waitcnt vmcnt(7)
    s_barrier
    s_waitcnt lgkmcnt(6)
    v_mfma_f32_32x32x16_bf16 v[144:159], v[192:195], v[80:83], v[144:159]
    ds_read_b64_tr_b16 v[176:177], v227 offset:32768
    ds_read_b64_tr_b16 v[178:179], v227 offset:33792
    s_waitcnt lgkmcnt(6)
    v_mfma_f32_32x32x16_bf16 v[144:159], v[196:199], v[84:87], v[144:159]
    ds_read_b64_tr_b16 v[180:181], v227 offset:34816
    ds_read_b64_tr_b16 v[182:183], v227 offset:35840
    s_waitcnt lgkmcnt(6)
    v_mfma_f32_32x32x16_bf16 v[144:159], v[200:203], v[88:91], v[144:159]
    ds_read_b64_tr_b16 v[184:185], v227 offset:36864
    ds_read_b64_tr_b16 v[186:187], v227 offset:37888
    s_waitcnt lgkmcnt(6)
    v_mfma_f32_32x32x16_bf16 v[144:159], v[204:207], v[92:95], v[144:159]
    ds_read_b64_tr_b16 v[188:189], v227 offset:38912
    ds_read_b64_tr_b16 v[190:191], v227 offset:39936
    s_add_u32 m0, s45, 16384
    s_mov_b32 s49, 768
    buffer_load_dwordx4 v225, s[32:35], s49 offen lds
    s_waitcnt vmcnt(7)
    s_barrier
    s_waitcnt lgkmcnt(6)
    v_mfma_f32_32x32x16_bf16 v[160:175], v[176:179], v[0:3], 0
    ds_read_b64_tr_b16 v[192:193], v227 offset:40960
    ds_read_b64_tr_b16 v[194:195], v227 offset:41984
    s_waitcnt lgkmcnt(6)
    v_mfma_f32_32x32x16_bf16 v[160:175], v[180:183], v[4:7], v[160:175]
    ds_read_b64_tr_b16 v[196:197], v227 offset:43008
    ds_read_b64_tr_b16 v[198:199], v227 offset:44032
    s_waitcnt lgkmcnt(6)
    v_mfma_f32_32x32x16_bf16 v[160:175], v[184:187], v[8:11], v[160:175]
    ds_read_b64_tr_b16 v[200:201], v227 offset:45056
    ds_read_b64_tr_b16 v[202:203], v227 offset:46080
    s_waitcnt lgkmcnt(6)
    v_mfma_f32_32x32x16_bf16 v[160:175], v[188:191], v[12:15], v[160:175]
    ds_read_b64_tr_b16 v[204:205], v227 offset:47104
    ds_read_b64_tr_b16 v[206:207], v227 offset:48128
    s_add_u32 m0, s45, 24576
    s_mov_b32 s49, 74496
    buffer_load_dwordx4 v225, s[32:35], s49 offen lds
    s_waitcnt vmcnt(7)
    s_barrier
    s_waitcnt lgkmcnt(6)
    v_mfma_f32_32x32x16_bf16 v[160:175], v[192:195], v[16:19], v[160:175]
    ds_read_b64_tr_b16 v[176:177], v227 offset:49152
    ds_read_b64_tr_b16 v[178:179], v227 offset:50176
    s_waitcnt lgkmcnt(6)
    v_mfma_f32_32x32x16_bf16 v[160:175], v[196:199], v[20:23], v[160:175]
    ds_read_b64_tr_b16 v[180:181], v227 offset:51200
    ds_read_b64_tr_b16 v[182:183], v227 offset:52224
    s_waitcnt lgkmcnt(6)
    v_mfma_f32_32x32x16_bf16 v[160:175], v[200:203], v[24:27], v[160:175]
    ds_read_b64_tr_b16 v[184:185], v227 offset:53248
    ds_read_b64_tr_b16 v[186:187], v227 offset:54272
    s_waitcnt lgkmcnt(6)
    v_mfma_f32_32x32x16_bf16 v[160:175], v[204:207], v[28:31], v[160:175]
    ds_read_b64_tr_b16 v[188:189], v227 offset:55296
    ds_read_b64_tr_b16 v[190:191], v227 offset:56320
    s_add_u32 m0, s45, 32768
    s_mov_b32 s49, 148224
    buffer_load_dwordx4 v225, s[32:35], s49 offen lds
    v_cvt_pk_bf16_f32 v208, v144, v145
    v_cvt_pk_bf16_f32 v209, v146, v147
    v_cvt_pk_bf16_f32 v210, v148, v149
    v_cvt_pk_bf16_f32 v211, v150, v151
    s_mov_b32 s48, 16384
    buffer_store_dwordx4 v[208:211], v230, s[36:39], s48 offen offset:0 sc0 sc1
    s_waitcnt vmcnt(7)
    s_barrier
    s_waitcnt lgkmcnt(6)
    v_mfma_f32_32x32x16_bf16 v[160:175], v[176:179], v[32:35], v[160:175]
    ds_read_b64_tr_b16 v[192:193], v227 offset:57344
    ds_read_b64_tr_b16 v[194:195], v227 offset:58368
    s_waitcnt lgkmcnt(6)
    v_mfma_f32_32x32x16_bf16 v[160:175], v[180:183], v[36:39], v[160:175]
    ds_read_b64_tr_b16 v[196:197], v227 offset:59392
    ds_read_b64_tr_b16 v[198:199], v227 offset:60416
    s_waitcnt lgkmcnt(6)
    v_mfma_f32_32x32x16_bf16 v[160:175], v[184:187], v[40:43], v[160:175]
    ds_read_b64_tr_b16 v[200:201], v227 offset:61440
    ds_read_b64_tr_b16 v[202:203], v227 offset:62464
    s_waitcnt lgkmcnt(6)
    v_mfma_f32_32x32x16_bf16 v[160:175], v[188:191], v[44:47], v[160:175]
    ds_read_b64_tr_b16 v[204:205], v227 offset:63488
    ds_read_b64_tr_b16 v[206:207], v227 offset:64512
    s_add_u32 m0, s45, 40960
    s_mov_b32 s49, 221952
    buffer_load_dwordx4 v225, s[32:35], s49 offen lds
    s_waitcnt vmcnt(7)
    s_barrier
    s_waitcnt lgkmcnt(6)
    v_mfma_f32_32x32x16_bf16 v[160:175], v[192:195], v[48:51], v[160:175]
    ds_read_b64_tr_b16 v[176:177], v227 offset:0
    ds_read_b64_tr_b16 v[178:179], v227 offset:1024
    s_waitcnt lgkmcnt(6)
    v_mfma_f32_32x32x16_bf16 v[160:175], v[196:199], v[52:55], v[160:175]
    ds_read_b64_tr_b16 v[180:181], v227 offset:2048
    ds_read_b64_tr_b16 v[182:183], v227 offset:3072
    s_waitcnt lgkmcnt(6)
    v_mfma_f32_32x32x16_bf16 v[160:175], v[200:203], v[56:59], v[160:175]
    ds_read_b64_tr_b16 v[184:185], v227 offset:4096
    ds_read_b64_tr_b16 v[186:187], v227 offset:5120
    s_waitcnt lgkmcnt(6)
    v_mfma_f32_32x32x16_bf16 v[160:175], v[204:207], v[60:63], v[160:175]
    ds_read_b64_tr_b16 v[188:189], v227 offset:6144
    ds_read_b64_tr_b16 v[190:191], v227 offset:7168
    s_add_u32 m0, s45, 49152
    s_mov_b32 s49, 295680
    buffer_load_dwordx4 v225, s[32:35], s49 offen lds
    v_cvt_pk_bf16_f32 v212, v152, v153
    v_cvt_pk_bf16_f32 v213, v154, v155
    v_cvt_pk_bf16_f32 v214, v156, v157
    v_cvt_pk_bf16_f32 v215, v158, v159
    s_mov_b32 s48, 16384
    buffer_store_dwordx4 v[212:215], v230, s[36:39], s48 offen offset:1024 sc0 sc1
    s_waitcnt vmcnt(7)
    s_barrier
    s_waitcnt lgkmcnt(6)
    v_mfma_f32_32x32x16_bf16 v[160:175], v[176:179], v[64:67], v[160:175]
    ds_read_b64_tr_b16 v[192:193], v227 offset:8192
    ds_read_b64_tr_b16 v[194:195], v227 offset:9216
    s_waitcnt lgkmcnt(6)
    v_mfma_f32_32x32x16_bf16 v[160:175], v[180:183], v[68:71], v[160:175]
    ds_read_b64_tr_b16 v[196:197], v227 offset:10240
    ds_read_b64_tr_b16 v[198:199], v227 offset:11264
    s_waitcnt lgkmcnt(6)
    v_mfma_f32_32x32x16_bf16 v[160:175], v[184:187], v[72:75], v[160:175]
    ds_read_b64_tr_b16 v[200:201], v227 offset:12288
    ds_read_b64_tr_b16 v[202:203], v227 offset:13312
    s_waitcnt lgkmcnt(6)
    v_mfma_f32_32x32x16_bf16 v[160:175], v[188:191], v[76:79], v[160:175]
    ds_read_b64_tr_b16 v[204:205], v227 offset:14336
    ds_read_b64_tr_b16 v[206:207], v227 offset:15360
    s_add_u32 m0, s45, 57344
    s_mov_b32 s49, 369408
    buffer_load_dwordx4 v225, s[32:35], s49 offen lds
    s_waitcnt vmcnt(7)
    s_barrier
    s_waitcnt lgkmcnt(6)
    v_mfma_f32_32x32x16_bf16 v[160:175], v[192:195], v[80:83], v[160:175]
    ds_read_b64_tr_b16 v[176:177], v227 offset:16384
    ds_read_b64_tr_b16 v[178:179], v227 offset:17408
    s_waitcnt lgkmcnt(6)
    v_mfma_f32_32x32x16_bf16 v[160:175], v[196:199], v[84:87], v[160:175]
    ds_read_b64_tr_b16 v[180:181], v227 offset:18432
    ds_read_b64_tr_b16 v[182:183], v227 offset:19456
    s_waitcnt lgkmcnt(6)
    v_mfma_f32_32x32x16_bf16 v[160:175], v[200:203], v[88:91], v[160:175]
    ds_read_b64_tr_b16 v[184:185], v227 offset:20480
    ds_read_b64_tr_b16 v[186:187], v227 offset:21504
    s_waitcnt lgkmcnt(6)
    v_mfma_f32_32x32x16_bf16 v[160:175], v[204:207], v[92:95], v[160:175]
    ds_read_b64_tr_b16 v[188:189], v227 offset:22528
    ds_read_b64_tr_b16 v[190:191], v227 offset:23552
    s_add_u32 m0, s45, 0
    s_mov_b32 s49, 896
    buffer_load_dwordx4 v225, s[32:35], s49 offen lds
    s_waitcnt vmcnt(7)
    s_barrier
    s_waitcnt lgkmcnt(6)
    v_mfma_f32_32x32x16_bf16 v[144:159], v[176:179], v[0:3], 0
    ds_read_b64_tr_b16 v[192:193], v227 offset:24576
    ds_read_b64_tr_b16 v[194:195], v227 offset:25600
    s_waitcnt lgkmcnt(6)
    v_mfma_f32_32x32x16_bf16 v[144:159], v[180:183], v[4:7], v[144:159]
    ds_read_b64_tr_b16 v[196:197], v227 offset:26624
    ds_read_b64_tr_b16 v[198:199], v227 offset:27648
    s_waitcnt lgkmcnt(6)
    v_mfma_f32_32x32x16_bf16 v[144:159], v[184:187], v[8:11], v[144:159]
    ds_read_b64_tr_b16 v[200:201], v227 offset:28672
    ds_read_b64_tr_b16 v[202:203], v227 offset:29696
    s_waitcnt lgkmcnt(6)
    v_mfma_f32_32x32x16_bf16 v[144:159], v[188:191], v[12:15], v[144:159]
    ds_read_b64_tr_b16 v[204:205], v227 offset:30720
    ds_read_b64_tr_b16 v[206:207], v227 offset:31744
    s_add_u32 m0, s45, 8192
    s_mov_b32 s49, 74624
    buffer_load_dwordx4 v225, s[32:35], s49 offen lds
    s_waitcnt vmcnt(7)
    s_barrier
    s_waitcnt lgkmcnt(6)
    v_mfma_f32_32x32x16_bf16 v[144:159], v[192:195], v[16:19], v[144:159]
    ds_read_b64_tr_b16 v[176:177], v227 offset:32768
    ds_read_b64_tr_b16 v[178:179], v227 offset:33792
    s_waitcnt lgkmcnt(6)
    v_mfma_f32_32x32x16_bf16 v[144:159], v[196:199], v[20:23], v[144:159]
    ds_read_b64_tr_b16 v[180:181], v227 offset:34816
    ds_read_b64_tr_b16 v[182:183], v227 offset:35840
    s_waitcnt lgkmcnt(6)
    v_mfma_f32_32x32x16_bf16 v[144:159], v[200:203], v[24:27], v[144:159]
    ds_read_b64_tr_b16 v[184:185], v227 offset:36864
    ds_read_b64_tr_b16 v[186:187], v227 offset:37888
    s_waitcnt lgkmcnt(6)
    v_mfma_f32_32x32x16_bf16 v[144:159], v[204:207], v[28:31], v[144:159]
    ds_read_b64_tr_b16 v[188:189], v227 offset:38912
    ds_read_b64_tr_b16 v[190:191], v227 offset:39936
    s_add_u32 m0, s45, 16384
    s_mov_b32 s49, 148352
    buffer_load_dwordx4 v225, s[32:35], s49 offen lds
    v_cvt_pk_bf16_f32 v208, v160, v161
    v_cvt_pk_bf16_f32 v209, v162, v163
    v_cvt_pk_bf16_f32 v210, v164, v165
    v_cvt_pk_bf16_f32 v211, v166, v167
    s_mov_b32 s48, 20480
    buffer_store_dwordx4 v[208:211], v230, s[36:39], s48 offen offset:0 sc0 sc1
    s_waitcnt vmcnt(7)
    s_barrier
    s_waitcnt lgkmcnt(6)
    v_mfma_f32_32x32x16_bf16 v[144:159], v[176:179], v[32:35], v[144:159]
    ds_read_b64_tr_b16 v[192:193], v227 offset:40960
    ds_read_b64_tr_b16 v[194:195], v227 offset:41984
    s_waitcnt lgkmcnt(6)
    v_mfma_f32_32x32x16_bf16 v[144:159], v[180:183], v[36:39], v[144:159]
    ds_read_b64_tr_b16 v[196:197], v227 offset:43008
    ds_read_b64_tr_b16 v[198:199], v227 offset:44032
    s_waitcnt lgkmcnt(6)
    v_mfma_f32_32x32x16_bf16 v[144:159], v[184:187], v[40:43], v[144:159]
    ds_read_b64_tr_b16 v[200:201], v227 offset:45056
    ds_read_b64_tr_b16 v[202:203], v227 offset:46080
    s_waitcnt lgkmcnt(6)
    v_mfma_f32_32x32x16_bf16 v[144:159], v[188:191], v[44:47], v[144:159]
    ds_read_b64_tr_b16 v[204:205], v227 offset:47104
    ds_read_b64_tr_b16 v[206:207], v227 offset:48128
    s_add_u32 m0, s45, 24576
    s_mov_b32 s49, 222080
    buffer_load_dwordx4 v225, s[32:35], s49 offen lds
    s_waitcnt vmcnt(7)
    s_barrier
    s_waitcnt lgkmcnt(6)
    v_mfma_f32_32x32x16_bf16 v[144:159], v[192:195], v[48:51], v[144:159]
    ds_read_b64_tr_b16 v[176:177], v227 offset:49152
    ds_read_b64_tr_b16 v[178:179], v227 offset:50176
    s_waitcnt lgkmcnt(6)
    v_mfma_f32_32x32x16_bf16 v[144:159], v[196:199], v[52:55], v[144:159]
    ds_read_b64_tr_b16 v[180:181], v227 offset:51200
    ds_read_b64_tr_b16 v[182:183], v227 offset:52224
    s_waitcnt lgkmcnt(6)
    v_mfma_f32_32x32x16_bf16 v[144:159], v[200:203], v[56:59], v[144:159]
    ds_read_b64_tr_b16 v[184:185], v227 offset:53248
    ds_read_b64_tr_b16 v[186:187], v227 offset:54272
    s_waitcnt lgkmcnt(6)
    v_mfma_f32_32x32x16_bf16 v[144:159], v[204:207], v[60:63], v[144:159]
    ds_read_b64_tr_b16 v[188:189], v227 offset:55296
    ds_read_b64_tr_b16 v[190:191], v227 offset:56320
    s_add_u32 m0, s45, 32768
    s_mov_b32 s49, 295808
    buffer_load_dwordx4 v225, s[32:35], s49 offen lds
    v_cvt_pk_bf16_f32 v212, v168, v169
    v_cvt_pk_bf16_f32 v213, v170, v171
    v_cvt_pk_bf16_f32 v214, v172, v173
    v_cvt_pk_bf16_f32 v215, v174, v175
    s_mov_b32 s48, 20480
    buffer_store_dwordx4 v[212:215], v230, s[36:39], s48 offen offset:1024 sc0 sc1
    s_waitcnt vmcnt(7)
    s_barrier
    s_waitcnt lgkmcnt(6)
    v_mfma_f32_32x32x16_bf16 v[144:159], v[176:179], v[64:67], v[144:159]
    ds_read_b64_tr_b16 v[192:193], v227 offset:57344
    ds_read_b64_tr_b16 v[194:195], v227 offset:58368
    s_waitcnt lgkmcnt(6)
    v_mfma_f32_32x32x16_bf16 v[144:159], v[180:183], v[68:71], v[144:159]
    ds_read_b64_tr_b16 v[196:197], v227 offset:59392
    ds_read_b64_tr_b16 v[198:199], v227 offset:60416
    s_waitcnt lgkmcnt(6)
    v_mfma_f32_32x32x16_bf16 v[144:159], v[184:187], v[72:75], v[144:159]
    ds_read_b64_tr_b16 v[200:201], v227 offset:61440
    ds_read_b64_tr_b16 v[202:203], v227 offset:62464
    s_waitcnt lgkmcnt(6)
    v_mfma_f32_32x32x16_bf16 v[144:159], v[188:191], v[76:79], v[144:159]
    ds_read_b64_tr_b16 v[204:205], v227 offset:63488
    ds_read_b64_tr_b16 v[206:207], v227 offset:64512
    s_add_u32 m0, s45, 40960
    s_mov_b32 s49, 369536
    buffer_load_dwordx4 v225, s[32:35], s49 offen lds
    s_waitcnt vmcnt(7)
    s_barrier
    s_waitcnt lgkmcnt(6)
    v_mfma_f32_32x32x16_bf16 v[144:159], v[192:195], v[80:83], v[144:159]
    ds_read_b64_tr_b16 v[176:177], v227 offset:0
    ds_read_b64_tr_b16 v[178:179], v227 offset:1024
    s_waitcnt lgkmcnt(6)
    v_mfma_f32_32x32x16_bf16 v[144:159], v[196:199], v[84:87], v[144:159]
    ds_read_b64_tr_b16 v[180:181], v227 offset:2048
    ds_read_b64_tr_b16 v[182:183], v227 offset:3072
    s_waitcnt lgkmcnt(6)
    v_mfma_f32_32x32x16_bf16 v[144:159], v[200:203], v[88:91], v[144:159]
    ds_read_b64_tr_b16 v[184:185], v227 offset:4096
    ds_read_b64_tr_b16 v[186:187], v227 offset:5120
    s_waitcnt lgkmcnt(6)
    v_mfma_f32_32x32x16_bf16 v[144:159], v[204:207], v[92:95], v[144:159]
    ds_read_b64_tr_b16 v[188:189], v227 offset:6144
    ds_read_b64_tr_b16 v[190:191], v227 offset:7168
    s_add_u32 m0, s45, 49152
    s_mov_b32 s49, 1024
    buffer_load_dwordx4 v225, s[32:35], s49 offen lds
    s_waitcnt vmcnt(7)
    s_barrier
    s_waitcnt lgkmcnt(6)
    v_mfma_f32_32x32x16_bf16 v[160:175], v[176:179], v[0:3], 0
    ds_read_b64_tr_b16 v[192:193], v227 offset:8192
    ds_read_b64_tr_b16 v[194:195], v227 offset:9216
    s_waitcnt lgkmcnt(6)
    v_mfma_f32_32x32x16_bf16 v[160:175], v[180:183], v[4:7], v[160:175]
    ds_read_b64_tr_b16 v[196:197], v227 offset:10240
    ds_read_b64_tr_b16 v[198:199], v227 offset:11264
    s_waitcnt lgkmcnt(6)
    v_mfma_f32_32x32x16_bf16 v[160:175], v[184:187], v[8:11], v[160:175]
    ds_read_b64_tr_b16 v[200:201], v227 offset:12288
    ds_read_b64_tr_b16 v[202:203], v227 offset:13312
    s_waitcnt lgkmcnt(6)
    v_mfma_f32_32x32x16_bf16 v[160:175], v[188:191], v[12:15], v[160:175]
    ds_read_b64_tr_b16 v[204:205], v227 offset:14336
    ds_read_b64_tr_b16 v[206:207], v227 offset:15360
    s_add_u32 m0, s45, 57344
    s_mov_b32 s49, 74752
    buffer_load_dwordx4 v225, s[32:35], s49 offen lds
    s_waitcnt vmcnt(7)
    s_barrier
    s_waitcnt lgkmcnt(6)
    v_mfma_f32_32x32x16_bf16 v[160:175], v[192:195], v[16:19], v[160:175]
    ds_read_b64_tr_b16 v[176:177], v227 offset:16384
    ds_read_b64_tr_b16 v[178:179], v227 offset:17408
    s_waitcnt lgkmcnt(6)
    v_mfma_f32_32x32x16_bf16 v[160:175], v[196:199], v[20:23], v[160:175]
    ds_read_b64_tr_b16 v[180:181], v227 offset:18432
    ds_read_b64_tr_b16 v[182:183], v227 offset:19456
    s_waitcnt lgkmcnt(6)
    v_mfma_f32_32x32x16_bf16 v[160:175], v[200:203], v[24:27], v[160:175]
    ds_read_b64_tr_b16 v[184:185], v227 offset:20480
    ds_read_b64_tr_b16 v[186:187], v227 offset:21504
    s_waitcnt lgkmcnt(6)
    v_mfma_f32_32x32x16_bf16 v[160:175], v[204:207], v[28:31], v[160:175]
    ds_read_b64_tr_b16 v[188:189], v227 offset:22528
    ds_read_b64_tr_b16 v[190:191], v227 offset:23552
    s_add_u32 m0, s45, 0
    s_mov_b32 s49, 148480
    buffer_load_dwordx4 v225, s[32:35], s49 offen lds
    v_cvt_pk_bf16_f32 v208, v144, v145
    v_cvt_pk_bf16_f32 v209, v146, v147
    v_cvt_pk_bf16_f32 v210, v148, v149
    v_cvt_pk_bf16_f32 v211, v150, v151
    s_mov_b32 s48, 24576
    buffer_store_dwordx4 v[208:211], v230, s[36:39], s48 offen offset:0 sc0 sc1
    s_waitcnt vmcnt(7)
    s_barrier
    s_waitcnt lgkmcnt(6)
    v_mfma_f32_32x32x16_bf16 v[160:175], v[176:179], v[32:35], v[160:175]
    ds_read_b64_tr_b16 v[192:193], v227 offset:24576
    ds_read_b64_tr_b16 v[194:195], v227 offset:25600
    s_waitcnt lgkmcnt(6)
    v_mfma_f32_32x32x16_bf16 v[160:175], v[180:183], v[36:39], v[160:175]
    ds_read_b64_tr_b16 v[196:197], v227 offset:26624
    ds_read_b64_tr_b16 v[198:199], v227 offset:27648
    s_waitcnt lgkmcnt(6)
    v_mfma_f32_32x32x16_bf16 v[160:175], v[184:187], v[40:43], v[160:175]
    ds_read_b64_tr_b16 v[200:201], v227 offset:28672
    ds_read_b64_tr_b16 v[202:203], v227 offset:29696
    s_waitcnt lgkmcnt(6)
    v_mfma_f32_32x32x16_bf16 v[160:175], v[188:191], v[44:47], v[160:175]
    ds_read_b64_tr_b16 v[204:205], v227 offset:30720
    ds_read_b64_tr_b16 v[206:207], v227 offset:31744
    s_add_u32 m0, s45, 8192
    s_mov_b32 s49, 222208
    buffer_load_dwordx4 v225, s[32:35], s49 offen lds
    s_waitcnt vmcnt(7)
    s_barrier
    s_waitcnt lgkmcnt(6)
    v_mfma_f32_32x32x16_bf16 v[160:175], v[192:195], v[48:51], v[160:175]
    ds_read_b64_tr_b16 v[176:177], v227 offset:32768
    ds_read_b64_tr_b16 v[178:179], v227 offset:33792
    s_waitcnt lgkmcnt(6)
    v_mfma_f32_32x32x16_bf16 v[160:175], v[196:199], v[52:55], v[160:175]
    ds_read_b64_tr_b16 v[180:181], v227 offset:34816
    ds_read_b64_tr_b16 v[182:183], v227 offset:35840
    s_waitcnt lgkmcnt(6)
    v_mfma_f32_32x32x16_bf16 v[160:175], v[200:203], v[56:59], v[160:175]
    ds_read_b64_tr_b16 v[184:185], v227 offset:36864
    ds_read_b64_tr_b16 v[186:187], v227 offset:37888
    s_waitcnt lgkmcnt(6)
    v_mfma_f32_32x32x16_bf16 v[160:175], v[204:207], v[60:63], v[160:175]
    ds_read_b64_tr_b16 v[188:189], v227 offset:38912
    ds_read_b64_tr_b16 v[190:191], v227 offset:39936
    s_add_u32 m0, s45, 16384
    s_mov_b32 s49, 295936
    buffer_load_dwordx4 v225, s[32:35], s49 offen lds
    v_cvt_pk_bf16_f32 v212, v152, v153
    v_cvt_pk_bf16_f32 v213, v154, v155
    v_cvt_pk_bf16_f32 v214, v156, v157
    v_cvt_pk_bf16_f32 v215, v158, v159
    s_mov_b32 s48, 24576
    buffer_store_dwordx4 v[212:215], v230, s[36:39], s48 offen offset:1024 sc0 sc1
    s_waitcnt vmcnt(7)
    s_barrier
    s_waitcnt lgkmcnt(6)
    v_mfma_f32_32x32x16_bf16 v[160:175], v[176:179], v[64:67], v[160:175]
    ds_read_b64_tr_b16 v[192:193], v227 offset:40960
    ds_read_b64_tr_b16 v[194:195], v227 offset:41984
    s_waitcnt lgkmcnt(6)
    v_mfma_f32_32x32x16_bf16 v[160:175], v[180:183], v[68:71], v[160:175]
    ds_read_b64_tr_b16 v[196:197], v227 offset:43008
    ds_read_b64_tr_b16 v[198:199], v227 offset:44032
    s_waitcnt lgkmcnt(6)
    v_mfma_f32_32x32x16_bf16 v[160:175], v[184:187], v[72:75], v[160:175]
    ds_read_b64_tr_b16 v[200:201], v227 offset:45056
    ds_read_b64_tr_b16 v[202:203], v227 offset:46080
    s_waitcnt lgkmcnt(6)
    v_mfma_f32_32x32x16_bf16 v[160:175], v[188:191], v[76:79], v[160:175]
    ds_read_b64_tr_b16 v[204:205], v227 offset:47104
    ds_read_b64_tr_b16 v[206:207], v227 offset:48128
    s_add_u32 m0, s45, 24576
    s_mov_b32 s49, 369664
    buffer_load_dwordx4 v225, s[32:35], s49 offen lds
    s_waitcnt vmcnt(7)
    s_barrier
    s_waitcnt lgkmcnt(6)
    v_mfma_f32_32x32x16_bf16 v[160:175], v[192:195], v[80:83], v[160:175]
    ds_read_b64_tr_b16 v[176:177], v227 offset:49152
    ds_read_b64_tr_b16 v[178:179], v227 offset:50176
    s_waitcnt lgkmcnt(6)
    v_mfma_f32_32x32x16_bf16 v[160:175], v[196:199], v[84:87], v[160:175]
    ds_read_b64_tr_b16 v[180:181], v227 offset:51200
    ds_read_b64_tr_b16 v[182:183], v227 offset:52224
    s_waitcnt lgkmcnt(6)
    v_mfma_f32_32x32x16_bf16 v[160:175], v[200:203], v[88:91], v[160:175]
    ds_read_b64_tr_b16 v[184:185], v227 offset:53248
    ds_read_b64_tr_b16 v[186:187], v227 offset:54272
    s_waitcnt lgkmcnt(6)
    v_mfma_f32_32x32x16_bf16 v[160:175], v[204:207], v[92:95], v[160:175]
    ds_read_b64_tr_b16 v[188:189], v227 offset:55296
    ds_read_b64_tr_b16 v[190:191], v227 offset:56320
    s_waitcnt vmcnt(6)
    s_barrier
    s_waitcnt lgkmcnt(6)
    v_mfma_f32_32x32x16_bf16 v[144:159], v[176:179], v[0:3], 0
    ds_read_b64_tr_b16 v[192:193], v227 offset:57344
    ds_read_b64_tr_b16 v[194:195], v227 offset:58368
    s_waitcnt lgkmcnt(6)
    v_mfma_f32_32x32x16_bf16 v[144:159], v[180:183], v[4:7], v[144:159]
    ds_read_b64_tr_b16 v[196:197], v227 offset:59392
    ds_read_b64_tr_b16 v[198:199], v227 offset:60416
    s_waitcnt lgkmcnt(6)
    v_mfma_f32_32x32x16_bf16 v[144:159], v[184:187], v[8:11], v[144:159]
    ds_read_b64_tr_b16 v[200:201], v227 offset:61440
    ds_read_b64_tr_b16 v[202:203], v227 offset:62464
    s_waitcnt lgkmcnt(6)
    v_mfma_f32_32x32x16_bf16 v[144:159], v[188:191], v[12:15], v[144:159]
    ds_read_b64_tr_b16 v[204:205], v227 offset:63488
    ds_read_b64_tr_b16 v[206:207], v227 offset:64512
    s_waitcnt vmcnt(5)
    s_barrier
    s_waitcnt lgkmcnt(6)
    v_mfma_f32_32x32x16_bf16 v[144:159], v[192:195], v[16:19], v[144:159]
    ds_read_b64_tr_b16 v[176:177], v227 offset:0
    ds_read_b64_tr_b16 v[178:179], v227 offset:1024
    s_waitcnt lgkmcnt(6)
    v_mfma_f32_32x32x16_bf16 v[144:159], v[196:199], v[20:23], v[144:159]
    ds_read_b64_tr_b16 v[180:181], v227 offset:2048
    ds_read_b64_tr_b16 v[182:183], v227 offset:3072
    s_waitcnt lgkmcnt(6)
    v_mfma_f32_32x32x16_bf16 v[144:159], v[200:203], v[24:27], v[144:159]
    ds_read_b64_tr_b16 v[184:185], v227 offset:4096
    ds_read_b64_tr_b16 v[186:187], v227 offset:5120
    s_waitcnt lgkmcnt(6)
    v_mfma_f32_32x32x16_bf16 v[144:159], v[204:207], v[28:31], v[144:159]
    ds_read_b64_tr_b16 v[188:189], v227 offset:6144
    ds_read_b64_tr_b16 v[190:191], v227 offset:7168
    v_cvt_pk_bf16_f32 v208, v160, v161
    v_cvt_pk_bf16_f32 v209, v162, v163
    v_cvt_pk_bf16_f32 v210, v164, v165
    v_cvt_pk_bf16_f32 v211, v166, v167
    s_mov_b32 s48, 28672
    buffer_store_dwordx4 v[208:211], v230, s[36:39], s48 offen offset:0 sc0 sc1
    s_waitcnt vmcnt(4)
    s_barrier
    s_waitcnt lgkmcnt(6)
    v_mfma_f32_32x32x16_bf16 v[144:159], v[176:179], v[32:35], v[144:159]
    ds_read_b64_tr_b16 v[192:193], v227 offset:8192
    ds_read_b64_tr_b16 v[194:195], v227 offset:9216
    s_waitcnt lgkmcnt(6)
    v_mfma_f32_32x32x16_bf16 v[144:159], v[180:183], v[36:39], v[144:159]
    ds_read_b64_tr_b16 v[196:197], v227 offset:10240
    ds_read_b64_tr_b16 v[198:199], v227 offset:11264
    s_waitcnt lgkmcnt(6)
    v_mfma_f32_32x32x16_bf16 v[144:159], v[184:187], v[40:43], v[144:159]
    ds_read_b64_tr_b16 v[200:201], v227 offset:12288
    ds_read_b64_tr_b16 v[202:203], v227 offset:13312
    s_waitcnt lgkmcnt(6)
    v_mfma_f32_32x32x16_bf16 v[144:159], v[188:191], v[44:47], v[144:159]
    ds_read_b64_tr_b16 v[204:205], v227 offset:14336
    ds_read_b64_tr_b16 v[206:207], v227 offset:15360
    s_waitcnt vmcnt(3)
    s_barrier
    s_waitcnt lgkmcnt(6)
    v_mfma_f32_32x32x16_bf16 v[144:159], v[192:195], v[48:51], v[144:159]
    ds_read_b64_tr_b16 v[176:177], v227 offset:16384
    ds_read_b64_tr_b16 v[178:179], v227 offset:17408
    s_waitcnt lgkmcnt(6)
    v_mfma_f32_32x32x16_bf16 v[144:159], v[196:199], v[52:55], v[144:159]
    ds_read_b64_tr_b16 v[180:181], v227 offset:18432
    ds_read_b64_tr_b16 v[182:183], v227 offset:19456
    s_waitcnt lgkmcnt(6)
    v_mfma_f32_32x32x16_bf16 v[144:159], v[200:203], v[56:59], v[144:159]
    ds_read_b64_tr_b16 v[184:185], v227 offset:20480
    ds_read_b64_tr_b16 v[186:187], v227 offset:21504
    s_waitcnt lgkmcnt(6)
    v_mfma_f32_32x32x16_bf16 v[144:159], v[204:207], v[60:63], v[144:159]
    ds_read_b64_tr_b16 v[188:189], v227 offset:22528
    ds_read_b64_tr_b16 v[190:191], v227 offset:23552
    v_cvt_pk_bf16_f32 v212, v168, v169
    v_cvt_pk_bf16_f32 v213, v170, v171
    v_cvt_pk_bf16_f32 v214, v172, v173
    v_cvt_pk_bf16_f32 v215, v174, v175
    s_mov_b32 s48, 28672
    buffer_store_dwordx4 v[212:215], v230, s[36:39], s48 offen offset:1024 sc0 sc1
    s_waitcnt vmcnt(2)
    s_barrier
    s_waitcnt lgkmcnt(6)
    v_mfma_f32_32x32x16_bf16 v[144:159], v[176:179], v[64:67], v[144:159]
    ds_read_b64_tr_b16 v[192:193], v227 offset:24576
    ds_read_b64_tr_b16 v[194:195], v227 offset:25600
    s_waitcnt lgkmcnt(6)
    v_mfma_f32_32x32x16_bf16 v[144:159], v[180:183], v[68:71], v[144:159]
    ds_read_b64_tr_b16 v[196:197], v227 offset:26624
    ds_read_b64_tr_b16 v[198:199], v227 offset:27648
    s_waitcnt lgkmcnt(6)
    v_mfma_f32_32x32x16_bf16 v[144:159], v[184:187], v[72:75], v[144:159]
    ds_read_b64_tr_b16 v[200:201], v227 offset:28672
    ds_read_b64_tr_b16 v[202:203], v227 offset:29696
    s_waitcnt lgkmcnt(6)
    v_mfma_f32_32x32x16_bf16 v[144:159], v[188:191], v[76:79], v[144:159]
    ds_read_b64_tr_b16 v[204:205], v227 offset:30720
    ds_read_b64_tr_b16 v[206:207], v227 offset:31744
    s_barrier
    s_waitcnt lgkmcnt(6)
    v_mfma_f32_32x32x16_bf16 v[144:159], v[192:195], v[80:83], v[144:159]
    s_waitcnt lgkmcnt(4)
    v_mfma_f32_32x32x16_bf16 v[144:159], v[196:199], v[84:87], v[144:159]
    s_waitcnt lgkmcnt(2)
    v_mfma_f32_32x32x16_bf16 v[144:159], v[200:203], v[88:91], v[144:159]
    s_waitcnt lgkmcnt(0)
    v_mfma_f32_32x32x16_bf16 v[144:159], v[204:207], v[92:95], v[144:159]
    s_nop 7
    s_nop 7
    v_cvt_pk_bf16_f32 v208, v144, v145
    v_cvt_pk_bf16_f32 v209, v146, v147
    v_cvt_pk_bf16_f32 v210, v148, v149
    v_cvt_pk_bf16_f32 v211, v150, v151
    s_mov_b32 s48, 32768
    buffer_store_dwordx4 v[208:211], v230, s[36:39], s48 offen offset:0 sc0 sc1
    v_cvt_pk_bf16_f32 v212, v152, v153
    v_cvt_pk_bf16_f32 v213, v154, v155
    v_cvt_pk_bf16_f32 v214, v156, v157
    v_cvt_pk_bf16_f32 v215, v158, v159
    s_mov_b32 s48, 32768
    buffer_store_dwordx4 v[212:215], v230, s[36:39], s48 offen offset:1024 sc0 sc1
    s_waitcnt vmcnt(0) lgkmcnt(0)
    v_mbcnt_lo_u32_b32 v1, -1, 0
    v_mbcnt_hi_u32_b32 v1, -1, v1
    s_load_dwordx2 s[4:5], s[0:1], 0
    s_load_dwordx4 s[12:15], s[0:1], 48
    s_load_dwordx2 s[20:21], s[0:1], 64
    s_barrier
    s_waitcnt lgkmcnt(0)
    s_mov_b32 s16, s14
    s_and_b32 s17, s15, 0xffff
    s_mov_b32 s18, 0x100
    s_mov_b32 s19, 0x20000
    s_lshl_b32 s47, s44, 7
    s_add_u32 s47, s47, 46137344
    s_add_u32 s36, s20, s47
    s_addc_u32 s37, s21, 0
    s_and_b32 s37, s37, 0xffff
    s_mov_b32 s38, 64
    s_mov_b32 s39, 0x20000
    v_mov_b32 v6, 240
    s_mov_b32 s47, 0
L_tag_m0:
    buffer_load_dword v5, v6, s[16:19], 0 offen sc1
    s_waitcnt vmcnt(0)
    v_readfirstlane_b32 s58, v5
    s_add_u32 s47, s47, 1
    s_nop 2
    s_cmp_lg_u32 s58, 0
    s_cbranch_scc1 L_tagok_m0
    s_cmp_lt_u32 s47, 200000
    s_cbranch_scc1 L_tag_m0
L_tagok_m0:
    s_cmp_lg_u32 s40, 0
    s_cbranch_scc1 L_t_nosig_m0
    s_mov_b32 s46, s43
    s_lshl_b32 s46, s46, 2
    v_mov_b32 v4, s58
    v_mov_b32 v5, s46
    s_mov_b64 exec, 1
    buffer_store_dword v4, v5, s[36:39], 0 offen sc0 sc1
    s_mov_b64 exec, -1
L_t_nosig_m0:
    s_mov_b32 s24, s4
    s_and_b32 s25, s5, 0xffff
    s_mov_b32 s26, 0x240000
    s_mov_b32 s27, 0x20000
    s_mov_b32 s28, s12
    s_and_b32 s29, s13, 0xffff
    s_mov_b32 s30, 0x240000
    s_mov_b32 s31, 0x20000
    s_mov_b32 s32, s20
    s_and_b32 s33, s21, 0xffff
    s_mov_b32 s34, 0x2400000
    s_mov_b32 s35, 0x20000
    s_mul_i32 s55, s43, 12
    s_add_u32 s46, s55, s40
    s_mov_b32 s22, s46
    s_lshr_b32 s47, s22, 1
    s_and_b32 s48, s22, 1
    s_mul_i32 s49, s47, 3641
    s_lshr_b32 s49, s49, 16
    s_mul_i32 s56, s49, 18
    s_sub_u32 s56, s47, s56
    s_mul_i32 s57, s44, 72
    s_add_u32 s57, s57, s47
    s_lshl_b32 s57, s57, 1
    s_add_u32 s57, s57, s48
    s_lshl_b32 s57, s57, 10
    v_lshlrev_b32 v2, 4, v1
    v_add_u32 v2, s57, v2
    s_lshl_b32 s57, s44, 7
    s_lshl_b32 s49, s49, 5
    s_add_u32 s57, s57, s49
    v_and_b32 v3, 31, v1
    v_add_u32 v3, s57, v3
    v_mul_u32_u24 v3, 1152, v3
    v_lshrrev_b32 v4, 5, v1
    v_lshl_add_u32 v3, v4, 4, v3
    s_lshl_b32 s56, s56, 6
    s_lshl_b32 s48, s48, 5
    s_add_u32 s56, s56, s48
    v_add_u32 v3, s56, v3
    buffer_load_dwordx4 v[8:11], v3, s[24:27], 0 offen
    s_and_b32 s46, s40, 3
    s_add_u32 s22, s55, s46
    s_add_u32 s22, s22, 8
    s_lshr_b32 s47, s22, 1
    s_and_b32 s48, s22, 1
    s_mul_i32 s49, s47, 3641
    s_lshr_b32 s49, s49, 16
    s_mul_i32 s56, s49, 18
    s_sub_u32 s56, s47, s56
    s_mul_i32 s57, s44, 72
    s_add_u32 s57, s57, s47
    s_lshl_b32 s57, s57, 1
    s_add_u32 s57, s57, s48
    s_lshl_b32 s57, s57, 10
    v_lshlrev_b32 v7, 4, v1
    v_add_u32 v7, s57, v7
    s_lshl_b32 s57, s44, 7
    s_lshl_b32 s49, s49, 5
    s_add_u32 s57, s57, s49
    v_and_b32 v240, 31, v1
    v_add_u32 v240, s57, v240
    v_mul_u32_u24 v240, 1152, v240
    v_lshrrev_b32 v4, 5, v1
    v_lshl_add_u32 v240, v4, 4, v240
    s_lshl_b32 s56, s56, 6
    s_lshl_b32 s48, s48, 5
    s_add_u32 s56, s56, s48
    v_add_u32 v240, s56, v240
    buffer_load_dwordx4 v[12:15], v240, s[24:27], 0 offen
    v_lshlrev_b32 v6, 2, v1
    v_mov_b32 v80, 0
    v_mov_b32 v81, 0
    v_mov_b32 v82, 0
    v_mov_b32 v83, 0
    v_mov_b32 v84, 0
    v_mov_b32 v85, 0
    v_mov_b32 v86, 0
    v_mov_b32 v87, 0
    v_mov_b32 v160, 0
    v_mov_b32 v161, 0
    v_mov_b32 v162, 0
    v_mov_b32 v163, 0
    v_mov_b32 v164, 0
    v_mov_b32 v165, 0
    v_mov_b32 v166, 0
    v_mov_b32 v167, 0
    s_cmp_lg_u32 s40, 0
    s_cbranch_scc1 L_pa_go_m0
    s_mov_b32 s47, 0
L_pa_poll_m0:
    buffer_load_dword v5, v6, s[36:39], 0 offen sc1
    s_waitcnt vmcnt(0)
    v_cmp_eq_u32 vcc, s58, v5
    s_add_u32 s47, s47, 1
    s_nop 3
    s_and_b32 s46, vcc_lo, 0xfff
    s_cmp_eq_u32 s46, 0xfff
    s_cbranch_scc1 L_pa_go_m0
    s_cmp_ge_u32 s47, 200000
    s_cbranch_scc1 L_pa_go_m0
    s_sleep 8
    s_branch L_pa_poll_m0
L_pa_go_m0:
    s_barrier
    s_cmp_ge_u32 s40, 4
    s_cbranch_scc1 L_a_one_m0
    s_mov_b32 s49, 0
    buffer_load_dwordx4 v[16:19], v2, s[32:35], s49 offen sc1
    s_mov_b32 s49, 2359296
    buffer_load_dwordx4 v[20:23], v2, s[32:35], s49 offen sc1
    s_mov_b32 s49, 4718592
    buffer_load_dwordx4 v[24:27], v2, s[32:35], s49 offen sc1
    s_mov_b32 s49, 7077888
    buffer_load_dwordx4 v[28:31], v2, s[32:35], s49 offen sc1
    s_mov_b32 s49, 9437184
    buffer_load_dwordx4 v[32:35], v2, s[32:35], s49 offen sc1
    s_mov_b32 s49, 11796480
    buffer_load_dwordx4 v[36:39], v2, s[32:35], s49 offen sc1
    s_mov_b32 s49, 14155776
    buffer_load_dwordx4 v[40:43], v2, s[32:35], s49 offen sc1
    s_mov_b32 s49, 16515072
    buffer_load_dwordx4 v[44:47], v2, s[32:35], s49 offen sc1
    s_mov_b32 s49, 18874368
    buffer_load_dwordx4 v[48:51], v2, s[32:35], s49 offen sc1
    s_mov_b32 s49, 21233664
    buffer_load_dwordx4 v[52:55], v2, s[32:35], s49 offen sc1
    s_mov_b32 s49, 23592960
    buffer_load_dwordx4 v[56:59], v2, s[32:35], s49 offen sc1
    s_mov_b32 s49, 25952256
    buffer_load_dwordx4 v[60:63], v2, s[32:35], s49 offen sc1
    s_mov_b32 s49, 0
    buffer_load_dwordx4 v[96:99], v7, s[32:35], s49 offen sc1
    s_mov_b32 s49, 2359296
    buffer_load_dwordx4 v[100:103], v7, s[32:35], s49 offen sc1
    s_mov_b32 s49, 4718592
    buffer_load_dwordx4 v[104:107], v7, s[32:35], s49 offen sc1
    s_mov_b32 s49, 7077888
    buffer_load_dwordx4 v[108:111], v7, s[32:35], s49 offen sc1
    s_mov_b32 s49, 9437184
    buffer_load_dwordx4 v[112:115], v7, s[32:35], s49 offen sc1
    s_mov_b32 s49, 11796480
    buffer_load_dwordx4 v[116:119], v7, s[32:35], s49 offen sc1
    s_mov_b32 s49, 14155776
    buffer_load_dwordx4 v[120:123], v7, s[32:35], s49 offen sc1
    s_mov_b32 s49, 16515072
    buffer_load_dwordx4 v[124:127], v7, s[32:35], s49 offen sc1
    s_mov_b32 s49, 18874368
    buffer_load_dwordx4 v[128:131], v7, s[32:35], s49 offen sc1
    s_mov_b32 s49, 21233664
    buffer_load_dwordx4 v[132:135], v7, s[32:35], s49 offen sc1
    s_mov_b32 s49, 23592960
    buffer_load_dwordx4 v[136:139], v7, s[32:35], s49 offen sc1
    s_mov_b32 s49, 25952256
    buffer_load_dwordx4 v[140:143], v7, s[32:35], s49 offen sc1
    s_waitcnt vmcnt(23)
    v_dot2_f32_bf16 v80, v16, s53, v80
    v_dot2_f32_bf16 v81, v16, s54, v81
    v_dot2_f32_bf16 v82, v17, s53, v82
    v_dot2_f32_bf16 v83, v17, s54, v83
    v_dot2_f32_bf16 v84, v18, s53, v84
    v_dot2_f32_bf16 v85, v18, s54, v85
    v_dot2_f32_bf16 v86, v19, s53, v86
    v_dot2_f32_bf16 v87, v19, s54, v87
    s_waitcnt vmcnt(22)
    v_dot2_f32_bf16 v80, v20, s53, v80
    v_dot2_f32_bf16 v81, v20, s54, v81
    v_dot2_f32_bf16 v82, v21, s53, v82
    v_dot2_f32_bf16 v83, v21, s54, v83
    v_dot2_f32_bf16 v84, v22, s53, v84
    v_dot2_f32_bf16 v85, v22, s54, v85
    v_dot2_f32_bf16 v86, v23, s53, v86
    v_dot2_f32_bf16 v87, v23, s54, v87
    s_waitcnt vmcnt(21)
    v_dot2_f32_bf16 v80, v24, s53, v80
    v_dot2_f32_bf16 v81, v24, s54, v81
    v_dot2_f32_bf16 v82, v25, s53, v82
    v_dot2_f32_bf16 v83, v25, s54, v83
    v_dot2_f32_bf16 v84, v26, s53, v84
    v_dot2_f32_bf16 v85, v26, s54, v85
    v_dot2_f32_bf16 v86, v27, s53, v86
    v_dot2_f32_bf16 v87, v27, s54, v87
    s_waitcnt vmcnt(20)
    v_dot2_f32_bf16 v80, v28, s53, v80
    v_dot2_f32_bf16 v81, v28, s54, v81
    v_dot2_f32_bf16 v82, v29, s53, v82
    v_dot2_f32_bf16 v83, v29, s54, v83
    v_dot2_f32_bf16 v84, v30, s53, v84
    v_dot2_f32_bf16 v85, v30, s54, v85
    v_dot2_f32_bf16 v86, v31, s53, v86
    v_dot2_f32_bf16 v87, v31, s54, v87
    s_waitcnt vmcnt(19)
    v_dot2_f32_bf16 v80, v32, s53, v80
    v_dot2_f32_bf16 v81, v32, s54, v81
    v_dot2_f32_bf16 v82, v33, s53, v82
    v_dot2_f32_bf16 v83, v33, s54, v83
    v_dot2_f32_bf16 v84, v34, s53, v84
    v_dot2_f32_bf16 v85, v34, s54, v85
    v_dot2_f32_bf16 v86, v35, s53, v86
    v_dot2_f32_bf16 v87, v35, s54, v87
    s_waitcnt vmcnt(18)
    v_dot2_f32_bf16 v80, v36, s53, v80
    v_dot2_f32_bf16 v81, v36, s54, v81
    v_dot2_f32_bf16 v82, v37, s53, v82
    v_dot2_f32_bf16 v83, v37, s54, v83
    v_dot2_f32_bf16 v84, v38, s53, v84
    v_dot2_f32_bf16 v85, v38, s54, v85
    v_dot2_f32_bf16 v86, v39, s53, v86
    v_dot2_f32_bf16 v87, v39, s54, v87
    s_waitcnt vmcnt(17)
    v_dot2_f32_bf16 v80, v40, s53, v80
    v_dot2_f32_bf16 v81, v40, s54, v81
    v_dot2_f32_bf16 v82, v41, s53, v82
    v_dot2_f32_bf16 v83, v41, s54, v83
    v_dot2_f32_bf16 v84, v42, s53, v84
    v_dot2_f32_bf16 v85, v42, s54, v85
    v_dot2_f32_bf16 v86, v43, s53, v86
    v_dot2_f32_bf16 v87, v43, s54, v87
    s_waitcnt vmcnt(16)
    v_dot2_f32_bf16 v80, v44, s53, v80
    v_dot2_f32_bf16 v81, v44, s54, v81
    v_dot2_f32_bf16 v82, v45, s53, v82
    v_dot2_f32_bf16 v83, v45, s54, v83
    v_dot2_f32_bf16 v84, v46, s53, v84
    v_dot2_f32_bf16 v85, v46, s54, v85
    v_dot2_f32_bf16 v86, v47, s53, v86
    v_dot2_f32_bf16 v87, v47, s54, v87
    s_waitcnt vmcnt(15)
    v_dot2_f32_bf16 v80, v48, s53, v80
    v_dot2_f32_bf16 v81, v48, s54, v81
    v_dot2_f32_bf16 v82, v49, s53, v82
    v_dot2_f32_bf16 v83, v49, s54, v83
    v_dot2_f32_bf16 v84, v50, s53, v84
    v_dot2_f32_bf16 v85, v50, s54, v85
    v_dot2_f32_bf16 v86, v51, s53, v86
    v_dot2_f32_bf16 v87, v51, s54, v87
    s_waitcnt vmcnt(14)
    v_dot2_f32_bf16 v80, v52, s53, v80
    v_dot2_f32_bf16 v81, v52, s54, v81
    v_dot2_f32_bf16 v82, v53, s53, v82
    v_dot2_f32_bf16 v83, v53, s54, v83
    v_dot2_f32_bf16 v84, v54, s53, v84
    v_dot2_f32_bf16 v85, v54, s54, v85
    v_dot2_f32_bf16 v86, v55, s53, v86
    v_dot2_f32_bf16 v87, v55, s54, v87
    s_waitcnt vmcnt(13)
    v_dot2_f32_bf16 v80, v56, s53, v80
    v_dot2_f32_bf16 v81, v56, s54, v81
    v_dot2_f32_bf16 v82, v57, s53, v82
    v_dot2_f32_bf16 v83, v57, s54, v83
    v_dot2_f32_bf16 v84, v58, s53, v84
    v_dot2_f32_bf16 v85, v58, s54, v85
    v_dot2_f32_bf16 v86, v59, s53, v86
    v_dot2_f32_bf16 v87, v59, s54, v87
    s_waitcnt vmcnt(12)
    v_dot2_f32_bf16 v80, v60, s53, v80
    v_dot2_f32_bf16 v81, v60, s54, v81
    v_dot2_f32_bf16 v82, v61, s53, v82
    v_dot2_f32_bf16 v83, v61, s54, v83
    v_dot2_f32_bf16 v84, v62, s53, v84
    v_dot2_f32_bf16 v85, v62, s54, v85
    v_dot2_f32_bf16 v86, v63, s53, v86
    v_dot2_f32_bf16 v87, v63, s54, v87
    s_waitcnt vmcnt(11)
    v_dot2_f32_bf16 v160, v96, s53, v160
    v_dot2_f32_bf16 v161, v96, s54, v161
    v_dot2_f32_bf16 v162, v97, s53, v162
    v_dot2_f32_bf16 v163, v97, s54, v163
    v_dot2_f32_bf16 v164, v98, s53, v164
    v_dot2_f32_bf16 v165, v98, s54, v165
    v_dot2_f32_bf16 v166, v99, s53, v166
    v_dot2_f32_bf16 v167, v99, s54, v167
    s_waitcnt vmcnt(10)
    v_dot2_f32_bf16 v160, v100, s53, v160
    v_dot2_f32_bf16 v161, v100, s54, v161
    v_dot2_f32_bf16 v162, v101, s53, v162
    v_dot2_f32_bf16 v163, v101, s54, v163
    v_dot2_f32_bf16 v164, v102, s53, v164
    v_dot2_f32_bf16 v165, v102, s54, v165
    v_dot2_f32_bf16 v166, v103, s53, v166
    v_dot2_f32_bf16 v167, v103, s54, v167
    s_waitcnt vmcnt(9)
    v_dot2_f32_bf16 v160, v104, s53, v160
    v_dot2_f32_bf16 v161, v104, s54, v161
    v_dot2_f32_bf16 v162, v105, s53, v162
    v_dot2_f32_bf16 v163, v105, s54, v163
    v_dot2_f32_bf16 v164, v106, s53, v164
    v_dot2_f32_bf16 v165, v106, s54, v165
    v_dot2_f32_bf16 v166, v107, s53, v166
    v_dot2_f32_bf16 v167, v107, s54, v167
    s_waitcnt vmcnt(8)
    v_dot2_f32_bf16 v160, v108, s53, v160
    v_dot2_f32_bf16 v161, v108, s54, v161
    v_dot2_f32_bf16 v162, v109, s53, v162
    v_dot2_f32_bf16 v163, v109, s54, v163
    v_dot2_f32_bf16 v164, v110, s53, v164
    v_dot2_f32_bf16 v165, v110, s54, v165
    v_dot2_f32_bf16 v166, v111, s53, v166
    v_dot2_f32_bf16 v167, v111, s54, v167
    s_waitcnt vmcnt(7)
    v_dot2_f32_bf16 v160, v112, s53, v160
    v_dot2_f32_bf16 v161, v112, s54, v161
    v_dot2_f32_bf16 v162, v113, s53, v162
    v_dot2_f32_bf16 v163, v113, s54, v163
    v_dot2_f32_bf16 v164, v114, s53, v164
    v_dot2_f32_bf16 v165, v114, s54, v165
    v_dot2_f32_bf16 v166, v115, s53, v166
    v_dot2_f32_bf16 v167, v115, s54, v167
    s_waitcnt vmcnt(6)
    v_dot2_f32_bf16 v160, v116, s53, v160
    v_dot2_f32_bf16 v161, v116, s54, v161
    v_dot2_f32_bf16 v162, v117, s53, v162
    v_dot2_f32_bf16 v163, v117, s54, v163
    v_dot2_f32_bf16 v164, v118, s53, v164
    v_dot2_f32_bf16 v165, v118, s54, v165
    v_dot2_f32_bf16 v166, v119, s53, v166
    v_dot2_f32_bf16 v167, v119, s54, v167
    s_waitcnt vmcnt(5)
    v_dot2_f32_bf16 v160, v120, s53, v160
    v_dot2_f32_bf16 v161, v120, s54, v161
    v_dot2_f32_bf16 v162, v121, s53, v162
    v_dot2_f32_bf16 v163, v121, s54, v163
    v_dot2_f32_bf16 v164, v122, s53, v164
    v_dot2_f32_bf16 v165, v122, s54, v165
    v_dot2_f32_bf16 v166, v123, s53, v166
    v_dot2_f32_bf16 v167, v123, s54, v167
    s_waitcnt vmcnt(4)
    v_dot2_f32_bf16 v160, v124, s53, v160
    v_dot2_f32_bf16 v161, v124, s54, v161
    v_dot2_f32_bf16 v162, v125, s53, v162
    v_dot2_f32_bf16 v163, v125, s54, v163
    v_dot2_f32_bf16 v164, v126, s53, v164
    v_dot2_f32_bf16 v165, v126, s54, v165
    v_dot2_f32_bf16 v166, v127, s53, v166
    v_dot2_f32_bf16 v167, v127, s54, v167
    s_waitcnt vmcnt(3)
    v_dot2_f32_bf16 v160, v128, s53, v160
    v_dot2_f32_bf16 v161, v128, s54, v161
    v_dot2_f32_bf16 v162, v129, s53, v162
    v_dot2_f32_bf16 v163, v129, s54, v163
    v_dot2_f32_bf16 v164, v130, s53, v164
    v_dot2_f32_bf16 v165, v130, s54, v165
    v_dot2_f32_bf16 v166, v131, s53, v166
    v_dot2_f32_bf16 v167, v131, s54, v167
    s_waitcnt vmcnt(2)
    v_dot2_f32_bf16 v160, v132, s53, v160
    v_dot2_f32_bf16 v161, v132, s54, v161
    v_dot2_f32_bf16 v162, v133, s53, v162
    v_dot2_f32_bf16 v163, v133, s54, v163
    v_dot2_f32_bf16 v164, v134, s53, v164
    v_dot2_f32_bf16 v165, v134, s54, v165
    v_dot2_f32_bf16 v166, v135, s53, v166
    v_dot2_f32_bf16 v167, v135, s54, v167
    s_waitcnt vmcnt(1)
    v_dot2_f32_bf16 v160, v136, s53, v160
    v_dot2_f32_bf16 v161, v136, s54, v161
    v_dot2_f32_bf16 v162, v137, s53, v162
    v_dot2_f32_bf16 v163, v137, s54, v163
    v_dot2_f32_bf16 v164, v138, s53, v164
    v_dot2_f32_bf16 v165, v138, s54, v165
    v_dot2_f32_bf16 v166, v139, s53, v166
    v_dot2_f32_bf16 v167, v139, s54, v167
    s_waitcnt vmcnt(0)
    v_dot2_f32_bf16 v160, v140, s53, v160
    v_dot2_f32_bf16 v161, v140, s54, v161
    v_dot2_f32_bf16 v162, v141, s53, v162
    v_dot2_f32_bf16 v163, v141, s54, v163
    v_dot2_f32_bf16 v164, v142, s53, v164
    v_dot2_f32_bf16 v165, v142, s54, v165
    v_dot2_f32_bf16 v166, v143, s53, v166
    v_dot2_f32_bf16 v167, v143, s54, v167
    s_branch L_a_done_m0
L_a_one_m0:
    s_mov_b32 s49, 0
    buffer_load_dwordx4 v[16:19], v2, s[32:35], s49 offen sc1
    s_mov_b32 s49, 2359296
    buffer_load_dwordx4 v[20:23], v2, s[32:35], s49 offen sc1
    s_mov_b32 s49, 4718592
    buffer_load_dwordx4 v[24:27], v2, s[32:35], s49 offen sc1
    s_mov_b32 s49, 7077888
    buffer_load_dwordx4 v[28:31], v2, s[32:35], s49 offen sc1
    s_mov_b32 s49, 9437184
    buffer_load_dwordx4 v[32:35], v2, s[32:35], s49 offen sc1
    s_mov_b32 s49, 11796480
    buffer_load_dwordx4 v[36:39], v2, s[32:35], s49 offen sc1
    s_mov_b32 s49, 14155776
    buffer_load_dwordx4 v[40:43], v2, s[32:35], s49 offen sc1
    s_mov_b32 s49, 16515072
    buffer_load_dwordx4 v[44:47], v2, s[32:35], s49 offen sc1
    s_mov_b32 s49, 18874368
    buffer_load_dwordx4 v[48:51], v2, s[32:35], s49 offen sc1
    s_mov_b32 s49, 21233664
    buffer_load_dwordx4 v[52:55], v2, s[32:35], s49 offen sc1
    s_mov_b32 s49, 23592960
    buffer_load_dwordx4 v[56:59], v2, s[32:35], s49 offen sc1
    s_mov_b32 s49, 25952256
    buffer_load_dwordx4 v[60:63], v2, s[32:35], s49 offen sc1
    s_waitcnt vmcnt(11)
    v_dot2_f32_bf16 v80, v16, s53, v80
    v_dot2_f32_bf16 v81, v16, s54, v81
    v_dot2_f32_bf16 v82, v17, s53, v82
    v_dot2_f32_bf16 v83, v17, s54, v83
    v_dot2_f32_bf16 v84, v18, s53, v84
    v_dot2_f32_bf16 v85, v18, s54, v85
    v_dot2_f32_bf16 v86, v19, s53, v86
    v_dot2_f32_bf16 v87, v19, s54, v87
    s_waitcnt vmcnt(10)
    v_dot2_f32_bf16 v80, v20, s53, v80
    v_dot2_f32_bf16 v81, v20, s54, v81
    v_dot2_f32_bf16 v82, v21, s53, v82
    v_dot2_f32_bf16 v83, v21, s54, v83
    v_dot2_f32_bf16 v84, v22, s53, v84
    v_dot2_f32_bf16 v85, v22, s54, v85
    v_dot2_f32_bf16 v86, v23, s53, v86
    v_dot2_f32_bf16 v87, v23, s54, v87
    s_waitcnt vmcnt(9)
    v_dot2_f32_bf16 v80, v24, s53, v80
    v_dot2_f32_bf16 v81, v24, s54, v81
    v_dot2_f32_bf16 v82, v25, s53, v82
    v_dot2_f32_bf16 v83, v25, s54, v83
    v_dot2_f32_bf16 v84, v26, s53, v84
    v_dot2_f32_bf16 v85, v26, s54, v85
    v_dot2_f32_bf16 v86, v27, s53, v86
    v_dot2_f32_bf16 v87, v27, s54, v87
    s_waitcnt vmcnt(8)
    v_dot2_f32_bf16 v80, v28, s53, v80
    v_dot2_f32_bf16 v81, v28, s54, v81
    v_dot2_f32_bf16 v82, v29, s53, v82
    v_dot2_f32_bf16 v83, v29, s54, v83
    v_dot2_f32_bf16 v84, v30, s53, v84
    v_dot2_f32_bf16 v85, v30, s54, v85
    v_dot2_f32_bf16 v86, v31, s53, v86
    v_dot2_f32_bf16 v87, v31, s54, v87
    s_waitcnt vmcnt(7)
    v_dot2_f32_bf16 v80, v32, s53, v80
    v_dot2_f32_bf16 v81, v32, s54, v81
    v_dot2_f32_bf16 v82, v33, s53, v82
    v_dot2_f32_bf16 v83, v33, s54, v83
    v_dot2_f32_bf16 v84, v34, s53, v84
    v_dot2_f32_bf16 v85, v34, s54, v85
    v_dot2_f32_bf16 v86, v35, s53, v86
    v_dot2_f32_bf16 v87, v35, s54, v87
    s_waitcnt vmcnt(6)
    v_dot2_f32_bf16 v80, v36, s53, v80
    v_dot2_f32_bf16 v81, v36, s54, v81
    v_dot2_f32_bf16 v82, v37, s53, v82
    v_dot2_f32_bf16 v83, v37, s54, v83
    v_dot2_f32_bf16 v84, v38, s53, v84
    v_dot2_f32_bf16 v85, v38, s54, v85
    v_dot2_f32_bf16 v86, v39, s53, v86
    v_dot2_f32_bf16 v87, v39, s54, v87
    s_waitcnt vmcnt(5)
    v_dot2_f32_bf16 v80, v40, s53, v80
    v_dot2_f32_bf16 v81, v40, s54, v81
    v_dot2_f32_bf16 v82, v41, s53, v82
    v_dot2_f32_bf16 v83, v41, s54, v83
    v_dot2_f32_bf16 v84, v42, s53, v84
    v_dot2_f32_bf16 v85, v42, s54, v85
    v_dot2_f32_bf16 v86, v43, s53, v86
    v_dot2_f32_bf16 v87, v43, s54, v87
    s_waitcnt vmcnt(4)
    v_dot2_f32_bf16 v80, v44, s53, v80
    v_dot2_f32_bf16 v81, v44, s54, v81
    v_dot2_f32_bf16 v82, v45, s53, v82
    v_dot2_f32_bf16 v83, v45, s54, v83
    v_dot2_f32_bf16 v84, v46, s53, v84
    v_dot2_f32_bf16 v85, v46, s54, v85
    v_dot2_f32_bf16 v86, v47, s53, v86
    v_dot2_f32_bf16 v87, v47, s54, v87
    s_waitcnt vmcnt(3)
    v_dot2_f32_bf16 v80, v48, s53, v80
    v_dot2_f32_bf16 v81, v48, s54, v81
    v_dot2_f32_bf16 v82, v49, s53, v82
    v_dot2_f32_bf16 v83, v49, s54, v83
    v_dot2_f32_bf16 v84, v50, s53, v84
    v_dot2_f32_bf16 v85, v50, s54, v85
    v_dot2_f32_bf16 v86, v51, s53, v86
    v_dot2_f32_bf16 v87, v51, s54, v87
    s_waitcnt vmcnt(2)
    v_dot2_f32_bf16 v80, v52, s53, v80
    v_dot2_f32_bf16 v81, v52, s54, v81
    v_dot2_f32_bf16 v82, v53, s53, v82
    v_dot2_f32_bf16 v83, v53, s54, v83
    v_dot2_f32_bf16 v84, v54, s53, v84
    v_dot2_f32_bf16 v85, v54, s54, v85
    v_dot2_f32_bf16 v86, v55, s53, v86
    v_dot2_f32_bf16 v87, v55, s54, v87
    s_waitcnt vmcnt(1)
    v_dot2_f32_bf16 v80, v56, s53, v80
    v_dot2_f32_bf16 v81, v56, s54, v81
    v_dot2_f32_bf16 v82, v57, s53, v82
    v_dot2_f32_bf16 v83, v57, s54, v83
    v_dot2_f32_bf16 v84, v58, s53, v84
    v_dot2_f32_bf16 v85, v58, s54, v85
    v_dot2_f32_bf16 v86, v59, s53, v86
    v_dot2_f32_bf16 v87, v59, s54, v87
    s_waitcnt vmcnt(0)
    v_dot2_f32_bf16 v80, v60, s53, v80
    v_dot2_f32_bf16 v81, v60, s54, v81
    v_dot2_f32_bf16 v82, v61, s53, v82
    v_dot2_f32_bf16 v83, v61, s54, v83
    v_dot2_f32_bf16 v84, v62, s53, v84
    v_dot2_f32_bf16 v85, v62, s54, v85
    v_dot2_f32_bf16 v86, v63, s53, v86
    v_dot2_f32_bf16 v87, v63, s54, v87
L_a_done_m0:
    s_cmp_lg_u32 s40, 0
    s_cbranch_scc1 L_pb_go_m0
    s_mov_b32 s47, 0
L_pb_poll_m0:
    buffer_load_dword v5, v6, s[36:39], 0 offen sc1
    s_waitcnt vmcnt(0)
    v_cmp_eq_u32 vcc, s58, v5
    s_add_u32 s47, s47, 1
    s_nop 3
    s_and_b32 s46, vcc_lo, 0xf000
    s_cmp_eq_u32 s46, 0xf000
    s_cbranch_scc1 L_pb_go_m0
    s_cmp_ge_u32 s47, 200000
    s_cbranch_scc1 L_pb_go_m0
    s_sleep 8
    s_branch L_pb_poll_m0
L_pb_go_m0:
    s_barrier
    s_cmp_ge_u32 s40, 4
    s_cbranch_scc1 L_b_one_m0
    s_mov_b32 s49, 28311552
    buffer_load_dwordx4 v[176:179], v2, s[32:35], s49 offen sc1
    s_mov_b32 s49, 30670848
    buffer_load_dwordx4 v[180:183], v2, s[32:35], s49 offen sc1
    s_mov_b32 s49, 33030144
    buffer_load_dwordx4 v[184:187], v2, s[32:35], s49 offen sc1
    s_mov_b32 s49, 35389440
    buffer_load_dwordx4 v[188:191], v2, s[32:35], s49 offen sc1
    s_mov_b32 s49, 28311552
    buffer_load_dwordx4 v[192:195], v7, s[32:35], s49 offen sc1
    s_mov_b32 s49, 30670848
    buffer_load_dwordx4 v[196:199], v7, s[32:35], s49 offen sc1
    s_mov_b32 s49, 33030144
    buffer_load_dwordx4 v[200:203], v7, s[32:35], s49 offen sc1
    s_mov_b32 s49, 35389440
    buffer_load_dwordx4 v[204:207], v7, s[32:35], s49 offen sc1
    s_waitcnt vmcnt(7)
    v_dot2_f32_bf16 v80, v176, s53, v80
    v_dot2_f32_bf16 v81, v176, s54, v81
    v_dot2_f32_bf16 v82, v177, s53, v82
    v_dot2_f32_bf16 v83, v177, s54, v83
    v_dot2_f32_bf16 v84, v178, s53, v84
    v_dot2_f32_bf16 v85, v178, s54, v85
    v_dot2_f32_bf16 v86, v179, s53, v86
    v_dot2_f32_bf16 v87, v179, s54, v87
    s_waitcnt vmcnt(6)
    v_dot2_f32_bf16 v80, v180, s53, v80
    v_dot2_f32_bf16 v81, v180, s54, v81
    v_dot2_f32_bf16 v82, v181, s53, v82
    v_dot2_f32_bf16 v83, v181, s54, v83
    v_dot2_f32_bf16 v84, v182, s53, v84
    v_dot2_f32_bf16 v85, v182, s54, v85
    v_dot2_f32_bf16 v86, v183, s53, v86
    v_dot2_f32_bf16 v87, v183, s54, v87
    s_waitcnt vmcnt(5)
    v_dot2_f32_bf16 v80, v184, s53, v80
    v_dot2_f32_bf16 v81, v184, s54, v81
    v_dot2_f32_bf16 v82, v185, s53, v82
    v_dot2_f32_bf16 v83, v185, s54, v83
    v_dot2_f32_bf16 v84, v186, s53, v84
    v_dot2_f32_bf16 v85, v186, s54, v85
    v_dot2_f32_bf16 v86, v187, s53, v86
    v_dot2_f32_bf16 v87, v187, s54, v87
    s_waitcnt vmcnt(4)
    v_dot2_f32_bf16 v80, v188, s53, v80
    v_dot2_f32_bf16 v81, v188, s54, v81
    v_dot2_f32_bf16 v82, v189, s53, v82
    v_dot2_f32_bf16 v83, v189, s54, v83
    v_dot2_f32_bf16 v84, v190, s53, v84
    v_dot2_f32_bf16 v85, v190, s54, v85
    v_dot2_f32_bf16 v86, v191, s53, v86
    v_dot2_f32_bf16 v87, v191, s54, v87
    s_waitcnt vmcnt(3)
    v_dot2_f32_bf16 v160, v192, s53, v160
    v_dot2_f32_bf16 v161, v192, s54, v161
    v_dot2_f32_bf16 v162, v193, s53, v162
    v_dot2_f32_bf16 v163, v193, s54, v163
    v_dot2_f32_bf16 v164, v194, s53, v164
    v_dot2_f32_bf16 v165, v194, s54, v165
    v_dot2_f32_bf16 v166, v195, s53, v166
    v_dot2_f32_bf16 v167, v195, s54, v167
    s_waitcnt vmcnt(2)
    v_dot2_f32_bf16 v160, v196, s53, v160
    v_dot2_f32_bf16 v161, v196, s54, v161
    v_dot2_f32_bf16 v162, v197, s53, v162
    v_dot2_f32_bf16 v163, v197, s54, v163
    v_dot2_f32_bf16 v164, v198, s53, v164
    v_dot2_f32_bf16 v165, v198, s54, v165
    v_dot2_f32_bf16 v166, v199, s53, v166
    v_dot2_f32_bf16 v167, v199, s54, v167
    s_waitcnt vmcnt(1)
    v_dot2_f32_bf16 v160, v200, s53, v160
    v_dot2_f32_bf16 v161, v200, s54, v161
    v_dot2_f32_bf16 v162, v201, s53, v162
    v_dot2_f32_bf16 v163, v201, s54, v163
    v_dot2_f32_bf16 v164, v202, s53, v164
    v_dot2_f32_bf16 v165, v202, s54, v165
    v_dot2_f32_bf16 v166, v203, s53, v166
    v_dot2_f32_bf16 v167, v203, s54, v167
    s_waitcnt vmcnt(0)
    v_dot2_f32_bf16 v160, v204, s53, v160
    v_dot2_f32_bf16 v161, v204, s54, v161
    v_dot2_f32_bf16 v162, v205, s53, v162
    v_dot2_f32_bf16 v163, v205, s54, v163
    v_dot2_f32_bf16 v164, v206, s53, v164
    v_dot2_f32_bf16 v165, v206, s54, v165
    v_dot2_f32_bf16 v166, v207, s53, v166
    v_dot2_f32_bf16 v167, v207, s54, v167
    s_nop 2
    v_permlane32_swap_b32 v80, v84
    v_permlane32_swap_b32 v81, v85
    v_permlane32_swap_b32 v82, v86
    v_permlane32_swap_b32 v83, v87
    s_nop 1
    v_lshlrev_b32 v4, 16, v8
    v_and_b32 v5, 0xffff0000, v8
    v_add_f32 v80, v80, v4
    v_add_f32 v81, v81, v5
    v_lshlrev_b32 v4, 16, v9
    v_and_b32 v5, 0xffff0000, v9
    v_add_f32 v82, v82, v4
    v_add_f32 v83, v83, v5
    v_lshlrev_b32 v4, 16, v10
    v_and_b32 v5, 0xffff0000, v10
    v_add_f32 v84, v84, v4
    v_add_f32 v85, v85, v5
    v_lshlrev_b32 v4, 16, v11
    v_and_b32 v5, 0xffff0000, v11
    v_add_f32 v86, v86, v4
    v_add_f32 v87, v87, v5
    v_cvt_pk_bf16_f32 v8, v80, v81
    v_cvt_pk_bf16_f32 v9, v82, v83
    v_cvt_pk_bf16_f32 v10, v84, v85
    v_cvt_pk_bf16_f32 v11, v86, v87
    buffer_store_dwordx4 v[8:11], v3, s[28:31], 0 offen
    s_nop 2
    v_permlane32_swap_b32 v160, v164
    v_permlane32_swap_b32 v161, v165
    v_permlane32_swap_b32 v162, v166
    v_permlane32_swap_b32 v163, v167
    s_nop 1
    v_lshlrev_b32 v4, 16, v12
    v_and_b32 v5, 0xffff0000, v12
    v_add_f32 v160, v160, v4
    v_add_f32 v161, v161, v5
    v_lshlrev_b32 v4, 16, v13
    v_and_b32 v5, 0xffff0000, v13
    v_add_f32 v162, v162, v4
    v_add_f32 v163, v163, v5
    v_lshlrev_b32 v4, 16, v14
    v_and_b32 v5, 0xffff0000, v14
    v_add_f32 v164, v164, v4
    v_add_f32 v165, v165, v5
    v_lshlrev_b32 v4, 16, v15
    v_and_b32 v5, 0xffff0000, v15
    v_add_f32 v166, v166, v4
    v_add_f32 v167, v167, v5
    v_cvt_pk_bf16_f32 v12, v160, v161
    v_cvt_pk_bf16_f32 v13, v162, v163
    v_cvt_pk_bf16_f32 v14, v164, v165
    v_cvt_pk_bf16_f32 v15, v166, v167
    buffer_store_dwordx4 v[12:15], v240, s[28:31], 0 offen
    s_branch L_b_done_m0
L_b_one_m0:
    s_mov_b32 s49, 28311552
    buffer_load_dwordx4 v[176:179], v2, s[32:35], s49 offen sc1
    s_mov_b32 s49, 30670848
    buffer_load_dwordx4 v[180:183], v2, s[32:35], s49 offen sc1
    s_mov_b32 s49, 33030144
    buffer_load_dwordx4 v[184:187], v2, s[32:35], s49 offen sc1
    s_mov_b32 s49, 35389440
    buffer_load_dwordx4 v[188:191], v2, s[32:35], s49 offen sc1
    s_waitcnt vmcnt(3)
    v_dot2_f32_bf16 v80, v176, s53, v80
    v_dot2_f32_bf16 v81, v176, s54, v81
    v_dot2_f32_bf16 v82, v177, s53, v82
    v_dot2_f32_bf16 v83, v177, s54, v83
    v_dot2_f32_bf16 v84, v178, s53, v84
    v_dot2_f32_bf16 v85, v178, s54, v85
    v_dot2_f32_bf16 v86, v179, s53, v86
    v_dot2_f32_bf16 v87, v179, s54, v87
    s_waitcnt vmcnt(2)
    v_dot2_f32_bf16 v80, v180, s53, v80
    v_dot2_f32_bf16 v81, v180, s54, v81
    v_dot2_f32_bf16 v82, v181, s53, v82
    v_dot2_f32_bf16 v83, v181, s54, v83
    v_dot2_f32_bf16 v84, v182, s53, v84
    v_dot2_f32_bf16 v85, v182, s54, v85
    v_dot2_f32_bf16 v86, v183, s53, v86
    v_dot2_f32_bf16 v87, v183, s54, v87
    s_waitcnt vmcnt(1)
    v_dot2_f32_bf16 v80, v184, s53, v80
    v_dot2_f32_bf16 v81, v184, s54, v81
    v_dot2_f32_bf16 v82, v185, s53, v82
    v_dot2_f32_bf16 v83, v185, s54, v83
    v_dot2_f32_bf16 v84, v186, s53, v84
    v_dot2_f32_bf16 v85, v186, s54, v85
    v_dot2_f32_bf16 v86, v187, s53, v86
    v_dot2_f32_bf16 v87, v187, s54, v87
    s_waitcnt vmcnt(0)
    v_dot2_f32_bf16 v80, v188, s53, v80
    v_dot2_f32_bf16 v81, v188, s54, v81
    v_dot2_f32_bf16 v82, v189, s53, v82
    v_dot2_f32_bf16 v83, v189, s54, v83
    v_dot2_f32_bf16 v84, v190, s53, v84
    v_dot2_f32_bf16 v85, v190, s54, v85
    v_dot2_f32_bf16 v86, v191, s53, v86
    v_dot2_f32_bf16 v87, v191, s54, v87
    s_nop 2
    v_permlane32_swap_b32 v80, v84
    v_permlane32_swap_b32 v81, v85
    v_permlane32_swap_b32 v82, v86
    v_permlane32_swap_b32 v83, v87
    s_nop 1
    v_lshlrev_b32 v4, 16, v8
    v_and_b32 v5, 0xffff0000, v8
    v_add_f32 v80, v80, v4
    v_add_f32 v81, v81, v5
    v_lshlrev_b32 v4, 16, v9
    v_and_b32 v5, 0xffff0000, v9
    v_add_f32 v82, v82, v4
    v_add_f32 v83, v83, v5
    v_lshlrev_b32 v4, 16, v10
    v_and_b32 v5, 0xffff0000, v10
    v_add_f32 v84, v84, v4
    v_add_f32 v85, v85, v5
    v_lshlrev_b32 v4, 16, v11
    v_and_b32 v5, 0xffff0000, v11
    v_add_f32 v86, v86, v4
    v_add_f32 v87, v87, v5
    v_cvt_pk_bf16_f32 v8, v80, v81
    v_cvt_pk_bf16_f32 v9, v82, v83
    v_cvt_pk_bf16_f32 v10, v84, v85
    v_cvt_pk_bf16_f32 v11, v86, v87
    buffer_store_dwordx4 v[8:11], v3, s[28:31], 0 offen
L_b_done_m0:
    s_endpgm
L_mlp1:
    v_and_b32 v250, 63, v0
    s_lshl_b32 s46, s44, 7
    s_lshl_b32 s47, s40, 4
    s_add_u32 s46, s46, s47
    s_mul_i32 s46, s46, 1152
    v_lshrrev_b32 v251, 3, v250
    v_mul_u32_u24 v252, 1152, v251
    v_add_u32 v252, s46, v252
    v_lshrrev_b32 v253, 4, v250
    v_and_b32 v254, 7, v250
    v_xor_b32 v244, v254, v253
    v_lshl_add_u32 v244, v244, 4, v252
    v_add_u32 v253, 4, v253
    v_xor_b32 v245, v254, v253
    v_lshl_add_u32 v245, v245, 4, v252
    v_add_u32 v245, 9216, v245
    s_lshl_b32 s52, s40, 11
    s_add_u32 s52, s52, 65536
    s_add_u32 m0, s52, 0
    s_movk_i32 s49, 0
    buffer_load_dwordx4 v244, s[24:27], s49 offen lds
    s_add_u32 m0, s52, 1024
    s_movk_i32 s49, 0
    buffer_load_dwordx4 v245, s[24:27], s49 offen lds
    s_add_u32 m0, s52, 16384
    s_movk_i32 s49, 128
    buffer_load_dwordx4 v244, s[24:27], s49 offen lds
    s_add_u32 m0, s52, 17408
    s_movk_i32 s49, 128
    buffer_load_dwordx4 v245, s[24:27], s49 offen lds
    s_add_u32 m0, s52, 32768
    s_movk_i32 s49, 256
    buffer_load_dwordx4 v244, s[24:27], s49 offen lds
    s_add_u32 m0, s52, 33792
    s_movk_i32 s49, 256
    buffer_load_dwordx4 v245, s[24:27], s49 offen lds
    s_mul_i32 s46, s43, 768
    s_add_u32 s28, s12, s46
    s_addc_u32 s29, s13, 0
    s_and_b32 s29, s29, 0xffff
    s_sub_u32 s30, 0x510000, s46
    s_mov_b32 s31, 0x20000
    s_lshl_b32 s46, s40, 3
    v_add_u32 v251, s46, v251
    v_lshrrev_b32 v253, 2, v250
    v_and_b32 v253, 4, v253
    v_xor_b32 v253, v254, v253
    v_lshlrev_b32 v253, 4, v253
    v_mul_u32_u24 v224, 9216, v251
    v_add_u32 v224, v224, v253
    v_mul_u32_u24 v225, 1152, v251
    v_add_u32 v225, v225, v253
    s_lshl_b32 s45, s40, 10
    s_add_u32 m0, s52, 49152
    s_movk_i32 s49, 384
    buffer_load_dwordx4 v244, s[24:27], s49 offen lds
    s_add_u32 m0, s52, 50176
    s_movk_i32 s49, 384
    buffer_load_dwordx4 v245, s[24:27], s49 offen lds
    s_add_u32 m0, s52, 65536
    s_movk_i32 s49, 512
    buffer_load_dwordx4 v244, s[24:27], s49 offen lds
    s_add_u32 m0, s52, 66560
    s_movk_i32 s49, 512
    buffer_load_dwordx4 v245, s[24:27], s49 offen lds
    s_add_u32 m0, s52, 81920
    s_movk_i32 s49, 640
    buffer_load_dwordx4 v244, s[24:27], s49 offen lds
    s_add_u32 m0, s52, 82944
    s_movk_i32 s49, 640
    buffer_load_dwordx4 v245, s[24:27], s49 offen lds
    s_mul_i32 s46, s43, 442368
    s_add_u32 s32, s14, s46
    s_addc_u32 s33, s15, 0
    s_and_b32 s33, s33, 0xffff
    s_sub_u32 s34, 0x510000, s46
    s_mov_b32 s35, 0x20000
    s_mul_i32 s46, s43, 2359296
    s_mul_i32 s47, s44, 147456
    s_add_u32 s46, s46, s47
    s_add_u32 s36, s20, s46
    s_addc_u32 s37, s21, 0
    s_and_b32 s37, s37, 0xffff
    s_sub_u32 s38, 0x2400000, s46
    s_mov_b32 s39, 0x20000
    v_lshrrev_b32 v252, 5, v250
    v_lshrrev_b32 v251, 2, v250
    v_and_b32 v251, 3, v251
    v_lshrrev_b32 v253, 4, v250
    v_and_b32 v253, 1, v253
    v_lshlrev_b32 v253, 1, v253
    v_lshrrev_b32 v254, 1, v250
    v_and_b32 v254, 1, v254
    v_add_u32 v253, v253, v254
    v_add_u32 v253, 4, v253
    v_lshrrev_b32 v254, 1, v251
    v_lshlrev_b32 v254, 2, v254
    v_xor_b32 v253, v253, v254
    v_lshlrev_b32 v253, 4, v253
    v_and_b32 v254, 1, v250
    v_lshlrev_b32 v254, 3, v254
    v_add_u32 v253, v253, v254
    v_lshlrev_b32 v254, 2, v252
    v_add_u32 v254, v254, v251
    v_lshlrev_b32 v254, 7, v254
    v_add_u32 v227, v254, v253
    v_lshlrev_b32 v254, 3, v252
    v_add_u32 v254, v254, v251
    v_lshlrev_b32 v254, 7, v254
    v_add_u32 v226, v254, v253
    v_and_b32 v251, 31, v250
    s_lshl_b32 s46, s41, 5
    v_add_u32 v251, s46, v251
    v_lshrrev_b32 v253, 1, v250
    v_and_b32 v253, 7, v253
    v_xor_b32 v253, v253, v252
    v_lshlrev_b32 v253, 4, v253
    v_lshl_add_u32 v253, v251, 7, v253
    v_add_u32 v240, 65536, v253
    v_xor_b32 v241, 32, v240
    v_xor_b32 v242, 64, v240
    v_xor_b32 v243, 96, v240
    s_mul_i32 s46, s41, 24576
    s_add_u32 s46, s46, 65536
    s_mov_b32 s56, s46
    v_lshlrev_b32 v254, 4, v250
    v_add_u32 v229, s46, v254
    v_add_u32 v228, 2048, v229
    s_mul_i32 s46, s41, 18
    s_add_u32 s46, s46, 1
    s_lshl_b32 s46, s46, 11
    v_add_u32 v230, s46, v254
    v_and_b32 v251, 31, v250
    s_lshl_b32 s46, s40, 8
    s_add_u32 s46, s46, 57344
    v_lshl_add_u32 v255, v251, 3, s46
    v_mov_b32 v246, 0
    v_mov_b32 v248, 0
    v_mov_b32 v247, 0
    v_mov_b32 v249, 0
    s_waitcnt vmcnt(6)
    s_barrier
    ds_read_b128 v[8:11], v242 offset:0
    ds_read_b128 v[12:15], v243 offset:0
    ds_read_b128 v[24:27], v242 offset:16384
    ds_read_b128 v[28:31], v243 offset:16384
    ds_read_b128 v[40:43], v242 offset:32768
    ds_read_b128 v[44:47], v243 offset:32768
    ds_read_b128 v[0:3], v240 offset:0
    ds_read_b128 v[4:7], v241 offset:0
    ds_read_b128 v[16:19], v240 offset:16384
    ds_read_b128 v[20:23], v241 offset:16384
    ds_read_b128 v[32:35], v240 offset:32768
    ds_read_b128 v[36:39], v241 offset:32768
    s_waitcnt lgkmcnt(11)
    v_dot2_f32_bf16 v246, v8, s50, v246
    v_dot2_f32_bf16 v248, v8, v8, v248
    v_dot2_f32_bf16 v247, v9, s50, v247
    v_dot2_f32_bf16 v249, v9, v9, v249
    v_dot2_f32_bf16 v246, v10, s50, v246
    v_dot2_f32_bf16 v248, v10, v10, v248
    v_dot2_f32_bf16 v247, v11, s50, v247
    v_dot2_f32_bf16 v249, v11, v11, v249
    s_waitcnt lgkmcnt(10)
    v_dot2_f32_bf16 v246, v12, s50, v246
    v_dot2_f32_bf16 v248, v12, v12, v248
    v_dot2_f32_bf16 v247, v13, s50, v247
    v_dot2_f32_bf16 v249, v13, v13, v249
    v_dot2_f32_bf16 v246, v14, s50, v246
    v_dot2_f32_bf16 v248, v14, v14, v248
    v_dot2_f32_bf16 v247, v15, s50, v247
    v_dot2_f32_bf16 v249, v15, v15, v249
    s_waitcnt lgkmcnt(9)
    v_dot2_f32_bf16 v246, v24, s50, v246
    v_dot2_f32_bf16 v248, v24, v24, v248
    v_dot2_f32_bf16 v247, v25, s50, v247
    v_dot2_f32_bf16 v249, v25, v25, v249
    v_dot2_f32_bf16 v246, v26, s50, v246
    v_dot2_f32_bf16 v248, v26, v26, v248
    v_dot2_f32_bf16 v247, v27, s50, v247
    v_dot2_f32_bf16 v249, v27, v27, v249
    s_waitcnt lgkmcnt(8)
    v_dot2_f32_bf16 v246, v28, s50, v246
    v_dot2_f32_bf16 v248, v28, v28, v248
    v_dot2_f32_bf16 v247, v29, s50, v247
    v_dot2_f32_bf16 v249, v29, v29, v249
    v_dot2_f32_bf16 v246, v30, s50, v246
    v_dot2_f32_bf16 v248, v30, v30, v248
    v_dot2_f32_bf16 v247, v31, s50, v247
    v_dot2_f32_bf16 v249, v31, v31, v249
    s_waitcnt lgkmcnt(7)
    v_dot2_f32_bf16 v246, v40, s50, v246
    v_dot2_f32_bf16 v248, v40, v40, v248
    v_dot2_f32_bf16 v247, v41, s50, v247
    v_dot2_f32_bf16 v249, v41, v41, v249
    v_dot2_f32_bf16 v246, v42, s50, v246
    v_dot2_f32_bf16 v248, v42, v42, v248
    v_dot2_f32_bf16 v247, v43, s50, v247
    v_dot2_f32_bf16 v249, v43, v43, v249
    s_waitcnt lgkmcnt(6)
    v_dot2_f32_bf16 v246, v44, s50, v246
    v_dot2_f32_bf16 v248, v44, v44, v248
    v_dot2_f32_bf16 v247, v45, s50, v247
    v_dot2_f32_bf16 v249, v45, v45, v249
    v_dot2_f32_bf16 v246, v46, s50, v246
    v_dot2_f32_bf16 v248, v46, v46, v248
    v_dot2_f32_bf16 v247, v47, s50, v247
    v_dot2_f32_bf16 v249, v47, v47, v249
    s_waitcnt lgkmcnt(0)
    s_waitcnt vmcnt(0)
    s_barrier
    s_add_u32 m0, s52, 0
    s_movk_i32 s49, 768
    buffer_load_dwordx4 v244, s[24:27], s49 offen lds
    s_add_u32 m0, s52, 1024
    s_movk_i32 s49, 768
    buffer_load_dwordx4 v245, s[24:27], s49 offen lds
    s_add_u32 m0, s52, 16384
    s_movk_i32 s49, 896
    buffer_load_dwordx4 v244, s[24:27], s49 offen lds
    s_add_u32 m0, s52, 17408
    s_movk_i32 s49, 896
    buffer_load_dwordx4 v245, s[24:27], s49 offen lds
    s_add_u32 m0, s52, 32768
    s_movk_i32 s49, 1024
    buffer_load_dwordx4 v244, s[24:27], s49 offen lds
    s_add_u32 m0, s52, 33792
    s_movk_i32 s49, 1024
    buffer_load_dwordx4 v245, s[24:27], s49 offen lds
    s_add_u32 m0, s45, 0
    s_mov_b32 s49, 0
    buffer_load_dwordx4 v224, s[28:31], s49 offen lds
    s_add_u32 m0, s45, 8192
    s_mov_b32 s49, 589824
    buffer_load_dwordx4 v224, s[28:31], s49 offen lds
    ds_read_b128 v[56:59], v242 offset:49152
    ds_read_b128 v[60:63], v243 offset:49152
    v_add_u32 v218, 0x10000, v242
    ds_read_b128 v[72:75], v218 offset:0
    v_add_u32 v219, 0x10000, v243
    ds_read_b128 v[76:79], v219 offset:0
    v_add_u32 v218, 0x10000, v242
    ds_read_b128 v[88:91], v218 offset:16384
    v_add_u32 v219, 0x10000, v243
    ds_read_b128 v[92:95], v219 offset:16384
    ds_read_b128 v[48:51], v240 offset:49152
    ds_read_b128 v[52:55], v241 offset:49152
    v_add_u32 v216, 0x10000, v240
    ds_read_b128 v[64:67], v216 offset:0
    v_add_u32 v217, 0x10000, v241
    ds_read_b128 v[68:71], v217 offset:0
    v_add_u32 v216, 0x10000, v240
    ds_read_b128 v[80:83], v216 offset:16384
    v_add_u32 v217, 0x10000, v241
    ds_read_b128 v[84:87], v217 offset:16384
    s_waitcnt lgkmcnt(11)
    v_dot2_f32_bf16 v246, v56, s50, v246
    v_dot2_f32_bf16 v248, v56, v56, v248
    v_dot2_f32_bf16 v247, v57, s50, v247
    v_dot2_f32_bf16 v249, v57, v57, v249
    v_dot2_f32_bf16 v246, v58, s50, v246
    v_dot2_f32_bf16 v248, v58, v58, v248
    v_dot2_f32_bf16 v247, v59, s50, v247
    v_dot2_f32_bf16 v249, v59, v59, v249
    s_waitcnt lgkmcnt(10)
    v_dot2_f32_bf16 v246, v60, s50, v246
    v_dot2_f32_bf16 v248, v60, v60, v248
    v_dot2_f32_bf16 v247, v61, s50, v247
    v_dot2_f32_bf16 v249, v61, v61, v249
    v_dot2_f32_bf16 v246, v62, s50, v246
    v_dot2_f32_bf16 v248, v62, v62, v248
    v_dot2_f32_bf16 v247, v63, s50, v247
    v_dot2_f32_bf16 v249, v63, v63, v249
    s_waitcnt lgkmcnt(9)
    v_dot2_f32_bf16 v246, v72, s50, v246
    v_dot2_f32_bf16 v248, v72, v72, v248
    v_dot2_f32_bf16 v247, v73, s50, v247
    v_dot2_f32_bf16 v249, v73, v73, v249
    v_dot2_f32_bf16 v246, v74, s50, v246
    v_dot2_f32_bf16 v248, v74, v74, v248
    v_dot2_f32_bf16 v247, v75, s50, v247
    v_dot2_f32_bf16 v249, v75, v75, v249
    s_waitcnt lgkmcnt(8)
    v_dot2_f32_bf16 v246, v76, s50, v246
    v_dot2_f32_bf16 v248, v76, v76, v248
    v_dot2_f32_bf16 v247, v77, s50, v247
    v_dot2_f32_bf16 v249, v77, v77, v249
    v_dot2_f32_bf16 v246, v78, s50, v246
    v_dot2_f32_bf16 v248, v78, v78, v248
    v_dot2_f32_bf16 v247, v79, s50, v247
    v_dot2_f32_bf16 v249, v79, v79, v249
    s_waitcnt lgkmcnt(7)
    v_dot2_f32_bf16 v246, v88, s50, v246
    v_dot2_f32_bf16 v248, v88, v88, v248
    v_dot2_f32_bf16 v247, v89, s50, v247
    v_dot2_f32_bf16 v249, v89, v89, v249
    v_dot2_f32_bf16 v246, v90, s50, v246
    v_dot2_f32_bf16 v248, v90, v90, v248
    v_dot2_f32_bf16 v247, v91, s50, v247
    v_dot2_f32_bf16 v249, v91, v91, v249
    s_waitcnt lgkmcnt(6)
    v_dot2_f32_bf16 v246, v92, s50, v246
    v_dot2_f32_bf16 v248, v92, v92, v248
    v_dot2_f32_bf16 v247, v93, s50, v247
    v_dot2_f32_bf16 v249, v93, v93, v249
    v_dot2_f32_bf16 v246, v94, s50, v246
    v_dot2_f32_bf16 v248, v94, v94, v248
    v_dot2_f32_bf16 v247, v95, s50, v247
    v_dot2_f32_bf16 v249, v95, v95, v249
    s_waitcnt lgkmcnt(0)
    s_waitcnt vmcnt(2)
    s_barrier
    ds_read_b128 v[104:107], v242 offset:0
    ds_read_b128 v[108:111], v243 offset:0
    ds_read_b128 v[120:123], v242 offset:16384
    ds_read_b128 v[124:127], v243 offset:16384
    ds_read_b128 v[136:139], v242 offset:32768
    ds_read_b128 v[140:143], v243 offset:32768
    ds_read_b128 v[96:99], v240 offset:0
    ds_read_b128 v[100:103], v241 offset:0
    ds_read_b128 v[112:115], v240 offset:16384
    ds_read_b128 v[116:119], v241 offset:16384
    ds_read_b128 v[128:131], v240 offset:32768
    ds_read_b128 v[132:135], v241 offset:32768
    s_waitcnt lgkmcnt(11)
    v_dot2_f32_bf16 v246, v104, s50, v246
    v_dot2_f32_bf16 v248, v104, v104, v248
    v_dot2_f32_bf16 v247, v105, s50, v247
    v_dot2_f32_bf16 v249, v105, v105, v249
    v_dot2_f32_bf16 v246, v106, s50, v246
    v_dot2_f32_bf16 v248, v106, v106, v248
    v_dot2_f32_bf16 v247, v107, s50, v247
    v_dot2_f32_bf16 v249, v107, v107, v249
    s_waitcnt lgkmcnt(10)
    v_dot2_f32_bf16 v246, v108, s50, v246
    v_dot2_f32_bf16 v248, v108, v108, v248
    v_dot2_f32_bf16 v247, v109, s50, v247
    v_dot2_f32_bf16 v249, v109, v109, v249
    v_dot2_f32_bf16 v246, v110, s50, v246
    v_dot2_f32_bf16 v248, v110, v110, v248
    v_dot2_f32_bf16 v247, v111, s50, v247
    v_dot2_f32_bf16 v249, v111, v111, v249
    s_waitcnt lgkmcnt(9)
    v_dot2_f32_bf16 v246, v120, s50, v246
    v_dot2_f32_bf16 v248, v120, v120, v248
    v_dot2_f32_bf16 v247, v121, s50, v247
    v_dot2_f32_bf16 v249, v121, v121, v249
    v_dot2_f32_bf16 v246, v122, s50, v246
    v_dot2_f32_bf16 v248, v122, v122, v248
    v_dot2_f32_bf16 v247, v123, s50, v247
    v_dot2_f32_bf16 v249, v123, v123, v249
    s_waitcnt lgkmcnt(8)
    v_dot2_f32_bf16 v246, v124, s50, v246
    v_dot2_f32_bf16 v248, v124, v124, v248
    v_dot2_f32_bf16 v247, v125, s50, v247
    v_dot2_f32_bf16 v249, v125, v125, v249
    v_dot2_f32_bf16 v246, v126, s50, v246
    v_dot2_f32_bf16 v248, v126, v126, v248
    v_dot2_f32_bf16 v247, v127, s50, v247
    v_dot2_f32_bf16 v249, v127, v127, v249
    s_waitcnt lgkmcnt(7)
    v_dot2_f32_bf16 v246, v136, s50, v246
    v_dot2_f32_bf16 v248, v136, v136, v248
    v_dot2_f32_bf16 v247, v137, s50, v247
    v_dot2_f32_bf16 v249, v137, v137, v249
    v_dot2_f32_bf16 v246, v138, s50, v246
    v_dot2_f32_bf16 v248, v138, v138, v248
    v_dot2_f32_bf16 v247, v139, s50, v247
    v_dot2_f32_bf16 v249, v139, v139, v249
    s_waitcnt lgkmcnt(6)
    v_dot2_f32_bf16 v246, v140, s50, v246
    v_dot2_f32_bf16 v248, v140, v140, v248
    v_dot2_f32_bf16 v247, v141, s50, v247
    v_dot2_f32_bf16 v249, v141, v141, v249
    v_dot2_f32_bf16 v246, v142, s50, v246
    v_dot2_f32_bf16 v248, v142, v142, v248
    v_dot2_f32_bf16 v247, v143, s50, v247
    v_dot2_f32_bf16 v249, v143, v143, v249
    s_waitcnt lgkmcnt(0)
    s_add_u32 m0, s45, 16384
    s_mov_b32 s49, 1179648
    buffer_load_dwordx4 v224, s[28:31], s49 offen lds
    s_add_u32 m0, s45, 24576
    s_mov_b32 s49, 1769472
    buffer_load_dwordx4 v224, s[28:31], s49 offen lds
    s_add_u32 m0, s45, 32768
    s_mov_b32 s49, 2359296
    buffer_load_dwordx4 v224, s[28:31], s49 offen lds
    s_add_u32 m0, s45, 40960
    s_mov_b32 s49, 2949120
    buffer_load_dwordx4 v224, s[28:31], s49 offen lds
    s_add_u32 m0, s45, 49152
    s_mov_b32 s49, 3538944
    buffer_load_dwordx4 v224, s[28:31], s49 offen lds
    s_and_b32 s46, s44, 7
    s_lshl_b32 s46, s46, 3
    s_add_u32 s46, s46, s40
    s_mul_i32 s46, s46, 6912
    v_lshl_add_u32 v251, v250, 7, s46
    v_mov_b32 v253, 0x7fffff00
    v_cmp_gt_u32 vcc, 54, v250
    s_nop 1
    v_cndmask_b32 v251, v253, v251, vcc
    buffer_load_dword v233, v251, s[32:35], 0 offen
    s_nop 1
    v_add_f32 v246, v246, v247
    v_add_f32 v248, v248, v249
    v_mov_b32 v247, v246
    s_nop 1
    v_permlane32_swap_b32 v246, v247
    s_nop 1
    v_add_f32 v246, v246, v247
    v_mov_b32 v249, v248
    s_nop 1
    v_permlane32_swap_b32 v248, v249
    s_nop 1
    v_add_f32 v248, v248, v249
    v_mov_b32 v247, v248
    ds_write_b64 v255, v[246:247]
    v_xor_b32 v251, 1024, v255
    s_waitcnt lgkmcnt(0)
    s_barrier
    ds_read_b64 v[216:217], v251
    s_waitcnt lgkmcnt(0)
    v_add_f32 v246, v246, v216
    v_add_f32 v248, v248, v217
    v_mul_f32 v246, 0x3ae38e39, v246
    v_mul_f32 v248, 0x3ae38e39, v248
    v_fma_f32 v248, -v246, v246, v248
    v_max_f32 v248, 0, v248
    v_add_f32 v248, 0x3727c5ac, v248
    v_sub_f32 v246, 0, v246
    v_rsq_f32 v231, v248
    v_sqrt_f32 v232, v248
    s_nop 0
    v_mul_f32 v231, s51, v231
    v_dot2_f32_bf16 v216, v0, s53, v246
    v_dot2_f32_bf16 v217, v0, s54, v246
    v_dot2_f32_bf16 v218, v1, s53, v246
    v_dot2_f32_bf16 v219, v1, s54, v246
    v_dot2_f32_bf16 v220, v2, s53, v246
    v_dot2_f32_bf16 v221, v2, s54, v246
    v_dot2_f32_bf16 v222, v3, s53, v246
    v_dot2_f32_bf16 v223, v3, s54, v246
    s_nop 0
    v_cvt_pk_bf16_f32 v0, v216, v217
    v_cvt_pk_bf16_f32 v1, v218, v219
    v_cvt_pk_bf16_f32 v2, v220, v221
    v_cvt_pk_bf16_f32 v3, v222, v223
    v_dot2_f32_bf16 v216, v4, s53, v246
    v_dot2_f32_bf16 v217, v4, s54, v246
    v_dot2_f32_bf16 v218, v5, s53, v246
    v_dot2_f32_bf16 v219, v5, s54, v246
    v_dot2_f32_bf16 v220, v6, s53, v246
    v_dot2_f32_bf16 v221, v6, s54, v246
    v_dot2_f32_bf16 v222, v7, s53, v246
    v_dot2_f32_bf16 v223, v7, s54, v246
    s_nop 0
    v_cvt_pk_bf16_f32 v4, v216, v217
    v_cvt_pk_bf16_f32 v5, v218, v219
    v_cvt_pk_bf16_f32 v6, v220, v221
    v_cvt_pk_bf16_f32 v7, v222, v223
    v_dot2_f32_bf16 v216, v8, s53, v246
    v_dot2_f32_bf16 v217, v8, s54, v246
    v_dot2_f32_bf16 v218, v9, s53, v246
    v_dot2_f32_bf16 v219, v9, s54, v246
    v_dot2_f32_bf16 v220, v10, s53, v246
    v_dot2_f32_bf16 v221, v10, s54, v246
    v_dot2_f32_bf16 v222, v11, s53, v246
    v_dot2_f32_bf16 v223, v11, s54, v246
    s_nop 0
    v_cvt_pk_bf16_f32 v8, v216, v217
    v_cvt_pk_bf16_f32 v9, v218, v219
    v_cvt_pk_bf16_f32 v10, v220, v221
    v_cvt_pk_bf16_f32 v11, v222, v223
    v_dot2_f32_bf16 v216, v12, s53, v246
    v_dot2_f32_bf16 v217, v12, s54, v246
    v_dot2_f32_bf16 v218, v13, s53, v246
    v_dot2_f32_bf16 v219, v13, s54, v246
    v_dot2_f32_bf16 v220, v14, s53, v246
    v_dot2_f32_bf16 v221, v14, s54, v246
    v_dot2_f32_bf16 v222, v15, s53, v246
    v_dot2_f32_bf16 v223, v15, s54, v246
    s_nop 0
    v_cvt_pk_bf16_f32 v12, v216, v217
    v_cvt_pk_bf16_f32 v13, v218, v219
    v_cvt_pk_bf16_f32 v14, v220, v221
    v_cvt_pk_bf16_f32 v15, v222, v223
    v_dot2_f32_bf16 v216, v16, s53, v246
    v_dot2_f32_bf16 v217, v16, s54, v246
    v_dot2_f32_bf16 v218, v17, s53, v246
    v_dot2_f32_bf16 v219, v17, s54, v246
    v_dot2_f32_bf16 v220, v18, s53, v246
    v_dot2_f32_bf16 v221, v18, s54, v246
    v_dot2_f32_bf16 v222, v19, s53, v246
    v_dot2_f32_bf16 v223, v19, s54, v246
    s_nop 0
    v_cvt_pk_bf16_f32 v16, v216, v217
    v_cvt_pk_bf16_f32 v17, v218, v219
    v_cvt_pk_bf16_f32 v18, v220, v221
    v_cvt_pk_bf16_f32 v19, v222, v223
    v_dot2_f32_bf16 v216, v20, s53, v246
    v_dot2_f32_bf16 v217, v20, s54, v246
    v_dot2_f32_bf16 v218, v21, s53, v246
    v_dot2_f32_bf16 v219, v21, s54, v246
    v_dot2_f32_bf16 v220, v22, s53, v246
    v_dot2_f32_bf16 v221, v22, s54, v246
    v_dot2_f32_bf16 v222, v23, s53, v246
    v_dot2_f32_bf16 v223, v23, s54, v246
    s_nop 0
    v_cvt_pk_bf16_f32 v20, v216, v217
    v_cvt_pk_bf16_f32 v21, v218, v219
    v_cvt_pk_bf16_f32 v22, v220, v221
    v_cvt_pk_bf16_f32 v23, v222, v223
    v_dot2_f32_bf16 v216, v24, s53, v246
    v_dot2_f32_bf16 v217, v24, s54, v246
    v_dot2_f32_bf16 v218, v25, s53, v246
    v_dot2_f32_bf16 v219, v25, s54, v246
    v_dot2_f32_bf16 v220, v26, s53, v246
    v_dot2_f32_bf16 v221, v26, s54, v246
    v_dot2_f32_bf16 v222, v27, s53, v246
    v_dot2_f32_bf16 v223, v27, s54, v246
    s_nop 0
    v_cvt_pk_bf16_f32 v24, v216, v217
    v_cvt_pk_bf16_f32 v25, v218, v219
    v_cvt_pk_bf16_f32 v26, v220, v221
    v_cvt_pk_bf16_f32 v27, v222, v223
    v_dot2_f32_bf16 v216, v28, s53, v246
    v_dot2_f32_bf16 v217, v28, s54, v246
    v_dot2_f32_bf16 v218, v29, s53, v246
    v_dot2_f32_bf16 v219, v29, s54, v246
    v_dot2_f32_bf16 v220, v30, s53, v246
    v_dot2_f32_bf16 v221, v30, s54, v246
    v_dot2_f32_bf16 v222, v31, s53, v246
    v_dot2_f32_bf16 v223, v31, s54, v246
    s_nop 0
    v_cvt_pk_bf16_f32 v28, v216, v217
    v_cvt_pk_bf16_f32 v29, v218, v219
    v_cvt_pk_bf16_f32 v30, v220, v221
    v_cvt_pk_bf16_f32 v31, v222, v223
    v_dot2_f32_bf16 v216, v32, s53, v246
    v_dot2_f32_bf16 v217, v32, s54, v246
    v_dot2_f32_bf16 v218, v33, s53, v246
    v_dot2_f32_bf16 v219, v33, s54, v246
    v_dot2_f32_bf16 v220, v34, s53, v246
    v_dot2_f32_bf16 v221, v34, s54, v246
    v_dot2_f32_bf16 v222, v35, s53, v246
    v_dot2_f32_bf16 v223, v35, s54, v246
    s_nop 0
    v_cvt_pk_bf16_f32 v32, v216, v217
    v_cvt_pk_bf16_f32 v33, v218, v219
    v_cvt_pk_bf16_f32 v34, v220, v221
    v_cvt_pk_bf16_f32 v35, v222, v223
    v_dot2_f32_bf16 v216, v36, s53, v246
    v_dot2_f32_bf16 v217, v36, s54, v246
    v_dot2_f32_bf16 v218, v37, s53, v246
    v_dot2_f32_bf16 v219, v37, s54, v246
    v_dot2_f32_bf16 v220, v38, s53, v246
    v_dot2_f32_bf16 v221, v38, s54, v246
    v_dot2_f32_bf16 v222, v39, s53, v246
    v_dot2_f32_bf16 v223, v39, s54, v246
    s_nop 0
    v_cvt_pk_bf16_f32 v36, v216, v217
    v_cvt_pk_bf16_f32 v37, v218, v219
    v_cvt_pk_bf16_f32 v38, v220, v221
    v_cvt_pk_bf16_f32 v39, v222, v223
    v_dot2_f32_bf16 v216, v40, s53, v246
    v_dot2_f32_bf16 v217, v40, s54, v246
    v_dot2_f32_bf16 v218, v41, s53, v246
    v_dot2_f32_bf16 v219, v41, s54, v246
    v_dot2_f32_bf16 v220, v42, s53, v246
    v_dot2_f32_bf16 v221, v42, s54, v246
    v_dot2_f32_bf16 v222, v43, s53, v246
    v_dot2_f32_bf16 v223, v43, s54, v246
    s_nop 0
    v_cvt_pk_bf16_f32 v40, v216, v217
    v_cvt_pk_bf16_f32 v41, v218, v219
    v_cvt_pk_bf16_f32 v42, v220, v221
    v_cvt_pk_bf16_f32 v43, v222, v223
    v_dot2_f32_bf16 v216, v44, s53, v246
    v_dot2_f32_bf16 v217, v44, s54, v246
    v_dot2_f32_bf16 v218, v45, s53, v246
    v_dot2_f32_bf16 v219, v45, s54, v246
    v_dot2_f32_bf16 v220, v46, s53, v246
    v_dot2_f32_bf16 v221, v46, s54, v246
    v_dot2_f32_bf16 v222, v47, s53, v246
    v_dot2_f32_bf16 v223, v47, s54, v246
    s_nop 0
    v_cvt_pk_bf16_f32 v44, v216, v217
    v_cvt_pk_bf16_f32 v45, v218, v219
    v_cvt_pk_bf16_f32 v46, v220, v221
    v_cvt_pk_bf16_f32 v47, v222, v223
    v_dot2_f32_bf16 v216, v48, s53, v246
    v_dot2_f32_bf16 v217, v48, s54, v246
    v_dot2_f32_bf16 v218, v49, s53, v246
    v_dot2_f32_bf16 v219, v49, s54, v246
    v_dot2_f32_bf16 v220, v50, s53, v246
    v_dot2_f32_bf16 v221, v50, s54, v246
    v_dot2_f32_bf16 v222, v51, s53, v246
    v_dot2_f32_bf16 v223, v51, s54, v246
    s_nop 0
    v_cvt_pk_bf16_f32 v48, v216, v217
    v_cvt_pk_bf16_f32 v49, v218, v219
    v_cvt_pk_bf16_f32 v50, v220, v221
    v_cvt_pk_bf16_f32 v51, v222, v223
    v_dot2_f32_bf16 v216, v52, s53, v246
    v_dot2_f32_bf16 v217, v52, s54, v246
    v_dot2_f32_bf16 v218, v53, s53, v246
    v_dot2_f32_bf16 v219, v53, s54, v246
    v_dot2_f32_bf16 v220, v54, s53, v246
    v_dot2_f32_bf16 v221, v54, s54, v246
    v_dot2_f32_bf16 v222, v55, s53, v246
    v_dot2_f32_bf16 v223, v55, s54, v246
    s_nop 0
    v_cvt_pk_bf16_f32 v52, v216, v217
    v_cvt_pk_bf16_f32 v53, v218, v219
    v_cvt_pk_bf16_f32 v54, v220, v221
    v_cvt_pk_bf16_f32 v55, v222, v223
    v_dot2_f32_bf16 v216, v56, s53, v246
    v_dot2_f32_bf16 v217, v56, s54, v246
    v_dot2_f32_bf16 v218, v57, s53, v246
    v_dot2_f32_bf16 v219, v57, s54, v246
    v_dot2_f32_bf16 v220, v58, s53, v246
    v_dot2_f32_bf16 v221, v58, s54, v246
    v_dot2_f32_bf16 v222, v59, s53, v246
    v_dot2_f32_bf16 v223, v59, s54, v246
    s_nop 0
    v_cvt_pk_bf16_f32 v56, v216, v217
    v_cvt_pk_bf16_f32 v57, v218, v219
    v_cvt_pk_bf16_f32 v58, v220, v221
    v_cvt_pk_bf16_f32 v59, v222, v223
    v_dot2_f32_bf16 v216, v60, s53, v246
    v_dot2_f32_bf16 v217, v60, s54, v246
    v_dot2_f32_bf16 v218, v61, s53, v246
    v_dot2_f32_bf16 v219, v61, s54, v246
    v_dot2_f32_bf16 v220, v62, s53, v246
    v_dot2_f32_bf16 v221, v62, s54, v246
    v_dot2_f32_bf16 v222, v63, s53, v246
    v_dot2_f32_bf16 v223, v63, s54, v246
    s_nop 0
    v_cvt_pk_bf16_f32 v60, v216, v217
    v_cvt_pk_bf16_f32 v61, v218, v219
    v_cvt_pk_bf16_f32 v62, v220, v221
    v_cvt_pk_bf16_f32 v63, v222, v223
    v_dot2_f32_bf16 v216, v64, s53, v246
    v_dot2_f32_bf16 v217, v64, s54, v246
    v_dot2_f32_bf16 v218, v65, s53, v246
    v_dot2_f32_bf16 v219, v65, s54, v246
    v_dot2_f32_bf16 v220, v66, s53, v246
    v_dot2_f32_bf16 v221, v66, s54, v246
    v_dot2_f32_bf16 v222, v67, s53, v246
    v_dot2_f32_bf16 v223, v67, s54, v246
    s_nop 0
    v_cvt_pk_bf16_f32 v64, v216, v217
    v_cvt_pk_bf16_f32 v65, v218, v219
    v_cvt_pk_bf16_f32 v66, v220, v221
    v_cvt_pk_bf16_f32 v67, v222, v223
    v_dot2_f32_bf16 v216, v68, s53, v246
    v_dot2_f32_bf16 v217, v68, s54, v246
    v_dot2_f32_bf16 v218, v69, s53, v246
    v_dot2_f32_bf16 v219, v69, s54, v246
    v_dot2_f32_bf16 v220, v70, s53, v246
    v_dot2_f32_bf16 v221, v70, s54, v246
    v_dot2_f32_bf16 v222, v71, s53, v246
    v_dot2_f32_bf16 v223, v71, s54, v246
    s_nop 0
    v_cvt_pk_bf16_f32 v68, v216, v217
    v_cvt_pk_bf16_f32 v69, v218, v219
    v_cvt_pk_bf16_f32 v70, v220, v221
    v_cvt_pk_bf16_f32 v71, v222, v223
    v_dot2_f32_bf16 v216, v72, s53, v246
    v_dot2_f32_bf16 v217, v72, s54, v246
    v_dot2_f32_bf16 v218, v73, s53, v246
    v_dot2_f32_bf16 v219, v73, s54, v246
    v_dot2_f32_bf16 v220, v74, s53, v246
    v_dot2_f32_bf16 v221, v74, s54, v246
    v_dot2_f32_bf16 v222, v75, s53, v246
    v_dot2_f32_bf16 v223, v75, s54, v246
    s_nop 0
    v_cvt_pk_bf16_f32 v72, v216, v217
    v_cvt_pk_bf16_f32 v73, v218, v219
    v_cvt_pk_bf16_f32 v74, v220, v221
    v_cvt_pk_bf16_f32 v75, v222, v223
    v_dot2_f32_bf16 v216, v76, s53, v246
    v_dot2_f32_bf16 v217, v76, s54, v246
    v_dot2_f32_bf16 v218, v77, s53, v246
    v_dot2_f32_bf16 v219, v77, s54, v246
    v_dot2_f32_bf16 v220, v78, s53, v246
    v_dot2_f32_bf16 v221, v78, s54, v246
    v_dot2_f32_bf16 v222, v79, s53, v246
    v_dot2_f32_bf16 v223, v79, s54, v246
    s_nop 0
    v_cvt_pk_bf16_f32 v76, v216, v217
    v_cvt_pk_bf16_f32 v77, v218, v219
    v_cvt_pk_bf16_f32 v78, v220, v221
    v_cvt_pk_bf16_f32 v79, v222, v223
    v_dot2_f32_bf16 v216, v80, s53, v246
    v_dot2_f32_bf16 v217, v80, s54, v246
    v_dot2_f32_bf16 v218, v81, s53, v246
    v_dot2_f32_bf16 v219, v81, s54, v246
    v_dot2_f32_bf16 v220, v82, s53, v246
    v_dot2_f32_bf16 v221, v82, s54, v246
    v_dot2_f32_bf16 v222, v83, s53, v246
    v_dot2_f32_bf16 v223, v83, s54, v246
    s_nop 0
    v_cvt_pk_bf16_f32 v80, v216, v217
    v_cvt_pk_bf16_f32 v81, v218, v219
    v_cvt_pk_bf16_f32 v82, v220, v221
    v_cvt_pk_bf16_f32 v83, v222, v223
    v_dot2_f32_bf16 v216, v84, s53, v246
    v_dot2_f32_bf16 v217, v84, s54, v246
    v_dot2_f32_bf16 v218, v85, s53, v246
    v_dot2_f32_bf16 v219, v85, s54, v246
    v_dot2_f32_bf16 v220, v86, s53, v246
    v_dot2_f32_bf16 v221, v86, s54, v246
    v_dot2_f32_bf16 v222, v87, s53, v246
    v_dot2_f32_bf16 v223, v87, s54, v246
    s_nop 0
    v_cvt_pk_bf16_f32 v84, v216, v217
    v_cvt_pk_bf16_f32 v85, v218, v219
    v_cvt_pk_bf16_f32 v86, v220, v221
    v_cvt_pk_bf16_f32 v87, v222, v223
    v_dot2_f32_bf16 v216, v88, s53, v246
    v_dot2_f32_bf16 v217, v88, s54, v246
    v_dot2_f32_bf16 v218, v89, s53, v246
    v_dot2_f32_bf16 v219, v89, s54, v246
    v_dot2_f32_bf16 v220, v90, s53, v246
    v_dot2_f32_bf16 v221, v90, s54, v246
    v_dot2_f32_bf16 v222, v91, s53, v246
    v_dot2_f32_bf16 v223, v91, s54, v246
    s_nop 0
    v_cvt_pk_bf16_f32 v88, v216, v217
    v_cvt_pk_bf16_f32 v89, v218, v219
    v_cvt_pk_bf16_f32 v90, v220, v221
    v_cvt_pk_bf16_f32 v91, v222, v223
    v_dot2_f32_bf16 v216, v92, s53, v246
    v_dot2_f32_bf16 v217, v92, s54, v246
    v_dot2_f32_bf16 v218, v93, s53, v246
    v_dot2_f32_bf16 v219, v93, s54, v246
    v_dot2_f32_bf16 v220, v94, s53, v246
    v_dot2_f32_bf16 v221, v94, s54, v246
    v_dot2_f32_bf16 v222, v95, s53, v246
    v_dot2_f32_bf16 v223, v95, s54, v246
    s_nop 0
    v_cvt_pk_bf16_f32 v92, v216, v217
    v_cvt_pk_bf16_f32 v93, v218, v219
    v_cvt_pk_bf16_f32 v94, v220, v221
    v_cvt_pk_bf16_f32 v95, v222, v223
    v_dot2_f32_bf16 v216, v96, s53, v246
    v_dot2_f32_bf16 v217, v96, s54, v246
    v_dot2_f32_bf16 v218, v97, s53, v246
    v_dot2_f32_bf16 v219, v97, s54, v246
    v_dot2_f32_bf16 v220, v98, s53, v246
    v_dot2_f32_bf16 v221, v98, s54, v246
    v_dot2_f32_bf16 v222, v99, s53, v246
    v_dot2_f32_bf16 v223, v99, s54, v246
    s_nop 0
    v_cvt_pk_bf16_f32 v96, v216, v217
    v_cvt_pk_bf16_f32 v97, v218, v219
    v_cvt_pk_bf16_f32 v98, v220, v221
    v_cvt_pk_bf16_f32 v99, v222, v223
    v_dot2_f32_bf16 v216, v100, s53, v246
    v_dot2_f32_bf16 v217, v100, s54, v246
    v_dot2_f32_bf16 v218, v101, s53, v246
    v_dot2_f32_bf16 v219, v101, s54, v246
    v_dot2_f32_bf16 v220, v102, s53, v246
    v_dot2_f32_bf16 v221, v102, s54, v246
    v_dot2_f32_bf16 v222, v103, s53, v246
    v_dot2_f32_bf16 v223, v103, s54, v246
    s_nop 0
    v_cvt_pk_bf16_f32 v100, v216, v217
    v_cvt_pk_bf16_f32 v101, v218, v219
    v_cvt_pk_bf16_f32 v102, v220, v221
    v_cvt_pk_bf16_f32 v103, v222, v223
    v_dot2_f32_bf16 v216, v104, s53, v246
    v_dot2_f32_bf16 v217, v104, s54, v246
    v_dot2_f32_bf16 v218, v105, s53, v246
    v_dot2_f32_bf16 v219, v105, s54, v246
    v_dot2_f32_bf16 v220, v106, s53, v246
    v_dot2_f32_bf16 v221, v106, s54, v246
    v_dot2_f32_bf16 v222, v107, s53, v246
    v_dot2_f32_bf16 v223, v107, s54, v246
    s_nop 0
    v_cvt_pk_bf16_f32 v104, v216, v217
    v_cvt_pk_bf16_f32 v105, v218, v219
    v_cvt_pk_bf16_f32 v106, v220, v221
    v_cvt_pk_bf16_f32 v107, v222, v223
    v_dot2_f32_bf16 v216, v108, s53, v246
    v_dot2_f32_bf16 v217, v108, s54, v246
    v_dot2_f32_bf16 v218, v109, s53, v246
    v_dot2_f32_bf16 v219, v109, s54, v246
    v_dot2_f32_bf16 v220, v110, s53, v246
    v_dot2_f32_bf16 v221, v110, s54, v246
    v_dot2_f32_bf16 v222, v111, s53, v246
    v_dot2_f32_bf16 v223, v111, s54, v246
    s_nop 0
    v_cvt_pk_bf16_f32 v108, v216, v217
    v_cvt_pk_bf16_f32 v109, v218, v219
    v_cvt_pk_bf16_f32 v110, v220, v221
    v_cvt_pk_bf16_f32 v111, v222, v223
    v_dot2_f32_bf16 v216, v112, s53, v246
    v_dot2_f32_bf16 v217, v112, s54, v246
    v_dot2_f32_bf16 v218, v113, s53, v246
    v_dot2_f32_bf16 v219, v113, s54, v246
    v_dot2_f32_bf16 v220, v114, s53, v246
    v_dot2_f32_bf16 v221, v114, s54, v246
    v_dot2_f32_bf16 v222, v115, s53, v246
    v_dot2_f32_bf16 v223, v115, s54, v246
    s_nop 0
    v_cvt_pk_bf16_f32 v112, v216, v217
    v_cvt_pk_bf16_f32 v113, v218, v219
    v_cvt_pk_bf16_f32 v114, v220, v221
    v_cvt_pk_bf16_f32 v115, v222, v223
    v_dot2_f32_bf16 v216, v116, s53, v246
    v_dot2_f32_bf16 v217, v116, s54, v246
    v_dot2_f32_bf16 v218, v117, s53, v246
    v_dot2_f32_bf16 v219, v117, s54, v246
    v_dot2_f32_bf16 v220, v118, s53, v246
    v_dot2_f32_bf16 v221, v118, s54, v246
    v_dot2_f32_bf16 v222, v119, s53, v246
    v_dot2_f32_bf16 v223, v119, s54, v246
    s_nop 0
    v_cvt_pk_bf16_f32 v116, v216, v217
    v_cvt_pk_bf16_f32 v117, v218, v219
    v_cvt_pk_bf16_f32 v118, v220, v221
    v_cvt_pk_bf16_f32 v119, v222, v223
    v_dot2_f32_bf16 v216, v120, s53, v246
    v_dot2_f32_bf16 v217, v120, s54, v246
    v_dot2_f32_bf16 v218, v121, s53, v246
    v_dot2_f32_bf16 v219, v121, s54, v246
    v_dot2_f32_bf16 v220, v122, s53, v246
    v_dot2_f32_bf16 v221, v122, s54, v246
    v_dot2_f32_bf16 v222, v123, s53, v246
    v_dot2_f32_bf16 v223, v123, s54, v246
    s_nop 0
    v_cvt_pk_bf16_f32 v120, v216, v217
    v_cvt_pk_bf16_f32 v121, v218, v219
    v_cvt_pk_bf16_f32 v122, v220, v221
    v_cvt_pk_bf16_f32 v123, v222, v223
    v_dot2_f32_bf16 v216, v124, s53, v246
    v_dot2_f32_bf16 v217, v124, s54, v246
    v_dot2_f32_bf16 v218, v125, s53, v246
    v_dot2_f32_bf16 v219, v125, s54, v246
    v_dot2_f32_bf16 v220, v126, s53, v246
    v_dot2_f32_bf16 v221, v126, s54, v246
    v_dot2_f32_bf16 v222, v127, s53, v246
    v_dot2_f32_bf16 v223, v127, s54, v246
    s_nop 0
    v_cvt_pk_bf16_f32 v124, v216, v217
    v_cvt_pk_bf16_f32 v125, v218, v219
    v_cvt_pk_bf16_f32 v126, v220, v221
    v_cvt_pk_bf16_f32 v127, v222, v223
    v_dot2_f32_bf16 v216, v128, s53, v246
    v_dot2_f32_bf16 v217, v128, s54, v246
    v_dot2_f32_bf16 v218, v129, s53, v246
    v_dot2_f32_bf16 v219, v129, s54, v246
    v_dot2_f32_bf16 v220, v130, s53, v246
    v_dot2_f32_bf16 v221, v130, s54, v246
    v_dot2_f32_bf16 v222, v131, s53, v246
    v_dot2_f32_bf16 v223, v131, s54, v246
    s_nop 0
    v_cvt_pk_bf16_f32 v128, v216, v217
    v_cvt_pk_bf16_f32 v129, v218, v219
    v_cvt_pk_bf16_f32 v130, v220, v221
    v_cvt_pk_bf16_f32 v131, v222, v223
    v_dot2_f32_bf16 v216, v132, s53, v246
    v_dot2_f32_bf16 v217, v132, s54, v246
    v_dot2_f32_bf16 v218, v133, s53, v246
    v_dot2_f32_bf16 v219, v133, s54, v246
    v_dot2_f32_bf16 v220, v134, s53, v246
    v_dot2_f32_bf16 v221, v134, s54, v246
    v_dot2_f32_bf16 v222, v135, s53, v246
    v_dot2_f32_bf16 v223, v135, s54, v246
    s_nop 0
    v_cvt_pk_bf16_f32 v132, v216, v217
    v_cvt_pk_bf16_f32 v133, v218, v219
    v_cvt_pk_bf16_f32 v134, v220, v221
    v_cvt_pk_bf16_f32 v135, v222, v223
    v_dot2_f32_bf16 v216, v136, s53, v246
    v_dot2_f32_bf16 v217, v136, s54, v246
    v_dot2_f32_bf16 v218, v137, s53, v246
    v_dot2_f32_bf16 v219, v137, s54, v246
    v_dot2_f32_bf16 v220, v138, s53, v246
    v_dot2_f32_bf16 v221, v138, s54, v246
    v_dot2_f32_bf16 v222, v139, s53, v246
    v_dot2_f32_bf16 v223, v139, s54, v246
    s_nop 0
    v_cvt_pk_bf16_f32 v136, v216, v217
    v_cvt_pk_bf16_f32 v137, v218, v219
    v_cvt_pk_bf16_f32 v138, v220, v221
    v_cvt_pk_bf16_f32 v139, v222, v223
    v_dot2_f32_bf16 v216, v140, s53, v246
    v_dot2_f32_bf16 v217, v140, s54, v246
    v_dot2_f32_bf16 v218, v141, s53, v246
    v_dot2_f32_bf16 v219, v141, s54, v246
    v_dot2_f32_bf16 v220, v142, s53, v246
    v_dot2_f32_bf16 v221, v142, s54, v246
    v_dot2_f32_bf16 v222, v143, s53, v246
    v_dot2_f32_bf16 v223, v143, s54, v246
    s_nop 0
    v_cvt_pk_bf16_f32 v140, v216, v217
    v_cvt_pk_bf16_f32 v141, v218, v219
    v_cvt_pk_bf16_f32 v142, v220, v221
    v_cvt_pk_bf16_f32 v143, v222, v223
    s_waitcnt vmcnt(7)
    s_barrier
    ds_read_b64_tr_b16 v[176:177], v226 offset:0
    ds_read_b64_tr_b16 v[178:179], v226 offset:512
    ds_read_b64_tr_b16 v[180:181], v226 offset:2048
    ds_read_b64_tr_b16 v[182:183], v226 offset:2560
    ds_read_b64_tr_b16 v[184:185], v226 offset:4096
    ds_read_b64_tr_b16 v[186:187], v226 offset:4608
    ds_read_b64_tr_b16 v[188:189], v226 offset:6144
    ds_read_b64_tr_b16 v[190:191], v226 offset:6656
    s_waitcnt vmcnt(6)
    s_barrier
    s_add_u32 m0, s45, 57344
    s_mov_b32 s49, 4128768
    buffer_load_dwordx4 v224, s[28:31], s49 offen lds
    s_waitcnt lgkmcnt(6)
    v_mfma_f32_32x32x16_bf16 v[144:159], v[176:179], v[0:3], 0
    ds_read_b64_tr_b16 v[192:193], v226 offset:8192
    ds_read_b64_tr_b16 v[194:195], v226 offset:8704
    s_waitcnt lgkmcnt(6)
    v_mfma_f32_32x32x16_bf16 v[144:159], v[180:183], v[4:7], v[144:159]
    ds_read_b64_tr_b16 v[196:197], v226 offset:10240
    ds_read_b64_tr_b16 v[198:199], v226 offset:10752
    s_waitcnt lgkmcnt(6)
    v_mfma_f32_32x32x16_bf16 v[144:159], v[184:187], v[8:11], v[144:159]
    ds_read_b64_tr_b16 v[200:201], v226 offset:12288
    ds_read_b64_tr_b16 v[202:203], v226 offset:12800
    s_waitcnt lgkmcnt(6)
    v_mfma_f32_32x32x16_bf16 v[144:159], v[188:191], v[12:15], v[144:159]
    ds_read_b64_tr_b16 v[204:205], v226 offset:14336
    ds_read_b64_tr_b16 v[206:207], v226 offset:14848
    s_waitcnt vmcnt(6)
    s_barrier
    s_add_u32 m0, s45, 0
    s_mov_b32 s49, 4718592
    buffer_load_dwordx4 v224, s[28:31], s49 offen lds
    s_waitcnt lgkmcnt(6)
    v_mfma_f32_32x32x16_bf16 v[144:159], v[192:195], v[16:19], v[144:159]
    ds_read_b64_tr_b16 v[176:177], v226 offset:16384
    ds_read_b64_tr_b16 v[178:179], v226 offset:16896
    s_waitcnt lgkmcnt(6)
    v_mfma_f32_32x32x16_bf16 v[144:159], v[196:199], v[20:23], v[144:159]
    ds_read_b64_tr_b16 v[180:181], v226 offset:18432
    ds_read_b64_tr_b16 v[182:183], v226 offset:18944
    s_waitcnt lgkmcnt(6)
    v_mfma_f32_32x32x16_bf16 v[144:159], v[200:203], v[24:27], v[144:159]
    ds_read_b64_tr_b16 v[184:185], v226 offset:20480
    ds_read_b64_tr_b16 v[186:187], v226 offset:20992
    s_waitcnt lgkmcnt(6)
    v_mfma_f32_32x32x16_bf16 v[144:159], v[204:207], v[28:31], v[144:159]
    ds_read_b64_tr_b16 v[188:189], v226 offset:22528
    ds_read_b64_tr_b16 v[190:191], v226 offset:23040
    s_waitcnt vmcnt(6)
    s_barrier
    s_add_u32 m0, s45, 8192
    s_mov_b32 s49, 128
    buffer_load_dwordx4 v224, s[28:31], s49 offen lds
    s_waitcnt lgkmcnt(6)
    v_mfma_f32_32x32x16_bf16 v[144:159], v[176:179], v[32:35], v[144:159]
    ds_read_b64_tr_b16 v[192:193], v226 offset:24576
    ds_read_b64_tr_b16 v[194:195], v226 offset:25088
    s_waitcnt lgkmcnt(6)
    v_mfma_f32_32x32x16_bf16 v[144:159], v[180:183], v[36:39], v[144:159]
    ds_read_b64_tr_b16 v[196:197], v226 offset:26624
    ds_read_b64_tr_b16 v[198:199], v226 offset:27136
    s_waitcnt lgkmcnt(6)
    v_mfma_f32_32x32x16_bf16 v[144:159], v[184:187], v[40:43], v[144:159]
    ds_read_b64_tr_b16 v[200:201], v226 offset:28672
    ds_read_b64_tr_b16 v[202:203], v226 offset:29184
    s_waitcnt lgkmcnt(6)
    v_mfma_f32_32x32x16_bf16 v[144:159], v[188:191], v[44:47], v[144:159]
    ds_read_b64_tr_b16 v[204:205], v226 offset:30720
    ds_read_b64_tr_b16 v[206:207], v226 offset:31232
    s_waitcnt vmcnt(6)
    s_barrier
    s_add_u32 m0, s45, 16384
    s_mov_b32 s49, 589952
    buffer_load_dwordx4 v224, s[28:31], s49 offen lds
    s_waitcnt lgkmcnt(6)
    v_mfma_f32_32x32x16_bf16 v[144:159], v[192:195], v[48:51], v[144:159]
    ds_read_b64_tr_b16 v[176:177], v226 offset:32768
    ds_read_b64_tr_b16 v[178:179], v226 offset:33280
    s_waitcnt lgkmcnt(6)
    v_mfma_f32_32x32x16_bf16 v[144:159], v[196:199], v[52:55], v[144:159]
    ds_read_b64_tr_b16 v[180:181], v226 offset:34816
    ds_read_b64_tr_b16 v[182:183], v226 offset:35328
    s_waitcnt lgkmcnt(6)
    v_mfma_f32_32x32x16_bf16 v[144:159], v[200:203], v[56:59], v[144:159]
    ds_read_b64_tr_b16 v[184:185], v226 offset:36864
    ds_read_b64_tr_b16 v[186:187], v226 offset:37376
    s_waitcnt lgkmcnt(6)
    v_mfma_f32_32x32x16_bf16 v[144:159], v[204:207], v[60:63], v[144:159]
    ds_read_b64_tr_b16 v[188:189], v226 offset:38912
    ds_read_b64_tr_b16 v[190:191], v226 offset:39424
    s_waitcnt vmcnt(6)
    s_barrier
    s_add_u32 m0, s45, 24576
    s_mov_b32 s49, 1179776
    buffer_load_dwordx4 v224, s[28:31], s49 offen lds
    s_waitcnt lgkmcnt(6)
    v_mfma_f32_32x32x16_bf16 v[144:159], v[176:179], v[64:67], v[144:159]
    ds_read_b64_tr_b16 v[192:193], v226 offset:40960
    ds_read_b64_tr_b16 v[194:195], v226 offset:41472
    s_waitcnt lgkmcnt(6)
    v_mfma_f32_32x32x16_bf16 v[144:159], v[180:183], v[68:71], v[144:159]
    ds_read_b64_tr_b16 v[196:197], v226 offset:43008
    ds_read_b64_tr_b16 v[198:199], v226 offset:43520
    s_waitcnt lgkmcnt(6)
    v_mfma_f32_32x32x16_bf16 v[144:159], v[184:187], v[72:75], v[144:159]
    ds_read_b64_tr_b16 v[200:201], v226 offset:45056
    ds_read_b64_tr_b16 v[202:203], v226 offset:45568
    s_waitcnt lgkmcnt(6)
    v_mfma_f32_32x32x16_bf16 v[144:159], v[188:191], v[76:79], v[144:159]
    ds_read_b64_tr_b16 v[204:205], v226 offset:47104
    ds_read_b64_tr_b16 v[206:207], v226 offset:47616
    s_waitcnt vmcnt(6)
    s_barrier
    s_add_u32 m0, s45, 32768
    s_mov_b32 s49, 1769600
    buffer_load_dwordx4 v224, s[28:31], s49 offen lds
    s_waitcnt lgkmcnt(6)
    v_mfma_f32_32x32x16_bf16 v[144:159], v[192:195], v[80:83], v[144:159]
    ds_read_b64_tr_b16 v[176:177], v226 offset:49152
    ds_read_b64_tr_b16 v[178:179], v226 offset:49664
    s_waitcnt lgkmcnt(6)
    v_mfma_f32_32x32x16_bf16 v[144:159], v[196:199], v[84:87], v[144:159]
    ds_read_b64_tr_b16 v[180:181], v226 offset:51200
    ds_read_b64_tr_b16 v[182:183], v226 offset:51712
    s_waitcnt lgkmcnt(6)
    v_mfma_f32_32x32x16_bf16 v[144:159], v[200:203], v[88:91], v[144:159]
    ds_read_b64_tr_b16 v[184:185], v226 offset:53248
    ds_read_b64_tr_b16 v[186:187], v226 offset:53760
    s_waitcnt lgkmcnt(6)
    v_mfma_f32_32x32x16_bf16 v[144:159], v[204:207], v[92:95], v[144:159]
    ds_read_b64_tr_b16 v[188:189], v226 offset:55296
    ds_read_b64_tr_b16 v[190:191], v226 offset:55808
    s_waitcnt vmcnt(5)
    s_barrier
    s_add_u32 m0, s45, 40960
    s_mov_b32 s49, 2359424
    buffer_load_dwordx4 v224, s[28:31], s49 offen lds
    s_waitcnt lgkmcnt(6)
    v_mfma_f32_32x32x16_bf16 v[144:159], v[176:179], v[96:99], v[144:159]
    ds_read_b64_tr_b16 v[192:193], v226 offset:57344
    ds_read_b64_tr_b16 v[194:195], v226 offset:57856
    s_waitcnt lgkmcnt(6)
    v_mfma_f32_32x32x16_bf16 v[144:159], v[180:183], v[100:103], v[144:159]
    ds_read_b64_tr_b16 v[196:197], v226 offset:59392
    ds_read_b64_tr_b16 v[198:199], v226 offset:59904
    s_waitcnt lgkmcnt(6)
    v_mfma_f32_32x32x16_bf16 v[144:159], v[184:187], v[104:107], v[144:159]
    ds_read_b64_tr_b16 v[200:201], v226 offset:61440
    ds_read_b64_tr_b16 v[202:203], v226 offset:61952
    s_waitcnt lgkmcnt(6)
    v_mfma_f32_32x32x16_bf16 v[144:159], v[188:191], v[108:111], v[144:159]
    ds_read_b64_tr_b16 v[204:205], v226 offset:63488
    ds_read_b64_tr_b16 v[206:207], v226 offset:64000
    s_waitcnt vmcnt(5)
    s_barrier
    s_add_u32 m0, s45, 49152
    s_mov_b32 s49, 2949248
    buffer_load_dwordx4 v224, s[28:31], s49 offen lds
    s_waitcnt lgkmcnt(6)
    v_mfma_f32_32x32x16_bf16 v[144:159], v[192:195], v[112:115], v[144:159]
    ds_read_b64_tr_b16 v[176:177], v226 offset:0
    ds_read_b64_tr_b16 v[178:179], v226 offset:512
    s_waitcnt lgkmcnt(6)
    v_mfma_f32_32x32x16_bf16 v[144:159], v[196:199], v[116:119], v[144:159]
    ds_read_b64_tr_b16 v[180:181], v226 offset:2048
    ds_read_b64_tr_b16 v[182:183], v226 offset:2560
    s_waitcnt lgkmcnt(6)
    v_mfma_f32_32x32x16_bf16 v[144:159], v[200:203], v[120:123], v[144:159]
    ds_read_b64_tr_b16 v[184:185], v226 offset:4096
    ds_read_b64_tr_b16 v[186:187], v226 offset:4608
    s_waitcnt lgkmcnt(6)
    v_mfma_f32_32x32x16_bf16 v[144:159], v[204:207], v[124:127], v[144:159]
    ds_read_b64_tr_b16 v[188:189], v226 offset:6144
    ds_read_b64_tr_b16 v[190:191], v226 offset:6656
    s_waitcnt vmcnt(5)
    s_barrier
    s_add_u32 m0, s45, 57344
    s_mov_b32 s49, 3539072
    buffer_load_dwordx4 v224, s[28:31], s49 offen lds
    s_waitcnt lgkmcnt(6)
    v_mfma_f32_32x32x16_bf16 v[144:159], v[176:179], v[128:131], v[144:159]
    ds_read_b64_tr_b16 v[192:193], v226 offset:8192
    ds_read_b64_tr_b16 v[194:195], v226 offset:8704
    s_waitcnt lgkmcnt(6)
    v_mfma_f32_32x32x16_bf16 v[144:159], v[180:183], v[132:135], v[144:159]
    ds_read_b64_tr_b16 v[196:197], v226 offset:10240
    ds_read_b64_tr_b16 v[198:199], v226 offset:10752
    s_waitcnt lgkmcnt(6)
    v_mfma_f32_32x32x16_bf16 v[144:159], v[184:187], v[136:139], v[144:159]
    ds_read_b64_tr_b16 v[200:201], v226 offset:12288
    ds_read_b64_tr_b16 v[202:203], v226 offset:12800
    s_waitcnt lgkmcnt(6)
    v_mfma_f32_32x32x16_bf16 v[144:159], v[188:191], v[140:143], v[144:159]
    ds_read_b64_tr_b16 v[204:205], v226 offset:14336
    ds_read_b64_tr_b16 v[206:207], v226 offset:14848
    s_waitcnt vmcnt(5)
    s_barrier
    s_add_u32 m0, s45, 0
    s_mov_b32 s49, 4128896
    buffer_load_dwordx4 v224, s[28:31], s49 offen lds
    s_waitcnt lgkmcnt(6)
    v_mfma_f32_32x32x16_bf16 v[160:175], v[192:195], v[0:3], 0
    ds_read_b64_tr_b16 v[176:177], v226 offset:16384
    ds_read_b64_tr_b16 v[178:179], v226 offset:16896
    s_waitcnt lgkmcnt(6)
    v_mfma_f32_32x32x16_bf16 v[160:175], v[196:199], v[4:7], v[160:175]
    ds_read_b64_tr_b16 v[180:181], v226 offset:18432
    ds_read_b64_tr_b16 v[182:183], v226 offset:18944
    s_waitcnt lgkmcnt(6)
    v_mfma_f32_32x32x16_bf16 v[160:175], v[200:203], v[8:11], v[160:175]
    ds_read_b64_tr_b16 v[184:185], v226 offset:20480
    ds_read_b64_tr_b16 v[186:187], v226 offset:20992
    s_waitcnt lgkmcnt(6)
    v_mfma_f32_32x32x16_bf16 v[160:175], v[204:207], v[12:15], v[160:175]
    ds_read_b64_tr_b16 v[188:189], v226 offset:22528
    ds_read_b64_tr_b16 v[190:191], v226 offset:23040
    s_waitcnt vmcnt(5)
    s_barrier
    s_add_u32 m0, s45, 8192
    s_mov_b32 s49, 4718720
    buffer_load_dwordx4 v224, s[28:31], s49 offen lds
    s_waitcnt lgkmcnt(6)
    v_mfma_f32_32x32x16_bf16 v[160:175], v[176:179], v[16:19], v[160:175]
    ds_read_b64_tr_b16 v[192:193], v226 offset:24576
    ds_read_b64_tr_b16 v[194:195], v226 offset:25088
    v_mul_f32 v216, v144, v231
    v_mul_f32 v217, v145, v231
    v_exp_f32_e64 v216, -v216
    s_waitcnt lgkmcnt(6)
    v_mfma_f32_32x32x16_bf16 v[160:175], v[180:183], v[20:23], v[160:175]
    ds_read_b64_tr_b16 v[196:197], v226 offset:26624
    ds_read_b64_tr_b16 v[198:199], v226 offset:27136
    v_exp_f32_e64 v217, -v217
    v_fma_f32 v216, v216, v232, v232
    s_waitcnt lgkmcnt(6)
    v_mfma_f32_32x32x16_bf16 v[160:175], v[184:187], v[24:27], v[160:175]
    ds_read_b64_tr_b16 v[200:201], v226 offset:28672
    ds_read_b64_tr_b16 v[202:203], v226 offset:29184
    v_fma_f32 v217, v217, v232, v232
    v_rcp_f32 v216, v216
    s_waitcnt lgkmcnt(6)
    v_mfma_f32_32x32x16_bf16 v[160:175], v[188:191], v[28:31], v[160:175]
    ds_read_b64_tr_b16 v[204:205], v226 offset:30720
    ds_read_b64_tr_b16 v[206:207], v226 offset:31232
    v_rcp_f32 v217, v217
    s_waitcnt vmcnt(5)
    s_barrier
    v_mul_f32 v216, v144, v216
    v_mul_f32 v217, v145, v217
    v_cvt_pk_bf16_f32 v208, v216, v217
    s_add_u32 m0, s45, 16384
    s_mov_b32 s49, 256
    buffer_load_dwordx4 v224, s[28:31], s49 offen lds
    s_waitcnt lgkmcnt(6)
    v_mfma_f32_32x32x16_bf16 v[160:175], v[192:195], v[32:35], v[160:175]
    ds_read_b64_tr_b16 v[176:177], v226 offset:32768
    ds_read_b64_tr_b16 v[178:179], v226 offset:33280
    v_mul_f32 v216, v146, v231
    v_mul_f32 v217, v147, v231
    v_exp_f32_e64 v216, -v216
    s_waitcnt lgkmcnt(6)
    v_mfma_f32_32x32x16_bf16 v[160:175], v[196:199], v[36:39], v[160:175]
    ds_read_b64_tr_b16 v[180:181], v226 offset:34816
    ds_read_b64_tr_b16 v[182:183], v226 offset:35328
    v_exp_f32_e64 v217, -v217
    v_fma_f32 v216, v216, v232, v232
    s_waitcnt lgkmcnt(6)
    v_mfma_f32_32x32x16_bf16 v[160:175], v[200:203], v[40:43], v[160:175]
    ds_read_b64_tr_b16 v[184:185], v226 offset:36864
    ds_read_b64_tr_b16 v[186:187], v226 offset:37376
    v_fma_f32 v217, v217, v232, v232
    v_rcp_f32 v216, v216
    s_waitcnt lgkmcnt(6)
    v_mfma_f32_32x32x16_bf16 v[160:175], v[204:207], v[44:47], v[160:175]
    ds_read_b64_tr_b16 v[188:189], v226 offset:38912
    ds_read_b64_tr_b16 v[190:191], v226 offset:39424
    v_rcp_f32 v217, v217
    s_waitcnt vmcnt(5)
    s_barrier
    v_mul_f32 v216, v146, v216
    v_mul_f32 v217, v147, v217
    v_cvt_pk_bf16_f32 v209, v216, v217
    s_add_u32 m0, s45, 24576
    s_mov_b32 s49, 590080
    buffer_load_dwordx4 v224, s[28:31], s49 offen lds
    s_waitcnt lgkmcnt(6)
    v_mfma_f32_32x32x16_bf16 v[160:175], v[176:179], v[48:51], v[160:175]
    ds_read_b64_tr_b16 v[192:193], v226 offset:40960
    ds_read_b64_tr_b16 v[194:195], v226 offset:41472
    v_mul_f32 v216, v148, v231
    v_mul_f32 v217, v149, v231
    v_exp_f32_e64 v216, -v216
    s_waitcnt lgkmcnt(6)
    v_mfma_f32_32x32x16_bf16 v[160:175], v[180:183], v[52:55], v[160:175]
    ds_read_b64_tr_b16 v[196:197], v226 offset:43008
    ds_read_b64_tr_b16 v[198:199], v226 offset:43520
    v_exp_f32_e64 v217, -v217
    v_fma_f32 v216, v216, v232, v232
    s_waitcnt lgkmcnt(6)
    v_mfma_f32_32x32x16_bf16 v[160:175], v[184:187], v[56:59], v[160:175]
    ds_read_b64_tr_b16 v[200:201], v226 offset:45056
    ds_read_b64_tr_b16 v[202:203], v226 offset:45568
    v_fma_f32 v217, v217, v232, v232
    v_rcp_f32 v216, v216
    s_waitcnt lgkmcnt(6)
    v_mfma_f32_32x32x16_bf16 v[160:175], v[188:191], v[60:63], v[160:175]
    ds_read_b64_tr_b16 v[204:205], v226 offset:47104
    ds_read_b64_tr_b16 v[206:207], v226 offset:47616
    v_rcp_f32 v217, v217
    s_waitcnt vmcnt(5)
    s_barrier
    v_mul_f32 v216, v148, v216
    v_mul_f32 v217, v149, v217
    v_cvt_pk_bf16_f32 v210, v216, v217
    s_add_u32 m0, s45, 32768
    s_mov_b32 s49, 1179904
    buffer_load_dwordx4 v224, s[28:31], s49 offen lds
    s_waitcnt lgkmcnt(6)
    v_mfma_f32_32x32x16_bf16 v[160:175], v[192:195], v[64:67], v[160:175]
    ds_read_b64_tr_b16 v[176:177], v226 offset:49152
    ds_read_b64_tr_b16 v[178:179], v226 offset:49664
    v_mul_f32 v216, v150, v231
    v_mul_f32 v217, v151, v231
    v_exp_f32_e64 v216, -v216
    s_waitcnt lgkmcnt(6)
    v_mfma_f32_32x32x16_bf16 v[160:175], v[196:199], v[68:71], v[160:175]
    ds_read_b64_tr_b16 v[180:181], v226 offset:51200
    ds_read_b64_tr_b16 v[182:183], v226 offset:51712
    v_exp_f32_e64 v217, -v217
    v_fma_f32 v216, v216, v232, v232
    s_waitcnt lgkmcnt(6)
    v_mfma_f32_32x32x16_bf16 v[160:175], v[200:203], v[72:75], v[160:175]
    ds_read_b64_tr_b16 v[184:185], v226 offset:53248
    ds_read_b64_tr_b16 v[186:187], v226 offset:53760
    v_fma_f32 v217, v217, v232, v232
    v_rcp_f32 v216, v216
    s_waitcnt lgkmcnt(6)
    v_mfma_f32_32x32x16_bf16 v[160:175], v[204:207], v[76:79], v[160:175]
    ds_read_b64_tr_b16 v[188:189], v226 offset:55296
    ds_read_b64_tr_b16 v[190:191], v226 offset:55808
    v_rcp_f32 v217, v217
    s_waitcnt vmcnt(5)
    s_barrier
    v_mul_f32 v216, v150, v216
    v_mul_f32 v217, v151, v217
    v_cvt_pk_bf16_f32 v211, v216, v217
    ds_write_b128 v228, v[208:211] offset:0
    s_add_u32 m0, s45, 40960
    s_mov_b32 s49, 1769728
    buffer_load_dwordx4 v224, s[28:31], s49 offen lds
    s_waitcnt lgkmcnt(7)
    v_mfma_f32_32x32x16_bf16 v[160:175], v[176:179], v[80:83], v[160:175]
    ds_read_b64_tr_b16 v[192:193], v226 offset:57344
    ds_read_b64_tr_b16 v[194:195], v226 offset:57856
    v_mul_f32 v216, v152, v231
    v_mul_f32 v217, v153, v231
    v_exp_f32_e64 v216, -v216
    s_waitcnt lgkmcnt(7)
    v_mfma_f32_32x32x16_bf16 v[160:175], v[180:183], v[84:87], v[160:175]
    ds_read_b64_tr_b16 v[196:197], v226 offset:59392
    ds_read_b64_tr_b16 v[198:199], v226 offset:59904
    v_exp_f32_e64 v217, -v217
    v_fma_f32 v216, v216, v232, v232
    s_waitcnt lgkmcnt(7)
    v_mfma_f32_32x32x16_bf16 v[160:175], v[184:187], v[88:91], v[160:175]
    ds_read_b64_tr_b16 v[200:201], v226 offset:61440
    ds_read_b64_tr_b16 v[202:203], v226 offset:61952
    v_fma_f32 v217, v217, v232, v232
    v_rcp_f32 v216, v216
    s_waitcnt lgkmcnt(7)
    v_mfma_f32_32x32x16_bf16 v[160:175], v[188:191], v[92:95], v[160:175]
    ds_read_b64_tr_b16 v[204:205], v226 offset:63488
    ds_read_b64_tr_b16 v[206:207], v226 offset:64000
    v_rcp_f32 v217, v217
    s_waitcnt vmcnt(5) lgkmcnt(8)
    s_barrier
    v_mul_f32 v216, v152, v216
    v_mul_f32 v217, v153, v217
    v_cvt_pk_bf16_f32 v212, v216, v217
    s_add_u32 m0, s45, 49152
    s_mov_b32 s49, 2359552
    buffer_load_dwordx4 v224, s[28:31], s49 offen lds
    s_waitcnt lgkmcnt(6)
    v_mfma_f32_32x32x16_bf16 v[160:175], v[192:195], v[96:99], v[160:175]
    ds_read_b64_tr_b16 v[176:177], v226 offset:0
    ds_read_b64_tr_b16 v[178:179], v226 offset:512
    v_mul_f32 v216, v154, v231
    v_mul_f32 v217, v155, v231
    v_exp_f32_e64 v216, -v216
    s_waitcnt lgkmcnt(6)
    v_mfma_f32_32x32x16_bf16 v[160:175], v[196:199], v[100:103], v[160:175]
    ds_read_b64_tr_b16 v[180:181], v226 offset:2048
    ds_read_b64_tr_b16 v[182:183], v226 offset:2560
    v_exp_f32_e64 v217, -v217
    v_fma_f32 v216, v216, v232, v232
    s_waitcnt lgkmcnt(6)
    v_mfma_f32_32x32x16_bf16 v[160:175], v[200:203], v[104:107], v[160:175]
    ds_read_b64_tr_b16 v[184:185], v226 offset:4096
    ds_read_b64_tr_b16 v[186:187], v226 offset:4608
    v_fma_f32 v217, v217, v232, v232
    v_rcp_f32 v216, v216
    s_waitcnt lgkmcnt(6)
    v_mfma_f32_32x32x16_bf16 v[160:175], v[204:207], v[108:111], v[160:175]
    ds_read_b64_tr_b16 v[188:189], v226 offset:6144
    ds_read_b64_tr_b16 v[190:191], v226 offset:6656
    v_rcp_f32 v217, v217
    s_waitcnt vmcnt(5)
    s_barrier
    v_mul_f32 v216, v154, v216
    v_mul_f32 v217, v155, v217
    v_cvt_pk_bf16_f32 v213, v216, v217
    s_add_u32 m0, s45, 57344
    s_mov_b32 s49, 2949376
    buffer_load_dwordx4 v224, s[28:31], s49 offen lds
    s_waitcnt lgkmcnt(6)
    v_mfma_f32_32x32x16_bf16 v[160:175], v[176:179], v[112:115], v[160:175]
    ds_read_b64_tr_b16 v[192:193], v226 offset:8192
    ds_read_b64_tr_b16 v[194:195], v226 offset:8704
    v_mul_f32 v216, v156, v231
    v_mul_f32 v217, v157, v231
    v_exp_f32_e64 v216, -v216
    s_waitcnt lgkmcnt(6)
    v_mfma_f32_32x32x16_bf16 v[160:175], v[180:183], v[116:119], v[160:175]
    ds_read_b64_tr_b16 v[196:197], v226 offset:10240
    ds_read_b64_tr_b16 v[198:199], v226 offset:10752
    v_exp_f32_e64 v217, -v217
    v_fma_f32 v216, v216, v232, v232
    s_waitcnt lgkmcnt(6)
    v_mfma_f32_32x32x16_bf16 v[160:175], v[184:187], v[120:123], v[160:175]
    ds_read_b64_tr_b16 v[200:201], v226 offset:12288
    ds_read_b64_tr_b16 v[202:203], v226 offset:12800
    v_fma_f32 v217, v217, v232, v232
    v_rcp_f32 v216, v216
    s_waitcnt lgkmcnt(6)
    v_mfma_f32_32x32x16_bf16 v[160:175], v[188:191], v[124:127], v[160:175]
    ds_read_b64_tr_b16 v[204:205], v226 offset:14336
    ds_read_b64_tr_b16 v[206:207], v226 offset:14848
    v_rcp_f32 v217, v217
    s_waitcnt vmcnt(5)
    s_barrier
    v_mul_f32 v216, v156, v216
    v_mul_f32 v217, v157, v217
    v_cvt_pk_bf16_f32 v214, v216, v217
    s_add_u32 m0, s45, 0
    s_mov_b32 s49, 3539200
    buffer_load_dwordx4 v224, s[28:31], s49 offen lds
    s_waitcnt lgkmcnt(6)
    v_mfma_f32_32x32x16_bf16 v[160:175], v[192:195], v[128:131], v[160:175]
    ds_read_b64_tr_b16 v[176:177], v226 offset:16384
    ds_read_b64_tr_b16 v[178:179], v226 offset:16896
    v_mul_f32 v216, v158, v231
    v_mul_f32 v217, v159, v231
    v_exp_f32_e64 v216, -v216
    s_waitcnt lgkmcnt(6)
    v_mfma_f32_32x32x16_bf16 v[160:175], v[196:199], v[132:135], v[160:175]
    ds_read_b64_tr_b16 v[180:181], v226 offset:18432
    ds_read_b64_tr_b16 v[182:183], v226 offset:18944
    v_exp_f32_e64 v217, -v217
    v_fma_f32 v216, v216, v232, v232
    s_waitcnt lgkmcnt(6)
    v_mfma_f32_32x32x16_bf16 v[160:175], v[200:203], v[136:139], v[160:175]
    ds_read_b64_tr_b16 v[184:185], v226 offset:20480
    ds_read_b64_tr_b16 v[186:187], v226 offset:20992
    v_fma_f32 v217, v217, v232, v232
    v_rcp_f32 v216, v216
    s_waitcnt lgkmcnt(6)
    v_mfma_f32_32x32x16_bf16 v[160:175], v[204:207], v[140:143], v[160:175]
    ds_read_b64_tr_b16 v[188:189], v226 offset:22528
    ds_read_b64_tr_b16 v[190:191], v226 offset:23040
    v_rcp_f32 v217, v217
    s_waitcnt vmcnt(5)
    s_barrier
    v_mul_f32 v216, v158, v216
    v_mul_f32 v217, v159, v217
    v_cvt_pk_bf16_f32 v215, v216, v217
    ds_write_b128 v228, v[212:215] offset:1024
    s_add_u32 m0, s45, 8192
    s_mov_b32 s49, 4129024
    buffer_load_dwordx4 v224, s[28:31], s49 offen lds
    s_waitcnt lgkmcnt(7)
    v_mfma_f32_32x32x16_bf16 v[144:159], v[176:179], v[0:3], 0
    ds_read_b64_tr_b16 v[192:193], v226 offset:24576
    ds_read_b64_tr_b16 v[194:195], v226 offset:25088
    s_waitcnt lgkmcnt(7)
    v_mfma_f32_32x32x16_bf16 v[144:159], v[180:183], v[4:7], v[144:159]
    ds_read_b64_tr_b16 v[196:197], v226 offset:26624
    ds_read_b64_tr_b16 v[198:199], v226 offset:27136
    s_waitcnt lgkmcnt(7)
    v_mfma_f32_32x32x16_bf16 v[144:159], v[184:187], v[8:11], v[144:159]
    ds_read_b64_tr_b16 v[200:201], v226 offset:28672
    ds_read_b64_tr_b16 v[202:203], v226 offset:29184
    s_waitcnt lgkmcnt(7)
    v_mfma_f32_32x32x16_bf16 v[144:159], v[188:191], v[12:15], v[144:159]
    ds_read_b64_tr_b16 v[204:205], v226 offset:30720
    ds_read_b64_tr_b16 v[206:207], v226 offset:31232
    s_waitcnt vmcnt(5) lgkmcnt(8)
    s_barrier
    s_add_u32 m0, s45, 16384
    s_mov_b32 s49, 4718848
    buffer_load_dwordx4 v224, s[28:31], s49 offen lds
    s_waitcnt lgkmcnt(6)
    v_mfma_f32_32x32x16_bf16 v[144:159], v[192:195], v[16:19], v[144:159]
    ds_read_b64_tr_b16 v[176:177], v226 offset:32768
    ds_read_b64_tr_b16 v[178:179], v226 offset:33280
    v_mul_f32 v216, v160, v231
    v_mul_f32 v217, v161, v231
    v_exp_f32_e64 v216, -v216
    s_waitcnt lgkmcnt(6)
    v_mfma_f32_32x32x16_bf16 v[144:159], v[196:199], v[20:23], v[144:159]
    ds_read_b64_tr_b16 v[180:181], v226 offset:34816
    ds_read_b64_tr_b16 v[182:183], v226 offset:35328
    v_exp_f32_e64 v217, -v217
    v_fma_f32 v216, v216, v232, v232
    s_waitcnt lgkmcnt(6)
    v_mfma_f32_32x32x16_bf16 v[144:159], v[200:203], v[24:27], v[144:159]
    ds_read_b64_tr_b16 v[184:185], v226 offset:36864
    ds_read_b64_tr_b16 v[186:187], v226 offset:37376
    v_fma_f32 v217, v217, v232, v232
    v_rcp_f32 v216, v216
    s_waitcnt lgkmcnt(6)
    v_mfma_f32_32x32x16_bf16 v[144:159], v[204:207], v[28:31], v[144:159]
    ds_read_b64_tr_b16 v[188:189], v226 offset:38912
    ds_read_b64_tr_b16 v[190:191], v226 offset:39424
    v_rcp_f32 v217, v217
    s_waitcnt vmcnt(5)
    s_barrier
    v_mul_f32 v216, v160, v216
    v_mul_f32 v217, v161, v217
    v_cvt_pk_bf16_f32 v208, v216, v217
    s_add_u32 m0, s45, 24576
    s_mov_b32 s49, 384
    buffer_load_dwordx4 v224, s[28:31], s49 offen lds
    s_waitcnt lgkmcnt(6)
    v_mfma_f32_32x32x16_bf16 v[144:159], v[176:179], v[32:35], v[144:159]
    ds_read_b64_tr_b16 v[192:193], v226 offset:40960
    ds_read_b64_tr_b16 v[194:195], v226 offset:41472
    v_mul_f32 v216, v162, v231
    v_mul_f32 v217, v163, v231
    v_exp_f32_e64 v216, -v216
    s_waitcnt lgkmcnt(6)
    v_mfma_f32_32x32x16_bf16 v[144:159], v[180:183], v[36:39], v[144:159]
    ds_read_b64_tr_b16 v[196:197], v226 offset:43008
    ds_read_b64_tr_b16 v[198:199], v226 offset:43520
    v_exp_f32_e64 v217, -v217
    v_fma_f32 v216, v216, v232, v232
    s_waitcnt lgkmcnt(6)
    v_mfma_f32_32x32x16_bf16 v[144:159], v[184:187], v[40:43], v[144:159]
    ds_read_b64_tr_b16 v[200:201], v226 offset:45056
    ds_read_b64_tr_b16 v[202:203], v226 offset:45568
    v_fma_f32 v217, v217, v232, v232
    v_rcp_f32 v216, v216
    s_waitcnt lgkmcnt(6)
    v_mfma_f32_32x32x16_bf16 v[144:159], v[188:191], v[44:47], v[144:159]
    ds_read_b64_tr_b16 v[204:205], v226 offset:47104
    ds_read_b64_tr_b16 v[206:207], v226 offset:47616
    v_rcp_f32 v217, v217
    s_waitcnt vmcnt(5)
    s_barrier
    v_mul_f32 v216, v162, v216
    v_mul_f32 v217, v163, v217
    v_cvt_pk_bf16_f32 v209, v216, v217
    s_add_u32 m0, s45, 32768
    s_mov_b32 s49, 590208
    buffer_load_dwordx4 v224, s[28:31], s49 offen lds
    s_waitcnt lgkmcnt(6)
    v_mfma_f32_32x32x16_bf16 v[144:159], v[192:195], v[48:51], v[144:159]
    ds_read_b64_tr_b16 v[176:177], v226 offset:49152
    ds_read_b64_tr_b16 v[178:179], v226 offset:49664
    v_mul_f32 v216, v164, v231
    v_mul_f32 v217, v165, v231
    v_exp_f32_e64 v216, -v216
    s_waitcnt lgkmcnt(6)
    v_mfma_f32_32x32x16_bf16 v[144:159], v[196:199], v[52:55], v[144:159]
    ds_read_b64_tr_b16 v[180:181], v226 offset:51200
    ds_read_b64_tr_b16 v[182:183], v226 offset:51712
    v_exp_f32_e64 v217, -v217
    v_fma_f32 v216, v216, v232, v232
    s_waitcnt lgkmcnt(6)
    v_mfma_f32_32x32x16_bf16 v[144:159], v[200:203], v[56:59], v[144:159]
    ds_read_b64_tr_b16 v[184:185], v226 offset:53248
    ds_read_b64_tr_b16 v[186:187], v226 offset:53760
    v_fma_f32 v217, v217, v232, v232
    v_rcp_f32 v216, v216
    s_waitcnt lgkmcnt(6)
    v_mfma_f32_32x32x16_bf16 v[144:159], v[204:207], v[60:63], v[144:159]
    ds_read_b64_tr_b16 v[188:189], v226 offset:55296
    ds_read_b64_tr_b16 v[190:191], v226 offset:55808
    v_rcp_f32 v217, v217
    s_waitcnt vmcnt(5)
    s_barrier
    v_mul_f32 v216, v164, v216
    v_mul_f32 v217, v165, v217
    v_cvt_pk_bf16_f32 v210, v216, v217
    s_add_u32 m0, s45, 40960
    s_mov_b32 s49, 1180032
    buffer_load_dwordx4 v224, s[28:31], s49 offen lds
    s_waitcnt lgkmcnt(6)
    v_mfma_f32_32x32x16_bf16 v[144:159], v[176:179], v[64:67], v[144:159]
    ds_read_b64_tr_b16 v[192:193], v226 offset:57344
    ds_read_b64_tr_b16 v[194:195], v226 offset:57856
    v_mul_f32 v216, v166, v231
    v_mul_f32 v217, v167, v231
    v_exp_f32_e64 v216, -v216
    s_waitcnt lgkmcnt(6)
    v_mfma_f32_32x32x16_bf16 v[144:159], v[180:183], v[68:71], v[144:159]
    ds_read_b64_tr_b16 v[196:197], v226 offset:59392
    ds_read_b64_tr_b16 v[198:199], v226 offset:59904
    v_exp_f32_e64 v217, -v217
    v_fma_f32 v216, v216, v232, v232
    s_waitcnt lgkmcnt(6)
    v_mfma_f32_32x32x16_bf16 v[144:159], v[184:187], v[72:75], v[144:159]
    ds_read_b64_tr_b16 v[200:201], v226 offset:61440
    ds_read_b64_tr_b16 v[202:203], v226 offset:61952
    v_fma_f32 v217, v217, v232, v232
    v_rcp_f32 v216, v216
    s_waitcnt lgkmcnt(6)
    v_mfma_f32_32x32x16_bf16 v[144:159], v[188:191], v[76:79], v[144:159]
    ds_read_b64_tr_b16 v[204:205], v226 offset:63488
    ds_read_b64_tr_b16 v[206:207], v226 offset:64000
    v_rcp_f32 v217, v217
    s_waitcnt vmcnt(5)
    s_barrier
    v_mul_f32 v216, v166, v216
    v_mul_f32 v217, v167, v217
    v_cvt_pk_bf16_f32 v211, v216, v217
    ds_write_b128 v228, v[208:211] offset:4096
    s_add_u32 m0, s45, 49152
    s_mov_b32 s49, 1769856
    buffer_load_dwordx4 v224, s[28:31], s49 offen lds
    s_waitcnt lgkmcnt(7)
    v_mfma_f32_32x32x16_bf16 v[144:159], v[192:195], v[80:83], v[144:159]
    ds_read_b64_tr_b16 v[176:177], v226 offset:0
    ds_read_b64_tr_b16 v[178:179], v226 offset:512
    v_mul_f32 v216, v168, v231
    v_mul_f32 v217, v169, v231
    v_exp_f32_e64 v216, -v216
    s_waitcnt lgkmcnt(7)
    v_mfma_f32_32x32x16_bf16 v[144:159], v[196:199], v[84:87], v[144:159]
    ds_read_b64_tr_b16 v[180:181], v226 offset:2048
    ds_read_b64_tr_b16 v[182:183], v226 offset:2560
    v_exp_f32_e64 v217, -v217
    v_fma_f32 v216, v216, v232, v232
    s_waitcnt lgkmcnt(7)
    v_mfma_f32_32x32x16_bf16 v[144:159], v[200:203], v[88:91], v[144:159]
    ds_read_b64_tr_b16 v[184:185], v226 offset:4096
    ds_read_b64_tr_b16 v[186:187], v226 offset:4608
    v_fma_f32 v217, v217, v232, v232
    v_rcp_f32 v216, v216
    s_waitcnt lgkmcnt(7)
    v_mfma_f32_32x32x16_bf16 v[144:159], v[204:207], v[92:95], v[144:159]
    ds_read_b64_tr_b16 v[188:189], v226 offset:6144
    ds_read_b64_tr_b16 v[190:191], v226 offset:6656
    v_rcp_f32 v217, v217
    s_waitcnt vmcnt(5) lgkmcnt(8)
    s_barrier
    v_mul_f32 v216, v168, v216
    v_mul_f32 v217, v169, v217
    v_cvt_pk_bf16_f32 v212, v216, v217
    s_add_u32 m0, s45, 57344
    s_mov_b32 s49, 2359680
    buffer_load_dwordx4 v224, s[28:31], s49 offen lds
    s_waitcnt lgkmcnt(6)
    v_mfma_f32_32x32x16_bf16 v[144:159], v[176:179], v[96:99], v[144:159]
    ds_read_b64_tr_b16 v[192:193], v226 offset:8192
    ds_read_b64_tr_b16 v[194:195], v226 offset:8704
    v_mul_f32 v216, v170, v231
    v_mul_f32 v217, v171, v231
    v_exp_f32_e64 v216, -v216
    s_waitcnt lgkmcnt(6)
    v_mfma_f32_32x32x16_bf16 v[144:159], v[180:183], v[100:103], v[144:159]
    ds_read_b64_tr_b16 v[196:197], v226 offset:10240
    ds_read_b64_tr_b16 v[198:199], v226 offset:10752
    v_exp_f32_e64 v217, -v217
    v_fma_f32 v216, v216, v232, v232
    s_waitcnt lgkmcnt(6)
    v_mfma_f32_32x32x16_bf16 v[144:159], v[184:187], v[104:107], v[144:159]
    ds_read_b64_tr_b16 v[200:201], v226 offset:12288
    ds_read_b64_tr_b16 v[202:203], v226 offset:12800
    v_fma_f32 v217, v217, v232, v232
    v_rcp_f32 v216, v216
    s_waitcnt lgkmcnt(6)
    v_mfma_f32_32x32x16_bf16 v[144:159], v[188:191], v[108:111], v[144:159]
    ds_read_b64_tr_b16 v[204:205], v226 offset:14336
    ds_read_b64_tr_b16 v[206:207], v226 offset:14848
    v_rcp_f32 v217, v217
    s_waitcnt vmcnt(5)
    s_barrier
    v_mul_f32 v216, v170, v216
    v_mul_f32 v217, v171, v217
    v_cvt_pk_bf16_f32 v213, v216, v217
    s_add_u32 m0, s45, 0
    s_mov_b32 s49, 2949504
    buffer_load_dwordx4 v224, s[28:31], s49 offen lds
    s_waitcnt lgkmcnt(6)
    v_mfma_f32_32x32x16_bf16 v[144:159], v[192:195], v[112:115], v[144:159]
    ds_read_b64_tr_b16 v[176:177], v226 offset:16384
    ds_read_b64_tr_b16 v[178:179], v226 offset:16896
    v_mul_f32 v216, v172, v231
    v_mul_f32 v217, v173, v231
    v_exp_f32_e64 v216, -v216
    s_waitcnt lgkmcnt(6)
    v_mfma_f32_32x32x16_bf16 v[144:159], v[196:199], v[116:119], v[144:159]
    ds_read_b64_tr_b16 v[180:181], v226 offset:18432
    ds_read_b64_tr_b16 v[182:183], v226 offset:18944
    v_exp_f32_e64 v217, -v217
    v_fma_f32 v216, v216, v232, v232
    s_waitcnt lgkmcnt(6)
    v_mfma_f32_32x32x16_bf16 v[144:159], v[200:203], v[120:123], v[144:159]
    ds_read_b64_tr_b16 v[184:185], v226 offset:20480
    ds_read_b64_tr_b16 v[186:187], v226 offset:20992
    v_fma_f32 v217, v217, v232, v232
    v_rcp_f32 v216, v216
    s_waitcnt lgkmcnt(6)
    v_mfma_f32_32x32x16_bf16 v[144:159], v[204:207], v[124:127], v[144:159]
    ds_read_b64_tr_b16 v[188:189], v226 offset:22528
    ds_read_b64_tr_b16 v[190:191], v226 offset:23040
    v_rcp_f32 v217, v217
    s_waitcnt vmcnt(5)
    s_barrier
    v_mul_f32 v216, v172, v216
    v_mul_f32 v217, v173, v217
    v_cvt_pk_bf16_f32 v214, v216, v217
    s_add_u32 m0, s45, 8192
    s_mov_b32 s49, 3539328
    buffer_load_dwordx4 v224, s[28:31], s49 offen lds
    s_waitcnt lgkmcnt(6)
    v_mfma_f32_32x32x16_bf16 v[144:159], v[176:179], v[128:131], v[144:159]
    ds_read_b64_tr_b16 v[192:193], v226 offset:24576
    ds_read_b64_tr_b16 v[194:195], v226 offset:25088
    v_mul_f32 v216, v174, v231
    v_mul_f32 v217, v175, v231
    v_exp_f32_e64 v216, -v216
    s_waitcnt lgkmcnt(6)
    v_mfma_f32_32x32x16_bf16 v[144:159], v[180:183], v[132:135], v[144:159]
    ds_read_b64_tr_b16 v[196:197], v226 offset:26624
    ds_read_b64_tr_b16 v[198:199], v226 offset:27136
    v_exp_f32_e64 v217, -v217
    v_fma_f32 v216, v216, v232, v232
    s_waitcnt lgkmcnt(6)
    v_mfma_f32_32x32x16_bf16 v[144:159], v[184:187], v[136:139], v[144:159]
    ds_read_b64_tr_b16 v[200:201], v226 offset:28672
    ds_read_b64_tr_b16 v[202:203], v226 offset:29184
    v_fma_f32 v217, v217, v232, v232
    v_rcp_f32 v216, v216
    s_waitcnt lgkmcnt(6)
    v_mfma_f32_32x32x16_bf16 v[144:159], v[188:191], v[140:143], v[144:159]
    ds_read_b64_tr_b16 v[204:205], v226 offset:30720
    ds_read_b64_tr_b16 v[206:207], v226 offset:31232
    v_rcp_f32 v217, v217
    s_waitcnt vmcnt(5)
    s_barrier
    v_mul_f32 v216, v174, v216
    v_mul_f32 v217, v175, v217
    v_cvt_pk_bf16_f32 v215, v216, v217
    ds_write_b128 v228, v[212:215] offset:5120
    s_add_u32 m0, s45, 16384
    s_mov_b32 s49, 4129152
    buffer_load_dwordx4 v224, s[28:31], s49 offen lds
    s_waitcnt lgkmcnt(7)
    v_mfma_f32_32x32x16_bf16 v[160:175], v[192:195], v[0:3], 0
    ds_read_b64_tr_b16 v[176:177], v226 offset:32768
    ds_read_b64_tr_b16 v[178:179], v226 offset:33280
    s_waitcnt lgkmcnt(7)
    v_mfma_f32_32x32x16_bf16 v[160:175], v[196:199], v[4:7], v[160:175]
    ds_read_b64_tr_b16 v[180:181], v226 offset:34816
    ds_read_b64_tr_b16 v[182:183], v226 offset:35328
    s_waitcnt lgkmcnt(7)
    v_mfma_f32_32x32x16_bf16 v[160:175], v[200:203], v[8:11], v[160:175]
    ds_read_b64_tr_b16 v[184:185], v226 offset:36864
    ds_read_b64_tr_b16 v[186:187], v226 offset:37376
    s_waitcnt lgkmcnt(7)
    v_mfma_f32_32x32x16_bf16 v[160:175], v[204:207], v[12:15], v[160:175]
    ds_read_b64_tr_b16 v[188:189], v226 offset:38912
    ds_read_b64_tr_b16 v[190:191], v226 offset:39424
    s_waitcnt vmcnt(5) lgkmcnt(8)
    s_barrier
    s_add_u32 m0, s45, 24576
    s_mov_b32 s49, 4718976
    buffer_load_dwordx4 v224, s[28:31], s49 offen lds
    s_waitcnt lgkmcnt(6)
    v_mfma_f32_32x32x16_bf16 v[160:175], v[176:179], v[16:19], v[160:175]
    ds_read_b64_tr_b16 v[192:193], v226 offset:40960
    ds_read_b64_tr_b16 v[194:195], v226 offset:41472
    v_mul_f32 v216, v144, v231
    v_mul_f32 v217, v145, v231
    v_exp_f32_e64 v216, -v216
    s_waitcnt lgkmcnt(6)
    v_mfma_f32_32x32x16_bf16 v[160:175], v[180:183], v[20:23], v[160:175]
    ds_read_b64_tr_b16 v[196:197], v226 offset:43008
    ds_read_b64_tr_b16 v[198:199], v226 offset:43520
    v_exp_f32_e64 v217, -v217
    v_fma_f32 v216, v216, v232, v232
    s_waitcnt lgkmcnt(6)
    v_mfma_f32_32x32x16_bf16 v[160:175], v[184:187], v[24:27], v[160:175]
    ds_read_b64_tr_b16 v[200:201], v226 offset:45056
    ds_read_b64_tr_b16 v[202:203], v226 offset:45568
    v_fma_f32 v217, v217, v232, v232
    v_rcp_f32 v216, v216
    s_waitcnt lgkmcnt(6)
    v_mfma_f32_32x32x16_bf16 v[160:175], v[188:191], v[28:31], v[160:175]
    ds_read_b64_tr_b16 v[204:205], v226 offset:47104
    ds_read_b64_tr_b16 v[206:207], v226 offset:47616
    v_rcp_f32 v217, v217
    s_waitcnt vmcnt(5)
    s_barrier
    v_mul_f32 v216, v144, v216
    v_mul_f32 v217, v145, v217
    v_cvt_pk_bf16_f32 v208, v216, v217
    s_add_u32 m0, s45, 32768
    s_mov_b32 s49, 512
    buffer_load_dwordx4 v224, s[28:31], s49 offen lds
    s_waitcnt lgkmcnt(6)
    v_mfma_f32_32x32x16_bf16 v[160:175], v[192:195], v[32:35], v[160:175]
    ds_read_b64_tr_b16 v[176:177], v226 offset:49152
    ds_read_b64_tr_b16 v[178:179], v226 offset:49664
    v_mul_f32 v216, v146, v231
    v_mul_f32 v217, v147, v231
    v_exp_f32_e64 v216, -v216
    s_waitcnt lgkmcnt(6)
    v_mfma_f32_32x32x16_bf16 v[160:175], v[196:199], v[36:39], v[160:175]
    ds_read_b64_tr_b16 v[180:181], v226 offset:51200
    ds_read_b64_tr_b16 v[182:183], v226 offset:51712
    v_exp_f32_e64 v217, -v217
    v_fma_f32 v216, v216, v232, v232
    s_waitcnt lgkmcnt(6)
    v_mfma_f32_32x32x16_bf16 v[160:175], v[200:203], v[40:43], v[160:175]
    ds_read_b64_tr_b16 v[184:185], v226 offset:53248
    ds_read_b64_tr_b16 v[186:187], v226 offset:53760
    v_fma_f32 v217, v217, v232, v232
    v_rcp_f32 v216, v216
    s_waitcnt lgkmcnt(6)
    v_mfma_f32_32x32x16_bf16 v[160:175], v[204:207], v[44:47], v[160:175]
    ds_read_b64_tr_b16 v[188:189], v226 offset:55296
    ds_read_b64_tr_b16 v[190:191], v226 offset:55808
    v_rcp_f32 v217, v217
    s_waitcnt vmcnt(5)
    s_barrier
    v_mul_f32 v216, v146, v216
    v_mul_f32 v217, v147, v217
    v_cvt_pk_bf16_f32 v209, v216, v217
    s_add_u32 m0, s45, 40960
    s_mov_b32 s49, 590336
    buffer_load_dwordx4 v224, s[28:31], s49 offen lds
    s_waitcnt lgkmcnt(6)
    v_mfma_f32_32x32x16_bf16 v[160:175], v[176:179], v[48:51], v[160:175]
    ds_read_b64_tr_b16 v[192:193], v226 offset:57344
    ds_read_b64_tr_b16 v[194:195], v226 offset:57856
    v_mul_f32 v216, v148, v231
    v_mul_f32 v217, v149, v231
    v_exp_f32_e64 v216, -v216
    s_waitcnt lgkmcnt(6)
    v_mfma_f32_32x32x16_bf16 v[160:175], v[180:183], v[52:55], v[160:175]
    ds_read_b64_tr_b16 v[196:197], v226 offset:59392
    ds_read_b64_tr_b16 v[198:199], v226 offset:59904
    v_exp_f32_e64 v217, -v217
    v_fma_f32 v216, v216, v232, v232
    s_waitcnt lgkmcnt(6)
    v_mfma_f32_32x32x16_bf16 v[160:175], v[184:187], v[56:59], v[160:175]
    ds_read_b64_tr_b16 v[200:201], v226 offset:61440
    ds_read_b64_tr_b16 v[202:203], v226 offset:61952
    v_fma_f32 v217, v217, v232, v232
    v_rcp_f32 v216, v216
    s_waitcnt lgkmcnt(6)
    v_mfma_f32_32x32x16_bf16 v[160:175], v[188:191], v[60:63], v[160:175]
    ds_read_b64_tr_b16 v[204:205], v226 offset:63488
    ds_read_b64_tr_b16 v[206:207], v226 offset:64000
    v_rcp_f32 v217, v217
    s_waitcnt vmcnt(5)
    s_barrier
    v_mul_f32 v216, v148, v216
    v_mul_f32 v217, v149, v217
    v_cvt_pk_bf16_f32 v210, v216, v217
    s_add_u32 m0, s45, 49152
    s_mov_b32 s49, 1180160
    buffer_load_dwordx4 v224, s[28:31], s49 offen lds
    s_waitcnt lgkmcnt(6)
    v_mfma_f32_32x32x16_bf16 v[160:175], v[192:195], v[64:67], v[160:175]
    ds_read_b64_tr_b16 v[176:177], v226 offset:0
    ds_read_b64_tr_b16 v[178:179], v226 offset:512
    v_mul_f32 v216, v150, v231
    v_mul_f32 v217, v151, v231
    v_exp_f32_e64 v216, -v216
    s_waitcnt lgkmcnt(6)
    v_mfma_f32_32x32x16_bf16 v[160:175], v[196:199], v[68:71], v[160:175]
    ds_read_b64_tr_b16 v[180:181], v226 offset:2048
    ds_read_b64_tr_b16 v[182:183], v226 offset:2560
    v_exp_f32_e64 v217, -v217
    v_fma_f32 v216, v216, v232, v232
    s_waitcnt lgkmcnt(6)
    v_mfma_f32_32x32x16_bf16 v[160:175], v[200:203], v[72:75], v[160:175]
    ds_read_b64_tr_b16 v[184:185], v226 offset:4096
    ds_read_b64_tr_b16 v[186:187], v226 offset:4608
    v_fma_f32 v217, v217, v232, v232
    v_rcp_f32 v216, v216
    s_waitcnt lgkmcnt(6)
    v_mfma_f32_32x32x16_bf16 v[160:175], v[204:207], v[76:79], v[160:175]
    ds_read_b64_tr_b16 v[188:189], v226 offset:6144
    ds_read_b64_tr_b16 v[190:191], v226 offset:6656
    v_rcp_f32 v217, v217
    s_waitcnt vmcnt(5)
    s_barrier
    v_mul_f32 v216, v150, v216
    v_mul_f32 v217, v151, v217
    v_cvt_pk_bf16_f32 v211, v216, v217
    ds_write_b128 v228, v[208:211] offset:8192
    s_add_u32 m0, s45, 57344
    s_mov_b32 s49, 1769984
    buffer_load_dwordx4 v224, s[28:31], s49 offen lds
    s_waitcnt lgkmcnt(7)
    v_mfma_f32_32x32x16_bf16 v[160:175], v[176:179], v[80:83], v[160:175]
    ds_read_b64_tr_b16 v[192:193], v226 offset:8192
    ds_read_b64_tr_b16 v[194:195], v226 offset:8704
    v_mul_f32 v216, v152, v231
    v_mul_f32 v217, v153, v231
    v_exp_f32_e64 v216, -v216
    s_waitcnt lgkmcnt(7)
    v_mfma_f32_32x32x16_bf16 v[160:175], v[180:183], v[84:87], v[160:175]
    ds_read_b64_tr_b16 v[196:197], v226 offset:10240
    ds_read_b64_tr_b16 v[198:199], v226 offset:10752
    v_exp_f32_e64 v217, -v217
    v_fma_f32 v216, v216, v232, v232
    s_waitcnt lgkmcnt(7)
    v_mfma_f32_32x32x16_bf16 v[160:175], v[184:187], v[88:91], v[160:175]
    ds_read_b64_tr_b16 v[200:201], v226 offset:12288
    ds_read_b64_tr_b16 v[202:203], v226 offset:12800
    v_fma_f32 v217, v217, v232, v232
    v_rcp_f32 v216, v216
    s_waitcnt lgkmcnt(7)
    v_mfma_f32_32x32x16_bf16 v[160:175], v[188:191], v[92:95], v[160:175]
    ds_read_b64_tr_b16 v[204:205], v226 offset:14336
    ds_read_b64_tr_b16 v[206:207], v226 offset:14848
    v_rcp_f32 v217, v217
    s_waitcnt vmcnt(5) lgkmcnt(8)
    s_barrier
    v_mul_f32 v216, v152, v216
    v_mul_f32 v217, v153, v217
    v_cvt_pk_bf16_f32 v212, v216, v217
    s_add_u32 m0, s45, 0
    s_mov_b32 s49, 2359808
    buffer_load_dwordx4 v224, s[28:31], s49 offen lds
    s_waitcnt lgkmcnt(6)
    v_mfma_f32_32x32x16_bf16 v[160:175], v[192:195], v[96:99], v[160:175]
    ds_read_b64_tr_b16 v[176:177], v226 offset:16384
    ds_read_b64_tr_b16 v[178:179], v226 offset:16896
    v_mul_f32 v216, v154, v231
    v_mul_f32 v217, v155, v231
    v_exp_f32_e64 v216, -v216
    s_waitcnt lgkmcnt(6)
    v_mfma_f32_32x32x16_bf16 v[160:175], v[196:199], v[100:103], v[160:175]
    ds_read_b64_tr_b16 v[180:181], v226 offset:18432
    ds_read_b64_tr_b16 v[182:183], v226 offset:18944
    v_exp_f32_e64 v217, -v217
    v_fma_f32 v216, v216, v232, v232
    s_waitcnt lgkmcnt(6)
    v_mfma_f32_32x32x16_bf16 v[160:175], v[200:203], v[104:107], v[160:175]
    ds_read_b64_tr_b16 v[184:185], v226 offset:20480
    ds_read_b64_tr_b16 v[186:187], v226 offset:20992
    v_fma_f32 v217, v217, v232, v232
    v_rcp_f32 v216, v216
    s_waitcnt lgkmcnt(6)
    v_mfma_f32_32x32x16_bf16 v[160:175], v[204:207], v[108:111], v[160:175]
    ds_read_b64_tr_b16 v[188:189], v226 offset:22528
    ds_read_b64_tr_b16 v[190:191], v226 offset:23040
    v_rcp_f32 v217, v217
    s_waitcnt vmcnt(5)
    s_barrier
    v_mul_f32 v216, v154, v216
    v_mul_f32 v217, v155, v217
    v_cvt_pk_bf16_f32 v213, v216, v217
    s_add_u32 m0, s45, 8192
    s_mov_b32 s49, 2949632
    buffer_load_dwordx4 v224, s[28:31], s49 offen lds
    s_waitcnt lgkmcnt(6)
    v_mfma_f32_32x32x16_bf16 v[160:175], v[176:179], v[112:115], v[160:175]
    ds_read_b64_tr_b16 v[192:193], v226 offset:24576
    ds_read_b64_tr_b16 v[194:195], v226 offset:25088
    v_mul_f32 v216, v156, v231
    v_mul_f32 v217, v157, v231
    v_exp_f32_e64 v216, -v216
    s_waitcnt lgkmcnt(6)
    v_mfma_f32_32x32x16_bf16 v[160:175], v[180:183], v[116:119], v[160:175]
    ds_read_b64_tr_b16 v[196:197], v226 offset:26624
    ds_read_b64_tr_b16 v[198:199], v226 offset:27136
    v_exp_f32_e64 v217, -v217
    v_fma_f32 v216, v216, v232, v232
    s_waitcnt lgkmcnt(6)
    v_mfma_f32_32x32x16_bf16 v[160:175], v[184:187], v[120:123], v[160:175]
    ds_read_b64_tr_b16 v[200:201], v226 offset:28672
    ds_read_b64_tr_b16 v[202:203], v226 offset:29184
    v_fma_f32 v217, v217, v232, v232
    v_rcp_f32 v216, v216
    s_waitcnt lgkmcnt(6)
    v_mfma_f32_32x32x16_bf16 v[160:175], v[188:191], v[124:127], v[160:175]
    ds_read_b64_tr_b16 v[204:205], v226 offset:30720
    ds_read_b64_tr_b16 v[206:207], v226 offset:31232
    v_rcp_f32 v217, v217
    s_waitcnt vmcnt(5)
    s_barrier
    v_mul_f32 v216, v156, v216
    v_mul_f32 v217, v157, v217
    v_cvt_pk_bf16_f32 v214, v216, v217
    s_add_u32 m0, s45, 16384
    s_mov_b32 s49, 3539456
    buffer_load_dwordx4 v224, s[28:31], s49 offen lds
    s_waitcnt lgkmcnt(6)
    v_mfma_f32_32x32x16_bf16 v[160:175], v[192:195], v[128:131], v[160:175]
    ds_read_b64_tr_b16 v[176:177], v226 offset:32768
    ds_read_b64_tr_b16 v[178:179], v226 offset:33280
    v_mul_f32 v216, v158, v231
    v_mul_f32 v217, v159, v231
    v_exp_f32_e64 v216, -v216
    s_waitcnt lgkmcnt(6)
    v_mfma_f32_32x32x16_bf16 v[160:175], v[196:199], v[132:135], v[160:175]
    ds_read_b64_tr_b16 v[180:181], v226 offset:34816
    ds_read_b64_tr_b16 v[182:183], v226 offset:35328
    v_exp_f32_e64 v217, -v217
    v_fma_f32 v216, v216, v232, v232
    s_waitcnt lgkmcnt(6)
    v_mfma_f32_32x32x16_bf16 v[160:175], v[200:203], v[136:139], v[160:175]
    ds_read_b64_tr_b16 v[184:185], v226 offset:36864
    ds_read_b64_tr_b16 v[186:187], v226 offset:37376
    v_fma_f32 v217, v217, v232, v232
    v_rcp_f32 v216, v216
    s_waitcnt lgkmcnt(6)
    v_mfma_f32_32x32x16_bf16 v[160:175], v[204:207], v[140:143], v[160:175]
    ds_read_b64_tr_b16 v[188:189], v226 offset:38912
    ds_read_b64_tr_b16 v[190:191], v226 offset:39424
    v_rcp_f32 v217, v217
    s_waitcnt vmcnt(5)
    s_barrier
    v_mul_f32 v216, v158, v216
    v_mul_f32 v217, v159, v217
    v_cvt_pk_bf16_f32 v215, v216, v217
    ds_write_b128 v228, v[212:215] offset:9216
    s_add_u32 m0, s45, 24576
    s_mov_b32 s49, 4129280
    buffer_load_dwordx4 v224, s[28:31], s49 offen lds
    s_waitcnt lgkmcnt(7)
    v_mfma_f32_32x32x16_bf16 v[144:159], v[176:179], v[0:3], 0
    ds_read_b64_tr_b16 v[192:193], v226 offset:40960
    ds_read_b64_tr_b16 v[194:195], v226 offset:41472
    s_waitcnt lgkmcnt(7)
    v_mfma_f32_32x32x16_bf16 v[144:159], v[180:183], v[4:7], v[144:159]
    ds_read_b64_tr_b16 v[196:197], v226 offset:43008
    ds_read_b64_tr_b16 v[198:199], v226 offset:43520
    s_waitcnt lgkmcnt(7)
    v_mfma_f32_32x32x16_bf16 v[144:159], v[184:187], v[8:11], v[144:159]
    ds_read_b64_tr_b16 v[200:201], v226 offset:45056
    ds_read_b64_tr_b16 v[202:203], v226 offset:45568
    s_waitcnt lgkmcnt(7)
    v_mfma_f32_32x32x16_bf16 v[144:159], v[188:191], v[12:15], v[144:159]
    ds_read_b64_tr_b16 v[204:205], v226 offset:47104
    ds_read_b64_tr_b16 v[206:207], v226 offset:47616
    s_waitcnt vmcnt(5) lgkmcnt(8)
    s_barrier
    s_add_u32 m0, s45, 32768
    s_mov_b32 s49, 4719104
    buffer_load_dwordx4 v224, s[28:31], s49 offen lds
    s_waitcnt lgkmcnt(6)
    v_mfma_f32_32x32x16_bf16 v[144:159], v[192:195], v[16:19], v[144:159]
    ds_read_b64_tr_b16 v[176:177], v226 offset:49152
    ds_read_b64_tr_b16 v[178:179], v226 offset:49664
    v_mul_f32 v216, v160, v231
    v_mul_f32 v217, v161, v231
    v_exp_f32_e64 v216, -v216
    s_waitcnt lgkmcnt(6)
    v_mfma_f32_32x32x16_bf16 v[144:159], v[196:199], v[20:23], v[144:159]
    ds_read_b64_tr_b16 v[180:181], v226 offset:51200
    ds_read_b64_tr_b16 v[182:183], v226 offset:51712
    v_exp_f32_e64 v217, -v217
    v_fma_f32 v216, v216, v232, v232
    s_waitcnt lgkmcnt(6)
    v_mfma_f32_32x32x16_bf16 v[144:159], v[200:203], v[24:27], v[144:159]
    ds_read_b64_tr_b16 v[184:185], v226 offset:53248
    ds_read_b64_tr_b16 v[186:187], v226 offset:53760
    v_fma_f32 v217, v217, v232, v232
    v_rcp_f32 v216, v216
    s_waitcnt lgkmcnt(6)
    v_mfma_f32_32x32x16_bf16 v[144:159], v[204:207], v[28:31], v[144:159]
    ds_read_b64_tr_b16 v[188:189], v226 offset:55296
    ds_read_b64_tr_b16 v[190:191], v226 offset:55808
    v_rcp_f32 v217, v217
    s_waitcnt vmcnt(5)
    s_barrier
    v_mul_f32 v216, v160, v216
    v_mul_f32 v217, v161, v217
    v_cvt_pk_bf16_f32 v208, v216, v217
    s_add_u32 m0, s45, 40960
    s_mov_b32 s49, 640
    buffer_load_dwordx4 v224, s[28:31], s49 offen lds
    s_waitcnt lgkmcnt(6)
    v_mfma_f32_32x32x16_bf16 v[144:159], v[176:179], v[32:35], v[144:159]
    ds_read_b64_tr_b16 v[192:193], v226 offset:57344
    ds_read_b64_tr_b16 v[194:195], v226 offset:57856
    v_mul_f32 v216, v162, v231
    v_mul_f32 v217, v163, v231
    v_exp_f32_e64 v216, -v216
    s_waitcnt lgkmcnt(6)
    v_mfma_f32_32x32x16_bf16 v[144:159], v[180:183], v[36:39], v[144:159]
    ds_read_b64_tr_b16 v[196:197], v226 offset:59392
    ds_read_b64_tr_b16 v[198:199], v226 offset:59904
    v_exp_f32_e64 v217, -v217
    v_fma_f32 v216, v216, v232, v232
    s_waitcnt lgkmcnt(6)
    v_mfma_f32_32x32x16_bf16 v[144:159], v[184:187], v[40:43], v[144:159]
    ds_read_b64_tr_b16 v[200:201], v226 offset:61440
    ds_read_b64_tr_b16 v[202:203], v226 offset:61952
    v_fma_f32 v217, v217, v232, v232
    v_rcp_f32 v216, v216
    s_waitcnt lgkmcnt(6)
    v_mfma_f32_32x32x16_bf16 v[144:159], v[188:191], v[44:47], v[144:159]
    ds_read_b64_tr_b16 v[204:205], v226 offset:63488
    ds_read_b64_tr_b16 v[206:207], v226 offset:64000
    v_rcp_f32 v217, v217
    s_waitcnt vmcnt(5)
    s_barrier
    v_mul_f32 v216, v162, v216
    v_mul_f32 v217, v163, v217
    v_cvt_pk_bf16_f32 v209, v216, v217
    s_add_u32 m0, s45, 49152
    s_mov_b32 s49, 590464
    buffer_load_dwordx4 v224, s[28:31], s49 offen lds
    s_waitcnt lgkmcnt(6)
    v_mfma_f32_32x32x16_bf16 v[144:159], v[192:195], v[48:51], v[144:159]
    ds_read_b64_tr_b16 v[176:177], v226 offset:0
    ds_read_b64_tr_b16 v[178:179], v226 offset:512
    v_mul_f32 v216, v164, v231
    v_mul_f32 v217, v165, v231
    v_exp_f32_e64 v216, -v216
    s_waitcnt lgkmcnt(6)
    v_mfma_f32_32x32x16_bf16 v[144:159], v[196:199], v[52:55], v[144:159]
    ds_read_b64_tr_b16 v[180:181], v226 offset:2048
    ds_read_b64_tr_b16 v[182:183], v226 offset:2560
    v_exp_f32_e64 v217, -v217
    v_fma_f32 v216, v216, v232, v232
    s_waitcnt lgkmcnt(6)
    v_mfma_f32_32x32x16_bf16 v[144:159], v[200:203], v[56:59], v[144:159]
    ds_read_b64_tr_b16 v[184:185], v226 offset:4096
    ds_read_b64_tr_b16 v[186:187], v226 offset:4608
    v_fma_f32 v217, v217, v232, v232
    v_rcp_f32 v216, v216
    s_waitcnt lgkmcnt(6)
    v_mfma_f32_32x32x16_bf16 v[144:159], v[204:207], v[60:63], v[144:159]
    ds_read_b64_tr_b16 v[188:189], v226 offset:6144
    ds_read_b64_tr_b16 v[190:191], v226 offset:6656
    v_rcp_f32 v217, v217
    s_waitcnt vmcnt(5)
    s_barrier
    v_mul_f32 v216, v164, v216
    v_mul_f32 v217, v165, v217
    v_cvt_pk_bf16_f32 v210, v216, v217
    s_add_u32 m0, s45, 57344
    s_mov_b32 s49, 1180288
    buffer_load_dwordx4 v224, s[28:31], s49 offen lds
    s_waitcnt lgkmcnt(6)
    v_mfma_f32_32x32x16_bf16 v[144:159], v[176:179], v[64:67], v[144:159]
    ds_read_b64_tr_b16 v[192:193], v226 offset:8192
    ds_read_b64_tr_b16 v[194:195], v226 offset:8704
    v_mul_f32 v216, v166, v231
    v_mul_f32 v217, v167, v231
    v_exp_f32_e64 v216, -v216
    s_waitcnt lgkmcnt(6)
    v_mfma_f32_32x32x16_bf16 v[144:159], v[180:183], v[68:71], v[144:159]
    ds_read_b64_tr_b16 v[196:197], v226 offset:10240
    ds_read_b64_tr_b16 v[198:199], v226 offset:10752
    v_exp_f32_e64 v217, -v217
    v_fma_f32 v216, v216, v232, v232
    s_waitcnt lgkmcnt(6)
    v_mfma_f32_32x32x16_bf16 v[144:159], v[184:187], v[72:75], v[144:159]
    ds_read_b64_tr_b16 v[200:201], v226 offset:12288
    ds_read_b64_tr_b16 v[202:203], v226 offset:12800
    v_fma_f32 v217, v217, v232, v232
    v_rcp_f32 v216, v216
    s_waitcnt lgkmcnt(6)
    v_mfma_f32_32x32x16_bf16 v[144:159], v[188:191], v[76:79], v[144:159]
    ds_read_b64_tr_b16 v[204:205], v226 offset:14336
    ds_read_b64_tr_b16 v[206:207], v226 offset:14848
    v_rcp_f32 v217, v217
    s_waitcnt vmcnt(5)
    s_barrier
    v_mul_f32 v216, v166, v216
    v_mul_f32 v217, v167, v217
    v_cvt_pk_bf16_f32 v211, v216, v217
    ds_write_b128 v228, v[208:211] offset:12288
    s_add_u32 m0, s45, 0
    s_mov_b32 s49, 1770112
    buffer_load_dwordx4 v224, s[28:31], s49 offen lds
    s_waitcnt lgkmcnt(7)
    v_mfma_f32_32x32x16_bf16 v[144:159], v[192:195], v[80:83], v[144:159]
    ds_read_b64_tr_b16 v[176:177], v226 offset:16384
    ds_read_b64_tr_b16 v[178:179], v226 offset:16896
    v_mul_f32 v216, v168, v231
    v_mul_f32 v217, v169, v231
    v_exp_f32_e64 v216, -v216
    s_waitcnt lgkmcnt(7)
    v_mfma_f32_32x32x16_bf16 v[144:159], v[196:199], v[84:87], v[144:159]
    ds_read_b64_tr_b16 v[180:181], v226 offset:18432
    ds_read_b64_tr_b16 v[182:183], v226 offset:18944
    v_exp_f32_e64 v217, -v217
    v_fma_f32 v216, v216, v232, v232
    s_waitcnt lgkmcnt(7)
    v_mfma_f32_32x32x16_bf16 v[144:159], v[200:203], v[88:91], v[144:159]
    ds_read_b64_tr_b16 v[184:185], v226 offset:20480
    ds_read_b64_tr_b16 v[186:187], v226 offset:20992
    v_fma_f32 v217, v217, v232, v232
    v_rcp_f32 v216, v216
    s_waitcnt lgkmcnt(7)
    v_mfma_f32_32x32x16_bf16 v[144:159], v[204:207], v[92:95], v[144:159]
    ds_read_b64_tr_b16 v[188:189], v226 offset:22528
    ds_read_b64_tr_b16 v[190:191], v226 offset:23040
    v_rcp_f32 v217, v217
    s_waitcnt vmcnt(5) lgkmcnt(8)
    s_barrier
    v_mul_f32 v216, v168, v216
    v_mul_f32 v217, v169, v217
    v_cvt_pk_bf16_f32 v212, v216, v217
    s_add_u32 m0, s45, 8192
    s_mov_b32 s49, 2359936
    buffer_load_dwordx4 v224, s[28:31], s49 offen lds
    s_waitcnt lgkmcnt(6)
    v_mfma_f32_32x32x16_bf16 v[144:159], v[176:179], v[96:99], v[144:159]
    ds_read_b64_tr_b16 v[192:193], v226 offset:24576
    ds_read_b64_tr_b16 v[194:195], v226 offset:25088
    v_mul_f32 v216, v170, v231
    v_mul_f32 v217, v171, v231
    v_exp_f32_e64 v216, -v216
    s_waitcnt lgkmcnt(6)
    v_mfma_f32_32x32x16_bf16 v[144:159], v[180:183], v[100:103], v[144:159]
    ds_read_b64_tr_b16 v[196:197], v226 offset:26624
    ds_read_b64_tr_b16 v[198:199], v226 offset:27136
    v_exp_f32_e64 v217, -v217
    v_fma_f32 v216, v216, v232, v232
    s_waitcnt lgkmcnt(6)
    v_mfma_f32_32x32x16_bf16 v[144:159], v[184:187], v[104:107], v[144:159]
    ds_read_b64_tr_b16 v[200:201], v226 offset:28672
    ds_read_b64_tr_b16 v[202:203], v226 offset:29184
    v_fma_f32 v217, v217, v232, v232
    v_rcp_f32 v216, v216
    s_waitcnt lgkmcnt(6)
    v_mfma_f32_32x32x16_bf16 v[144:159], v[188:191], v[108:111], v[144:159]
    ds_read_b64_tr_b16 v[204:205], v226 offset:30720
    ds_read_b64_tr_b16 v[206:207], v226 offset:31232
    v_rcp_f32 v217, v217
    s_waitcnt vmcnt(5)
    s_barrier
    v_mul_f32 v216, v170, v216
    v_mul_f32 v217, v171, v217
    v_cvt_pk_bf16_f32 v213, v216, v217
    s_add_u32 m0, s45, 16384
    s_mov_b32 s49, 2949760
    buffer_load_dwordx4 v224, s[28:31], s49 offen lds
    s_waitcnt lgkmcnt(6)
    v_mfma_f32_32x32x16_bf16 v[144:159], v[192:195], v[112:115], v[144:159]
    ds_read_b64_tr_b16 v[176:177], v226 offset:32768
    ds_read_b64_tr_b16 v[178:179], v226 offset:33280
    v_mul_f32 v216, v172, v231
    v_mul_f32 v217, v173, v231
    v_exp_f32_e64 v216, -v216
    s_waitcnt lgkmcnt(6)
    v_mfma_f32_32x32x16_bf16 v[144:159], v[196:199], v[116:119], v[144:159]
    ds_read_b64_tr_b16 v[180:181], v226 offset:34816
    ds_read_b64_tr_b16 v[182:183], v226 offset:35328
    v_exp_f32_e64 v217, -v217
    v_fma_f32 v216, v216, v232, v232
    s_waitcnt lgkmcnt(6)
    v_mfma_f32_32x32x16_bf16 v[144:159], v[200:203], v[120:123], v[144:159]
    ds_read_b64_tr_b16 v[184:185], v226 offset:36864
    ds_read_b64_tr_b16 v[186:187], v226 offset:37376
    v_fma_f32 v217, v217, v232, v232
    v_rcp_f32 v216, v216
    s_waitcnt lgkmcnt(6)
    v_mfma_f32_32x32x16_bf16 v[144:159], v[204:207], v[124:127], v[144:159]
    ds_read_b64_tr_b16 v[188:189], v226 offset:38912
    ds_read_b64_tr_b16 v[190:191], v226 offset:39424
    v_rcp_f32 v217, v217
    s_waitcnt vmcnt(5)
    s_barrier
    v_mul_f32 v216, v172, v216
    v_mul_f32 v217, v173, v217
    v_cvt_pk_bf16_f32 v214, v216, v217
    s_add_u32 m0, s45, 24576
    s_mov_b32 s49, 3539584
    buffer_load_dwordx4 v224, s[28:31], s49 offen lds
    s_waitcnt lgkmcnt(6)
    v_mfma_f32_32x32x16_bf16 v[144:159], v[176:179], v[128:131], v[144:159]
    ds_read_b64_tr_b16 v[192:193], v226 offset:40960
    ds_read_b64_tr_b16 v[194:195], v226 offset:41472
    v_mul_f32 v216, v174, v231
    v_mul_f32 v217, v175, v231
    v_exp_f32_e64 v216, -v216
    s_waitcnt lgkmcnt(6)
    v_mfma_f32_32x32x16_bf16 v[144:159], v[180:183], v[132:135], v[144:159]
    ds_read_b64_tr_b16 v[196:197], v226 offset:43008
    ds_read_b64_tr_b16 v[198:199], v226 offset:43520
    v_exp_f32_e64 v217, -v217
    v_fma_f32 v216, v216, v232, v232
    s_waitcnt lgkmcnt(6)
    v_mfma_f32_32x32x16_bf16 v[144:159], v[184:187], v[136:139], v[144:159]
    ds_read_b64_tr_b16 v[200:201], v226 offset:45056
    ds_read_b64_tr_b16 v[202:203], v226 offset:45568
    v_fma_f32 v217, v217, v232, v232
    v_rcp_f32 v216, v216
    s_waitcnt lgkmcnt(6)
    v_mfma_f32_32x32x16_bf16 v[144:159], v[188:191], v[140:143], v[144:159]
    ds_read_b64_tr_b16 v[204:205], v226 offset:47104
    ds_read_b64_tr_b16 v[206:207], v226 offset:47616
    v_rcp_f32 v217, v217
    s_waitcnt vmcnt(5)
    s_barrier
    v_mul_f32 v216, v174, v216
    v_mul_f32 v217, v175, v217
    v_cvt_pk_bf16_f32 v215, v216, v217
    ds_write_b128 v228, v[212:215] offset:13312
    s_add_u32 m0, s45, 32768
    s_mov_b32 s49, 4129408
    buffer_load_dwordx4 v224, s[28:31], s49 offen lds
    s_waitcnt lgkmcnt(7)
    v_mfma_f32_32x32x16_bf16 v[160:175], v[192:195], v[0:3], 0
    ds_read_b64_tr_b16 v[176:177], v226 offset:49152
    ds_read_b64_tr_b16 v[178:179], v226 offset:49664
    s_waitcnt lgkmcnt(7)
    v_mfma_f32_32x32x16_bf16 v[160:175], v[196:199], v[4:7], v[160:175]
    ds_read_b64_tr_b16 v[180:181], v226 offset:51200
    ds_read_b64_tr_b16 v[182:183], v226 offset:51712
    s_waitcnt lgkmcnt(7)
    v_mfma_f32_32x32x16_bf16 v[160:175], v[200:203], v[8:11], v[160:175]
    ds_read_b64_tr_b16 v[184:185], v226 offset:53248
    ds_read_b64_tr_b16 v[186:187], v226 offset:53760
    s_waitcnt lgkmcnt(7)
    v_mfma_f32_32x32x16_bf16 v[160:175], v[204:207], v[12:15], v[160:175]
    ds_read_b64_tr_b16 v[188:189], v226 offset:55296
    ds_read_b64_tr_b16 v[190:191], v226 offset:55808
    s_waitcnt vmcnt(5) lgkmcnt(8)
    s_barrier
    s_add_u32 m0, s45, 40960
    s_mov_b32 s49, 4719232
    buffer_load_dwordx4 v224, s[28:31], s49 offen lds
    s_waitcnt lgkmcnt(6)
    v_mfma_f32_32x32x16_bf16 v[160:175], v[176:179], v[16:19], v[160:175]
    ds_read_b64_tr_b16 v[192:193], v226 offset:57344
    ds_read_b64_tr_b16 v[194:195], v226 offset:57856
    v_mul_f32 v216, v144, v231
    v_mul_f32 v217, v145, v231
    v_exp_f32_e64 v216, -v216
    ds_read_b128 v[0:3], v229 offset:0
    s_waitcnt lgkmcnt(7)
    v_mfma_f32_32x32x16_bf16 v[160:175], v[180:183], v[20:23], v[160:175]
    ds_read_b64_tr_b16 v[196:197], v226 offset:59392
    ds_read_b64_tr_b16 v[198:199], v226 offset:59904
    v_exp_f32_e64 v217, -v217
    v_fma_f32 v216, v216, v232, v232
    ds_read_b128 v[4:7], v229 offset:1024
    s_waitcnt lgkmcnt(8)
    v_mfma_f32_32x32x16_bf16 v[160:175], v[184:187], v[24:27], v[160:175]
    ds_read_b64_tr_b16 v[200:201], v226 offset:61440
    ds_read_b64_tr_b16 v[202:203], v226 offset:61952
    v_fma_f32 v217, v217, v232, v232
    v_rcp_f32 v216, v216
    ds_read_b128 v[8:11], v229 offset:2048
    s_waitcnt lgkmcnt(9)
    v_mfma_f32_32x32x16_bf16 v[160:175], v[188:191], v[28:31], v[160:175]
    ds_read_b64_tr_b16 v[204:205], v226 offset:63488
    ds_read_b64_tr_b16 v[206:207], v226 offset:64000
    v_rcp_f32 v217, v217
    ds_read_b128 v[12:15], v229 offset:3072
    s_waitcnt vmcnt(5)
    s_barrier
    v_mul_f32 v216, v144, v216
    v_mul_f32 v217, v145, v217
    v_cvt_pk_bf16_f32 v208, v216, v217
    s_add_u32 m0, s45, 49152
    s_mov_b32 s49, 0
    buffer_load_dwordx4 v225, s[32:35], s49 offen lds
    s_waitcnt lgkmcnt(10)
    v_mfma_f32_32x32x16_bf16 v[160:175], v[192:195], v[32:35], v[160:175]
    ds_read_b64_tr_b16 v[176:177], v226 offset:0
    ds_read_b64_tr_b16 v[178:179], v226 offset:512
    v_mul_f32 v216, v146, v231
    v_mul_f32 v217, v147, v231
    v_exp_f32_e64 v216, -v216
    ds_read_b128 v[16:19], v229 offset:4096
    s_waitcnt lgkmcnt(10)
    v_mfma_f32_32x32x16_bf16 v[160:175], v[196:199], v[36:39], v[160:175]
    ds_read_b64_tr_b16 v[180:181], v226 offset:2048
    ds_read_b64_tr_b16 v[182:183], v226 offset:2560
    v_exp_f32_e64 v217, -v217
    v_fma_f32 v216, v216, v232, v232
    ds_read_b128 v[20:23], v229 offset:5120
    s_waitcnt lgkmcnt(10)
    v_mfma_f32_32x32x16_bf16 v[160:175], v[200:203], v[40:43], v[160:175]
    ds_read_b64_tr_b16 v[184:185], v226 offset:4096
    ds_read_b64_tr_b16 v[186:187], v226 offset:4608
    v_fma_f32 v217, v217, v232, v232
    v_rcp_f32 v216, v216
    ds_read_b128 v[24:27], v229 offset:6144
    s_waitcnt lgkmcnt(10)
    v_mfma_f32_32x32x16_bf16 v[160:175], v[204:207], v[44:47], v[160:175]
    ds_read_b64_tr_b16 v[188:189], v226 offset:6144
    ds_read_b64_tr_b16 v[190:191], v226 offset:6656
    v_rcp_f32 v217, v217
    ds_read_b128 v[28:31], v229 offset:7168
    s_waitcnt vmcnt(5)
    s_barrier
    v_mul_f32 v216, v146, v216
    v_mul_f32 v217, v147, v217
    v_cvt_pk_bf16_f32 v209, v216, v217
    s_add_u32 m0, s45, 57344
    s_mov_b32 s49, 73728
    buffer_load_dwordx4 v225, s[32:35], s49 offen lds
    s_waitcnt lgkmcnt(10)
    v_mfma_f32_32x32x16_bf16 v[160:175], v[176:179], v[48:51], v[160:175]
    ds_read_b64_tr_b16 v[192:193], v226 offset:8192
    ds_read_b64_tr_b16 v[194:195], v226 offset:8704
    v_mul_f32 v216, v148, v231
    v_mul_f32 v217, v149, v231
    v_exp_f32_e64 v216, -v216
    ds_read_b128 v[32:35], v229 offset:8192
    s_waitcnt lgkmcnt(10)
    v_mfma_f32_32x32x16_bf16 v[160:175], v[180:183], v[52:55], v[160:175]
    ds_read_b64_tr_b16 v[196:197], v226 offset:10240
    ds_read_b64_tr_b16 v[198:199], v226 offset:10752
    v_exp_f32_e64 v217, -v217
    v_fma_f32 v216, v216, v232, v232
    ds_read_b128 v[36:39], v229 offset:9216
    s_waitcnt lgkmcnt(10)
    v_mfma_f32_32x32x16_bf16 v[160:175], v[184:187], v[56:59], v[160:175]
    ds_read_b64_tr_b16 v[200:201], v226 offset:12288
    ds_read_b64_tr_b16 v[202:203], v226 offset:12800
    v_fma_f32 v217, v217, v232, v232
    v_rcp_f32 v216, v216
    ds_read_b128 v[40:43], v229 offset:10240
    s_waitcnt lgkmcnt(10)
    v_mfma_f32_32x32x16_bf16 v[160:175], v[188:191], v[60:63], v[160:175]
    ds_read_b64_tr_b16 v[204:205], v226 offset:14336
    ds_read_b64_tr_b16 v[206:207], v226 offset:14848
    v_rcp_f32 v217, v217
    ds_read_b128 v[44:47], v229 offset:11264
    s_waitcnt vmcnt(5)
    s_barrier
    v_mul_f32 v216, v148, v216
    v_mul_f32 v217, v149, v217
    v_cvt_pk_bf16_f32 v210, v216, v217
    s_add_u32 m0, s45, 0
    s_mov_b32 s49, 147456
    buffer_load_dwordx4 v225, s[32:35], s49 offen lds
    s_waitcnt lgkmcnt(10)
    v_mfma_f32_32x32x16_bf16 v[160:175], v[192:195], v[64:67], v[160:175]
    ds_read_b64_tr_b16 v[176:177], v226 offset:16384
    ds_read_b64_tr_b16 v[178:179], v226 offset:16896
    v_mul_f32 v216, v150, v231
    v_mul_f32 v217, v151, v231
    v_exp_f32_e64 v216, -v216
    ds_read_b128 v[48:51], v229 offset:12288
    s_waitcnt lgkmcnt(10)
    v_mfma_f32_32x32x16_bf16 v[160:175], v[196:199], v[68:71], v[160:175]
    ds_read_b64_tr_b16 v[180:181], v226 offset:18432
    ds_read_b64_tr_b16 v[182:183], v226 offset:18944
    v_exp_f32_e64 v217, -v217
    v_fma_f32 v216, v216, v232, v232
    ds_read_b128 v[52:55], v229 offset:13312
    s_waitcnt lgkmcnt(10)
    v_mfma_f32_32x32x16_bf16 v[160:175], v[200:203], v[72:75], v[160:175]
    ds_read_b64_tr_b16 v[184:185], v226 offset:20480
    ds_read_b64_tr_b16 v[186:187], v226 offset:20992
    v_fma_f32 v217, v217, v232, v232
    v_rcp_f32 v216, v216
    ds_read_b128 v[56:59], v229 offset:14336
    s_waitcnt lgkmcnt(10)
    v_mfma_f32_32x32x16_bf16 v[160:175], v[204:207], v[76:79], v[160:175]
    ds_read_b64_tr_b16 v[188:189], v226 offset:22528
    ds_read_b64_tr_b16 v[190:191], v226 offset:23040
    v_rcp_f32 v217, v217
    ds_read_b128 v[60:63], v229 offset:15360
    s_waitcnt vmcnt(5)
    s_barrier
    v_mul_f32 v216, v150, v216
    v_mul_f32 v217, v151, v217
    v_cvt_pk_bf16_f32 v211, v216, v217
    ds_write_b128 v228, v[208:211] offset:16384
    s_add_u32 m0, s45, 8192
    s_mov_b32 s49, 221184
    buffer_load_dwordx4 v225, s[32:35], s49 offen lds
    s_waitcnt lgkmcnt(11)
    v_mfma_f32_32x32x16_bf16 v[160:175], v[176:179], v[80:83], v[160:175]
    ds_read_b64_tr_b16 v[192:193], v226 offset:24576
    ds_read_b64_tr_b16 v[194:195], v226 offset:25088
    v_mul_f32 v216, v152, v231
    v_mul_f32 v217, v153, v231
    v_exp_f32_e64 v216, -v216
    s_waitcnt lgkmcnt(10)
    v_mfma_f32_32x32x16_bf16 v[160:175], v[180:183], v[84:87], v[160:175]
    ds_read_b64_tr_b16 v[196:197], v226 offset:26624
    ds_read_b64_tr_b16 v[198:199], v226 offset:27136
    v_exp_f32_e64 v217, -v217
    v_fma_f32 v216, v216, v232, v232
    s_waitcnt lgkmcnt(9)
    v_mfma_f32_32x32x16_bf16 v[160:175], v[184:187], v[88:91], v[160:175]
    ds_read_b64_tr_b16 v[200:201], v226 offset:28672
    ds_read_b64_tr_b16 v[202:203], v226 offset:29184
    v_fma_f32 v217, v217, v232, v232
    v_rcp_f32 v216, v216
    s_waitcnt lgkmcnt(8)
    v_mfma_f32_32x32x16_bf16 v[160:175], v[188:191], v[92:95], v[160:175]
    ds_read_b64_tr_b16 v[204:205], v226 offset:30720
    ds_read_b64_tr_b16 v[206:207], v226 offset:31232
    v_rcp_f32 v217, v217
    s_waitcnt vmcnt(5) lgkmcnt(8)
    s_barrier
    v_mul_f32 v216, v152, v216
    v_mul_f32 v217, v153, v217
    v_cvt_pk_bf16_f32 v212, v216, v217
    s_add_u32 m0, s45, 16384
    s_mov_b32 s49, 294912
    buffer_load_dwordx4 v225, s[32:35], s49 offen lds
    s_waitcnt lgkmcnt(6)
    v_mfma_f32_32x32x16_bf16 v[160:175], v[192:195], v[96:99], v[160:175]
    ds_read_b64_tr_b16 v[176:177], v226 offset:32768
    ds_read_b64_tr_b16 v[178:179], v226 offset:33280
    v_mul_f32 v216, v154, v231
    v_mul_f32 v217, v155, v231
    v_exp_f32_e64 v216, -v216
    s_waitcnt lgkmcnt(6)
    v_mfma_f32_32x32x16_bf16 v[160:175], v[196:199], v[100:103], v[160:175]
    ds_read_b64_tr_b16 v[180:181], v226 offset:34816
    ds_read_b64_tr_b16 v[182:183], v226 offset:35328
    v_exp_f32_e64 v217, -v217
    v_fma_f32 v216, v216, v232, v232
    s_waitcnt lgkmcnt(6)
    v_mfma_f32_32x32x16_bf16 v[160:175], v[200:203], v[104:107], v[160:175]
    ds_read_b64_tr_b16 v[184:185], v226 offset:36864
    ds_read_b64_tr_b16 v[186:187], v226 offset:37376
    v_fma_f32 v217, v217, v232, v232
    v_rcp_f32 v216, v216
    s_waitcnt lgkmcnt(6)
    v_mfma_f32_32x32x16_bf16 v[160:175], v[204:207], v[108:111], v[160:175]
    ds_read_b64_tr_b16 v[188:189], v226 offset:38912
    ds_read_b64_tr_b16 v[190:191], v226 offset:39424
    v_rcp_f32 v217, v217
    s_waitcnt vmcnt(5)
    s_barrier
    v_mul_f32 v216, v154, v216
    v_mul_f32 v217, v155, v217
    v_cvt_pk_bf16_f32 v213, v216, v217
    s_add_u32 m0, s45, 24576
    s_mov_b32 s49, 368640
    buffer_load_dwordx4 v225, s[32:35], s49 offen lds
    s_waitcnt lgkmcnt(6)
    v_mfma_f32_32x32x16_bf16 v[160:175], v[176:179], v[112:115], v[160:175]
    ds_read_b64_tr_b16 v[192:193], v226 offset:40960
    ds_read_b64_tr_b16 v[194:195], v226 offset:41472
    v_mul_f32 v216, v156, v231
    v_mul_f32 v217, v157, v231
    v_exp_f32_e64 v216, -v216
    s_waitcnt lgkmcnt(6)
    v_mfma_f32_32x32x16_bf16 v[160:175], v[180:183], v[116:119], v[160:175]
    ds_read_b64_tr_b16 v[196:197], v226 offset:43008
    ds_read_b64_tr_b16 v[198:199], v226 offset:43520
    v_exp_f32_e64 v217, -v217
    v_fma_f32 v216, v216, v232, v232
    s_waitcnt lgkmcnt(6)
    v_mfma_f32_32x32x16_bf16 v[160:175], v[184:187], v[120:123], v[160:175]
    ds_read_b64_tr_b16 v[200:201], v226 offset:45056
    ds_read_b64_tr_b16 v[202:203], v226 offset:45568
    v_fma_f32 v217, v217, v232, v232
    v_rcp_f32 v216, v216
    s_waitcnt lgkmcnt(6)
    v_mfma_f32_32x32x16_bf16 v[160:175], v[188:191], v[124:127], v[160:175]
    ds_read_b64_tr_b16 v[204:205], v226 offset:47104
    ds_read_b64_tr_b16 v[206:207], v226 offset:47616
    v_rcp_f32 v217, v217
    s_waitcnt vmcnt(5)
    s_barrier
    v_mul_f32 v216, v156, v216
    v_mul_f32 v217, v157, v217
    v_cvt_pk_bf16_f32 v214, v216, v217
    s_add_u32 m0, s45, 32768
    s_mov_b32 s49, 128
    buffer_load_dwordx4 v225, s[32:35], s49 offen lds
    s_waitcnt lgkmcnt(6)
    v_mfma_f32_32x32x16_bf16 v[160:175], v[192:195], v[128:131], v[160:175]
    ds_read_b64_tr_b16 v[176:177], v227 offset:49152
    ds_read_b64_tr_b16 v[178:179], v227 offset:50176
    v_mul_f32 v216, v158, v231
    v_mul_f32 v217, v159, v231
    v_exp_f32_e64 v216, -v216
    s_waitcnt lgkmcnt(6)
    v_mfma_f32_32x32x16_bf16 v[160:175], v[196:199], v[132:135], v[160:175]
    ds_read_b64_tr_b16 v[180:181], v227 offset:51200
    ds_read_b64_tr_b16 v[182:183], v227 offset:52224
    v_exp_f32_e64 v217, -v217
    v_fma_f32 v216, v216, v232, v232
    s_waitcnt lgkmcnt(6)
    v_mfma_f32_32x32x16_bf16 v[160:175], v[200:203], v[136:139], v[160:175]
    ds_read_b64_tr_b16 v[184:185], v227 offset:53248
    ds_read_b64_tr_b16 v[186:187], v227 offset:54272
    v_fma_f32 v217, v217, v232, v232
    v_rcp_f32 v216, v216
    s_waitcnt lgkmcnt(6)
    v_mfma_f32_32x32x16_bf16 v[160:175], v[204:207], v[140:143], v[160:175]
    ds_read_b64_tr_b16 v[188:189], v227 offset:55296
    ds_read_b64_tr_b16 v[190:191], v227 offset:56320
    v_rcp_f32 v217, v217
    s_waitcnt vmcnt(5)
    s_barrier
    v_mul_f32 v216, v158, v216
    v_mul_f32 v217, v159, v217
    v_cvt_pk_bf16_f32 v215, v216, v217
    ds_write_b128 v228, v[212:215] offset:17408
    s_add_u32 m0, s45, 40960
    s_mov_b32 s49, 73856
    buffer_load_dwordx4 v225, s[32:35], s49 offen lds
    s_waitcnt lgkmcnt(7)
    v_mfma_f32_32x32x16_bf16 v[144:159], v[176:179], v[0:3], 0
    ds_read_b64_tr_b16 v[192:193], v227 offset:57344
    ds_read_b64_tr_b16 v[194:195], v227 offset:58368
    s_nop 7
    s_nop 3
    v_mul_f32 v216, v160, v231
    v_mul_f32 v217, v161, v231
    v_exp_f32_e64 v216, -v216
    v_mul_f32 v218, v162, v231
    v_mul_f32 v219, v163, v231
    v_exp_f32_e64 v218, -v218
    v_mul_f32 v220, v164, v231
    v_mul_f32 v221, v165, v231
    v_exp_f32_e64 v220, -v220
    v_mul_f32 v222, v166, v231
    v_mul_f32 v223, v167, v231
    v_exp_f32_e64 v222, -v222
    s_waitcnt lgkmcnt(7)
    v_mfma_f32_32x32x16_bf16 v[144:159], v[180:183], v[4:7], v[144:159]
    ds_read_b64_tr_b16 v[196:197], v227 offset:59392
    ds_read_b64_tr_b16 v[198:199], v227 offset:60416
    v_exp_f32_e64 v217, -v217
    v_fma_f32 v216, v216, v232, v232
    v_exp_f32_e64 v219, -v219
    v_fma_f32 v218, v218, v232, v232
    v_exp_f32_e64 v221, -v221
    v_fma_f32 v220, v220, v232, v232
    v_exp_f32_e64 v223, -v223
    v_fma_f32 v222, v222, v232, v232
    s_waitcnt lgkmcnt(7)
    v_mfma_f32_32x32x16_bf16 v[144:159], v[184:187], v[8:11], v[144:159]
    ds_read_b64_tr_b16 v[200:201], v227 offset:61440
    ds_read_b64_tr_b16 v[202:203], v227 offset:62464
    v_fma_f32 v217, v217, v232, v232
    v_rcp_f32 v216, v216
    v_fma_f32 v219, v219, v232, v232
    v_rcp_f32 v218, v218
    v_fma_f32 v221, v221, v232, v232
    v_rcp_f32 v220, v220
    v_fma_f32 v223, v223, v232, v232
    v_rcp_f32 v222, v222
    s_waitcnt lgkmcnt(7)
    v_mfma_f32_32x32x16_bf16 v[144:159], v[188:191], v[12:15], v[144:159]
    ds_read_b64_tr_b16 v[204:205], v227 offset:63488
    ds_read_b64_tr_b16 v[206:207], v227 offset:64512
    v_rcp_f32 v217, v217
    v_rcp_f32 v219, v219
    v_rcp_f32 v221, v221
    v_rcp_f32 v223, v223
    s_waitcnt vmcnt(5) lgkmcnt(8)
    s_barrier
    v_mul_f32 v216, v160, v216
    v_mul_f32 v217, v161, v217
    v_cvt_pk_bf16_f32 v208, v216, v217
    v_mul_f32 v218, v162, v218
    v_mul_f32 v219, v163, v219
    v_cvt_pk_bf16_f32 v209, v218, v219
    v_mul_f32 v220, v164, v220
    v_mul_f32 v221, v165, v221
    v_cvt_pk_bf16_f32 v210, v220, v221
    v_mul_f32 v222, v166, v222
    v_mul_f32 v223, v167, v223
    v_cvt_pk_bf16_f32 v211, v222, v223
    ds_write_b128 v228, v[208:211] offset:20480
    s_add_u32 m0, s45, 49152
    s_mov_b32 s49, 147584
    buffer_load_dwordx4 v225, s[32:35], s49 offen lds
    s_waitcnt lgkmcnt(7)
    v_mfma_f32_32x32x16_bf16 v[144:159], v[192:195], v[16:19], v[144:159]
    ds_read_b64_tr_b16 v[176:177], v227 offset:0
    ds_read_b64_tr_b16 v[178:179], v227 offset:1024
    v_mul_f32 v216, v168, v231
    v_mul_f32 v217, v169, v231
    v_exp_f32_e64 v216, -v216
    v_mul_f32 v218, v170, v231
    v_mul_f32 v219, v171, v231
    v_exp_f32_e64 v218, -v218
    v_mul_f32 v220, v172, v231
    v_mul_f32 v221, v173, v231
    v_exp_f32_e64 v220, -v220
    v_mul_f32 v222, v174, v231
    v_mul_f32 v223, v175, v231
    v_exp_f32_e64 v222, -v222
    s_waitcnt lgkmcnt(7)
    v_mfma_f32_32x32x16_bf16 v[144:159], v[196:199], v[20:23], v[144:159]
    ds_read_b64_tr_b16 v[180:181], v227 offset:2048
    ds_read_b64_tr_b16 v[182:183], v227 offset:3072
    v_exp_f32_e64 v217, -v217
    v_fma_f32 v216, v216, v232, v232
    v_exp_f32_e64 v219, -v219
    v_fma_f32 v218, v218, v232, v232
    v_exp_f32_e64 v221, -v221
    v_fma_f32 v220, v220, v232, v232
    v_exp_f32_e64 v223, -v223
    v_fma_f32 v222, v222, v232, v232
    s_waitcnt lgkmcnt(7)
    v_mfma_f32_32x32x16_bf16 v[144:159], v[200:203], v[24:27], v[144:159]
    ds_read_b64_tr_b16 v[184:185], v227 offset:4096
    ds_read_b64_tr_b16 v[186:187], v227 offset:5120
    v_fma_f32 v217, v217, v232, v232
    v_rcp_f32 v216, v216
    v_fma_f32 v219, v219, v232, v232
    v_rcp_f32 v218, v218
    v_fma_f32 v221, v221, v232, v232
    v_rcp_f32 v220, v220
    v_fma_f32 v223, v223, v232, v232
    v_rcp_f32 v222, v222
    s_waitcnt lgkmcnt(7)
    v_mfma_f32_32x32x16_bf16 v[144:159], v[204:207], v[28:31], v[144:159]
    ds_read_b64_tr_b16 v[188:189], v227 offset:6144
    ds_read_b64_tr_b16 v[190:191], v227 offset:7168
    v_rcp_f32 v217, v217
    v_rcp_f32 v219, v219
    v_rcp_f32 v221, v221
    v_rcp_f32 v223, v223
    s_waitcnt vmcnt(5) lgkmcnt(8)
    s_barrier
    v_mul_f32 v216, v168, v216
    v_mul_f32 v217, v169, v217
    v_cvt_pk_bf16_f32 v212, v216, v217
    v_mul_f32 v218, v170, v218
    v_mul_f32 v219, v171, v219
    v_cvt_pk_bf16_f32 v213, v218, v219
    v_mul_f32 v220, v172, v220
    v_mul_f32 v221, v173, v221
    v_cvt_pk_bf16_f32 v214, v220, v221
    v_mul_f32 v222, v174, v222
    v_mul_f32 v223, v175, v223
    v_cvt_pk_bf16_f32 v215, v222, v223
    ds_write_b128 v228, v[212:215] offset:21504
    s_add_u32 m0, s45, 57344
    s_mov_b32 s49, 221312
    buffer_load_dwordx4 v225, s[32:35], s49 offen lds
    s_waitcnt lgkmcnt(7)
    v_mfma_f32_32x32x16_bf16 v[144:159], v[176:179], v[32:35], v[144:159]
    ds_read_b64_tr_b16 v[192:193], v227 offset:8192
    ds_read_b64_tr_b16 v[194:195], v227 offset:9216
    ds_read_b128 v[64:67], v229 offset:16384
    s_waitcnt lgkmcnt(8)
    v_mfma_f32_32x32x16_bf16 v[144:159], v[180:183], v[36:39], v[144:159]
    ds_read_b64_tr_b16 v[196:197], v227 offset:10240
    ds_read_b64_tr_b16 v[198:199], v227 offset:11264
    ds_read_b128 v[68:71], v229 offset:17408
    s_waitcnt lgkmcnt(9)
    v_mfma_f32_32x32x16_bf16 v[144:159], v[184:187], v[40:43], v[144:159]
    ds_read_b64_tr_b16 v[200:201], v227 offset:12288
    ds_read_b64_tr_b16 v[202:203], v227 offset:13312
    ds_read_b128 v[72:75], v229 offset:18432
    s_waitcnt lgkmcnt(10)
    v_mfma_f32_32x32x16_bf16 v[144:159], v[188:191], v[44:47], v[144:159]
    ds_read_b64_tr_b16 v[204:205], v227 offset:14336
    ds_read_b64_tr_b16 v[206:207], v227 offset:15360
    ds_read_b128 v[76:79], v229 offset:19456
    s_waitcnt vmcnt(5) lgkmcnt(12)
    s_barrier
    s_add_u32 m0, s45, 0
    s_mov_b32 s49, 295040
    buffer_load_dwordx4 v225, s[32:35], s49 offen lds
    s_waitcnt lgkmcnt(10)
    v_mfma_f32_32x32x16_bf16 v[144:159], v[192:195], v[48:51], v[144:159]
    ds_read_b64_tr_b16 v[176:177], v227 offset:16384
    ds_read_b64_tr_b16 v[178:179], v227 offset:17408
    s_waitcnt lgkmcnt(9)
    v_mfma_f32_32x32x16_bf16 v[144:159], v[196:199], v[52:55], v[144:159]
    ds_read_b64_tr_b16 v[180:181], v227 offset:18432
    ds_read_b64_tr_b16 v[182:183], v227 offset:19456
    s_waitcnt lgkmcnt(8)
    v_mfma_f32_32x32x16_bf16 v[144:159], v[200:203], v[56:59], v[144:159]
    ds_read_b64_tr_b16 v[184:185], v227 offset:20480
    ds_read_b64_tr_b16 v[186:187], v227 offset:21504
    s_waitcnt lgkmcnt(7)
    v_mfma_f32_32x32x16_bf16 v[144:159], v[204:207], v[60:63], v[144:159]
    ds_read_b64_tr_b16 v[188:189], v227 offset:22528
    ds_read_b64_tr_b16 v[190:191], v227 offset:23552
    s_waitcnt vmcnt(5)
    s_barrier
    s_add_u32 m0, s45, 8192
    s_mov_b32 s49, 368768
    buffer_load_dwordx4 v225, s[32:35], s49 offen lds
    s_waitcnt lgkmcnt(6)
    v_mfma_f32_32x32x16_bf16 v[144:159], v[176:179], v[64:67], v[144:159]
    ds_read_b64_tr_b16 v[192:193], v227 offset:24576
    ds_read_b64_tr_b16 v[194:195], v227 offset:25600
    ds_read_b128 v[80:83], v229 offset:20480
    s_waitcnt lgkmcnt(7)
    v_mfma_f32_32x32x16_bf16 v[144:159], v[180:183], v[68:71], v[144:159]
    ds_read_b64_tr_b16 v[196:197], v227 offset:26624
    ds_read_b64_tr_b16 v[198:199], v227 offset:27648
    ds_read_b128 v[84:87], v229 offset:21504
    s_waitcnt lgkmcnt(8)
    v_mfma_f32_32x32x16_bf16 v[144:159], v[184:187], v[72:75], v[144:159]
    ds_read_b64_tr_b16 v[200:201], v227 offset:28672
    ds_read_b64_tr_b16 v[202:203], v227 offset:29696
    ds_read_b128 v[88:91], v229 offset:22528
    s_waitcnt lgkmcnt(9)
    v_mfma_f32_32x32x16_bf16 v[144:159], v[188:191], v[76:79], v[144:159]
    ds_read_b64_tr_b16 v[204:205], v227 offset:30720
    ds_read_b64_tr_b16 v[206:207], v227 offset:31744
    ds_read_b128 v[92:95], v229 offset:23552
    s_waitcnt vmcnt(5)
    s_barrier
    s_add_u32 m0, s45, 16384
    s_mov_b32 s49, 256
    buffer_load_dwordx4 v225, s[32:35], s49 offen lds
    s_waitcnt lgkmcnt(9)
    v_mfma_f32_32x32x16_bf16 v[144:159], v[192:195], v[80:83], v[144:159]
    ds_read_b64_tr_b16 v[176:177], v227 offset:32768
    ds_read_b64_tr_b16 v[178:179], v227 offset:33792
    s_waitcnt lgkmcnt(8)
    v_mfma_f32_32x32x16_bf16 v[144:159], v[196:199], v[84:87], v[144:159]
    ds_read_b64_tr_b16 v[180:181], v227 offset:34816
    ds_read_b64_tr_b16 v[182:183], v227 offset:35840
    s_waitcnt lgkmcnt(7)
    v_mfma_f32_32x32x16_bf16 v[144:159], v[200:203], v[88:91], v[144:159]
    ds_read_b64_tr_b16 v[184:185], v227 offset:36864
    ds_read_b64_tr_b16 v[186:187], v227 offset:37888
    s_waitcnt lgkmcnt(6)
    v_mfma_f32_32x32x16_bf16 v[144:159], v[204:207], v[92:95], v[144:159]
    ds_read_b64_tr_b16 v[188:189], v227 offset:38912
    ds_read_b64_tr_b16 v[190:191], v227 offset:39936
    s_waitcnt vmcnt(5)
    s_barrier
    s_add_u32 m0, s45, 24576
    s_mov_b32 s49, 73984
    buffer_load_dwordx4 v225, s[32:35], s49 offen lds
    s_waitcnt lgkmcnt(6)
    v_mfma_f32_32x32x16_bf16 v[160:175], v[176:179], v[0:3], 0
    ds_read_b64_tr_b16 v[192:193], v227 offset:40960
    ds_read_b64_tr_b16 v[194:195], v227 offset:41984
    s_waitcnt lgkmcnt(6)
    v_mfma_f32_32x32x16_bf16 v[160:175], v[180:183], v[4:7], v[160:175]
    ds_read_b64_tr_b16 v[196:197], v227 offset:43008
    ds_read_b64_tr_b16 v[198:199], v227 offset:44032
    s_waitcnt lgkmcnt(6)
    v_mfma_f32_32x32x16_bf16 v[160:175], v[184:187], v[8:11], v[160:175]
    ds_read_b64_tr_b16 v[200:201], v227 offset:45056
    ds_read_b64_tr_b16 v[202:203], v227 offset:46080
    s_waitcnt lgkmcnt(6)
    v_mfma_f32_32x32x16_bf16 v[160:175], v[188:191], v[12:15], v[160:175]
    ds_read_b64_tr_b16 v[204:205], v227 offset:47104
    ds_read_b64_tr_b16 v[206:207], v227 offset:48128
    s_waitcnt vmcnt(5)
    s_barrier
    s_add_u32 m0, s45, 32768
    s_mov_b32 s49, 147712
    buffer_load_dwordx4 v225, s[32:35], s49 offen lds
    v_cvt_pk_bf16_f32 v208, v144, v145
    v_cvt_pk_bf16_f32 v209, v146, v147
    v_cvt_pk_bf16_f32 v210, v148, v149
    v_cvt_pk_bf16_f32 v211, v150, v151
    s_mov_b32 s48, 0
    buffer_store_dwordx4 v[208:211], v230, s[36:39], s48 offen offset:0 sc0 sc1
    s_waitcnt lgkmcnt(6)
    v_mfma_f32_32x32x16_bf16 v[160:175], v[192:195], v[16:19], v[160:175]
    ds_read_b64_tr_b16 v[176:177], v227 offset:49152
    ds_read_b64_tr_b16 v[178:179], v227 offset:50176
    s_waitcnt lgkmcnt(6)
    v_mfma_f32_32x32x16_bf16 v[160:175], v[196:199], v[20:23], v[160:175]
    ds_read_b64_tr_b16 v[180:181], v227 offset:51200
    ds_read_b64_tr_b16 v[182:183], v227 offset:52224
    s_waitcnt lgkmcnt(6)
    v_mfma_f32_32x32x16_bf16 v[160:175], v[200:203], v[24:27], v[160:175]
    ds_read_b64_tr_b16 v[184:185], v227 offset:53248
    ds_read_b64_tr_b16 v[186:187], v227 offset:54272
    s_waitcnt lgkmcnt(6)
    v_mfma_f32_32x32x16_bf16 v[160:175], v[204:207], v[28:31], v[160:175]
    ds_read_b64_tr_b16 v[188:189], v227 offset:55296
    ds_read_b64_tr_b16 v[190:191], v227 offset:56320
    s_waitcnt vmcnt(6)
    s_barrier
    s_add_u32 m0, s45, 40960
    s_mov_b32 s49, 221440
    buffer_load_dwordx4 v225, s[32:35], s49 offen lds
    s_waitcnt lgkmcnt(6)
    v_mfma_f32_32x32x16_bf16 v[160:175], v[176:179], v[32:35], v[160:175]
    ds_read_b64_tr_b16 v[192:193], v227 offset:57344
    ds_read_b64_tr_b16 v[194:195], v227 offset:58368
    s_waitcnt lgkmcnt(6)
    v_mfma_f32_32x32x16_bf16 v[160:175], v[180:183], v[36:39], v[160:175]
    ds_read_b64_tr_b16 v[196:197], v227 offset:59392
    ds_read_b64_tr_b16 v[198:199], v227 offset:60416
    s_waitcnt lgkmcnt(6)
    v_mfma_f32_32x32x16_bf16 v[160:175], v[184:187], v[40:43], v[160:175]
    ds_read_b64_tr_b16 v[200:201], v227 offset:61440
    ds_read_b64_tr_b16 v[202:203], v227 offset:62464
    s_waitcnt lgkmcnt(6)
    v_mfma_f32_32x32x16_bf16 v[160:175], v[188:191], v[44:47], v[160:175]
    ds_read_b64_tr_b16 v[204:205], v227 offset:63488
    ds_read_b64_tr_b16 v[206:207], v227 offset:64512
    s_waitcnt vmcnt(6)
    s_barrier
    s_add_u32 m0, s45, 49152
    s_mov_b32 s49, 295168
    buffer_load_dwordx4 v225, s[32:35], s49 offen lds
    v_cvt_pk_bf16_f32 v212, v152, v153
    v_cvt_pk_bf16_f32 v213, v154, v155
    v_cvt_pk_bf16_f32 v214, v156, v157
    v_cvt_pk_bf16_f32 v215, v158, v159
    s_mov_b32 s48, 0
    buffer_store_dwordx4 v[212:215], v230, s[36:39], s48 offen offset:1024 sc0 sc1
    s_waitcnt lgkmcnt(6)
    v_mfma_f32_32x32x16_bf16 v[160:175], v[192:195], v[48:51], v[160:175]
    ds_read_b64_tr_b16 v[176:177], v227 offset:0
    ds_read_b64_tr_b16 v[178:179], v227 offset:1024
    s_waitcnt lgkmcnt(6)
    v_mfma_f32_32x32x16_bf16 v[160:175], v[196:199], v[52:55], v[160:175]
    ds_read_b64_tr_b16 v[180:181], v227 offset:2048
    ds_read_b64_tr_b16 v[182:183], v227 offset:3072
    s_waitcnt lgkmcnt(6)
    v_mfma_f32_32x32x16_bf16 v[160:175], v[200:203], v[56:59], v[160:175]
    ds_read_b64_tr_b16 v[184:185], v227 offset:4096
    ds_read_b64_tr_b16 v[186:187], v227 offset:5120
    s_waitcnt lgkmcnt(6)
    v_mfma_f32_32x32x16_bf16 v[160:175], v[204:207], v[60:63], v[160:175]
    ds_read_b64_tr_b16 v[188:189], v227 offset:6144
    ds_read_b64_tr_b16 v[190:191], v227 offset:7168
    s_waitcnt vmcnt(7)
    s_barrier
    s_add_u32 m0, s45, 57344
    s_mov_b32 s49, 368896
    buffer_load_dwordx4 v225, s[32:35], s49 offen lds
    s_waitcnt lgkmcnt(6)
    v_mfma_f32_32x32x16_bf16 v[160:175], v[176:179], v[64:67], v[160:175]
    ds_read_b64_tr_b16 v[192:193], v227 offset:8192
    ds_read_b64_tr_b16 v[194:195], v227 offset:9216
    s_waitcnt lgkmcnt(6)
    v_mfma_f32_32x32x16_bf16 v[160:175], v[180:183], v[68:71], v[160:175]
    ds_read_b64_tr_b16 v[196:197], v227 offset:10240
    ds_read_b64_tr_b16 v[198:199], v227 offset:11264
    s_waitcnt lgkmcnt(6)
    v_mfma_f32_32x32x16_bf16 v[160:175], v[184:187], v[72:75], v[160:175]
    ds_read_b64_tr_b16 v[200:201], v227 offset:12288
    ds_read_b64_tr_b16 v[202:203], v227 offset:13312
    s_waitcnt lgkmcnt(6)
    v_mfma_f32_32x32x16_bf16 v[160:175], v[188:191], v[76:79], v[160:175]
    ds_read_b64_tr_b16 v[204:205], v227 offset:14336
    ds_read_b64_tr_b16 v[206:207], v227 offset:15360
    s_waitcnt vmcnt(7)
    s_barrier
    s_add_u32 m0, s45, 0
    s_mov_b32 s49, 384
    buffer_load_dwordx4 v225, s[32:35], s49 offen lds
    s_waitcnt lgkmcnt(6)
    v_mfma_f32_32x32x16_bf16 v[160:175], v[192:195], v[80:83], v[160:175]
    ds_read_b64_tr_b16 v[176:177], v227 offset:16384
    ds_read_b64_tr_b16 v[178:179], v227 offset:17408
    s_waitcnt lgkmcnt(6)
    v_mfma_f32_32x32x16_bf16 v[160:175], v[196:199], v[84:87], v[160:175]
    ds_read_b64_tr_b16 v[180:181], v227 offset:18432
    ds_read_b64_tr_b16 v[182:183], v227 offset:19456
    s_waitcnt lgkmcnt(6)
    v_mfma_f32_32x32x16_bf16 v[160:175], v[200:203], v[88:91], v[160:175]
    ds_read_b64_tr_b16 v[184:185], v227 offset:20480
    ds_read_b64_tr_b16 v[186:187], v227 offset:21504
    s_waitcnt lgkmcnt(6)
    v_mfma_f32_32x32x16_bf16 v[160:175], v[204:207], v[92:95], v[160:175]
    ds_read_b64_tr_b16 v[188:189], v227 offset:22528
    ds_read_b64_tr_b16 v[190:191], v227 offset:23552
    s_waitcnt vmcnt(7)
    s_barrier
    s_add_u32 m0, s45, 8192
    s_mov_b32 s49, 74112
    buffer_load_dwordx4 v225, s[32:35], s49 offen lds
    s_waitcnt lgkmcnt(6)
    v_mfma_f32_32x32x16_bf16 v[144:159], v[176:179], v[0:3], 0
    ds_read_b64_tr_b16 v[192:193], v227 offset:24576
    ds_read_b64_tr_b16 v[194:195], v227 offset:25600
    s_waitcnt lgkmcnt(6)
    v_mfma_f32_32x32x16_bf16 v[144:159], v[180:183], v[4:7], v[144:159]
    ds_read_b64_tr_b16 v[196:197], v227 offset:26624
    ds_read_b64_tr_b16 v[198:199], v227 offset:27648
    s_waitcnt lgkmcnt(6)
    v_mfma_f32_32x32x16_bf16 v[144:159], v[184:187], v[8:11], v[144:159]
    ds_read_b64_tr_b16 v[200:201], v227 offset:28672
    ds_read_b64_tr_b16 v[202:203], v227 offset:29696
    s_waitcnt lgkmcnt(6)
    v_mfma_f32_32x32x16_bf16 v[144:159], v[188:191], v[12:15], v[144:159]
    ds_read_b64_tr_b16 v[204:205], v227 offset:30720
    ds_read_b64_tr_b16 v[206:207], v227 offset:31744
    s_waitcnt vmcnt(7)
    s_barrier
    s_add_u32 m0, s45, 16384
    s_mov_b32 s49, 147840
    buffer_load_dwordx4 v225, s[32:35], s49 offen lds
    v_cvt_pk_bf16_f32 v208, v160, v161
    v_cvt_pk_bf16_f32 v209, v162, v163
    v_cvt_pk_bf16_f32 v210, v164, v165
    v_cvt_pk_bf16_f32 v211, v166, v167
    s_mov_b32 s48, 4096
    buffer_store_dwordx4 v[208:211], v230, s[36:39], s48 offen offset:0 sc0 sc1
    s_waitcnt lgkmcnt(6)
    v_mfma_f32_32x32x16_bf16 v[144:159], v[192:195], v[16:19], v[144:159]
    ds_read_b64_tr_b16 v[176:177], v227 offset:32768
    ds_read_b64_tr_b16 v[178:179], v227 offset:33792
    s_waitcnt lgkmcnt(6)
    v_mfma_f32_32x32x16_bf16 v[144:159], v[196:199], v[20:23], v[144:159]
    ds_read_b64_tr_b16 v[180:181], v227 offset:34816
    ds_read_b64_tr_b16 v[182:183], v227 offset:35840
    s_waitcnt lgkmcnt(6)
    v_mfma_f32_32x32x16_bf16 v[144:159], v[200:203], v[24:27], v[144:159]
    ds_read_b64_tr_b16 v[184:185], v227 offset:36864
    ds_read_b64_tr_b16 v[186:187], v227 offset:37888
    s_waitcnt lgkmcnt(6)
    v_mfma_f32_32x32x16_bf16 v[144:159], v[204:207], v[28:31], v[144:159]
    ds_read_b64_tr_b16 v[188:189], v227 offset:38912
    ds_read_b64_tr_b16 v[190:191], v227 offset:39936
    s_waitcnt vmcnt(7)
    s_barrier
    s_add_u32 m0, s45, 24576
    s_mov_b32 s49, 221568
    buffer_load_dwordx4 v225, s[32:35], s49 offen lds
    s_waitcnt lgkmcnt(6)
    v_mfma_f32_32x32x16_bf16 v[144:159], v[176:179], v[32:35], v[144:159]
    ds_read_b64_tr_b16 v[192:193], v227 offset:40960
    ds_read_b64_tr_b16 v[194:195], v227 offset:41984
    s_waitcnt lgkmcnt(6)
    v_mfma_f32_32x32x16_bf16 v[144:159], v[180:183], v[36:39], v[144:159]
    ds_read_b64_tr_b16 v[196:197], v227 offset:43008
    ds_read_b64_tr_b16 v[198:199], v227 offset:44032
    s_waitcnt lgkmcnt(6)
    v_mfma_f32_32x32x16_bf16 v[144:159], v[184:187], v[40:43], v[144:159]
    ds_read_b64_tr_b16 v[200:201], v227 offset:45056
    ds_read_b64_tr_b16 v[202:203], v227 offset:46080
    s_waitcnt lgkmcnt(6)
    v_mfma_f32_32x32x16_bf16 v[144:159], v[188:191], v[44:47], v[144:159]
    ds_read_b64_tr_b16 v[204:205], v227 offset:47104
    ds_read_b64_tr_b16 v[206:207], v227 offset:48128
    s_waitcnt vmcnt(7)
    s_barrier
    s_add_u32 m0, s45, 32768
    s_mov_b32 s49, 295296
    buffer_load_dwordx4 v225, s[32:35], s49 offen lds
    v_cvt_pk_bf16_f32 v212, v168, v169
    v_cvt_pk_bf16_f32 v213, v170, v171
    v_cvt_pk_bf16_f32 v214, v172, v173
    v_cvt_pk_bf16_f32 v215, v174, v175
    s_mov_b32 s48, 4096
    buffer_store_dwordx4 v[212:215], v230, s[36:39], s48 offen offset:1024 sc0 sc1
    s_waitcnt lgkmcnt(6)
    v_mfma_f32_32x32x16_bf16 v[144:159], v[192:195], v[48:51], v[144:159]
    ds_read_b64_tr_b16 v[176:177], v227 offset:49152
    ds_read_b64_tr_b16 v[178:179], v227 offset:50176
    s_waitcnt lgkmcnt(6)
    v_mfma_f32_32x32x16_bf16 v[144:159], v[196:199], v[52:55], v[144:159]
    ds_read_b64_tr_b16 v[180:181], v227 offset:51200
    ds_read_b64_tr_b16 v[182:183], v227 offset:52224
    s_waitcnt lgkmcnt(6)
    v_mfma_f32_32x32x16_bf16 v[144:159], v[200:203], v[56:59], v[144:159]
    ds_read_b64_tr_b16 v[184:185], v227 offset:53248
    ds_read_b64_tr_b16 v[186:187], v227 offset:54272
    s_waitcnt lgkmcnt(6)
    v_mfma_f32_32x32x16_bf16 v[144:159], v[204:207], v[60:63], v[144:159]
    ds_read_b64_tr_b16 v[188:189], v227 offset:55296
    ds_read_b64_tr_b16 v[190:191], v227 offset:56320
    s_waitcnt vmcnt(7)
    s_barrier
    s_add_u32 m0, s45, 40960
    s_mov_b32 s49, 369024
    buffer_load_dwordx4 v225, s[32:35], s49 offen lds
    s_waitcnt lgkmcnt(6)
    v_mfma_f32_32x32x16_bf16 v[144:159], v[176:179], v[64:67], v[144:159]
    ds_read_b64_tr_b16 v[192:193], v227 offset:57344
    ds_read_b64_tr_b16 v[194:195], v227 offset:58368
    s_waitcnt lgkmcnt(6)
    v_mfma_f32_32x32x16_bf16 v[144:159], v[180:183], v[68:71], v[144:159]
    ds_read_b64_tr_b16 v[196:197], v227 offset:59392
    ds_read_b64_tr_b16 v[198:199], v227 offset:60416
    s_waitcnt lgkmcnt(6)
    v_mfma_f32_32x32x16_bf16 v[144:159], v[184:187], v[72:75], v[144:159]
    ds_read_b64_tr_b16 v[200:201], v227 offset:61440
    ds_read_b64_tr_b16 v[202:203], v227 offset:62464
    s_waitcnt lgkmcnt(6)
    v_mfma_f32_32x32x16_bf16 v[144:159], v[188:191], v[76:79], v[144:159]
    ds_read_b64_tr_b16 v[204:205], v227 offset:63488
    ds_read_b64_tr_b16 v[206:207], v227 offset:64512
    s_waitcnt vmcnt(7)
    s_barrier
    s_add_u32 m0, s45, 49152
    s_mov_b32 s49, 512
    buffer_load_dwordx4 v225, s[32:35], s49 offen lds
    s_waitcnt lgkmcnt(6)
    v_mfma_f32_32x32x16_bf16 v[144:159], v[192:195], v[80:83], v[144:159]
    ds_read_b64_tr_b16 v[176:177], v227 offset:0
    ds_read_b64_tr_b16 v[178:179], v227 offset:1024
    s_waitcnt lgkmcnt(6)
    v_mfma_f32_32x32x16_bf16 v[144:159], v[196:199], v[84:87], v[144:159]
    ds_read_b64_tr_b16 v[180:181], v227 offset:2048
    ds_read_b64_tr_b16 v[182:183], v227 offset:3072
    s_waitcnt lgkmcnt(6)
    v_mfma_f32_32x32x16_bf16 v[144:159], v[200:203], v[88:91], v[144:159]
    ds_read_b64_tr_b16 v[184:185], v227 offset:4096
    ds_read_b64_tr_b16 v[186:187], v227 offset:5120
    s_waitcnt lgkmcnt(6)
    v_mfma_f32_32x32x16_bf16 v[144:159], v[204:207], v[92:95], v[144:159]
    ds_read_b64_tr_b16 v[188:189], v227 offset:6144
    ds_read_b64_tr_b16 v[190:191], v227 offset:7168
    s_waitcnt vmcnt(7)
    s_barrier
    s_add_u32 m0, s45, 57344
    s_mov_b32 s49, 74240
    buffer_load_dwordx4 v225, s[32:35], s49 offen lds
    s_waitcnt lgkmcnt(6)
    v_mfma_f32_32x32x16_bf16 v[160:175], v[176:179], v[0:3], 0
    ds_read_b64_tr_b16 v[192:193], v227 offset:8192
    ds_read_b64_tr_b16 v[194:195], v227 offset:9216
    s_waitcnt lgkmcnt(6)
    v_mfma_f32_32x32x16_bf16 v[160:175], v[180:183], v[4:7], v[160:175]
    ds_read_b64_tr_b16 v[196:197], v227 offset:10240
    ds_read_b64_tr_b16 v[198:199], v227 offset:11264
    s_waitcnt lgkmcnt(6)
    v_mfma_f32_32x32x16_bf16 v[160:175], v[184:187], v[8:11], v[160:175]
    ds_read_b64_tr_b16 v[200:201], v227 offset:12288
    ds_read_b64_tr_b16 v[202:203], v227 offset:13312
    s_waitcnt lgkmcnt(6)
    v_mfma_f32_32x32x16_bf16 v[160:175], v[188:191], v[12:15], v[160:175]
    ds_read_b64_tr_b16 v[204:205], v227 offset:14336
    ds_read_b64_tr_b16 v[206:207], v227 offset:15360
    s_waitcnt vmcnt(7)
    s_barrier
    s_add_u32 m0, s45, 0
    s_mov_b32 s49, 147968
    buffer_load_dwordx4 v225, s[32:35], s49 offen lds
    v_cvt_pk_bf16_f32 v208, v144, v145
    v_cvt_pk_bf16_f32 v209, v146, v147
    v_cvt_pk_bf16_f32 v210, v148, v149
    v_cvt_pk_bf16_f32 v211, v150, v151
    s_mov_b32 s48, 8192
    buffer_store_dwordx4 v[208:211], v230, s[36:39], s48 offen offset:0 sc0 sc1
    s_waitcnt lgkmcnt(6)
    v_mfma_f32_32x32x16_bf16 v[160:175], v[192:195], v[16:19], v[160:175]
    ds_read_b64_tr_b16 v[176:177], v227 offset:16384
    ds_read_b64_tr_b16 v[178:179], v227 offset:17408
    s_waitcnt lgkmcnt(6)
    v_mfma_f32_32x32x16_bf16 v[160:175], v[196:199], v[20:23], v[160:175]
    ds_read_b64_tr_b16 v[180:181], v227 offset:18432
    ds_read_b64_tr_b16 v[182:183], v227 offset:19456
    s_waitcnt lgkmcnt(6)
    v_mfma_f32_32x32x16_bf16 v[160:175], v[200:203], v[24:27], v[160:175]
    ds_read_b64_tr_b16 v[184:185], v227 offset:20480
    ds_read_b64_tr_b16 v[186:187], v227 offset:21504
    s_waitcnt lgkmcnt(6)
    v_mfma_f32_32x32x16_bf16 v[160:175], v[204:207], v[28:31], v[160:175]
    ds_read_b64_tr_b16 v[188:189], v227 offset:22528
    ds_read_b64_tr_b16 v[190:191], v227 offset:23552
    s_waitcnt vmcnt(7)
    s_barrier
    s_add_u32 m0, s45, 8192
    s_mov_b32 s49, 221696
    buffer_load_dwordx4 v225, s[32:35], s49 offen lds
    s_waitcnt lgkmcnt(6)
    v_mfma_f32_32x32x16_bf16 v[160:175], v[176:179], v[32:35], v[160:175]
    ds_read_b64_tr_b16 v[192:193], v227 offset:24576
    ds_read_b64_tr_b16 v[194:195], v227 offset:25600
    s_waitcnt lgkmcnt(6)
    v_mfma_f32_32x32x16_bf16 v[160:175], v[180:183], v[36:39], v[160:175]
    ds_read_b64_tr_b16 v[196:197], v227 offset:26624
    ds_read_b64_tr_b16 v[198:199], v227 offset:27648
    s_waitcnt lgkmcnt(6)
    v_mfma_f32_32x32x16_bf16 v[160:175], v[184:187], v[40:43], v[160:175]
    ds_read_b64_tr_b16 v[200:201], v227 offset:28672
    ds_read_b64_tr_b16 v[202:203], v227 offset:29696
    s_waitcnt lgkmcnt(6)
    v_mfma_f32_32x32x16_bf16 v[160:175], v[188:191], v[44:47], v[160:175]
    ds_read_b64_tr_b16 v[204:205], v227 offset:30720
    ds_read_b64_tr_b16 v[206:207], v227 offset:31744
    s_waitcnt vmcnt(7)
    s_barrier
    s_add_u32 m0, s45, 16384
    s_mov_b32 s49, 295424
    buffer_load_dwordx4 v225, s[32:35], s49 offen lds
    v_cvt_pk_bf16_f32 v212, v152, v153
    v_cvt_pk_bf16_f32 v213, v154, v155
    v_cvt_pk_bf16_f32 v214, v156, v157
    v_cvt_pk_bf16_f32 v215, v158, v159
    s_mov_b32 s48, 8192
    buffer_store_dwordx4 v[212:215], v230, s[36:39], s48 offen offset:1024 sc0 sc1
    s_waitcnt lgkmcnt(6)
    v_mfma_f32_32x32x16_bf16 v[160:175], v[192:195], v[48:51], v[160:175]
    ds_read_b64_tr_b16 v[176:177], v227 offset:32768
    ds_read_b64_tr_b16 v[178:179], v227 offset:33792
    s_waitcnt lgkmcnt(6)
    v_mfma_f32_32x32x16_bf16 v[160:175], v[196:199], v[52:55], v[160:175]
    ds_read_b64_tr_b16 v[180:181], v227 offset:34816
    ds_read_b64_tr_b16 v[182:183], v227 offset:35840
    s_waitcnt lgkmcnt(6)
    v_mfma_f32_32x32x16_bf16 v[160:175], v[200:203], v[56:59], v[160:175]
    ds_read_b64_tr_b16 v[184:185], v227 offset:36864
    ds_read_b64_tr_b16 v[186:187], v227 offset:37888
    s_waitcnt lgkmcnt(6)
    v_mfma_f32_32x32x16_bf16 v[160:175], v[204:207], v[60:63], v[160:175]
    ds_read_b64_tr_b16 v[188:189], v227 offset:38912
    ds_read_b64_tr_b16 v[190:191], v227 offset:39936
    s_waitcnt vmcnt(7)
    s_barrier
    s_add_u32 m0, s45, 24576
    s_mov_b32 s49, 369152
    buffer_load_dwordx4 v225, s[32:35], s49 offen lds
    s_waitcnt lgkmcnt(6)
    v_mfma_f32_32x32x16_bf16 v[160:175], v[176:179], v[64:67], v[160:175]
    ds_read_b64_tr_b16 v[192:193], v227 offset:40960
    ds_read_b64_tr_b16 v[194:195], v227 offset:41984
    s_waitcnt lgkmcnt(6)
    v_mfma_f32_32x32x16_bf16 v[160:175], v[180:183], v[68:71], v[160:175]
    ds_read_b64_tr_b16 v[196:197], v227 offset:43008
    ds_read_b64_tr_b16 v[198:199], v227 offset:44032
    s_waitcnt lgkmcnt(6)
    v_mfma_f32_32x32x16_bf16 v[160:175], v[184:187], v[72:75], v[160:175]
    ds_read_b64_tr_b16 v[200:201], v227 offset:45056
    ds_read_b64_tr_b16 v[202:203], v227 offset:46080
    s_waitcnt lgkmcnt(6)
    v_mfma_f32_32x32x16_bf16 v[160:175], v[188:191], v[76:79], v[160:175]
    ds_read_b64_tr_b16 v[204:205], v227 offset:47104
    ds_read_b64_tr_b16 v[206:207], v227 offset:48128
    s_waitcnt vmcnt(7)
    s_barrier
    s_add_u32 m0, s45, 32768
    s_mov_b32 s49, 640
    buffer_load_dwordx4 v225, s[32:35], s49 offen lds
    s_waitcnt lgkmcnt(6)
    v_mfma_f32_32x32x16_bf16 v[160:175], v[192:195], v[80:83], v[160:175]
    ds_read_b64_tr_b16 v[176:177], v227 offset:49152
    ds_read_b64_tr_b16 v[178:179], v227 offset:50176
    s_waitcnt lgkmcnt(6)
    v_mfma_f32_32x32x16_bf16 v[160:175], v[196:199], v[84:87], v[160:175]
    ds_read_b64_tr_b16 v[180:181], v227 offset:51200
    ds_read_b64_tr_b16 v[182:183], v227 offset:52224
    s_waitcnt lgkmcnt(6)
    v_mfma_f32_32x32x16_bf16 v[160:175], v[200:203], v[88:91], v[160:175]
    ds_read_b64_tr_b16 v[184:185], v227 offset:53248
    ds_read_b64_tr_b16 v[186:187], v227 offset:54272
    s_waitcnt lgkmcnt(6)
    v_mfma_f32_32x32x16_bf16 v[160:175], v[204:207], v[92:95], v[160:175]
    ds_read_b64_tr_b16 v[188:189], v227 offset:55296
    ds_read_b64_tr_b16 v[190:191], v227 offset:56320
    s_waitcnt vmcnt(7)
    s_barrier
    s_add_u32 m0, s45, 40960
    s_mov_b32 s49, 74368
    buffer_load_dwordx4 v225, s[32:35], s49 offen lds
    s_waitcnt lgkmcnt(6)
    v_mfma_f32_32x32x16_bf16 v[144:159], v[176:179], v[0:3], 0
    ds_read_b64_tr_b16 v[192:193], v227 offset:57344
    ds_read_b64_tr_b16 v[194:195], v227 offset:58368
    s_waitcnt lgkmcnt(6)
    v_mfma_f32_32x32x16_bf16 v[144:159], v[180:183], v[4:7], v[144:159]
    ds_read_b64_tr_b16 v[196:197], v227 offset:59392
    ds_read_b64_tr_b16 v[198:199], v227 offset:60416
    s_waitcnt lgkmcnt(6)
    v_mfma_f32_32x32x16_bf16 v[144:159], v[184:187], v[8:11], v[144:159]
    ds_read_b64_tr_b16 v[200:201], v227 offset:61440
    ds_read_b64_tr_b16 v[202:203], v227 offset:62464
    s_waitcnt lgkmcnt(6)
    v_mfma_f32_32x32x16_bf16 v[144:159], v[188:191], v[12:15], v[144:159]
    ds_read_b64_tr_b16 v[204:205], v227 offset:63488
    ds_read_b64_tr_b16 v[206:207], v227 offset:64512
    s_waitcnt vmcnt(7)
    s_barrier
    s_add_u32 m0, s45, 49152
    s_mov_b32 s49, 148096
    buffer_load_dwordx4 v225, s[32:35], s49 offen lds
    v_cvt_pk_bf16_f32 v208, v160, v161
    v_cvt_pk_bf16_f32 v209, v162, v163
    v_cvt_pk_bf16_f32 v210, v164, v165
    v_cvt_pk_bf16_f32 v211, v166, v167
    s_mov_b32 s48, 12288
    buffer_store_dwordx4 v[208:211], v230, s[36:39], s48 offen offset:0 sc0 sc1
    s_waitcnt lgkmcnt(6)
    v_mfma_f32_32x32x16_bf16 v[144:159], v[192:195], v[16:19], v[144:159]
    ds_read_b64_tr_b16 v[176:177], v227 offset:0
    ds_read_b64_tr_b16 v[178:179], v227 offset:1024
    s_waitcnt lgkmcnt(6)
    v_mfma_f32_32x32x16_bf16 v[144:159], v[196:199], v[20:23], v[144:159]
    ds_read_b64_tr_b16 v[180:181], v227 offset:2048
    ds_read_b64_tr_b16 v[182:183], v227 offset:3072
    s_waitcnt lgkmcnt(6)
    v_mfma_f32_32x32x16_bf16 v[144:159], v[200:203], v[24:27], v[144:159]
    ds_read_b64_tr_b16 v[184:185], v227 offset:4096
    ds_read_b64_tr_b16 v[186:187], v227 offset:5120
    s_waitcnt lgkmcnt(6)
    v_mfma_f32_32x32x16_bf16 v[144:159], v[204:207], v[28:31], v[144:159]
    ds_read_b64_tr_b16 v[188:189], v227 offset:6144
    ds_read_b64_tr_b16 v[190:191], v227 offset:7168
    s_waitcnt vmcnt(7)
    s_barrier
    s_add_u32 m0, s45, 57344
    s_mov_b32 s49, 221824
    buffer_load_dwordx4 v225, s[32:35], s49 offen lds
    s_waitcnt lgkmcnt(6)
    v_mfma_f32_32x32x16_bf16 v[144:159], v[176:179], v[32:35], v[144:159]
    ds_read_b64_tr_b16 v[192:193], v227 offset:8192
    ds_read_b64_tr_b16 v[194:195], v227 offset:9216
    s_waitcnt lgkmcnt(6)
    v_mfma_f32_32x32x16_bf16 v[144:159], v[180:183], v[36:39], v[144:159]
    ds_read_b64_tr_b16 v[196:197], v227 offset:10240
    ds_read_b64_tr_b16 v[198:199], v227 offset:11264
    s_waitcnt lgkmcnt(6)
    v_mfma_f32_32x32x16_bf16 v[144:159], v[184:187], v[40:43], v[144:159]
    ds_read_b64_tr_b16 v[200:201], v227 offset:12288
    ds_read_b64_tr_b16 v[202:203], v227 offset:13312
    s_waitcnt lgkmcnt(6)
    v_mfma_f32_32x32x16_bf16 v[144:159], v[188:191], v[44:47], v[144:159]
    ds_read_b64_tr_b16 v[204:205], v227 offset:14336
    ds_read_b64_tr_b16 v[206:207], v227 offset:15360
    s_waitcnt vmcnt(7)
    s_barrier
    s_add_u32 m0, s45, 0
    s_mov_b32 s49, 295552
    buffer_load_dwordx4 v225, s[32:35], s49 offen lds
    v_cvt_pk_bf16_f32 v212, v168, v169
    v_cvt_pk_bf16_f32 v213, v170, v171
    v_cvt_pk_bf16_f32 v214, v172, v173
    v_cvt_pk_bf16_f32 v215, v174, v175
    s_mov_b32 s48, 12288
    buffer_store_dwordx4 v[212:215], v230, s[36:39], s48 offen offset:1024 sc0 sc1
    s_waitcnt lgkmcnt(6)
    v_mfma_f32_32x32x16_bf16 v[144:159], v[192:195], v[48:51], v[144:159]
    ds_read_b64_tr_b16 v[176:177], v227 offset:16384
    ds_read_b64_tr_b16 v[178:179], v227 offset:17408
    s_waitcnt lgkmcnt(6)
    v_mfma_f32_32x32x16_bf16 v[144:159], v[196:199], v[52:55], v[144:159]
    ds_read_b64_tr_b16 v[180:181], v227 offset:18432
    ds_read_b64_tr_b16 v[182:183], v227 offset:19456
    s_waitcnt lgkmcnt(6)
    v_mfma_f32_32x32x16_bf16 v[144:159], v[200:203], v[56:59], v[144:159]
    ds_read_b64_tr_b16 v[184:185], v227 offset:20480
    ds_read_b64_tr_b16 v[186:187], v227 offset:21504
    s_waitcnt lgkmcnt(6)
    v_mfma_f32_32x32x16_bf16 v[144:159], v[204:207], v[60:63], v[144:159]
    ds_read_b64_tr_b16 v[188:189], v227 offset:22528
    ds_read_b64_tr_b16 v[190:191], v227 offset:23552
    s_waitcnt vmcnt(7)
    s_barrier
    s_add_u32 m0, s45, 8192
    s_mov_b32 s49, 369280
    buffer_load_dwordx4 v225, s[32:35], s49 offen lds
    s_waitcnt lgkmcnt(6)
    v_mfma_f32_32x32x16_bf16 v[144:159], v[176:179], v[64:67], v[144:159]
    ds_read_b64_tr_b16 v[192:193], v227 offset:24576
    ds_read_b64_tr_b16 v[194:195], v227 offset:25600
    s_waitcnt lgkmcnt(6)
    v_mfma_f32_32x32x16_bf16 v[144:159], v[180:183], v[68:71], v[144:159]
    ds_read_b64_tr_b16 v[196:197], v227 offset:26624
    ds_read_b64_tr_b16 v[198:199], v227 offset:27648
    s_waitcnt lgkmcnt(6)
    v_mfma_f32_32x32x16_bf16 v[144:159], v[184:187], v[72:75], v[144:159]
    ds_read_b64_tr_b16 v[200:201], v227 offset:28672
    ds_read_b64_tr_b16 v[202:203], v227 offset:29696
    s_waitcnt lgkmcnt(6)
    v_mfma_f32_32x32x16_bf16 v[144:159], v[188:191], v[76:79], v[144:159]
    ds_read_b64_tr_b16 v[204:205], v227 offset:30720
    ds_read_b64_tr_b16 v[206:207], v227 offset:31744
    s_waitcnt vmcnt(7)
    s_barrier
    s_add_u32 m0, s45, 16384
    s_mov_b32 s49, 768
    buffer_load_dwordx4 v225, s[32:35], s49 offen lds
    s_waitcnt lgkmcnt(6)
    v_mfma_f32_32x32x16_bf16 v[144:159], v[192:195], v[80:83], v[144:159]
    ds_read_b64_tr_b16 v[176:177], v227 offset:32768
    ds_read_b64_tr_b16 v[178:179], v227 offset:33792
    s_waitcnt lgkmcnt(6)
    v_mfma_f32_32x32x16_bf16 v[144:159], v[196:199], v[84:87], v[144:159]
    ds_read_b64_tr_b16 v[180:181], v227 offset:34816
    ds_read_b64_tr_b16 v[182:183], v227 offset:35840
    s_waitcnt lgkmcnt(6)
    v_mfma_f32_32x32x16_bf16 v[144:159], v[200:203], v[88:91], v[144:159]
    ds_read_b64_tr_b16 v[184:185], v227 offset:36864
    ds_read_b64_tr_b16 v[186:187], v227 offset:37888
    s_waitcnt lgkmcnt(6)
    v_mfma_f32_32x32x16_bf16 v[144:159], v[204:207], v[92:95], v[144:159]
    ds_read_b64_tr_b16 v[188:189], v227 offset:38912
    ds_read_b64_tr_b16 v[190:191], v227 offset:39936
    s_waitcnt vmcnt(7)
    s_barrier
    s_add_u32 m0, s45, 24576
    s_mov_b32 s49, 74496
    buffer_load_dwordx4 v225, s[32:35], s49 offen lds
    s_waitcnt lgkmcnt(6)
    v_mfma_f32_32x32x16_bf16 v[160:175], v[176:179], v[0:3], 0
    ds_read_b64_tr_b16 v[192:193], v227 offset:40960
    ds_read_b64_tr_b16 v[194:195], v227 offset:41984
    s_waitcnt lgkmcnt(6)
    v_mfma_f32_32x32x16_bf16 v[160:175], v[180:183], v[4:7], v[160:175]
    ds_read_b64_tr_b16 v[196:197], v227 offset:43008
    ds_read_b64_tr_b16 v[198:199], v227 offset:44032
    s_waitcnt lgkmcnt(6)
    v_mfma_f32_32x32x16_bf16 v[160:175], v[184:187], v[8:11], v[160:175]
    ds_read_b64_tr_b16 v[200:201], v227 offset:45056
    ds_read_b64_tr_b16 v[202:203], v227 offset:46080
    s_waitcnt lgkmcnt(6)
    v_mfma_f32_32x32x16_bf16 v[160:175], v[188:191], v[12:15], v[160:175]
    ds_read_b64_tr_b16 v[204:205], v227 offset:47104
    ds_read_b64_tr_b16 v[206:207], v227 offset:48128
    s_waitcnt vmcnt(7)
    s_barrier
    s_add_u32 m0, s45, 32768
    s_mov_b32 s49, 148224
    buffer_load_dwordx4 v225, s[32:35], s49 offen lds
    v_cvt_pk_bf16_f32 v208, v144, v145
    v_cvt_pk_bf16_f32 v209, v146, v147
    v_cvt_pk_bf16_f32 v210, v148, v149
    v_cvt_pk_bf16_f32 v211, v150, v151
    s_mov_b32 s48, 16384
    buffer_store_dwordx4 v[208:211], v230, s[36:39], s48 offen offset:0 sc0 sc1
    s_waitcnt lgkmcnt(6)
    v_mfma_f32_32x32x16_bf16 v[160:175], v[192:195], v[16:19], v[160:175]
    ds_read_b64_tr_b16 v[176:177], v227 offset:49152
    ds_read_b64_tr_b16 v[178:179], v227 offset:50176
    s_waitcnt lgkmcnt(6)
    v_mfma_f32_32x32x16_bf16 v[160:175], v[196:199], v[20:23], v[160:175]
    ds_read_b64_tr_b16 v[180:181], v227 offset:51200
    ds_read_b64_tr_b16 v[182:183], v227 offset:52224
    s_waitcnt lgkmcnt(6)
    v_mfma_f32_32x32x16_bf16 v[160:175], v[200:203], v[24:27], v[160:175]
    ds_read_b64_tr_b16 v[184:185], v227 offset:53248
    ds_read_b64_tr_b16 v[186:187], v227 offset:54272
    s_waitcnt lgkmcnt(6)
    v_mfma_f32_32x32x16_bf16 v[160:175], v[204:207], v[28:31], v[160:175]
    ds_read_b64_tr_b16 v[188:189], v227 offset:55296
    ds_read_b64_tr_b16 v[190:191], v227 offset:56320
    s_waitcnt vmcnt(7)
    s_barrier
    s_add_u32 m0, s45, 40960
    s_mov_b32 s49, 221952
    buffer_load_dwordx4 v225, s[32:35], s49 offen lds
    s_waitcnt lgkmcnt(6)
    v_mfma_f32_32x32x16_bf16 v[160:175], v[176:179], v[32:35], v[160:175]
    ds_read_b64_tr_b16 v[192:193], v227 offset:57344
    ds_read_b64_tr_b16 v[194:195], v227 offset:58368
    s_waitcnt lgkmcnt(6)
    v_mfma_f32_32x32x16_bf16 v[160:175], v[180:183], v[36:39], v[160:175]
    ds_read_b64_tr_b16 v[196:197], v227 offset:59392
    ds_read_b64_tr_b16 v[198:199], v227 offset:60416
    s_waitcnt lgkmcnt(6)
    v_mfma_f32_32x32x16_bf16 v[160:175], v[184:187], v[40:43], v[160:175]
    ds_read_b64_tr_b16 v[200:201], v227 offset:61440
    ds_read_b64_tr_b16 v[202:203], v227 offset:62464
    s_waitcnt lgkmcnt(6)
    v_mfma_f32_32x32x16_bf16 v[160:175], v[188:191], v[44:47], v[160:175]
    ds_read_b64_tr_b16 v[204:205], v227 offset:63488
    ds_read_b64_tr_b16 v[206:207], v227 offset:64512
    s_waitcnt vmcnt(7)
    s_barrier
    s_add_u32 m0, s45, 49152
    s_mov_b32 s49, 295680
    buffer_load_dwordx4 v225, s[32:35], s49 offen lds
    v_cvt_pk_bf16_f32 v212, v152, v153
    v_cvt_pk_bf16_f32 v213, v154, v155
    v_cvt_pk_bf16_f32 v214, v156, v157
    v_cvt_pk_bf16_f32 v215, v158, v159
    s_mov_b32 s48, 16384
    buffer_store_dwordx4 v[212:215], v230, s[36:39], s48 offen offset:1024 sc0 sc1
    s_waitcnt lgkmcnt(6)
    v_mfma_f32_32x32x16_bf16 v[160:175], v[192:195], v[48:51], v[160:175]
    ds_read_b64_tr_b16 v[176:177], v227 offset:0
    ds_read_b64_tr_b16 v[178:179], v227 offset:1024
    s_waitcnt lgkmcnt(6)
    v_mfma_f32_32x32x16_bf16 v[160:175], v[196:199], v[52:55], v[160:175]
    ds_read_b64_tr_b16 v[180:181], v227 offset:2048
    ds_read_b64_tr_b16 v[182:183], v227 offset:3072
    s_waitcnt lgkmcnt(6)
    v_mfma_f32_32x32x16_bf16 v[160:175], v[200:203], v[56:59], v[160:175]
    ds_read_b64_tr_b16 v[184:185], v227 offset:4096
    ds_read_b64_tr_b16 v[186:187], v227 offset:5120
    s_waitcnt lgkmcnt(6)
    v_mfma_f32_32x32x16_bf16 v[160:175], v[204:207], v[60:63], v[160:175]
    ds_read_b64_tr_b16 v[188:189], v227 offset:6144
    ds_read_b64_tr_b16 v[190:191], v227 offset:7168
    s_waitcnt vmcnt(7)
    s_barrier
    s_add_u32 m0, s45, 57344
    s_mov_b32 s49, 369408
    buffer_load_dwordx4 v225, s[32:35], s49 offen lds
    s_waitcnt lgkmcnt(6)
    v_mfma_f32_32x32x16_bf16 v[160:175], v[176:179], v[64:67], v[160:175]
    ds_read_b64_tr_b16 v[192:193], v227 offset:8192
    ds_read_b64_tr_b16 v[194:195], v227 offset:9216
    s_waitcnt lgkmcnt(6)
    v_mfma_f32_32x32x16_bf16 v[160:175], v[180:183], v[68:71], v[160:175]
    ds_read_b64_tr_b16 v[196:197], v227 offset:10240
    ds_read_b64_tr_b16 v[198:199], v227 offset:11264
    s_waitcnt lgkmcnt(6)
    v_mfma_f32_32x32x16_bf16 v[160:175], v[184:187], v[72:75], v[160:175]
    ds_read_b64_tr_b16 v[200:201], v227 offset:12288
    ds_read_b64_tr_b16 v[202:203], v227 offset:13312
    s_waitcnt lgkmcnt(6)
    v_mfma_f32_32x32x16_bf16 v[160:175], v[188:191], v[76:79], v[160:175]
    ds_read_b64_tr_b16 v[204:205], v227 offset:14336
    ds_read_b64_tr_b16 v[206:207], v227 offset:15360
    s_waitcnt vmcnt(7)
    s_barrier
    s_add_u32 m0, s45, 0
    s_mov_b32 s49, 896
    buffer_load_dwordx4 v225, s[32:35], s49 offen lds
    s_waitcnt lgkmcnt(6)
    v_mfma_f32_32x32x16_bf16 v[160:175], v[192:195], v[80:83], v[160:175]
    ds_read_b64_tr_b16 v[176:177], v227 offset:16384
    ds_read_b64_tr_b16 v[178:179], v227 offset:17408
    s_waitcnt lgkmcnt(6)
    v_mfma_f32_32x32x16_bf16 v[160:175], v[196:199], v[84:87], v[160:175]
    ds_read_b64_tr_b16 v[180:181], v227 offset:18432
    ds_read_b64_tr_b16 v[182:183], v227 offset:19456
    s_waitcnt lgkmcnt(6)
    v_mfma_f32_32x32x16_bf16 v[160:175], v[200:203], v[88:91], v[160:175]
    ds_read_b64_tr_b16 v[184:185], v227 offset:20480
    ds_read_b64_tr_b16 v[186:187], v227 offset:21504
    s_waitcnt lgkmcnt(6)
    v_mfma_f32_32x32x16_bf16 v[160:175], v[204:207], v[92:95], v[160:175]
    ds_read_b64_tr_b16 v[188:189], v227 offset:22528
    ds_read_b64_tr_b16 v[190:191], v227 offset:23552
    s_waitcnt vmcnt(7)
    s_barrier
    s_add_u32 m0, s45, 8192
    s_mov_b32 s49, 74624
    buffer_load_dwordx4 v225, s[32:35], s49 offen lds
    s_waitcnt lgkmcnt(6)
    v_mfma_f32_32x32x16_bf16 v[144:159], v[176:179], v[0:3], 0
    ds_read_b64_tr_b16 v[192:193], v227 offset:24576
    ds_read_b64_tr_b16 v[194:195], v227 offset:25600
    s_waitcnt lgkmcnt(6)
    v_mfma_f32_32x32x16_bf16 v[144:159], v[180:183], v[4:7], v[144:159]
    ds_read_b64_tr_b16 v[196:197], v227 offset:26624
    ds_read_b64_tr_b16 v[198:199], v227 offset:27648
    s_waitcnt lgkmcnt(6)
    v_mfma_f32_32x32x16_bf16 v[144:159], v[184:187], v[8:11], v[144:159]
    ds_read_b64_tr_b16 v[200:201], v227 offset:28672
    ds_read_b64_tr_b16 v[202:203], v227 offset:29696
    s_waitcnt lgkmcnt(6)
    v_mfma_f32_32x32x16_bf16 v[144:159], v[188:191], v[12:15], v[144:159]
    ds_read_b64_tr_b16 v[204:205], v227 offset:30720
    ds_read_b64_tr_b16 v[206:207], v227 offset:31744
    s_waitcnt vmcnt(7)
    s_barrier
    s_add_u32 m0, s45, 16384
    s_mov_b32 s49, 148352
    buffer_load_dwordx4 v225, s[32:35], s49 offen lds
    v_cvt_pk_bf16_f32 v208, v160, v161
    v_cvt_pk_bf16_f32 v209, v162, v163
    v_cvt_pk_bf16_f32 v210, v164, v165
    v_cvt_pk_bf16_f32 v211, v166, v167
    s_mov_b32 s48, 20480
    buffer_store_dwordx4 v[208:211], v230, s[36:39], s48 offen offset:0 sc0 sc1
    s_waitcnt lgkmcnt(6)
    v_mfma_f32_32x32x16_bf16 v[144:159], v[192:195], v[16:19], v[144:159]
    ds_read_b64_tr_b16 v[176:177], v227 offset:32768
    ds_read_b64_tr_b16 v[178:179], v227 offset:33792
    s_waitcnt lgkmcnt(6)
    v_mfma_f32_32x32x16_bf16 v[144:159], v[196:199], v[20:23], v[144:159]
    ds_read_b64_tr_b16 v[180:181], v227 offset:34816
    ds_read_b64_tr_b16 v[182:183], v227 offset:35840
    s_waitcnt lgkmcnt(6)
    v_mfma_f32_32x32x16_bf16 v[144:159], v[200:203], v[24:27], v[144:159]
    ds_read_b64_tr_b16 v[184:185], v227 offset:36864
    ds_read_b64_tr_b16 v[186:187], v227 offset:37888
    s_waitcnt lgkmcnt(6)
    v_mfma_f32_32x32x16_bf16 v[144:159], v[204:207], v[28:31], v[144:159]
    ds_read_b64_tr_b16 v[188:189], v227 offset:38912
    ds_read_b64_tr_b16 v[190:191], v227 offset:39936
    s_waitcnt vmcnt(7)
    s_barrier
    s_add_u32 m0, s45, 24576
    s_mov_b32 s49, 222080
    buffer_load_dwordx4 v225, s[32:35], s49 offen lds
    s_waitcnt lgkmcnt(6)
    v_mfma_f32_32x32x16_bf16 v[144:159], v[176:179], v[32:35], v[144:159]
    ds_read_b64_tr_b16 v[192:193], v227 offset:40960
    ds_read_b64_tr_b16 v[194:195], v227 offset:41984
    s_waitcnt lgkmcnt(6)
    v_mfma_f32_32x32x16_bf16 v[144:159], v[180:183], v[36:39], v[144:159]
    ds_read_b64_tr_b16 v[196:197], v227 offset:43008
    ds_read_b64_tr_b16 v[198:199], v227 offset:44032
    s_waitcnt lgkmcnt(6)
    v_mfma_f32_32x32x16_bf16 v[144:159], v[184:187], v[40:43], v[144:159]
    ds_read_b64_tr_b16 v[200:201], v227 offset:45056
    ds_read_b64_tr_b16 v[202:203], v227 offset:46080
    s_waitcnt lgkmcnt(6)
    v_mfma_f32_32x32x16_bf16 v[144:159], v[188:191], v[44:47], v[144:159]
    ds_read_b64_tr_b16 v[204:205], v227 offset:47104
    ds_read_b64_tr_b16 v[206:207], v227 offset:48128
    s_waitcnt vmcnt(7)
    s_barrier
    s_add_u32 m0, s45, 32768
    s_mov_b32 s49, 295808
    buffer_load_dwordx4 v225, s[32:35], s49 offen lds
    v_cvt_pk_bf16_f32 v212, v168, v169
    v_cvt_pk_bf16_f32 v213, v170, v171
    v_cvt_pk_bf16_f32 v214, v172, v173
    v_cvt_pk_bf16_f32 v215, v174, v175
    s_mov_b32 s48, 20480
    buffer_store_dwordx4 v[212:215], v230, s[36:39], s48 offen offset:1024 sc0 sc1
    s_waitcnt lgkmcnt(6)
    v_mfma_f32_32x32x16_bf16 v[144:159], v[192:195], v[48:51], v[144:159]
    ds_read_b64_tr_b16 v[176:177], v227 offset:49152
    ds_read_b64_tr_b16 v[178:179], v227 offset:50176
    s_waitcnt lgkmcnt(6)
    v_mfma_f32_32x32x16_bf16 v[144:159], v[196:199], v[52:55], v[144:159]
    ds_read_b64_tr_b16 v[180:181], v227 offset:51200
    ds_read_b64_tr_b16 v[182:183], v227 offset:52224
    s_waitcnt lgkmcnt(6)
    v_mfma_f32_32x32x16_bf16 v[144:159], v[200:203], v[56:59], v[144:159]
    ds_read_b64_tr_b16 v[184:185], v227 offset:53248
    ds_read_b64_tr_b16 v[186:187], v227 offset:54272
    s_waitcnt lgkmcnt(6)
    v_mfma_f32_32x32x16_bf16 v[144:159], v[204:207], v[60:63], v[144:159]
    ds_read_b64_tr_b16 v[188:189], v227 offset:55296
    ds_read_b64_tr_b16 v[190:191], v227 offset:56320
    s_waitcnt vmcnt(7)
    s_barrier
    s_add_u32 m0, s45, 40960
    s_mov_b32 s49, 369536
    buffer_load_dwordx4 v225, s[32:35], s49 offen lds
    s_waitcnt lgkmcnt(6)
    v_mfma_f32_32x32x16_bf16 v[144:159], v[176:179], v[64:67], v[144:159]
    ds_read_b64_tr_b16 v[192:193], v227 offset:57344
    ds_read_b64_tr_b16 v[194:195], v227 offset:58368
    s_waitcnt lgkmcnt(6)
    v_mfma_f32_32x32x16_bf16 v[144:159], v[180:183], v[68:71], v[144:159]
    ds_read_b64_tr_b16 v[196:197], v227 offset:59392
    ds_read_b64_tr_b16 v[198:199], v227 offset:60416
    s_waitcnt lgkmcnt(6)
    v_mfma_f32_32x32x16_bf16 v[144:159], v[184:187], v[72:75], v[144:159]
    ds_read_b64_tr_b16 v[200:201], v227 offset:61440
    ds_read_b64_tr_b16 v[202:203], v227 offset:62464
    s_waitcnt lgkmcnt(6)
    v_mfma_f32_32x32x16_bf16 v[144:159], v[188:191], v[76:79], v[144:159]
    ds_read_b64_tr_b16 v[204:205], v227 offset:63488
    ds_read_b64_tr_b16 v[206:207], v227 offset:64512
    s_waitcnt vmcnt(7)
    s_barrier
    s_add_u32 m0, s45, 49152
    s_mov_b32 s49, 1024
    buffer_load_dwordx4 v225, s[32:35], s49 offen lds
    s_waitcnt lgkmcnt(6)
    v_mfma_f32_32x32x16_bf16 v[144:159], v[192:195], v[80:83], v[144:159]
    ds_read_b64_tr_b16 v[176:177], v227 offset:0
    ds_read_b64_tr_b16 v[178:179], v227 offset:1024
    s_waitcnt lgkmcnt(6)
    v_mfma_f32_32x32x16_bf16 v[144:159], v[196:199], v[84:87], v[144:159]
    ds_read_b64_tr_b16 v[180:181], v227 offset:2048
    ds_read_b64_tr_b16 v[182:183], v227 offset:3072
    s_waitcnt lgkmcnt(6)
    v_mfma_f32_32x32x16_bf16 v[144:159], v[200:203], v[88:91], v[144:159]
    ds_read_b64_tr_b16 v[184:185], v227 offset:4096
    ds_read_b64_tr_b16 v[186:187], v227 offset:5120
    s_waitcnt lgkmcnt(6)
    v_mfma_f32_32x32x16_bf16 v[144:159], v[204:207], v[92:95], v[144:159]
    ds_read_b64_tr_b16 v[188:189], v227 offset:6144
    ds_read_b64_tr_b16 v[190:191], v227 offset:7168
    s_waitcnt vmcnt(7)
    s_barrier
    s_add_u32 m0, s45, 57344
    s_mov_b32 s49, 74752
    buffer_load_dwordx4 v225, s[32:35], s49 offen lds
    s_waitcnt lgkmcnt(6)
    v_mfma_f32_32x32x16_bf16 v[160:175], v[176:179], v[0:3], 0
    ds_read_b64_tr_b16 v[192:193], v227 offset:8192
    ds_read_b64_tr_b16 v[194:195], v227 offset:9216
    s_waitcnt lgkmcnt(6)
    v_mfma_f32_32x32x16_bf16 v[160:175], v[180:183], v[4:7], v[160:175]
    ds_read_b64_tr_b16 v[196:197], v227 offset:10240
    ds_read_b64_tr_b16 v[198:199], v227 offset:11264
    s_waitcnt lgkmcnt(6)
    v_mfma_f32_32x32x16_bf16 v[160:175], v[184:187], v[8:11], v[160:175]
    ds_read_b64_tr_b16 v[200:201], v227 offset:12288
    ds_read_b64_tr_b16 v[202:203], v227 offset:13312
    s_waitcnt lgkmcnt(6)
    v_mfma_f32_32x32x16_bf16 v[160:175], v[188:191], v[12:15], v[160:175]
    ds_read_b64_tr_b16 v[204:205], v227 offset:14336
    ds_read_b64_tr_b16 v[206:207], v227 offset:15360
    s_waitcnt vmcnt(7)
    s_barrier
    s_add_u32 m0, s45, 0
    s_mov_b32 s49, 148480
    buffer_load_dwordx4 v225, s[32:35], s49 offen lds
    v_cvt_pk_bf16_f32 v208, v144, v145
    v_cvt_pk_bf16_f32 v209, v146, v147
    v_cvt_pk_bf16_f32 v210, v148, v149
    v_cvt_pk_bf16_f32 v211, v150, v151
    s_mov_b32 s48, 24576
    buffer_store_dwordx4 v[208:211], v230, s[36:39], s48 offen offset:0 sc0 sc1
    s_waitcnt lgkmcnt(6)
    v_mfma_f32_32x32x16_bf16 v[160:175], v[192:195], v[16:19], v[160:175]
    ds_read_b64_tr_b16 v[176:177], v227 offset:16384
    ds_read_b64_tr_b16 v[178:179], v227 offset:17408
    s_waitcnt lgkmcnt(6)
    v_mfma_f32_32x32x16_bf16 v[160:175], v[196:199], v[20:23], v[160:175]
    ds_read_b64_tr_b16 v[180:181], v227 offset:18432
    ds_read_b64_tr_b16 v[182:183], v227 offset:19456
    s_waitcnt lgkmcnt(6)
    v_mfma_f32_32x32x16_bf16 v[160:175], v[200:203], v[24:27], v[160:175]
    ds_read_b64_tr_b16 v[184:185], v227 offset:20480
    ds_read_b64_tr_b16 v[186:187], v227 offset:21504
    s_waitcnt lgkmcnt(6)
    v_mfma_f32_32x32x16_bf16 v[160:175], v[204:207], v[28:31], v[160:175]
    ds_read_b64_tr_b16 v[188:189], v227 offset:22528
    ds_read_b64_tr_b16 v[190:191], v227 offset:23552
    s_waitcnt vmcnt(7)
    s_barrier
    s_add_u32 m0, s45, 8192
    s_mov_b32 s49, 222208
    buffer_load_dwordx4 v225, s[32:35], s49 offen lds
    s_waitcnt lgkmcnt(6)
    v_mfma_f32_32x32x16_bf16 v[160:175], v[176:179], v[32:35], v[160:175]
    ds_read_b64_tr_b16 v[192:193], v227 offset:24576
    ds_read_b64_tr_b16 v[194:195], v227 offset:25600
    s_waitcnt lgkmcnt(6)
    v_mfma_f32_32x32x16_bf16 v[160:175], v[180:183], v[36:39], v[160:175]
    ds_read_b64_tr_b16 v[196:197], v227 offset:26624
    ds_read_b64_tr_b16 v[198:199], v227 offset:27648
    s_waitcnt lgkmcnt(6)
    v_mfma_f32_32x32x16_bf16 v[160:175], v[184:187], v[40:43], v[160:175]
    ds_read_b64_tr_b16 v[200:201], v227 offset:28672
    ds_read_b64_tr_b16 v[202:203], v227 offset:29696
    s_waitcnt lgkmcnt(6)
    v_mfma_f32_32x32x16_bf16 v[160:175], v[188:191], v[44:47], v[160:175]
    ds_read_b64_tr_b16 v[204:205], v227 offset:30720
    ds_read_b64_tr_b16 v[206:207], v227 offset:31744
    s_waitcnt vmcnt(7)
    s_barrier
    s_add_u32 m0, s45, 16384
    s_mov_b32 s49, 295936
    buffer_load_dwordx4 v225, s[32:35], s49 offen lds
    v_cvt_pk_bf16_f32 v212, v152, v153
    v_cvt_pk_bf16_f32 v213, v154, v155
    v_cvt_pk_bf16_f32 v214, v156, v157
    v_cvt_pk_bf16_f32 v215, v158, v159
    s_mov_b32 s48, 24576
    buffer_store_dwordx4 v[212:215], v230, s[36:39], s48 offen offset:1024 sc0 sc1
    s_waitcnt lgkmcnt(6)
    v_mfma_f32_32x32x16_bf16 v[160:175], v[192:195], v[48:51], v[160:175]
    ds_read_b64_tr_b16 v[176:177], v227 offset:32768
    ds_read_b64_tr_b16 v[178:179], v227 offset:33792
    s_waitcnt lgkmcnt(6)
    v_mfma_f32_32x32x16_bf16 v[160:175], v[196:199], v[52:55], v[160:175]
    ds_read_b64_tr_b16 v[180:181], v227 offset:34816
    ds_read_b64_tr_b16 v[182:183], v227 offset:35840
    s_waitcnt lgkmcnt(6)
    v_mfma_f32_32x32x16_bf16 v[160:175], v[200:203], v[56:59], v[160:175]
    ds_read_b64_tr_b16 v[184:185], v227 offset:36864
    ds_read_b64_tr_b16 v[186:187], v227 offset:37888
    s_waitcnt lgkmcnt(6)
    v_mfma_f32_32x32x16_bf16 v[160:175], v[204:207], v[60:63], v[160:175]
    ds_read_b64_tr_b16 v[188:189], v227 offset:38912
    ds_read_b64_tr_b16 v[190:191], v227 offset:39936
    s_waitcnt vmcnt(7)
    s_barrier
    s_add_u32 m0, s45, 24576
    s_mov_b32 s49, 369664
    buffer_load_dwordx4 v225, s[32:35], s49 offen lds
    s_waitcnt lgkmcnt(6)
    v_mfma_f32_32x32x16_bf16 v[160:175], v[176:179], v[64:67], v[160:175]
    ds_read_b64_tr_b16 v[192:193], v227 offset:40960
    ds_read_b64_tr_b16 v[194:195], v227 offset:41984
    s_waitcnt lgkmcnt(6)
    v_mfma_f32_32x32x16_bf16 v[160:175], v[180:183], v[68:71], v[160:175]
    ds_read_b64_tr_b16 v[196:197], v227 offset:43008
    ds_read_b64_tr_b16 v[198:199], v227 offset:44032
    s_waitcnt lgkmcnt(6)
    v_mfma_f32_32x32x16_bf16 v[160:175], v[184:187], v[72:75], v[160:175]
    ds_read_b64_tr_b16 v[200:201], v227 offset:45056
    ds_read_b64_tr_b16 v[202:203], v227 offset:46080
    s_waitcnt lgkmcnt(6)
    v_mfma_f32_32x32x16_bf16 v[160:175], v[188:191], v[76:79], v[160:175]
    ds_read_b64_tr_b16 v[204:205], v227 offset:47104
    ds_read_b64_tr_b16 v[206:207], v227 offset:48128
    s_waitcnt vmcnt(7)
    s_barrier
    s_waitcnt lgkmcnt(6)
    v_mfma_f32_32x32x16_bf16 v[160:175], v[192:195], v[80:83], v[160:175]
    ds_read_b64_tr_b16 v[176:177], v227 offset:49152
    ds_read_b64_tr_b16 v[178:179], v227 offset:50176
    s_waitcnt lgkmcnt(6)
    v_mfma_f32_32x32x16_bf16 v[160:175], v[196:199], v[84:87], v[160:175]
    ds_read_b64_tr_b16 v[180:181], v227 offset:51200
    ds_read_b64_tr_b16 v[182:183], v227 offset:52224
    s_waitcnt lgkmcnt(6)
    v_mfma_f32_32x32x16_bf16 v[160:175], v[200:203], v[88:91], v[160:175]
    ds_read_b64_tr_b16 v[184:185], v227 offset:53248
    ds_read_b64_tr_b16 v[186:187], v227 offset:54272
    s_waitcnt lgkmcnt(6)
    v_mfma_f32_32x32x16_bf16 v[160:175], v[204:207], v[92:95], v[160:175]
    ds_read_b64_tr_b16 v[188:189], v227 offset:55296
    ds_read_b64_tr_b16 v[190:191], v227 offset:56320
    s_waitcnt vmcnt(6)
    s_barrier
    s_waitcnt lgkmcnt(6)
    v_mfma_f32_32x32x16_bf16 v[144:159], v[176:179], v[0:3], 0
    ds_read_b64_tr_b16 v[192:193], v227 offset:57344
    ds_read_b64_tr_b16 v[194:195], v227 offset:58368
    s_waitcnt lgkmcnt(6)
    v_mfma_f32_32x32x16_bf16 v[144:159], v[180:183], v[4:7], v[144:159]
    ds_read_b64_tr_b16 v[196:197], v227 offset:59392
    ds_read_b64_tr_b16 v[198:199], v227 offset:60416
    s_waitcnt lgkmcnt(6)
    v_mfma_f32_32x32x16_bf16 v[144:159], v[184:187], v[8:11], v[144:159]
    ds_read_b64_tr_b16 v[200:201], v227 offset:61440
    ds_read_b64_tr_b16 v[202:203], v227 offset:62464
    s_waitcnt lgkmcnt(6)
    v_mfma_f32_32x32x16_bf16 v[144:159], v[188:191], v[12:15], v[144:159]
    ds_read_b64_tr_b16 v[204:205], v227 offset:63488
    ds_read_b64_tr_b16 v[206:207], v227 offset:64512
    s_waitcnt vmcnt(5)
    s_barrier
    v_cvt_pk_bf16_f32 v208, v160, v161
    v_cvt_pk_bf16_f32 v209, v162, v163
    v_cvt_pk_bf16_f32 v210, v164, v165
    v_cvt_pk_bf16_f32 v211, v166, v167
    s_mov_b32 s48, 28672
    buffer_store_dwordx4 v[208:211], v230, s[36:39], s48 offen offset:0 sc0 sc1
    s_waitcnt lgkmcnt(6)
    v_mfma_f32_32x32x16_bf16 v[144:159], v[192:195], v[16:19], v[144:159]
    ds_read_b64_tr_b16 v[176:177], v227 offset:0
    ds_read_b64_tr_b16 v[178:179], v227 offset:1024
    s_waitcnt lgkmcnt(6)
    v_mfma_f32_32x32x16_bf16 v[144:159], v[196:199], v[20:23], v[144:159]
    ds_read_b64_tr_b16 v[180:181], v227 offset:2048
    ds_read_b64_tr_b16 v[182:183], v227 offset:3072
    s_waitcnt lgkmcnt(6)
    v_mfma_f32_32x32x16_bf16 v[144:159], v[200:203], v[24:27], v[144:159]
    ds_read_b64_tr_b16 v[184:185], v227 offset:4096
    ds_read_b64_tr_b16 v[186:187], v227 offset:5120
    s_waitcnt lgkmcnt(6)
    v_mfma_f32_32x32x16_bf16 v[144:159], v[204:207], v[28:31], v[144:159]
    ds_read_b64_tr_b16 v[188:189], v227 offset:6144
    ds_read_b64_tr_b16 v[190:191], v227 offset:7168
    s_waitcnt vmcnt(4)
    s_barrier
    s_waitcnt lgkmcnt(6)
    v_mfma_f32_32x32x16_bf16 v[144:159], v[176:179], v[32:35], v[144:159]
    ds_read_b64_tr_b16 v[192:193], v227 offset:8192
    ds_read_b64_tr_b16 v[194:195], v227 offset:9216
    s_waitcnt lgkmcnt(6)
    v_mfma_f32_32x32x16_bf16 v[144:159], v[180:183], v[36:39], v[144:159]
    ds_read_b64_tr_b16 v[196:197], v227 offset:10240
    ds_read_b64_tr_b16 v[198:199], v227 offset:11264
    s_waitcnt lgkmcnt(6)
    v_mfma_f32_32x32x16_bf16 v[144:159], v[184:187], v[40:43], v[144:159]
    ds_read_b64_tr_b16 v[200:201], v227 offset:12288
    ds_read_b64_tr_b16 v[202:203], v227 offset:13312
    s_waitcnt lgkmcnt(6)
    v_mfma_f32_32x32x16_bf16 v[144:159], v[188:191], v[44:47], v[144:159]
    ds_read_b64_tr_b16 v[204:205], v227 offset:14336
    ds_read_b64_tr_b16 v[206:207], v227 offset:15360
    s_waitcnt vmcnt(3)
    s_barrier
    v_cvt_pk_bf16_f32 v212, v168, v169
    v_cvt_pk_bf16_f32 v213, v170, v171
    v_cvt_pk_bf16_f32 v214, v172, v173
    v_cvt_pk_bf16_f32 v215, v174, v175
    s_mov_b32 s48, 28672
    buffer_store_dwordx4 v[212:215], v230, s[36:39], s48 offen offset:1024 sc0 sc1
    s_waitcnt lgkmcnt(6)
    v_mfma_f32_32x32x16_bf16 v[144:159], v[192:195], v[48:51], v[144:159]
    ds_read_b64_tr_b16 v[176:177], v227 offset:16384
    ds_read_b64_tr_b16 v[178:179], v227 offset:17408
    s_waitcnt lgkmcnt(6)
    v_mfma_f32_32x32x16_bf16 v[144:159], v[196:199], v[52:55], v[144:159]
    ds_read_b64_tr_b16 v[180:181], v227 offset:18432
    ds_read_b64_tr_b16 v[182:183], v227 offset:19456
    s_waitcnt lgkmcnt(6)
    v_mfma_f32_32x32x16_bf16 v[144:159], v[200:203], v[56:59], v[144:159]
    ds_read_b64_tr_b16 v[184:185], v227 offset:20480
    ds_read_b64_tr_b16 v[186:187], v227 offset:21504
    s_waitcnt lgkmcnt(6)
    v_mfma_f32_32x32x16_bf16 v[144:159], v[204:207], v[60:63], v[144:159]
    ds_read_b64_tr_b16 v[188:189], v227 offset:22528
    ds_read_b64_tr_b16 v[190:191], v227 offset:23552
    s_waitcnt vmcnt(2)
    s_barrier
    s_waitcnt lgkmcnt(6)
    v_mfma_f32_32x32x16_bf16 v[144:159], v[176:179], v[64:67], v[144:159]
    ds_read_b64_tr_b16 v[192:193], v227 offset:24576
    ds_read_b64_tr_b16 v[194:195], v227 offset:25600
    s_waitcnt lgkmcnt(6)
    v_mfma_f32_32x32x16_bf16 v[144:159], v[180:183], v[68:71], v[144:159]
    ds_read_b64_tr_b16 v[196:197], v227 offset:26624
    ds_read_b64_tr_b16 v[198:199], v227 offset:27648
    s_waitcnt lgkmcnt(6)
    v_mfma_f32_32x32x16_bf16 v[144:159], v[184:187], v[72:75], v[144:159]
    ds_read_b64_tr_b16 v[200:201], v227 offset:28672
    ds_read_b64_tr_b16 v[202:203], v227 offset:29696
    s_waitcnt lgkmcnt(6)
    v_mfma_f32_32x32x16_bf16 v[144:159], v[188:191], v[76:79], v[144:159]
    ds_read_b64_tr_b16 v[204:205], v227 offset:30720
    ds_read_b64_tr_b16 v[206:207], v227 offset:31744
    s_barrier
    s_waitcnt lgkmcnt(6)
    v_mfma_f32_32x32x16_bf16 v[144:159], v[192:195], v[80:83], v[144:159]
    s_waitcnt lgkmcnt(4)
    v_mfma_f32_32x32x16_bf16 v[144:159], v[196:199], v[84:87], v[144:159]
    s_waitcnt lgkmcnt(2)
    v_mfma_f32_32x32x16_bf16 v[144:159], v[200:203], v[88:91], v[144:159]
    s_waitcnt lgkmcnt(0)
    v_mfma_f32_32x32x16_bf16 v[144:159], v[204:207], v[92:95], v[144:159]
    s_nop 7
    s_nop 7
    v_cvt_pk_bf16_f32 v208, v144, v145
    v_cvt_pk_bf16_f32 v209, v146, v147
    v_cvt_pk_bf16_f32 v210, v148, v149
    v_cvt_pk_bf16_f32 v211, v150, v151
    s_mov_b32 s48, 32768
    buffer_store_dwordx4 v[208:211], v230, s[36:39], s48 offen offset:0 sc0 sc1
    v_cvt_pk_bf16_f32 v212, v152, v153
    v_cvt_pk_bf16_f32 v213, v154, v155
    v_cvt_pk_bf16_f32 v214, v156, v157
    v_cvt_pk_bf16_f32 v215, v158, v159
    s_mov_b32 s48, 32768
    buffer_store_dwordx4 v[212:215], v230, s[36:39], s48 offen offset:1024 sc0 sc1
    s_waitcnt vmcnt(0) lgkmcnt(0)
    v_mbcnt_lo_u32_b32 v1, -1, 0
    v_mbcnt_hi_u32_b32 v1, -1, v1
    s_load_dwordx2 s[4:5], s[0:1], 0
    s_load_dwordx4 s[12:15], s[0:1], 48
    s_load_dwordx2 s[20:21], s[0:1], 64
    s_barrier
    s_waitcnt lgkmcnt(0)
    s_mov_b32 s16, s14
    s_and_b32 s17, s15, 0xffff
    s_mov_b32 s18, 0x100
    s_mov_b32 s19, 0x20000
    s_lshl_b32 s47, s44, 7
    s_add_u32 s47, s47, 46137344
    s_add_u32 s36, s20, s47
    s_addc_u32 s37, s21, 0
    s_and_b32 s37, s37, 0xffff
    s_mov_b32 s38, 64
    s_mov_b32 s39, 0x20000
    v_mov_b32 v6, 240
    s_mov_b32 s47, 0
L_tag_m1:
    buffer_load_dword v5, v6, s[16:19], 0 offen sc1
    s_waitcnt vmcnt(0)
    v_readfirstlane_b32 s58, v5
    s_add_u32 s47, s47, 1
    s_nop 2
    s_cmp_lg_u32 s58, 0
    s_cbranch_scc1 L_tagok_m1
    s_cmp_lt_u32 s47, 200000
    s_cbranch_scc1 L_tag_m1
L_tagok_m1:
    s_cmp_lg_u32 s40, 0
    s_cbranch_scc1 L_t_nosig_m1
    s_mov_b32 s46, s43
    s_lshl_b32 s46, s46, 2
    v_mov_b32 v4, s58
    v_mov_b32 v5, s46
    s_mov_b64 exec, 1
    buffer_store_dword v4, v5, s[36:39], 0 offen sc0 sc1
    s_mov_b64 exec, -1
L_t_nosig_m1:
    s_mov_b32 s24, s4
    s_and_b32 s25, s5, 0xffff
    s_mov_b32 s26, 0x240000
    s_mov_b32 s27, 0x20000
    s_mov_b32 s28, s12
    s_and_b32 s29, s13, 0xffff
    s_mov_b32 s30, 0x240000
    s_mov_b32 s31, 0x20000
    s_mov_b32 s32, s20
    s_and_b32 s33, s21, 0xffff
    s_mov_b32 s34, 0x2400000
    s_mov_b32 s35, 0x20000
    s_mul_i32 s55, s43, 12
    s_add_u32 s46, s55, s40
    s_mov_b32 s22, s46
    s_lshr_b32 s47, s22, 1
    s_and_b32 s48, s22, 1
    s_mul_i32 s49, s47, 3641
    s_lshr_b32 s49, s49, 16
    s_mul_i32 s56, s49, 18
    s_sub_u32 s56, s47, s56
    s_mul_i32 s57, s44, 72
    s_add_u32 s57, s57, s47
    s_lshl_b32 s57, s57, 1
    s_add_u32 s57, s57, s48
    s_lshl_b32 s57, s57, 10
    v_lshlrev_b32 v2, 4, v1
    v_add_u32 v2, s57, v2
    s_lshl_b32 s57, s44, 7
    s_lshl_b32 s49, s49, 5
    s_add_u32 s57, s57, s49
    v_and_b32 v3, 31, v1
    v_add_u32 v3, s57, v3
    v_mul_u32_u24 v3, 1152, v3
    v_lshrrev_b32 v4, 5, v1
    v_lshl_add_u32 v3, v4, 4, v3
    s_lshl_b32 s56, s56, 6
    s_lshl_b32 s48, s48, 5
    s_add_u32 s56, s56, s48
    v_add_u32 v3, s56, v3
    buffer_load_dwordx4 v[8:11], v3, s[24:27], 0 offen
    s_and_b32 s46, s40, 3
    s_add_u32 s22, s55, s46
    s_add_u32 s22, s22, 8
    s_lshr_b32 s47, s22, 1
    s_and_b32 s48, s22, 1
    s_mul_i32 s49, s47, 3641
    s_lshr_b32 s49, s49, 16
    s_mul_i32 s56, s49, 18
    s_sub_u32 s56, s47, s56
    s_mul_i32 s57, s44, 72
    s_add_u32 s57, s57, s47
    s_lshl_b32 s57, s57, 1
    s_add_u32 s57, s57, s48
    s_lshl_b32 s57, s57, 10
    v_lshlrev_b32 v7, 4, v1
    v_add_u32 v7, s57, v7
    s_lshl_b32 s57, s44, 7
    s_lshl_b32 s49, s49, 5
    s_add_u32 s57, s57, s49
    v_and_b32 v240, 31, v1
    v_add_u32 v240, s57, v240
    v_mul_u32_u24 v240, 1152, v240
    v_lshrrev_b32 v4, 5, v1
    v_lshl_add_u32 v240, v4, 4, v240
    s_lshl_b32 s56, s56, 6
    s_lshl_b32 s48, s48, 5
    s_add_u32 s56, s56, s48
    v_add_u32 v240, s56, v240
    buffer_load_dwordx4 v[12:15], v240, s[24:27], 0 offen
    v_lshlrev_b32 v6, 2, v1
    v_mov_b32 v80, 0
    v_mov_b32 v81, 0
    v_mov_b32 v82, 0
    v_mov_b32 v83, 0
    v_mov_b32 v84, 0
    v_mov_b32 v85, 0
    v_mov_b32 v86, 0
    v_mov_b32 v87, 0
    v_mov_b32 v160, 0
    v_mov_b32 v161, 0
    v_mov_b32 v162, 0
    v_mov_b32 v163, 0
    v_mov_b32 v164, 0
    v_mov_b32 v165, 0
    v_mov_b32 v166, 0
    v_mov_b32 v167, 0
    s_cmp_lg_u32 s40, 0
    s_cbranch_scc1 L_pa_go_m1
    s_mov_b32 s47, 0
L_pa_poll_m1:
    buffer_load_dword v5, v6, s[36:39], 0 offen sc1
    s_waitcnt vmcnt(0)
    v_cmp_eq_u32 vcc, s58, v5
    s_add_u32 s47, s47, 1
    s_nop 3
    s_and_b32 s46, vcc_lo, 0xfff
    s_cmp_eq_u32 s46, 0xfff
    s_cbranch_scc1 L_pa_go_m1
    s_cmp_ge_u32 s47, 200000
    s_cbranch_scc1 L_pa_go_m1
    s_sleep 8
    s_branch L_pa_poll_m1
L_pa_go_m1:
    s_barrier
    s_cmp_ge_u32 s40, 4
    s_cbranch_scc1 L_a_one_m1
    s_mov_b32 s49, 0
    buffer_load_dwordx4 v[16:19], v2, s[32:35], s49 offen sc1
    s_mov_b32 s49, 2359296
    buffer_load_dwordx4 v[20:23], v2, s[32:35], s49 offen sc1
    s_mov_b32 s49, 4718592
    buffer_load_dwordx4 v[24:27], v2, s[32:35], s49 offen sc1
    s_mov_b32 s49, 7077888
    buffer_load_dwordx4 v[28:31], v2, s[32:35], s49 offen sc1
    s_mov_b32 s49, 9437184
    buffer_load_dwordx4 v[32:35], v2, s[32:35], s49 offen sc1
    s_mov_b32 s49, 11796480
    buffer_load_dwordx4 v[36:39], v2, s[32:35], s49 offen sc1
    s_mov_b32 s49, 14155776
    buffer_load_dwordx4 v[40:43], v2, s[32:35], s49 offen sc1
    s_mov_b32 s49, 16515072
    buffer_load_dwordx4 v[44:47], v2, s[32:35], s49 offen sc1
    s_mov_b32 s49, 18874368
    buffer_load_dwordx4 v[48:51], v2, s[32:35], s49 offen sc1
    s_mov_b32 s49, 21233664
    buffer_load_dwordx4 v[52:55], v2, s[32:35], s49 offen sc1
    s_mov_b32 s49, 23592960
    buffer_load_dwordx4 v[56:59], v2, s[32:35], s49 offen sc1
    s_mov_b32 s49, 25952256
    buffer_load_dwordx4 v[60:63], v2, s[32:35], s49 offen sc1
    s_mov_b32 s49, 0
    buffer_load_dwordx4 v[96:99], v7, s[32:35], s49 offen sc1
    s_mov_b32 s49, 2359296
    buffer_load_dwordx4 v[100:103], v7, s[32:35], s49 offen sc1
    s_mov_b32 s49, 4718592
    buffer_load_dwordx4 v[104:107], v7, s[32:35], s49 offen sc1
    s_mov_b32 s49, 7077888
    buffer_load_dwordx4 v[108:111], v7, s[32:35], s49 offen sc1
    s_mov_b32 s49, 9437184
    buffer_load_dwordx4 v[112:115], v7, s[32:35], s49 offen sc1
    s_mov_b32 s49, 11796480
    buffer_load_dwordx4 v[116:119], v7, s[32:35], s49 offen sc1
    s_mov_b32 s49, 14155776
    buffer_load_dwordx4 v[120:123], v7, s[32:35], s49 offen sc1
    s_mov_b32 s49, 16515072
    buffer_load_dwordx4 v[124:127], v7, s[32:35], s49 offen sc1
    s_mov_b32 s49, 18874368
    buffer_load_dwordx4 v[128:131], v7, s[32:35], s49 offen sc1
    s_mov_b32 s49, 21233664
    buffer_load_dwordx4 v[132:135], v7, s[32:35], s49 offen sc1
    s_mov_b32 s49, 23592960
    buffer_load_dwordx4 v[136:139], v7, s[32:35], s49 offen sc1
    s_mov_b32 s49, 25952256
    buffer_load_dwordx4 v[140:143], v7, s[32:35], s49 offen sc1
    s_waitcnt vmcnt(23)
    v_dot2_f32_bf16 v80, v16, s53, v80
    v_dot2_f32_bf16 v81, v16, s54, v81
    v_dot2_f32_bf16 v82, v17, s53, v82
    v_dot2_f32_bf16 v83, v17, s54, v83
    v_dot2_f32_bf16 v84, v18, s53, v84
    v_dot2_f32_bf16 v85, v18, s54, v85
    v_dot2_f32_bf16 v86, v19, s53, v86
    v_dot2_f32_bf16 v87, v19, s54, v87
    s_waitcnt vmcnt(22)
    v_dot2_f32_bf16 v80, v20, s53, v80
    v_dot2_f32_bf16 v81, v20, s54, v81
    v_dot2_f32_bf16 v82, v21, s53, v82
    v_dot2_f32_bf16 v83, v21, s54, v83
    v_dot2_f32_bf16 v84, v22, s53, v84
    v_dot2_f32_bf16 v85, v22, s54, v85
    v_dot2_f32_bf16 v86, v23, s53, v86
    v_dot2_f32_bf16 v87, v23, s54, v87
    s_waitcnt vmcnt(21)
    v_dot2_f32_bf16 v80, v24, s53, v80
    v_dot2_f32_bf16 v81, v24, s54, v81
    v_dot2_f32_bf16 v82, v25, s53, v82
    v_dot2_f32_bf16 v83, v25, s54, v83
    v_dot2_f32_bf16 v84, v26, s53, v84
    v_dot2_f32_bf16 v85, v26, s54, v85
    v_dot2_f32_bf16 v86, v27, s53, v86
    v_dot2_f32_bf16 v87, v27, s54, v87
    s_waitcnt vmcnt(20)
    v_dot2_f32_bf16 v80, v28, s53, v80
    v_dot2_f32_bf16 v81, v28, s54, v81
    v_dot2_f32_bf16 v82, v29, s53, v82
    v_dot2_f32_bf16 v83, v29, s54, v83
    v_dot2_f32_bf16 v84, v30, s53, v84
    v_dot2_f32_bf16 v85, v30, s54, v85
    v_dot2_f32_bf16 v86, v31, s53, v86
    v_dot2_f32_bf16 v87, v31, s54, v87
    s_waitcnt vmcnt(19)
    v_dot2_f32_bf16 v80, v32, s53, v80
    v_dot2_f32_bf16 v81, v32, s54, v81
    v_dot2_f32_bf16 v82, v33, s53, v82
    v_dot2_f32_bf16 v83, v33, s54, v83
    v_dot2_f32_bf16 v84, v34, s53, v84
    v_dot2_f32_bf16 v85, v34, s54, v85
    v_dot2_f32_bf16 v86, v35, s53, v86
    v_dot2_f32_bf16 v87, v35, s54, v87
    s_waitcnt vmcnt(18)
    v_dot2_f32_bf16 v80, v36, s53, v80
    v_dot2_f32_bf16 v81, v36, s54, v81
    v_dot2_f32_bf16 v82, v37, s53, v82
    v_dot2_f32_bf16 v83, v37, s54, v83
    v_dot2_f32_bf16 v84, v38, s53, v84
    v_dot2_f32_bf16 v85, v38, s54, v85
    v_dot2_f32_bf16 v86, v39, s53, v86
    v_dot2_f32_bf16 v87, v39, s54, v87
    s_waitcnt vmcnt(17)
    v_dot2_f32_bf16 v80, v40, s53, v80
    v_dot2_f32_bf16 v81, v40, s54, v81
    v_dot2_f32_bf16 v82, v41, s53, v82
    v_dot2_f32_bf16 v83, v41, s54, v83
    v_dot2_f32_bf16 v84, v42, s53, v84
    v_dot2_f32_bf16 v85, v42, s54, v85
    v_dot2_f32_bf16 v86, v43, s53, v86
    v_dot2_f32_bf16 v87, v43, s54, v87
    s_waitcnt vmcnt(16)
    v_dot2_f32_bf16 v80, v44, s53, v80
    v_dot2_f32_bf16 v81, v44, s54, v81
    v_dot2_f32_bf16 v82, v45, s53, v82
    v_dot2_f32_bf16 v83, v45, s54, v83
    v_dot2_f32_bf16 v84, v46, s53, v84
    v_dot2_f32_bf16 v85, v46, s54, v85
    v_dot2_f32_bf16 v86, v47, s53, v86
    v_dot2_f32_bf16 v87, v47, s54, v87
    s_waitcnt vmcnt(15)
    v_dot2_f32_bf16 v80, v48, s53, v80
    v_dot2_f32_bf16 v81, v48, s54, v81
    v_dot2_f32_bf16 v82, v49, s53, v82
    v_dot2_f32_bf16 v83, v49, s54, v83
    v_dot2_f32_bf16 v84, v50, s53, v84
    v_dot2_f32_bf16 v85, v50, s54, v85
    v_dot2_f32_bf16 v86, v51, s53, v86
    v_dot2_f32_bf16 v87, v51, s54, v87
    s_waitcnt vmcnt(14)
    v_dot2_f32_bf16 v80, v52, s53, v80
    v_dot2_f32_bf16 v81, v52, s54, v81
    v_dot2_f32_bf16 v82, v53, s53, v82
    v_dot2_f32_bf16 v83, v53, s54, v83
    v_dot2_f32_bf16 v84, v54, s53, v84
    v_dot2_f32_bf16 v85, v54, s54, v85
    v_dot2_f32_bf16 v86, v55, s53, v86
    v_dot2_f32_bf16 v87, v55, s54, v87
    s_waitcnt vmcnt(13)
    v_dot2_f32_bf16 v80, v56, s53, v80
    v_dot2_f32_bf16 v81, v56, s54, v81
    v_dot2_f32_bf16 v82, v57, s53, v82
    v_dot2_f32_bf16 v83, v57, s54, v83
    v_dot2_f32_bf16 v84, v58, s53, v84
    v_dot2_f32_bf16 v85, v58, s54, v85
    v_dot2_f32_bf16 v86, v59, s53, v86
    v_dot2_f32_bf16 v87, v59, s54, v87
    s_waitcnt vmcnt(12)
    v_dot2_f32_bf16 v80, v60, s53, v80
    v_dot2_f32_bf16 v81, v60, s54, v81
    v_dot2_f32_bf16 v82, v61, s53, v82
    v_dot2_f32_bf16 v83, v61, s54, v83
    v_dot2_f32_bf16 v84, v62, s53, v84
    v_dot2_f32_bf16 v85, v62, s54, v85
    v_dot2_f32_bf16 v86, v63, s53, v86
    v_dot2_f32_bf16 v87, v63, s54, v87
    s_waitcnt vmcnt(11)
    v_dot2_f32_bf16 v160, v96, s53, v160
    v_dot2_f32_bf16 v161, v96, s54, v161
    v_dot2_f32_bf16 v162, v97, s53, v162
    v_dot2_f32_bf16 v163, v97, s54, v163
    v_dot2_f32_bf16 v164, v98, s53, v164
    v_dot2_f32_bf16 v165, v98, s54, v165
    v_dot2_f32_bf16 v166, v99, s53, v166
    v_dot2_f32_bf16 v167, v99, s54, v167
    s_waitcnt vmcnt(10)
    v_dot2_f32_bf16 v160, v100, s53, v160
    v_dot2_f32_bf16 v161, v100, s54, v161
    v_dot2_f32_bf16 v162, v101, s53, v162
    v_dot2_f32_bf16 v163, v101, s54, v163
    v_dot2_f32_bf16 v164, v102, s53, v164
    v_dot2_f32_bf16 v165, v102, s54, v165
    v_dot2_f32_bf16 v166, v103, s53, v166
    v_dot2_f32_bf16 v167, v103, s54, v167
    s_waitcnt vmcnt(9)
    v_dot2_f32_bf16 v160, v104, s53, v160
    v_dot2_f32_bf16 v161, v104, s54, v161
    v_dot2_f32_bf16 v162, v105, s53, v162
    v_dot2_f32_bf16 v163, v105, s54, v163
    v_dot2_f32_bf16 v164, v106, s53, v164
    v_dot2_f32_bf16 v165, v106, s54, v165
    v_dot2_f32_bf16 v166, v107, s53, v166
    v_dot2_f32_bf16 v167, v107, s54, v167
    s_waitcnt vmcnt(8)
    v_dot2_f32_bf16 v160, v108, s53, v160
    v_dot2_f32_bf16 v161, v108, s54, v161
    v_dot2_f32_bf16 v162, v109, s53, v162
    v_dot2_f32_bf16 v163, v109, s54, v163
    v_dot2_f32_bf16 v164, v110, s53, v164
    v_dot2_f32_bf16 v165, v110, s54, v165
    v_dot2_f32_bf16 v166, v111, s53, v166
    v_dot2_f32_bf16 v167, v111, s54, v167
    s_waitcnt vmcnt(7)
    v_dot2_f32_bf16 v160, v112, s53, v160
    v_dot2_f32_bf16 v161, v112, s54, v161
    v_dot2_f32_bf16 v162, v113, s53, v162
    v_dot2_f32_bf16 v163, v113, s54, v163
    v_dot2_f32_bf16 v164, v114, s53, v164
    v_dot2_f32_bf16 v165, v114, s54, v165
    v_dot2_f32_bf16 v166, v115, s53, v166
    v_dot2_f32_bf16 v167, v115, s54, v167
    s_waitcnt vmcnt(6)
    v_dot2_f32_bf16 v160, v116, s53, v160
    v_dot2_f32_bf16 v161, v116, s54, v161
    v_dot2_f32_bf16 v162, v117, s53, v162
    v_dot2_f32_bf16 v163, v117, s54, v163
    v_dot2_f32_bf16 v164, v118, s53, v164
    v_dot2_f32_bf16 v165, v118, s54, v165
    v_dot2_f32_bf16 v166, v119, s53, v166
    v_dot2_f32_bf16 v167, v119, s54, v167
    s_waitcnt vmcnt(5)
    v_dot2_f32_bf16 v160, v120, s53, v160
    v_dot2_f32_bf16 v161, v120, s54, v161
    v_dot2_f32_bf16 v162, v121, s53, v162
    v_dot2_f32_bf16 v163, v121, s54, v163
    v_dot2_f32_bf16 v164, v122, s53, v164
    v_dot2_f32_bf16 v165, v122, s54, v165
    v_dot2_f32_bf16 v166, v123, s53, v166
    v_dot2_f32_bf16 v167, v123, s54, v167
    s_waitcnt vmcnt(4)
    v_dot2_f32_bf16 v160, v124, s53, v160
    v_dot2_f32_bf16 v161, v124, s54, v161
    v_dot2_f32_bf16 v162, v125, s53, v162
    v_dot2_f32_bf16 v163, v125, s54, v163
    v_dot2_f32_bf16 v164, v126, s53, v164
    v_dot2_f32_bf16 v165, v126, s54, v165
    v_dot2_f32_bf16 v166, v127, s53, v166
    v_dot2_f32_bf16 v167, v127, s54, v167
    s_waitcnt vmcnt(3)
    v_dot2_f32_bf16 v160, v128, s53, v160
    v_dot2_f32_bf16 v161, v128, s54, v161
    v_dot2_f32_bf16 v162, v129, s53, v162
    v_dot2_f32_bf16 v163, v129, s54, v163
    v_dot2_f32_bf16 v164, v130, s53, v164
    v_dot2_f32_bf16 v165, v130, s54, v165
    v_dot2_f32_bf16 v166, v131, s53, v166
    v_dot2_f32_bf16 v167, v131, s54, v167
    s_waitcnt vmcnt(2)
    v_dot2_f32_bf16 v160, v132, s53, v160
    v_dot2_f32_bf16 v161, v132, s54, v161
    v_dot2_f32_bf16 v162, v133, s53, v162
    v_dot2_f32_bf16 v163, v133, s54, v163
    v_dot2_f32_bf16 v164, v134, s53, v164
    v_dot2_f32_bf16 v165, v134, s54, v165
    v_dot2_f32_bf16 v166, v135, s53, v166
    v_dot2_f32_bf16 v167, v135, s54, v167
    s_waitcnt vmcnt(1)
    v_dot2_f32_bf16 v160, v136, s53, v160
    v_dot2_f32_bf16 v161, v136, s54, v161
    v_dot2_f32_bf16 v162, v137, s53, v162
    v_dot2_f32_bf16 v163, v137, s54, v163
    v_dot2_f32_bf16 v164, v138, s53, v164
    v_dot2_f32_bf16 v165, v138, s54, v165
    v_dot2_f32_bf16 v166, v139, s53, v166
    v_dot2_f32_bf16 v167, v139, s54, v167
    s_waitcnt vmcnt(0)
    v_dot2_f32_bf16 v160, v140, s53, v160
    v_dot2_f32_bf16 v161, v140, s54, v161
    v_dot2_f32_bf16 v162, v141, s53, v162
    v_dot2_f32_bf16 v163, v141, s54, v163
    v_dot2_f32_bf16 v164, v142, s53, v164
    v_dot2_f32_bf16 v165, v142, s54, v165
    v_dot2_f32_bf16 v166, v143, s53, v166
    v_dot2_f32_bf16 v167, v143, s54, v167
    s_branch L_a_done_m1
L_a_one_m1:
    s_mov_b32 s49, 0
    buffer_load_dwordx4 v[16:19], v2, s[32:35], s49 offen sc1
    s_mov_b32 s49, 2359296
    buffer_load_dwordx4 v[20:23], v2, s[32:35], s49 offen sc1
    s_mov_b32 s49, 4718592
    buffer_load_dwordx4 v[24:27], v2, s[32:35], s49 offen sc1
    s_mov_b32 s49, 7077888
    buffer_load_dwordx4 v[28:31], v2, s[32:35], s49 offen sc1
    s_mov_b32 s49, 9437184
    buffer_load_dwordx4 v[32:35], v2, s[32:35], s49 offen sc1
    s_mov_b32 s49, 11796480
    buffer_load_dwordx4 v[36:39], v2, s[32:35], s49 offen sc1
    s_mov_b32 s49, 14155776
    buffer_load_dwordx4 v[40:43], v2, s[32:35], s49 offen sc1
    s_mov_b32 s49, 16515072
    buffer_load_dwordx4 v[44:47], v2, s[32:35], s49 offen sc1
    s_mov_b32 s49, 18874368
    buffer_load_dwordx4 v[48:51], v2, s[32:35], s49 offen sc1
    s_mov_b32 s49, 21233664
    buffer_load_dwordx4 v[52:55], v2, s[32:35], s49 offen sc1
    s_mov_b32 s49, 23592960
    buffer_load_dwordx4 v[56:59], v2, s[32:35], s49 offen sc1
    s_mov_b32 s49, 25952256
    buffer_load_dwordx4 v[60:63], v2, s[32:35], s49 offen sc1
    s_waitcnt vmcnt(11)
    v_dot2_f32_bf16 v80, v16, s53, v80
    v_dot2_f32_bf16 v81, v16, s54, v81
    v_dot2_f32_bf16 v82, v17, s53, v82
    v_dot2_f32_bf16 v83, v17, s54, v83
    v_dot2_f32_bf16 v84, v18, s53, v84
    v_dot2_f32_bf16 v85, v18, s54, v85
    v_dot2_f32_bf16 v86, v19, s53, v86
    v_dot2_f32_bf16 v87, v19, s54, v87
    s_waitcnt vmcnt(10)
    v_dot2_f32_bf16 v80, v20, s53, v80
    v_dot2_f32_bf16 v81, v20, s54, v81
    v_dot2_f32_bf16 v82, v21, s53, v82
    v_dot2_f32_bf16 v83, v21, s54, v83
    v_dot2_f32_bf16 v84, v22, s53, v84
    v_dot2_f32_bf16 v85, v22, s54, v85
    v_dot2_f32_bf16 v86, v23, s53, v86
    v_dot2_f32_bf16 v87, v23, s54, v87
    s_waitcnt vmcnt(9)
    v_dot2_f32_bf16 v80, v24, s53, v80
    v_dot2_f32_bf16 v81, v24, s54, v81
    v_dot2_f32_bf16 v82, v25, s53, v82
    v_dot2_f32_bf16 v83, v25, s54, v83
    v_dot2_f32_bf16 v84, v26, s53, v84
    v_dot2_f32_bf16 v85, v26, s54, v85
    v_dot2_f32_bf16 v86, v27, s53, v86
    v_dot2_f32_bf16 v87, v27, s54, v87
    s_waitcnt vmcnt(8)
    v_dot2_f32_bf16 v80, v28, s53, v80
    v_dot2_f32_bf16 v81, v28, s54, v81
    v_dot2_f32_bf16 v82, v29, s53, v82
    v_dot2_f32_bf16 v83, v29, s54, v83
    v_dot2_f32_bf16 v84, v30, s53, v84
    v_dot2_f32_bf16 v85, v30, s54, v85
    v_dot2_f32_bf16 v86, v31, s53, v86
    v_dot2_f32_bf16 v87, v31, s54, v87
    s_waitcnt vmcnt(7)
    v_dot2_f32_bf16 v80, v32, s53, v80
    v_dot2_f32_bf16 v81, v32, s54, v81
    v_dot2_f32_bf16 v82, v33, s53, v82
    v_dot2_f32_bf16 v83, v33, s54, v83
    v_dot2_f32_bf16 v84, v34, s53, v84
    v_dot2_f32_bf16 v85, v34, s54, v85
    v_dot2_f32_bf16 v86, v35, s53, v86
    v_dot2_f32_bf16 v87, v35, s54, v87
    s_waitcnt vmcnt(6)
    v_dot2_f32_bf16 v80, v36, s53, v80
    v_dot2_f32_bf16 v81, v36, s54, v81
    v_dot2_f32_bf16 v82, v37, s53, v82
    v_dot2_f32_bf16 v83, v37, s54, v83
    v_dot2_f32_bf16 v84, v38, s53, v84
    v_dot2_f32_bf16 v85, v38, s54, v85
    v_dot2_f32_bf16 v86, v39, s53, v86
    v_dot2_f32_bf16 v87, v39, s54, v87
    s_waitcnt vmcnt(5)
    v_dot2_f32_bf16 v80, v40, s53, v80
    v_dot2_f32_bf16 v81, v40, s54, v81
    v_dot2_f32_bf16 v82, v41, s53, v82
    v_dot2_f32_bf16 v83, v41, s54, v83
    v_dot2_f32_bf16 v84, v42, s53, v84
    v_dot2_f32_bf16 v85, v42, s54, v85
    v_dot2_f32_bf16 v86, v43, s53, v86
    v_dot2_f32_bf16 v87, v43, s54, v87
    s_waitcnt vmcnt(4)
    v_dot2_f32_bf16 v80, v44, s53, v80
    v_dot2_f32_bf16 v81, v44, s54, v81
    v_dot2_f32_bf16 v82, v45, s53, v82
    v_dot2_f32_bf16 v83, v45, s54, v83
    v_dot2_f32_bf16 v84, v46, s53, v84
    v_dot2_f32_bf16 v85, v46, s54, v85
    v_dot2_f32_bf16 v86, v47, s53, v86
    v_dot2_f32_bf16 v87, v47, s54, v87
    s_waitcnt vmcnt(3)
    v_dot2_f32_bf16 v80, v48, s53, v80
    v_dot2_f32_bf16 v81, v48, s54, v81
    v_dot2_f32_bf16 v82, v49, s53, v82
    v_dot2_f32_bf16 v83, v49, s54, v83
    v_dot2_f32_bf16 v84, v50, s53, v84
    v_dot2_f32_bf16 v85, v50, s54, v85
    v_dot2_f32_bf16 v86, v51, s53, v86
    v_dot2_f32_bf16 v87, v51, s54, v87
    s_waitcnt vmcnt(2)
    v_dot2_f32_bf16 v80, v52, s53, v80
    v_dot2_f32_bf16 v81, v52, s54, v81
    v_dot2_f32_bf16 v82, v53, s53, v82
    v_dot2_f32_bf16 v83, v53, s54, v83
    v_dot2_f32_bf16 v84, v54, s53, v84
    v_dot2_f32_bf16 v85, v54, s54, v85
    v_dot2_f32_bf16 v86, v55, s53, v86
    v_dot2_f32_bf16 v87, v55, s54, v87
    s_waitcnt vmcnt(1)
    v_dot2_f32_bf16 v80, v56, s53, v80
    v_dot2_f32_bf16 v81, v56, s54, v81
    v_dot2_f32_bf16 v82, v57, s53, v82
    v_dot2_f32_bf16 v83, v57, s54, v83
    v_dot2_f32_bf16 v84, v58, s53, v84
    v_dot2_f32_bf16 v85, v58, s54, v85
    v_dot2_f32_bf16 v86, v59, s53, v86
    v_dot2_f32_bf16 v87, v59, s54, v87
    s_waitcnt vmcnt(0)
    v_dot2_f32_bf16 v80, v60, s53, v80
    v_dot2_f32_bf16 v81, v60, s54, v81
    v_dot2_f32_bf16 v82, v61, s53, v82
    v_dot2_f32_bf16 v83, v61, s54, v83
    v_dot2_f32_bf16 v84, v62, s53, v84
    v_dot2_f32_bf16 v85, v62, s54, v85
    v_dot2_f32_bf16 v86, v63, s53, v86
    v_dot2_f32_bf16 v87, v63, s54, v87
L_a_done_m1:
    s_cmp_lg_u32 s40, 0
    s_cbranch_scc1 L_pb_go_m1
    s_mov_b32 s47, 0
L_pb_poll_m1:
    buffer_load_dword v5, v6, s[36:39], 0 offen sc1
    s_waitcnt vmcnt(0)
    v_cmp_eq_u32 vcc, s58, v5
    s_add_u32 s47, s47, 1
    s_nop 3
    s_and_b32 s46, vcc_lo, 0xf000
    s_cmp_eq_u32 s46, 0xf000
    s_cbranch_scc1 L_pb_go_m1
    s_cmp_ge_u32 s47, 200000
    s_cbranch_scc1 L_pb_go_m1
    s_sleep 8
    s_branch L_pb_poll_m1
L_pb_go_m1:
    s_barrier
    s_cmp_ge_u32 s40, 4
    s_cbranch_scc1 L_b_one_m1
    s_mov_b32 s49, 28311552
    buffer_load_dwordx4 v[176:179], v2, s[32:35], s49 offen sc1
    s_mov_b32 s49, 30670848
    buffer_load_dwordx4 v[180:183], v2, s[32:35], s49 offen sc1
    s_mov_b32 s49, 33030144
    buffer_load_dwordx4 v[184:187], v2, s[32:35], s49 offen sc1
    s_mov_b32 s49, 35389440
    buffer_load_dwordx4 v[188:191], v2, s[32:35], s49 offen sc1
    s_mov_b32 s49, 28311552
    buffer_load_dwordx4 v[192:195], v7, s[32:35], s49 offen sc1
    s_mov_b32 s49, 30670848
    buffer_load_dwordx4 v[196:199], v7, s[32:35], s49 offen sc1
    s_mov_b32 s49, 33030144
    buffer_load_dwordx4 v[200:203], v7, s[32:35], s49 offen sc1
    s_mov_b32 s49, 35389440
    buffer_load_dwordx4 v[204:207], v7, s[32:35], s49 offen sc1
    s_waitcnt vmcnt(7)
    v_dot2_f32_bf16 v80, v176, s53, v80
    v_dot2_f32_bf16 v81, v176, s54, v81
    v_dot2_f32_bf16 v82, v177, s53, v82
    v_dot2_f32_bf16 v83, v177, s54, v83
    v_dot2_f32_bf16 v84, v178, s53, v84
    v_dot2_f32_bf16 v85, v178, s54, v85
    v_dot2_f32_bf16 v86, v179, s53, v86
    v_dot2_f32_bf16 v87, v179, s54, v87
    s_waitcnt vmcnt(6)
    v_dot2_f32_bf16 v80, v180, s53, v80
    v_dot2_f32_bf16 v81, v180, s54, v81
    v_dot2_f32_bf16 v82, v181, s53, v82
    v_dot2_f32_bf16 v83, v181, s54, v83
    v_dot2_f32_bf16 v84, v182, s53, v84
    v_dot2_f32_bf16 v85, v182, s54, v85
    v_dot2_f32_bf16 v86, v183, s53, v86
    v_dot2_f32_bf16 v87, v183, s54, v87
    s_waitcnt vmcnt(5)
    v_dot2_f32_bf16 v80, v184, s53, v80
    v_dot2_f32_bf16 v81, v184, s54, v81
    v_dot2_f32_bf16 v82, v185, s53, v82
    v_dot2_f32_bf16 v83, v185, s54, v83
    v_dot2_f32_bf16 v84, v186, s53, v84
    v_dot2_f32_bf16 v85, v186, s54, v85
    v_dot2_f32_bf16 v86, v187, s53, v86
    v_dot2_f32_bf16 v87, v187, s54, v87
    s_waitcnt vmcnt(4)
    v_dot2_f32_bf16 v80, v188, s53, v80
    v_dot2_f32_bf16 v81, v188, s54, v81
    v_dot2_f32_bf16 v82, v189, s53, v82
    v_dot2_f32_bf16 v83, v189, s54, v83
    v_dot2_f32_bf16 v84, v190, s53, v84
    v_dot2_f32_bf16 v85, v190, s54, v85
    v_dot2_f32_bf16 v86, v191, s53, v86
    v_dot2_f32_bf16 v87, v191, s54, v87
    s_waitcnt vmcnt(3)
    v_dot2_f32_bf16 v160, v192, s53, v160
    v_dot2_f32_bf16 v161, v192, s54, v161
    v_dot2_f32_bf16 v162, v193, s53, v162
    v_dot2_f32_bf16 v163, v193, s54, v163
    v_dot2_f32_bf16 v164, v194, s53, v164
    v_dot2_f32_bf16 v165, v194, s54, v165
    v_dot2_f32_bf16 v166, v195, s53, v166
    v_dot2_f32_bf16 v167, v195, s54, v167
    s_waitcnt vmcnt(2)
    v_dot2_f32_bf16 v160, v196, s53, v160
    v_dot2_f32_bf16 v161, v196, s54, v161
    v_dot2_f32_bf16 v162, v197, s53, v162
    v_dot2_f32_bf16 v163, v197, s54, v163
    v_dot2_f32_bf16 v164, v198, s53, v164
    v_dot2_f32_bf16 v165, v198, s54, v165
    v_dot2_f32_bf16 v166, v199, s53, v166
    v_dot2_f32_bf16 v167, v199, s54, v167
    s_waitcnt vmcnt(1)
    v_dot2_f32_bf16 v160, v200, s53, v160
    v_dot2_f32_bf16 v161, v200, s54, v161
    v_dot2_f32_bf16 v162, v201, s53, v162
    v_dot2_f32_bf16 v163, v201, s54, v163
    v_dot2_f32_bf16 v164, v202, s53, v164
    v_dot2_f32_bf16 v165, v202, s54, v165
    v_dot2_f32_bf16 v166, v203, s53, v166
    v_dot2_f32_bf16 v167, v203, s54, v167
    s_waitcnt vmcnt(0)
    v_dot2_f32_bf16 v160, v204, s53, v160
    v_dot2_f32_bf16 v161, v204, s54, v161
    v_dot2_f32_bf16 v162, v205, s53, v162
    v_dot2_f32_bf16 v163, v205, s54, v163
    v_dot2_f32_bf16 v164, v206, s53, v164
    v_dot2_f32_bf16 v165, v206, s54, v165
    v_dot2_f32_bf16 v166, v207, s53, v166
    v_dot2_f32_bf16 v167, v207, s54, v167
    s_nop 2
    v_permlane32_swap_b32 v80, v84
    v_permlane32_swap_b32 v81, v85
    v_permlane32_swap_b32 v82, v86
    v_permlane32_swap_b32 v83, v87
    s_nop 1
    v_lshlrev_b32 v4, 16, v8
    v_and_b32 v5, 0xffff0000, v8
    v_add_f32 v80, v80, v4
    v_add_f32 v81, v81, v5
    v_lshlrev_b32 v4, 16, v9
    v_and_b32 v5, 0xffff0000, v9
    v_add_f32 v82, v82, v4
    v_add_f32 v83, v83, v5
    v_lshlrev_b32 v4, 16, v10
    v_and_b32 v5, 0xffff0000, v10
    v_add_f32 v84, v84, v4
    v_add_f32 v85, v85, v5
    v_lshlrev_b32 v4, 16, v11
    v_and_b32 v5, 0xffff0000, v11
    v_add_f32 v86, v86, v4
    v_add_f32 v87, v87, v5
    v_cvt_pk_bf16_f32 v8, v80, v81
    v_cvt_pk_bf16_f32 v9, v82, v83
    v_cvt_pk_bf16_f32 v10, v84, v85
    v_cvt_pk_bf16_f32 v11, v86, v87
    buffer_store_dwordx4 v[8:11], v3, s[28:31], 0 offen
    s_nop 2
    v_permlane32_swap_b32 v160, v164
    v_permlane32_swap_b32 v161, v165
    v_permlane32_swap_b32 v162, v166
    v_permlane32_swap_b32 v163, v167
    s_nop 1
    v_lshlrev_b32 v4, 16, v12
    v_and_b32 v5, 0xffff0000, v12
    v_add_f32 v160, v160, v4
    v_add_f32 v161, v161, v5
    v_lshlrev_b32 v4, 16, v13
    v_and_b32 v5, 0xffff0000, v13
    v_add_f32 v162, v162, v4
    v_add_f32 v163, v163, v5
    v_lshlrev_b32 v4, 16, v14
    v_and_b32 v5, 0xffff0000, v14
    v_add_f32 v164, v164, v4
    v_add_f32 v165, v165, v5
    v_lshlrev_b32 v4, 16, v15
    v_and_b32 v5, 0xffff0000, v15
    v_add_f32 v166, v166, v4
    v_add_f32 v167, v167, v5
    v_cvt_pk_bf16_f32 v12, v160, v161
    v_cvt_pk_bf16_f32 v13, v162, v163
    v_cvt_pk_bf16_f32 v14, v164, v165
    v_cvt_pk_bf16_f32 v15, v166, v167
    buffer_store_dwordx4 v[12:15], v240, s[28:31], 0 offen
    s_branch L_b_done_m1
L_b_one_m1:
    s_mov_b32 s49, 28311552
    buffer_load_dwordx4 v[176:179], v2, s[32:35], s49 offen sc1
    s_mov_b32 s49, 30670848
    buffer_load_dwordx4 v[180:183], v2, s[32:35], s49 offen sc1
    s_mov_b32 s49, 33030144
    buffer_load_dwordx4 v[184:187], v2, s[32:35], s49 offen sc1
    s_mov_b32 s49, 35389440
    buffer_load_dwordx4 v[188:191], v2, s[32:35], s49 offen sc1
    s_waitcnt vmcnt(3)
    v_dot2_f32_bf16 v80, v176, s53, v80
    v_dot2_f32_bf16 v81, v176, s54, v81
    v_dot2_f32_bf16 v82, v177, s53, v82
    v_dot2_f32_bf16 v83, v177, s54, v83
    v_dot2_f32_bf16 v84, v178, s53, v84
    v_dot2_f32_bf16 v85, v178, s54, v85
    v_dot2_f32_bf16 v86, v179, s53, v86
    v_dot2_f32_bf16 v87, v179, s54, v87
    s_waitcnt vmcnt(2)
    v_dot2_f32_bf16 v80, v180, s53, v80
    v_dot2_f32_bf16 v81, v180, s54, v81
    v_dot2_f32_bf16 v82, v181, s53, v82
    v_dot2_f32_bf16 v83, v181, s54, v83
    v_dot2_f32_bf16 v84, v182, s53, v84
    v_dot2_f32_bf16 v85, v182, s54, v85
    v_dot2_f32_bf16 v86, v183, s53, v86
    v_dot2_f32_bf16 v87, v183, s54, v87
    s_waitcnt vmcnt(1)
    v_dot2_f32_bf16 v80, v184, s53, v80
    v_dot2_f32_bf16 v81, v184, s54, v81
    v_dot2_f32_bf16 v82, v185, s53, v82
    v_dot2_f32_bf16 v83, v185, s54, v83
    v_dot2_f32_bf16 v84, v186, s53, v84
    v_dot2_f32_bf16 v85, v186, s54, v85
    v_dot2_f32_bf16 v86, v187, s53, v86
    v_dot2_f32_bf16 v87, v187, s54, v87
    s_waitcnt vmcnt(0)
    v_dot2_f32_bf16 v80, v188, s53, v80
    v_dot2_f32_bf16 v81, v188, s54, v81
    v_dot2_f32_bf16 v82, v189, s53, v82
    v_dot2_f32_bf16 v83, v189, s54, v83
    v_dot2_f32_bf16 v84, v190, s53, v84
    v_dot2_f32_bf16 v85, v190, s54, v85
    v_dot2_f32_bf16 v86, v191, s53, v86
    v_dot2_f32_bf16 v87, v191, s54, v87
    s_nop 2
    v_permlane32_swap_b32 v80, v84
    v_permlane32_swap_b32 v81, v85
    v_permlane32_swap_b32 v82, v86
    v_permlane32_swap_b32 v83, v87
    s_nop 1
    v_lshlrev_b32 v4, 16, v8
    v_and_b32 v5, 0xffff0000, v8
    v_add_f32 v80, v80, v4
    v_add_f32 v81, v81, v5
    v_lshlrev_b32 v4, 16, v9
    v_and_b32 v5, 0xffff0000, v9
    v_add_f32 v82, v82, v4
    v_add_f32 v83, v83, v5
    v_lshlrev_b32 v4, 16, v10
    v_and_b32 v5, 0xffff0000, v10
    v_add_f32 v84, v84, v4
    v_add_f32 v85, v85, v5
    v_lshlrev_b32 v4, 16, v11
    v_and_b32 v5, 0xffff0000, v11
    v_add_f32 v86, v86, v4
    v_add_f32 v87, v87, v5
    v_cvt_pk_bf16_f32 v8, v80, v81
    v_cvt_pk_bf16_f32 v9, v82, v83
    v_cvt_pk_bf16_f32 v10, v84, v85
    v_cvt_pk_bf16_f32 v11, v86, v87
    buffer_store_dwordx4 v[8:11], v3, s[28:31], 0 offen
L_b_done_m1:
    s_endpgm
L_att0_j2:
    s_branch L_att0
L_att1_j2:
    s_branch L_att1
L_att0:
    v_and_b32 v247, 63, v0
    v_mov_b32 v144, v0
    s_lshl_b32 s46, s44, 7
    s_lshl_b32 s47, s40, 4
    s_add_u32 s46, s46, s47
    s_mul_i32 s46, s46, 1152
    v_lshrrev_b32 v248, 3, v247
    v_mul_u32_u24 v249, 1152, v248
    v_add_u32 v249, s46, v249
    v_lshrrev_b32 v250, 4, v247
    v_and_b32 v251, 7, v247
    v_xor_b32 v252, v251, v250
    v_lshl_add_u32 v252, v252, 4, v249
    v_add_u32 v250, 4, v250
    v_xor_b32 v253, v251, v250
    v_lshl_add_u32 v253, v253, 4, v249
    v_add_u32 v253, 9216, v253
    s_lshl_b32 s52, s40, 11
    s_add_u32 s52, s52, 65536
    s_add_u32 m0, s52, 0
    s_movk_i32 s49, 0
    buffer_load_dwordx4 v252, s[24:27], s49 offen lds
    s_add_u32 m0, s52, 1024
    s_movk_i32 s49, 0
    buffer_load_dwordx4 v253, s[24:27], s49 offen lds
    s_add_u32 m0, s52, 16384
    s_movk_i32 s49, 128
    buffer_load_dwordx4 v252, s[24:27], s49 offen lds
    s_add_u32 m0, s52, 17408
    s_movk_i32 s49, 128
    buffer_load_dwordx4 v253, s[24:27], s49 offen lds
    s_add_u32 m0, s52, 32768
    s_movk_i32 s49, 256
    buffer_load_dwordx4 v252, s[24:27], s49 offen lds
    s_add_u32 m0, s52, 33792
    s_movk_i32 s49, 256
    buffer_load_dwordx4 v253, s[24:27], s49 offen lds
    s_add_u32 m0, s52, 49152
    s_movk_i32 s49, 384
    buffer_load_dwordx4 v252, s[24:27], s49 offen lds
    s_add_u32 m0, s52, 50176
    s_movk_i32 s49, 384
    buffer_load_dwordx4 v253, s[24:27], s49 offen lds
    s_add_u32 m0, s52, 65536
    s_movk_i32 s49, 512
    buffer_load_dwordx4 v252, s[24:27], s49 offen lds
    s_add_u32 m0, s52, 66560
    s_movk_i32 s49, 512
    buffer_load_dwordx4 v253, s[24:27], s49 offen lds
    s_add_u32 m0, s52, 81920
    s_movk_i32 s49, 640
    buffer_load_dwordx4 v252, s[24:27], s49 offen lds
    s_add_u32 m0, s52, 82944
    s_movk_i32 s49, 640
    buffer_load_dwordx4 v253, s[24:27], s49 offen lds
    s_mov_b32 s28, s6
    s_and_b32 s29, s7, 0xffff
    s_mov_b32 s30, 0x1e6000
    s_mov_b32 s31, 0x20000
    s_mul_i32 s46, s43, 165888
    s_add_u32 s32, s8, s46
    s_addc_u32 s33, s9, 0
    s_and_b32 s33, s33, 0xffff
    s_sub_u32 s34, 0xa2000, s46
    s_mov_b32 s35, 0x20000
    s_and_b32 s46, s44, 7
    s_lshl_b32 s46, s46, 3
    s_add_u32 s46, s46, s40
    s_mul_i32 s47, s46, 9
    v_mul_u32_u24 v251, 2428, v247
    v_lshrrev_b32 v251, 16, v251
    v_mul_u32_u24 v248, 27, v251
    v_sub_u32 v250, v247, v248
    v_mul_u32_u24 v248, 21846, v250
    v_lshrrev_b32 v248, 16, v248
    v_mul_u32_u24 v249, 3, v248
    v_sub_u32 v249, v250, v249
    v_add_u32 v248, s47, v248
    v_mul_u32_u24 v248, 3456, v248
    v_lshl_add_u32 v248, v249, 7, v248
    v_mul_u32_u24 v251, 1152, v251
    v_add_u32 v248, v248, v251
    s_lshl_b32 s47, s43, 8
    s_add_u32 s47, s47, 1152
    v_add_u32 v248, s47, v248
    v_mov_b32 v250, 0x7fffff00
    v_cmp_gt_u32 vcc, 54, v247
    s_nop 1
    v_cndmask_b32 v248, v250, v248, vcc
    buffer_load_dword v254, v248, s[28:31], 0 offen
    s_lshr_b32 s46, s41, 1
    s_lshl_b32 s46, s46, 4
    s_and_b32 s47, s41, 1
    s_lshl_b32 s47, s47, 2
    s_add_u32 s46, s46, s47
    s_lshl_b32 s47, s43, 8
    v_add_u32 v248, 0, v247
    v_mul_u32_u24 v249, 2731, v248
    v_lshrrev_b32 v249, 16, v249
    v_mul_u32_u24 v250, 24, v249
    v_sub_u32 v250, v248, v250
    v_and_b32 v251, 6, v249
    v_xor_b32 v250, v250, v251
    v_lshrrev_b32 v251, 2, v249
    v_lshlrev_b32 v251, 3, v251
    v_and_b32 v249, 3, v249
    v_add_u32 v249, v249, v251
    v_add_u32 v249, s46, v249
    v_mul_u32_u24 v249, 3456, v249
    v_lshl_add_u32 v249, v250, 4, v249
    v_add_u32 v244, s47, v249
    v_add_u32 v248, 64, v247
    v_mul_u32_u24 v249, 2731, v248
    v_lshrrev_b32 v249, 16, v249
    v_mul_u32_u24 v250, 24, v249
    v_sub_u32 v250, v248, v250
    v_and_b32 v251, 6, v249
    v_xor_b32 v250, v250, v251
    v_lshrrev_b32 v251, 2, v249
    v_lshlrev_b32 v251, 3, v251
    v_and_b32 v249, 3, v249
    v_add_u32 v249, v249, v251
    v_add_u32 v249, s46, v249
    v_mul_u32_u24 v249, 3456, v249
    v_lshl_add_u32 v249, v250, 4, v249
    v_add_u32 v245, s47, v249
    v_add_u32 v248, 128, v247
    v_mul_u32_u24 v249, 2731, v248
    v_lshrrev_b32 v249, 16, v249
    v_mul_u32_u24 v250, 24, v249
    v_sub_u32 v250, v248, v250
    v_and_b32 v251, 6, v249
    v_xor_b32 v250, v250, v251
    v_lshrrev_b32 v251, 2, v249
    v_lshlrev_b32 v251, 3, v251
    v_and_b32 v249, 3, v249
    v_add_u32 v249, v249, v251
    v_add_u32 v249, s46, v249
    v_mul_u32_u24 v249, 3456, v249
    v_lshl_add_u32 v249, v250, 4, v249
    v_add_u32 v246, s47, v249
    s_mul_i32 s55, s41, 3072
    s_add_u32 s46, s43, 12
    s_mul_i32 s46, s46, 2359296
    s_mul_i32 s47, s44, 147456
    s_add_u32 s46, s46, s47
    s_add_u32 s36, s20, s46
    s_addc_u32 s37, s21, 0
    s_and_b32 s37, s37, 0xffff
    s_sub_u32 s38, 0x2400000, s46
    s_mov_b32 s39, 0x20000
    s_mul_i32 s46, s43, 36864
    s_add_u32 s46, s46, 41943040
    s_add_u32 s8, s20, s46
    s_addc_u32 s9, s21, 0
    s_and_b32 s9, s9, 0xffff
    s_mov_b32 s10, 36864
    s_mov_b32 s11, 0x20000
    s_mov_b32 s16, s18
    s_and_b32 s17, s19, 0xffff
    s_mov_b32 s18, 0x100
    s_mov_b32 s19, 0x20000
    s_cmp_lg_u32 s44, 0
    s_cbranch_scc1 L_att_nozero_c0
    v_mov_b32 v148, 0
    v_mov_b32 v149, 0
    v_mov_b32 v150, 0
    v_mov_b32 v151, 0
    v_lshlrev_b32 v145, 4, v144
    s_mov_b32 s49, 0
    buffer_store_dwordx4 v[148:151], v145, s[8:11], s49 offen sc0 sc1
    s_mov_b32 s49, 8192
    buffer_store_dwordx4 v[148:151], v145, s[8:11], s49 offen sc0 sc1
    s_mov_b32 s49, 16384
    buffer_store_dwordx4 v[148:151], v145, s[8:11], s49 offen sc0 sc1
    s_mov_b32 s49, 24576
    buffer_store_dwordx4 v[148:151], v145, s[8:11], s49 offen sc0 sc1
    s_mov_b32 s49, 32768
    buffer_store_dwordx4 v[148:151], v145, s[8:11], s49 offen sc0 sc1
    s_waitcnt vmcnt(0)
    s_barrier
    v_mov_b32 v146, 1
    s_lshl_b32 s46, s43, 2
    s_add_u32 s46, s46, 64
    v_mov_b32 v147, 0x7fffff00
    v_mov_b32 v148, s46
    v_cmp_eq_u32 vcc, 0, v144
    s_nop 1
    v_cndmask_b32 v147, v147, v148, vcc
    buffer_atomic_add v146, v147, s[16:19], 0 offen sc1
    s_waitcnt vmcnt(0)
L_att_nozero_c0:
    v_lshrrev_b32 v248, 4, v247
    v_lshrrev_b32 v249, 1, v248
    v_lshlrev_b32 v249, 4, v249
    v_and_b32 v250, 1, v248
    v_lshlrev_b32 v250, 2, v250
    v_add_u32 v249, v249, v250
    v_lshrrev_b32 v250, 2, v247
    v_and_b32 v250, 3, v250
    v_add_u32 v249, v249, v250
    v_and_b32 v251, 6, v249
    v_mul_u32_u24 v249, 384, v249
    v_and_b32 v250, 3, v247
    v_lshl_add_u32 v249, v250, 3, v249
    s_lshl_b32 s46, s43, 1
    s_add_u32 s46, s46, 0
    s_and_b32 s47, s46, 7
    s_lshr_b32 s46, s46, 3
    s_lshl_b32 s46, s46, 7
    v_xor_b32 v250, s47, v251
    v_lshl_add_u32 v250, v250, 4, v249
    v_add_u32 v236, s46, v250
    v_add_u32 v240, 49152, v236
    s_lshl_b32 s46, s43, 1
    s_add_u32 s46, s46, 2
    s_and_b32 s47, s46, 7
    s_lshr_b32 s46, s46, 3
    s_lshl_b32 s46, s46, 7
    v_xor_b32 v250, s47, v251
    v_lshl_add_u32 v250, v250, 4, v249
    v_add_u32 v237, s46, v250
    v_add_u32 v241, 49152, v237
    s_lshl_b32 s46, s43, 1
    s_add_u32 s46, s46, 4
    s_and_b32 s47, s46, 7
    s_lshr_b32 s46, s46, 3
    s_lshl_b32 s46, s46, 7
    v_xor_b32 v250, s47, v251
    v_lshl_add_u32 v250, v250, 4, v249
    v_add_u32 v238, s46, v250
    v_add_u32 v242, 49152, v238
    s_lshl_b32 s46, s43, 1
    s_add_u32 s46, s46, 6
    s_and_b32 s47, s46, 7
    s_lshr_b32 s46, s46, 3
    s_lshl_b32 s46, s46, 7
    v_xor_b32 v250, s47, v251
    v_lshl_add_u32 v250, v250, 4, v249
    v_add_u32 v239, s46, v250
    v_add_u32 v243, 49152, v239
    v_and_b32 v249, 15, v247
    v_lshrrev_b32 v250, 1, v249
    v_xor_b32 v250, v250, v248
    v_lshlrev_b32 v250, 4, v250
    s_lshl_b32 s46, s41, 5
    v_add_u32 v251, s46, v249
    v_lshl_add_u32 v250, v251, 7, v250
    v_add_u32 v152, 65536, v250
    v_xor_b32 v153, 64, v152
    v_add_u32 v154, 0x10000, v152
    v_add_u32 v155, 0x10000, v153
    v_lshlrev_b32 v156, 2, v251
    v_add_u32 v156, 162816, v156
    v_mov_b32 v160, 0
    v_mov_b32 v161, 0
    v_mov_b32 v162, 0
    v_mov_b32 v163, 0
    s_waitcnt vmcnt(7)
    s_barrier
    ds_read_b128 v[0:3], v152 offset:0
    ds_read_b128 v[4:7], v153 offset:0
    ds_read_b128 v[8:11], v152 offset:16384
    ds_read_b128 v[12:15], v153 offset:16384
    ds_read_b128 v[16:19], v152 offset:32768
    ds_read_b128 v[20:23], v153 offset:32768
    ds_read_b128 v[72:75], v152 offset:2048
    ds_read_b128 v[76:79], v153 offset:2048
    ds_read_b128 v[80:83], v152 offset:18432
    ds_read_b128 v[84:87], v153 offset:18432
    ds_read_b128 v[88:91], v152 offset:34816
    ds_read_b128 v[92:95], v153 offset:34816
    s_waitcnt lgkmcnt(11)
    v_dot2_f32_bf16 v160, v0, s50, v160
    v_dot2_f32_bf16 v162, v0, v0, v162
    v_dot2_f32_bf16 v161, v1, s50, v161
    v_dot2_f32_bf16 v163, v1, v1, v163
    v_dot2_f32_bf16 v160, v2, s50, v160
    v_dot2_f32_bf16 v162, v2, v2, v162
    v_dot2_f32_bf16 v161, v3, s50, v161
    v_dot2_f32_bf16 v163, v3, v3, v163
    s_waitcnt lgkmcnt(10)
    v_dot2_f32_bf16 v160, v4, s50, v160
    v_dot2_f32_bf16 v162, v4, v4, v162
    v_dot2_f32_bf16 v161, v5, s50, v161
    v_dot2_f32_bf16 v163, v5, v5, v163
    v_dot2_f32_bf16 v160, v6, s50, v160
    v_dot2_f32_bf16 v162, v6, v6, v162
    v_dot2_f32_bf16 v161, v7, s50, v161
    v_dot2_f32_bf16 v163, v7, v7, v163
    s_waitcnt lgkmcnt(9)
    v_dot2_f32_bf16 v160, v8, s50, v160
    v_dot2_f32_bf16 v162, v8, v8, v162
    v_dot2_f32_bf16 v161, v9, s50, v161
    v_dot2_f32_bf16 v163, v9, v9, v163
    v_dot2_f32_bf16 v160, v10, s50, v160
    v_dot2_f32_bf16 v162, v10, v10, v162
    v_dot2_f32_bf16 v161, v11, s50, v161
    v_dot2_f32_bf16 v163, v11, v11, v163
    s_waitcnt lgkmcnt(8)
    v_dot2_f32_bf16 v160, v12, s50, v160
    v_dot2_f32_bf16 v162, v12, v12, v162
    v_dot2_f32_bf16 v161, v13, s50, v161
    v_dot2_f32_bf16 v163, v13, v13, v163
    v_dot2_f32_bf16 v160, v14, s50, v160
    v_dot2_f32_bf16 v162, v14, v14, v162
    v_dot2_f32_bf16 v161, v15, s50, v161
    v_dot2_f32_bf16 v163, v15, v15, v163
    s_waitcnt lgkmcnt(7)
    v_dot2_f32_bf16 v160, v16, s50, v160
    v_dot2_f32_bf16 v162, v16, v16, v162
    v_dot2_f32_bf16 v161, v17, s50, v161
    v_dot2_f32_bf16 v163, v17, v17, v163
    v_dot2_f32_bf16 v160, v18, s50, v160
    v_dot2_f32_bf16 v162, v18, v18, v162
    v_dot2_f32_bf16 v161, v19, s50, v161
    v_dot2_f32_bf16 v163, v19, v19, v163
    s_waitcnt lgkmcnt(6)
    v_dot2_f32_bf16 v160, v20, s50, v160
    v_dot2_f32_bf16 v162, v20, v20, v162
    v_dot2_f32_bf16 v161, v21, s50, v161
    v_dot2_f32_bf16 v163, v21, v21, v163
    v_dot2_f32_bf16 v160, v22, s50, v160
    v_dot2_f32_bf16 v162, v22, v22, v162
    v_dot2_f32_bf16 v161, v23, s50, v161
    v_dot2_f32_bf16 v163, v23, v23, v163
    s_waitcnt lgkmcnt(0)
    s_waitcnt vmcnt(1)
    s_barrier
    s_add_u32 m0, s52, 0
    s_movk_i32 s49, 768
    buffer_load_dwordx4 v252, s[24:27], s49 offen lds
    s_add_u32 m0, s52, 1024
    s_movk_i32 s49, 768
    buffer_load_dwordx4 v253, s[24:27], s49 offen lds
    s_add_u32 m0, s52, 16384
    s_movk_i32 s49, 896
    buffer_load_dwordx4 v252, s[24:27], s49 offen lds
    s_add_u32 m0, s52, 17408
    s_movk_i32 s49, 896
    buffer_load_dwordx4 v253, s[24:27], s49 offen lds
    s_add_u32 m0, s52, 32768
    s_movk_i32 s49, 1024
    buffer_load_dwordx4 v252, s[24:27], s49 offen lds
    s_add_u32 m0, s52, 33792
    s_movk_i32 s49, 1024
    buffer_load_dwordx4 v253, s[24:27], s49 offen lds
    s_add_u32 m0, s55, 0
    s_mov_b32 s49, 1152
    buffer_load_dwordx4 v244, s[28:31], s49 offen lds
    s_add_u32 m0, s55, 1024
    s_mov_b32 s49, 1152
    buffer_load_dwordx4 v245, s[28:31], s49 offen lds
    s_add_u32 m0, s55, 2048
    s_mov_b32 s49, 1152
    buffer_load_dwordx4 v246, s[28:31], s49 offen lds
    ds_read_b128 v[24:27], v152 offset:49152
    ds_read_b128 v[28:31], v153 offset:49152
    ds_read_b128 v[32:35], v154 offset:0
    ds_read_b128 v[36:39], v155 offset:0
    ds_read_b128 v[40:43], v154 offset:16384
    ds_read_b128 v[44:47], v155 offset:16384
    ds_read_b128 v[96:99], v152 offset:51200
    ds_read_b128 v[100:103], v153 offset:51200
    ds_read_b128 v[104:107], v154 offset:2048
    ds_read_b128 v[108:111], v155 offset:2048
    ds_read_b128 v[112:115], v154 offset:18432
    ds_read_b128 v[116:119], v155 offset:18432
    s_waitcnt lgkmcnt(11)
    v_dot2_f32_bf16 v160, v24, s50, v160
    v_dot2_f32_bf16 v162, v24, v24, v162
    v_dot2_f32_bf16 v161, v25, s50, v161
    v_dot2_f32_bf16 v163, v25, v25, v163
    v_dot2_f32_bf16 v160, v26, s50, v160
    v_dot2_f32_bf16 v162, v26, v26, v162
    v_dot2_f32_bf16 v161, v27, s50, v161
    v_dot2_f32_bf16 v163, v27, v27, v163
    s_waitcnt lgkmcnt(10)
    v_dot2_f32_bf16 v160, v28, s50, v160
    v_dot2_f32_bf16 v162, v28, v28, v162
    v_dot2_f32_bf16 v161, v29, s50, v161
    v_dot2_f32_bf16 v163, v29, v29, v163
    v_dot2_f32_bf16 v160, v30, s50, v160
    v_dot2_f32_bf16 v162, v30, v30, v162
    v_dot2_f32_bf16 v161, v31, s50, v161
    v_dot2_f32_bf16 v163, v31, v31, v163
    s_waitcnt lgkmcnt(9)
    v_dot2_f32_bf16 v160, v32, s50, v160
    v_dot2_f32_bf16 v162, v32, v32, v162
    v_dot2_f32_bf16 v161, v33, s50, v161
    v_dot2_f32_bf16 v163, v33, v33, v163
    v_dot2_f32_bf16 v160, v34, s50, v160
    v_dot2_f32_bf16 v162, v34, v34, v162
    v_dot2_f32_bf16 v161, v35, s50, v161
    v_dot2_f32_bf16 v163, v35, v35, v163
    s_waitcnt lgkmcnt(8)
    v_dot2_f32_bf16 v160, v36, s50, v160
    v_dot2_f32_bf16 v162, v36, v36, v162
    v_dot2_f32_bf16 v161, v37, s50, v161
    v_dot2_f32_bf16 v163, v37, v37, v163
    v_dot2_f32_bf16 v160, v38, s50, v160
    v_dot2_f32_bf16 v162, v38, v38, v162
    v_dot2_f32_bf16 v161, v39, s50, v161
    v_dot2_f32_bf16 v163, v39, v39, v163
    s_waitcnt lgkmcnt(7)
    v_dot2_f32_bf16 v160, v40, s50, v160
    v_dot2_f32_bf16 v162, v40, v40, v162
    v_dot2_f32_bf16 v161, v41, s50, v161
    v_dot2_f32_bf16 v163, v41, v41, v163
    v_dot2_f32_bf16 v160, v42, s50, v160
    v_dot2_f32_bf16 v162, v42, v42, v162
    v_dot2_f32_bf16 v161, v43, s50, v161
    v_dot2_f32_bf16 v163, v43, v43, v163
    s_waitcnt lgkmcnt(6)
    v_dot2_f32_bf16 v160, v44, s50, v160
    v_dot2_f32_bf16 v162, v44, v44, v162
    v_dot2_f32_bf16 v161, v45, s50, v161
    v_dot2_f32_bf16 v163, v45, v45, v163
    v_dot2_f32_bf16 v160, v46, s50, v160
    v_dot2_f32_bf16 v162, v46, v46, v162
    v_dot2_f32_bf16 v161, v47, s50, v161
    v_dot2_f32_bf16 v163, v47, v47, v163
    s_waitcnt lgkmcnt(0)
    s_waitcnt vmcnt(3)
    s_barrier
    ds_read_b128 v[48:51], v152 offset:0
    ds_read_b128 v[52:55], v153 offset:0
    ds_read_b128 v[56:59], v152 offset:16384
    ds_read_b128 v[60:63], v153 offset:16384
    ds_read_b128 v[64:67], v152 offset:32768
    ds_read_b128 v[68:71], v153 offset:32768
    ds_read_b128 v[120:123], v152 offset:2048
    ds_read_b128 v[124:127], v153 offset:2048
    ds_read_b128 v[128:131], v152 offset:18432
    ds_read_b128 v[132:135], v153 offset:18432
    ds_read_b128 v[136:139], v152 offset:34816
    ds_read_b128 v[140:143], v153 offset:34816
    s_waitcnt lgkmcnt(11)
    v_dot2_f32_bf16 v160, v48, s50, v160
    v_dot2_f32_bf16 v162, v48, v48, v162
    v_dot2_f32_bf16 v161, v49, s50, v161
    v_dot2_f32_bf16 v163, v49, v49, v163
    v_dot2_f32_bf16 v160, v50, s50, v160
    v_dot2_f32_bf16 v162, v50, v50, v162
    v_dot2_f32_bf16 v161, v51, s50, v161
    v_dot2_f32_bf16 v163, v51, v51, v163
    s_waitcnt lgkmcnt(10)
    v_dot2_f32_bf16 v160, v52, s50, v160
    v_dot2_f32_bf16 v162, v52, v52, v162
    v_dot2_f32_bf16 v161, v53, s50, v161
    v_dot2_f32_bf16 v163, v53, v53, v163
    v_dot2_f32_bf16 v160, v54, s50, v160
    v_dot2_f32_bf16 v162, v54, v54, v162
    v_dot2_f32_bf16 v161, v55, s50, v161
    v_dot2_f32_bf16 v163, v55, v55, v163
    s_waitcnt lgkmcnt(9)
    v_dot2_f32_bf16 v160, v56, s50, v160
    v_dot2_f32_bf16 v162, v56, v56, v162
    v_dot2_f32_bf16 v161, v57, s50, v161
    v_dot2_f32_bf16 v163, v57, v57, v163
    v_dot2_f32_bf16 v160, v58, s50, v160
    v_dot2_f32_bf16 v162, v58, v58, v162
    v_dot2_f32_bf16 v161, v59, s50, v161
    v_dot2_f32_bf16 v163, v59, v59, v163
    s_waitcnt lgkmcnt(8)
    v_dot2_f32_bf16 v160, v60, s50, v160
    v_dot2_f32_bf16 v162, v60, v60, v162
    v_dot2_f32_bf16 v161, v61, s50, v161
    v_dot2_f32_bf16 v163, v61, v61, v163
    v_dot2_f32_bf16 v160, v62, s50, v160
    v_dot2_f32_bf16 v162, v62, v62, v162
    v_dot2_f32_bf16 v161, v63, s50, v161
    v_dot2_f32_bf16 v163, v63, v63, v163
    s_waitcnt lgkmcnt(7)
    v_dot2_f32_bf16 v160, v64, s50, v160
    v_dot2_f32_bf16 v162, v64, v64, v162
    v_dot2_f32_bf16 v161, v65, s50, v161
    v_dot2_f32_bf16 v163, v65, v65, v163
    v_dot2_f32_bf16 v160, v66, s50, v160
    v_dot2_f32_bf16 v162, v66, v66, v162
    v_dot2_f32_bf16 v161, v67, s50, v161
    v_dot2_f32_bf16 v163, v67, v67, v163
    s_waitcnt lgkmcnt(6)
    v_dot2_f32_bf16 v160, v68, s50, v160
    v_dot2_f32_bf16 v162, v68, v68, v162
    v_dot2_f32_bf16 v161, v69, s50, v161
    v_dot2_f32_bf16 v163, v69, v69, v163
    v_dot2_f32_bf16 v160, v70, s50, v160
    v_dot2_f32_bf16 v162, v70, v70, v162
    v_dot2_f32_bf16 v161, v71, s50, v161
    v_dot2_f32_bf16 v163, v71, v71, v163
    s_waitcnt lgkmcnt(0)
    s_add_u32 m0, s55, 24576
    s_mov_b32 s49, 111744
    buffer_load_dwordx4 v244, s[28:31], s49 offen lds
    s_add_u32 m0, s55, 25600
    s_mov_b32 s49, 111744
    buffer_load_dwordx4 v245, s[28:31], s49 offen lds
    s_add_u32 m0, s55, 26624
    s_mov_b32 s49, 111744
    buffer_load_dwordx4 v246, s[28:31], s49 offen lds
    s_and_b32 s46, s44, 7
    s_lshl_b32 s46, s46, 3
    s_add_u32 s46, s46, s40
    s_mul_i32 s47, s46, 9
    v_mul_u32_u24 v248, 21846, v247
    v_lshrrev_b32 v248, 16, v248
    v_mul_u32_u24 v249, 3, v248
    v_sub_u32 v249, v247, v249
    v_add_u32 v248, s47, v248
    v_mul_u32_u24 v248, 3456, v248
    v_lshl_add_u32 v248, v249, 7, v248
    s_lshl_b32 s47, s43, 8
    v_add_u32 v248, s47, v248
    v_mov_b32 v250, 0x7fffff00
    v_cmp_gt_u32 vcc, 27, v247
    s_nop 1
    v_cndmask_b32 v248, v250, v248, vcc
    buffer_load_dword v254, v248, s[28:31], 0 offen
    s_mul_i32 s46, s46, 2688
    v_lshl_add_u32 v248, v247, 7, s46
    v_cmp_gt_u32 vcc, 21, v247
    s_nop 1
    v_cndmask_b32 v248, v250, v248, vcc
    buffer_load_dword v254, v248, s[32:35], 0 offen
    s_nop 1
    v_add_f32 v160, v160, v161
    v_add_f32 v162, v162, v163
    v_mov_b32 v161, v160
    s_nop 1
    v_permlane16_swap_b32 v160, v161
    s_nop 1
    v_add_f32 v160, v160, v161
    v_mov_b32 v161, v160
    s_nop 1
    v_permlane32_swap_b32 v160, v161
    s_nop 1
    v_add_f32 v160, v160, v161
    v_mov_b32 v163, v162
    s_nop 1
    v_permlane16_swap_b32 v162, v163
    s_nop 1
    v_add_f32 v162, v162, v163
    v_mov_b32 v163, v162
    s_nop 1
    v_permlane32_swap_b32 v162, v163
    s_nop 1
    v_add_f32 v162, v162, v163
    v_mul_f32 v160, 0x3ae38e39, v160
    v_mul_f32 v162, 0x3ae38e39, v162
    v_fma_f32 v162, -v160, v160, v162
    v_max_f32 v162, 0, v162
    v_add_f32 v162, 0x3727c5ac, v162
    v_sub_f32 v160, 0, v160
    v_rsq_f32 v252, v162
    s_nop 0
    ds_write_b32 v156, v160 offset:0
    ds_write_b32 v156, v252 offset:512
    s_waitcnt lgkmcnt(0)
    s_barrier
    s_add_u32 m0, s55, 49152
    s_mov_b32 s49, 222336
    buffer_load_dwordx4 v244, s[28:31], s49 offen lds
    s_add_u32 m0, s55, 50176
    s_mov_b32 s49, 222336
    buffer_load_dwordx4 v245, s[28:31], s49 offen lds
    s_add_u32 m0, s55, 51200
    s_mov_b32 s49, 222336
    buffer_load_dwordx4 v246, s[28:31], s49 offen lds
    ds_read_b32 v161, v156 offset:64
    ds_read_b32 v253, v156 offset:576
    v_dot2_f32_bf16 v168, v0, s53, v160
    v_dot2_f32_bf16 v169, v0, s54, v160
    v_dot2_f32_bf16 v170, v1, s53, v160
    v_dot2_f32_bf16 v171, v1, s54, v160
    v_dot2_f32_bf16 v172, v2, s53, v160
    v_dot2_f32_bf16 v173, v2, s54, v160
    v_dot2_f32_bf16 v174, v3, s53, v160
    v_dot2_f32_bf16 v175, v3, s54, v160
    s_nop 0
    v_cvt_pk_bf16_f32 v0, v168, v169
    v_cvt_pk_bf16_f32 v1, v170, v171
    v_cvt_pk_bf16_f32 v2, v172, v173
    v_cvt_pk_bf16_f32 v3, v174, v175
    v_dot2_f32_bf16 v168, v4, s53, v160
    v_dot2_f32_bf16 v169, v4, s54, v160
    v_dot2_f32_bf16 v170, v5, s53, v160
    v_dot2_f32_bf16 v171, v5, s54, v160
    v_dot2_f32_bf16 v172, v6, s53, v160
    v_dot2_f32_bf16 v173, v6, s54, v160
    v_dot2_f32_bf16 v174, v7, s53, v160
    v_dot2_f32_bf16 v175, v7, s54, v160
    s_nop 0
    v_cvt_pk_bf16_f32 v4, v168, v169
    v_cvt_pk_bf16_f32 v5, v170, v171
    v_cvt_pk_bf16_f32 v6, v172, v173
    v_cvt_pk_bf16_f32 v7, v174, v175
    v_dot2_f32_bf16 v168, v8, s53, v160
    v_dot2_f32_bf16 v169, v8, s54, v160
    v_dot2_f32_bf16 v170, v9, s53, v160
    v_dot2_f32_bf16 v171, v9, s54, v160
    v_dot2_f32_bf16 v172, v10, s53, v160
    v_dot2_f32_bf16 v173, v10, s54, v160
    v_dot2_f32_bf16 v174, v11, s53, v160
    v_dot2_f32_bf16 v175, v11, s54, v160
    s_nop 0
    v_cvt_pk_bf16_f32 v8, v168, v169
    v_cvt_pk_bf16_f32 v9, v170, v171
    v_cvt_pk_bf16_f32 v10, v172, v173
    v_cvt_pk_bf16_f32 v11, v174, v175
    v_dot2_f32_bf16 v168, v12, s53, v160
    v_dot2_f32_bf16 v169, v12, s54, v160
    v_dot2_f32_bf16 v170, v13, s53, v160
    v_dot2_f32_bf16 v171, v13, s54, v160
    v_dot2_f32_bf16 v172, v14, s53, v160
    v_dot2_f32_bf16 v173, v14, s54, v160
    v_dot2_f32_bf16 v174, v15, s53, v160
    v_dot2_f32_bf16 v175, v15, s54, v160
    s_nop 0
    v_cvt_pk_bf16_f32 v12, v168, v169
    v_cvt_pk_bf16_f32 v13, v170, v171
    v_cvt_pk_bf16_f32 v14, v172, v173
    v_cvt_pk_bf16_f32 v15, v174, v175
    v_dot2_f32_bf16 v168, v16, s53, v160
    v_dot2_f32_bf16 v169, v16, s54, v160
    v_dot2_f32_bf16 v170, v17, s53, v160
    v_dot2_f32_bf16 v171, v17, s54, v160
    v_dot2_f32_bf16 v172, v18, s53, v160
    v_dot2_f32_bf16 v173, v18, s54, v160
    v_dot2_f32_bf16 v174, v19, s53, v160
    v_dot2_f32_bf16 v175, v19, s54, v160
    s_nop 0
    v_cvt_pk_bf16_f32 v16, v168, v169
    v_cvt_pk_bf16_f32 v17, v170, v171
    v_cvt_pk_bf16_f32 v18, v172, v173
    v_cvt_pk_bf16_f32 v19, v174, v175
    v_dot2_f32_bf16 v168, v20, s53, v160
    v_dot2_f32_bf16 v169, v20, s54, v160
    v_dot2_f32_bf16 v170, v21, s53, v160
    v_dot2_f32_bf16 v171, v21, s54, v160
    v_dot2_f32_bf16 v172, v22, s53, v160
    v_dot2_f32_bf16 v173, v22, s54, v160
    v_dot2_f32_bf16 v174, v23, s53, v160
    v_dot2_f32_bf16 v175, v23, s54, v160
    s_nop 0
    v_cvt_pk_bf16_f32 v20, v168, v169
    v_cvt_pk_bf16_f32 v21, v170, v171
    v_cvt_pk_bf16_f32 v22, v172, v173
    v_cvt_pk_bf16_f32 v23, v174, v175
    v_dot2_f32_bf16 v168, v24, s53, v160
    v_dot2_f32_bf16 v169, v24, s54, v160
    v_dot2_f32_bf16 v170, v25, s53, v160
    v_dot2_f32_bf16 v171, v25, s54, v160
    v_dot2_f32_bf16 v172, v26, s53, v160
    v_dot2_f32_bf16 v173, v26, s54, v160
    v_dot2_f32_bf16 v174, v27, s53, v160
    v_dot2_f32_bf16 v175, v27, s54, v160
    s_nop 0
    v_cvt_pk_bf16_f32 v24, v168, v169
    v_cvt_pk_bf16_f32 v25, v170, v171
    v_cvt_pk_bf16_f32 v26, v172, v173
    v_cvt_pk_bf16_f32 v27, v174, v175
    v_dot2_f32_bf16 v168, v28, s53, v160
    v_dot2_f32_bf16 v169, v28, s54, v160
    v_dot2_f32_bf16 v170, v29, s53, v160
    v_dot2_f32_bf16 v171, v29, s54, v160
    v_dot2_f32_bf16 v172, v30, s53, v160
    v_dot2_f32_bf16 v173, v30, s54, v160
    v_dot2_f32_bf16 v174, v31, s53, v160
    v_dot2_f32_bf16 v175, v31, s54, v160
    s_nop 0
    v_cvt_pk_bf16_f32 v28, v168, v169
    v_cvt_pk_bf16_f32 v29, v170, v171
    v_cvt_pk_bf16_f32 v30, v172, v173
    v_cvt_pk_bf16_f32 v31, v174, v175
    v_dot2_f32_bf16 v168, v32, s53, v160
    v_dot2_f32_bf16 v169, v32, s54, v160
    v_dot2_f32_bf16 v170, v33, s53, v160
    v_dot2_f32_bf16 v171, v33, s54, v160
    v_dot2_f32_bf16 v172, v34, s53, v160
    v_dot2_f32_bf16 v173, v34, s54, v160
    v_dot2_f32_bf16 v174, v35, s53, v160
    v_dot2_f32_bf16 v175, v35, s54, v160
    s_nop 0
    v_cvt_pk_bf16_f32 v32, v168, v169
    v_cvt_pk_bf16_f32 v33, v170, v171
    v_cvt_pk_bf16_f32 v34, v172, v173
    v_cvt_pk_bf16_f32 v35, v174, v175
    v_dot2_f32_bf16 v168, v36, s53, v160
    v_dot2_f32_bf16 v169, v36, s54, v160
    v_dot2_f32_bf16 v170, v37, s53, v160
    v_dot2_f32_bf16 v171, v37, s54, v160
    v_dot2_f32_bf16 v172, v38, s53, v160
    v_dot2_f32_bf16 v173, v38, s54, v160
    v_dot2_f32_bf16 v174, v39, s53, v160
    v_dot2_f32_bf16 v175, v39, s54, v160
    s_nop 0
    v_cvt_pk_bf16_f32 v36, v168, v169
    v_cvt_pk_bf16_f32 v37, v170, v171
    v_cvt_pk_bf16_f32 v38, v172, v173
    v_cvt_pk_bf16_f32 v39, v174, v175
    v_dot2_f32_bf16 v168, v40, s53, v160
    v_dot2_f32_bf16 v169, v40, s54, v160
    v_dot2_f32_bf16 v170, v41, s53, v160
    v_dot2_f32_bf16 v171, v41, s54, v160
    v_dot2_f32_bf16 v172, v42, s53, v160
    v_dot2_f32_bf16 v173, v42, s54, v160
    v_dot2_f32_bf16 v174, v43, s53, v160
    v_dot2_f32_bf16 v175, v43, s54, v160
    s_nop 0
    v_cvt_pk_bf16_f32 v40, v168, v169
    v_cvt_pk_bf16_f32 v41, v170, v171
    v_cvt_pk_bf16_f32 v42, v172, v173
    v_cvt_pk_bf16_f32 v43, v174, v175
    v_dot2_f32_bf16 v168, v44, s53, v160
    v_dot2_f32_bf16 v169, v44, s54, v160
    v_dot2_f32_bf16 v170, v45, s53, v160
    v_dot2_f32_bf16 v171, v45, s54, v160
    v_dot2_f32_bf16 v172, v46, s53, v160
    v_dot2_f32_bf16 v173, v46, s54, v160
    v_dot2_f32_bf16 v174, v47, s53, v160
    v_dot2_f32_bf16 v175, v47, s54, v160
    s_nop 0
    v_cvt_pk_bf16_f32 v44, v168, v169
    v_cvt_pk_bf16_f32 v45, v170, v171
    v_cvt_pk_bf16_f32 v46, v172, v173
    v_cvt_pk_bf16_f32 v47, v174, v175
    v_dot2_f32_bf16 v168, v48, s53, v160
    v_dot2_f32_bf16 v169, v48, s54, v160
    v_dot2_f32_bf16 v170, v49, s53, v160
    v_dot2_f32_bf16 v171, v49, s54, v160
    v_dot2_f32_bf16 v172, v50, s53, v160
    v_dot2_f32_bf16 v173, v50, s54, v160
    v_dot2_f32_bf16 v174, v51, s53, v160
    v_dot2_f32_bf16 v175, v51, s54, v160
    s_nop 0
    v_cvt_pk_bf16_f32 v48, v168, v169
    v_cvt_pk_bf16_f32 v49, v170, v171
    v_cvt_pk_bf16_f32 v50, v172, v173
    v_cvt_pk_bf16_f32 v51, v174, v175
    v_dot2_f32_bf16 v168, v52, s53, v160
    v_dot2_f32_bf16 v169, v52, s54, v160
    v_dot2_f32_bf16 v170, v53, s53, v160
    v_dot2_f32_bf16 v171, v53, s54, v160
    v_dot2_f32_bf16 v172, v54, s53, v160
    v_dot2_f32_bf16 v173, v54, s54, v160
    v_dot2_f32_bf16 v174, v55, s53, v160
    v_dot2_f32_bf16 v175, v55, s54, v160
    s_nop 0
    v_cvt_pk_bf16_f32 v52, v168, v169
    v_cvt_pk_bf16_f32 v53, v170, v171
    v_cvt_pk_bf16_f32 v54, v172, v173
    v_cvt_pk_bf16_f32 v55, v174, v175
    v_dot2_f32_bf16 v168, v56, s53, v160
    v_dot2_f32_bf16 v169, v56, s54, v160
    v_dot2_f32_bf16 v170, v57, s53, v160
    v_dot2_f32_bf16 v171, v57, s54, v160
    v_dot2_f32_bf16 v172, v58, s53, v160
    v_dot2_f32_bf16 v173, v58, s54, v160
    v_dot2_f32_bf16 v174, v59, s53, v160
    v_dot2_f32_bf16 v175, v59, s54, v160
    s_nop 0
    v_cvt_pk_bf16_f32 v56, v168, v169
    v_cvt_pk_bf16_f32 v57, v170, v171
    v_cvt_pk_bf16_f32 v58, v172, v173
    v_cvt_pk_bf16_f32 v59, v174, v175
    v_dot2_f32_bf16 v168, v60, s53, v160
    v_dot2_f32_bf16 v169, v60, s54, v160
    v_dot2_f32_bf16 v170, v61, s53, v160
    v_dot2_f32_bf16 v171, v61, s54, v160
    v_dot2_f32_bf16 v172, v62, s53, v160
    v_dot2_f32_bf16 v173, v62, s54, v160
    v_dot2_f32_bf16 v174, v63, s53, v160
    v_dot2_f32_bf16 v175, v63, s54, v160
    s_nop 0
    v_cvt_pk_bf16_f32 v60, v168, v169
    v_cvt_pk_bf16_f32 v61, v170, v171
    v_cvt_pk_bf16_f32 v62, v172, v173
    v_cvt_pk_bf16_f32 v63, v174, v175
    v_dot2_f32_bf16 v168, v64, s53, v160
    v_dot2_f32_bf16 v169, v64, s54, v160
    v_dot2_f32_bf16 v170, v65, s53, v160
    v_dot2_f32_bf16 v171, v65, s54, v160
    v_dot2_f32_bf16 v172, v66, s53, v160
    v_dot2_f32_bf16 v173, v66, s54, v160
    v_dot2_f32_bf16 v174, v67, s53, v160
    v_dot2_f32_bf16 v175, v67, s54, v160
    s_nop 0
    v_cvt_pk_bf16_f32 v64, v168, v169
    v_cvt_pk_bf16_f32 v65, v170, v171
    v_cvt_pk_bf16_f32 v66, v172, v173
    v_cvt_pk_bf16_f32 v67, v174, v175
    v_dot2_f32_bf16 v168, v68, s53, v160
    v_dot2_f32_bf16 v169, v68, s54, v160
    v_dot2_f32_bf16 v170, v69, s53, v160
    v_dot2_f32_bf16 v171, v69, s54, v160
    v_dot2_f32_bf16 v172, v70, s53, v160
    v_dot2_f32_bf16 v173, v70, s54, v160
    v_dot2_f32_bf16 v174, v71, s53, v160
    v_dot2_f32_bf16 v175, v71, s54, v160
    s_nop 0
    v_cvt_pk_bf16_f32 v68, v168, v169
    v_cvt_pk_bf16_f32 v69, v170, v171
    v_cvt_pk_bf16_f32 v70, v172, v173
    v_cvt_pk_bf16_f32 v71, v174, v175
    s_waitcnt lgkmcnt(0)
    v_dot2_f32_bf16 v168, v72, s53, v161
    v_dot2_f32_bf16 v169, v72, s54, v161
    v_dot2_f32_bf16 v170, v73, s53, v161
    v_dot2_f32_bf16 v171, v73, s54, v161
    v_dot2_f32_bf16 v172, v74, s53, v161
    v_dot2_f32_bf16 v173, v74, s54, v161
    v_dot2_f32_bf16 v174, v75, s53, v161
    v_dot2_f32_bf16 v175, v75, s54, v161
    s_nop 0
    v_cvt_pk_bf16_f32 v72, v168, v169
    v_cvt_pk_bf16_f32 v73, v170, v171
    v_cvt_pk_bf16_f32 v74, v172, v173
    v_cvt_pk_bf16_f32 v75, v174, v175
    v_dot2_f32_bf16 v168, v76, s53, v161
    v_dot2_f32_bf16 v169, v76, s54, v161
    v_dot2_f32_bf16 v170, v77, s53, v161
    v_dot2_f32_bf16 v171, v77, s54, v161
    v_dot2_f32_bf16 v172, v78, s53, v161
    v_dot2_f32_bf16 v173, v78, s54, v161
    v_dot2_f32_bf16 v174, v79, s53, v161
    v_dot2_f32_bf16 v175, v79, s54, v161
    s_nop 0
    v_cvt_pk_bf16_f32 v76, v168, v169
    v_cvt_pk_bf16_f32 v77, v170, v171
    v_cvt_pk_bf16_f32 v78, v172, v173
    v_cvt_pk_bf16_f32 v79, v174, v175
    v_dot2_f32_bf16 v168, v80, s53, v161
    v_dot2_f32_bf16 v169, v80, s54, v161
    v_dot2_f32_bf16 v170, v81, s53, v161
    v_dot2_f32_bf16 v171, v81, s54, v161
    v_dot2_f32_bf16 v172, v82, s53, v161
    v_dot2_f32_bf16 v173, v82, s54, v161
    v_dot2_f32_bf16 v174, v83, s53, v161
    v_dot2_f32_bf16 v175, v83, s54, v161
    s_nop 0
    v_cvt_pk_bf16_f32 v80, v168, v169
    v_cvt_pk_bf16_f32 v81, v170, v171
    v_cvt_pk_bf16_f32 v82, v172, v173
    v_cvt_pk_bf16_f32 v83, v174, v175
    v_dot2_f32_bf16 v168, v84, s53, v161
    v_dot2_f32_bf16 v169, v84, s54, v161
    v_dot2_f32_bf16 v170, v85, s53, v161
    v_dot2_f32_bf16 v171, v85, s54, v161
    v_dot2_f32_bf16 v172, v86, s53, v161
    v_dot2_f32_bf16 v173, v86, s54, v161
    v_dot2_f32_bf16 v174, v87, s53, v161
    v_dot2_f32_bf16 v175, v87, s54, v161
    s_nop 0
    v_cvt_pk_bf16_f32 v84, v168, v169
    v_cvt_pk_bf16_f32 v85, v170, v171
    v_cvt_pk_bf16_f32 v86, v172, v173
    v_cvt_pk_bf16_f32 v87, v174, v175
    v_dot2_f32_bf16 v168, v88, s53, v161
    v_dot2_f32_bf16 v169, v88, s54, v161
    v_dot2_f32_bf16 v170, v89, s53, v161
    v_dot2_f32_bf16 v171, v89, s54, v161
    v_dot2_f32_bf16 v172, v90, s53, v161
    v_dot2_f32_bf16 v173, v90, s54, v161
    v_dot2_f32_bf16 v174, v91, s53, v161
    v_dot2_f32_bf16 v175, v91, s54, v161
    s_nop 0
    v_cvt_pk_bf16_f32 v88, v168, v169
    v_cvt_pk_bf16_f32 v89, v170, v171
    v_cvt_pk_bf16_f32 v90, v172, v173
    v_cvt_pk_bf16_f32 v91, v174, v175
    v_dot2_f32_bf16 v168, v92, s53, v161
    v_dot2_f32_bf16 v169, v92, s54, v161
    v_dot2_f32_bf16 v170, v93, s53, v161
    v_dot2_f32_bf16 v171, v93, s54, v161
    v_dot2_f32_bf16 v172, v94, s53, v161
    v_dot2_f32_bf16 v173, v94, s54, v161
    v_dot2_f32_bf16 v174, v95, s53, v161
    v_dot2_f32_bf16 v175, v95, s54, v161
    s_nop 0
    v_cvt_pk_bf16_f32 v92, v168, v169
    v_cvt_pk_bf16_f32 v93, v170, v171
    v_cvt_pk_bf16_f32 v94, v172, v173
    v_cvt_pk_bf16_f32 v95, v174, v175
    v_dot2_f32_bf16 v168, v96, s53, v161
    v_dot2_f32_bf16 v169, v96, s54, v161
    v_dot2_f32_bf16 v170, v97, s53, v161
    v_dot2_f32_bf16 v171, v97, s54, v161
    v_dot2_f32_bf16 v172, v98, s53, v161
    v_dot2_f32_bf16 v173, v98, s54, v161
    v_dot2_f32_bf16 v174, v99, s53, v161
    v_dot2_f32_bf16 v175, v99, s54, v161
    s_nop 0
    v_cvt_pk_bf16_f32 v96, v168, v169
    v_cvt_pk_bf16_f32 v97, v170, v171
    v_cvt_pk_bf16_f32 v98, v172, v173
    v_cvt_pk_bf16_f32 v99, v174, v175
    v_dot2_f32_bf16 v168, v100, s53, v161
    v_dot2_f32_bf16 v169, v100, s54, v161
    v_dot2_f32_bf16 v170, v101, s53, v161
    v_dot2_f32_bf16 v171, v101, s54, v161
    v_dot2_f32_bf16 v172, v102, s53, v161
    v_dot2_f32_bf16 v173, v102, s54, v161
    v_dot2_f32_bf16 v174, v103, s53, v161
    v_dot2_f32_bf16 v175, v103, s54, v161
    s_nop 0
    v_cvt_pk_bf16_f32 v100, v168, v169
    v_cvt_pk_bf16_f32 v101, v170, v171
    v_cvt_pk_bf16_f32 v102, v172, v173
    v_cvt_pk_bf16_f32 v103, v174, v175
    v_dot2_f32_bf16 v168, v104, s53, v161
    v_dot2_f32_bf16 v169, v104, s54, v161
    v_dot2_f32_bf16 v170, v105, s53, v161
    v_dot2_f32_bf16 v171, v105, s54, v161
    v_dot2_f32_bf16 v172, v106, s53, v161
    v_dot2_f32_bf16 v173, v106, s54, v161
    v_dot2_f32_bf16 v174, v107, s53, v161
    v_dot2_f32_bf16 v175, v107, s54, v161
    s_nop 0
    v_cvt_pk_bf16_f32 v104, v168, v169
    v_cvt_pk_bf16_f32 v105, v170, v171
    v_cvt_pk_bf16_f32 v106, v172, v173
    v_cvt_pk_bf16_f32 v107, v174, v175
    v_dot2_f32_bf16 v168, v108, s53, v161
    v_dot2_f32_bf16 v169, v108, s54, v161
    v_dot2_f32_bf16 v170, v109, s53, v161
    v_dot2_f32_bf16 v171, v109, s54, v161
    v_dot2_f32_bf16 v172, v110, s53, v161
    v_dot2_f32_bf16 v173, v110, s54, v161
    v_dot2_f32_bf16 v174, v111, s53, v161
    v_dot2_f32_bf16 v175, v111, s54, v161
    s_nop 0
    v_cvt_pk_bf16_f32 v108, v168, v169
    v_cvt_pk_bf16_f32 v109, v170, v171
    v_cvt_pk_bf16_f32 v110, v172, v173
    v_cvt_pk_bf16_f32 v111, v174, v175
    v_dot2_f32_bf16 v168, v112, s53, v161
    v_dot2_f32_bf16 v169, v112, s54, v161
    v_dot2_f32_bf16 v170, v113, s53, v161
    v_dot2_f32_bf16 v171, v113, s54, v161
    v_dot2_f32_bf16 v172, v114, s53, v161
    v_dot2_f32_bf16 v173, v114, s54, v161
    v_dot2_f32_bf16 v174, v115, s53, v161
    v_dot2_f32_bf16 v175, v115, s54, v161
    s_nop 0
    v_cvt_pk_bf16_f32 v112, v168, v169
    v_cvt_pk_bf16_f32 v113, v170, v171
    v_cvt_pk_bf16_f32 v114, v172, v173
    v_cvt_pk_bf16_f32 v115, v174, v175
    v_dot2_f32_bf16 v168, v116, s53, v161
    v_dot2_f32_bf16 v169, v116, s54, v161
    v_dot2_f32_bf16 v170, v117, s53, v161
    v_dot2_f32_bf16 v171, v117, s54, v161
    v_dot2_f32_bf16 v172, v118, s53, v161
    v_dot2_f32_bf16 v173, v118, s54, v161
    v_dot2_f32_bf16 v174, v119, s53, v161
    v_dot2_f32_bf16 v175, v119, s54, v161
    s_nop 0
    v_cvt_pk_bf16_f32 v116, v168, v169
    v_cvt_pk_bf16_f32 v117, v170, v171
    v_cvt_pk_bf16_f32 v118, v172, v173
    v_cvt_pk_bf16_f32 v119, v174, v175
    v_dot2_f32_bf16 v168, v120, s53, v161
    v_dot2_f32_bf16 v169, v120, s54, v161
    v_dot2_f32_bf16 v170, v121, s53, v161
    v_dot2_f32_bf16 v171, v121, s54, v161
    v_dot2_f32_bf16 v172, v122, s53, v161
    v_dot2_f32_bf16 v173, v122, s54, v161
    v_dot2_f32_bf16 v174, v123, s53, v161
    v_dot2_f32_bf16 v175, v123, s54, v161
    s_nop 0
    v_cvt_pk_bf16_f32 v120, v168, v169
    v_cvt_pk_bf16_f32 v121, v170, v171
    v_cvt_pk_bf16_f32 v122, v172, v173
    v_cvt_pk_bf16_f32 v123, v174, v175
    v_dot2_f32_bf16 v168, v124, s53, v161
    v_dot2_f32_bf16 v169, v124, s54, v161
    v_dot2_f32_bf16 v170, v125, s53, v161
    v_dot2_f32_bf16 v171, v125, s54, v161
    v_dot2_f32_bf16 v172, v126, s53, v161
    v_dot2_f32_bf16 v173, v126, s54, v161
    v_dot2_f32_bf16 v174, v127, s53, v161
    v_dot2_f32_bf16 v175, v127, s54, v161
    s_nop 0
    v_cvt_pk_bf16_f32 v124, v168, v169
    v_cvt_pk_bf16_f32 v125, v170, v171
    v_cvt_pk_bf16_f32 v126, v172, v173
    v_cvt_pk_bf16_f32 v127, v174, v175
    v_dot2_f32_bf16 v168, v128, s53, v161
    v_dot2_f32_bf16 v169, v128, s54, v161
    v_dot2_f32_bf16 v170, v129, s53, v161
    v_dot2_f32_bf16 v171, v129, s54, v161
    v_dot2_f32_bf16 v172, v130, s53, v161
    v_dot2_f32_bf16 v173, v130, s54, v161
    v_dot2_f32_bf16 v174, v131, s53, v161
    v_dot2_f32_bf16 v175, v131, s54, v161
    s_nop 0
    v_cvt_pk_bf16_f32 v128, v168, v169
    v_cvt_pk_bf16_f32 v129, v170, v171
    v_cvt_pk_bf16_f32 v130, v172, v173
    v_cvt_pk_bf16_f32 v131, v174, v175
    v_dot2_f32_bf16 v168, v132, s53, v161
    v_dot2_f32_bf16 v169, v132, s54, v161
    v_dot2_f32_bf16 v170, v133, s53, v161
    v_dot2_f32_bf16 v171, v133, s54, v161
    v_dot2_f32_bf16 v172, v134, s53, v161
    v_dot2_f32_bf16 v173, v134, s54, v161
    v_dot2_f32_bf16 v174, v135, s53, v161
    v_dot2_f32_bf16 v175, v135, s54, v161
    s_nop 0
    v_cvt_pk_bf16_f32 v132, v168, v169
    v_cvt_pk_bf16_f32 v133, v170, v171
    v_cvt_pk_bf16_f32 v134, v172, v173
    v_cvt_pk_bf16_f32 v135, v174, v175
    v_dot2_f32_bf16 v168, v136, s53, v161
    v_dot2_f32_bf16 v169, v136, s54, v161
    v_dot2_f32_bf16 v170, v137, s53, v161
    v_dot2_f32_bf16 v171, v137, s54, v161
    v_dot2_f32_bf16 v172, v138, s53, v161
    v_dot2_f32_bf16 v173, v138, s54, v161
    v_dot2_f32_bf16 v174, v139, s53, v161
    v_dot2_f32_bf16 v175, v139, s54, v161
    s_nop 0
    v_cvt_pk_bf16_f32 v136, v168, v169
    v_cvt_pk_bf16_f32 v137, v170, v171
    v_cvt_pk_bf16_f32 v138, v172, v173
    v_cvt_pk_bf16_f32 v139, v174, v175
    v_dot2_f32_bf16 v168, v140, s53, v161
    v_dot2_f32_bf16 v169, v140, s54, v161
    v_dot2_f32_bf16 v170, v141, s53, v161
    v_dot2_f32_bf16 v171, v141, s54, v161
    v_dot2_f32_bf16 v172, v142, s53, v161
    v_dot2_f32_bf16 v173, v142, s54, v161
    v_dot2_f32_bf16 v174, v143, s53, v161
    v_dot2_f32_bf16 v175, v143, s54, v161
    s_nop 0
    v_cvt_pk_bf16_f32 v140, v168, v169
    v_cvt_pk_bf16_f32 v141, v170, v171
    v_cvt_pk_bf16_f32 v142, v172, v173
    v_cvt_pk_bf16_f32 v143, v174, v175
    s_waitcnt vmcnt(8)
    s_barrier
    ds_read_b64_tr_b16 v[216:217], v236 offset:0
    ds_read_b64_tr_b16 v[218:219], v236 offset:3072
    ds_read_b64_tr_b16 v[220:221], v237 offset:0
    ds_read_b64_tr_b16 v[222:223], v237 offset:3072
    ds_read_b64_tr_b16 v[224:225], v238 offset:0
    ds_read_b64_tr_b16 v[226:227], v238 offset:3072
    ds_read_b64_tr_b16 v[228:229], v239 offset:0
    ds_read_b64_tr_b16 v[230:231], v239 offset:3072
    ds_read_b64_tr_b16 v[232:233], v236 offset:128
    ds_read_b64_tr_b16 v[234:235], v236 offset:3200
    s_waitcnt vmcnt(5)
    s_barrier
    s_waitcnt lgkmcnt(8)
    v_mfma_f32_16x16x32_bf16 v[144:147], v[0:3], v[216:219], 0
    v_mfma_f32_16x16x32_bf16 v[148:151], v[72:75], v[216:219], 0
    ds_read_b64_tr_b16 v[216:217], v236 offset:12288
    ds_read_b64_tr_b16 v[218:219], v236 offset:15360
    s_add_u32 m0, s55, 73728
    s_mov_b32 s49, 332928
    buffer_load_dwordx4 v244, s[28:31], s49 offen lds
    s_waitcnt lgkmcnt(8)
    v_mfma_f32_16x16x32_bf16 v[152:155], v[0:3], v[220:223], 0
    v_mfma_f32_16x16x32_bf16 v[156:159], v[72:75], v[220:223], 0
    ds_read_b64_tr_b16 v[220:221], v237 offset:12288
    ds_read_b64_tr_b16 v[222:223], v237 offset:15360
    s_waitcnt lgkmcnt(8)
    v_mfma_f32_16x16x32_bf16 v[160:163], v[0:3], v[224:227], 0
    v_mfma_f32_16x16x32_bf16 v[164:167], v[72:75], v[224:227], 0
    ds_read_b64_tr_b16 v[224:225], v238 offset:12288
    ds_read_b64_tr_b16 v[226:227], v238 offset:15360
    s_add_u32 m0, s55, 74752
    s_mov_b32 s49, 332928
    buffer_load_dwordx4 v245, s[28:31], s49 offen lds
    s_waitcnt lgkmcnt(8)
    v_mfma_f32_16x16x32_bf16 v[168:171], v[0:3], v[228:231], 0
    v_mfma_f32_16x16x32_bf16 v[172:175], v[72:75], v[228:231], 0
    ds_read_b64_tr_b16 v[228:229], v239 offset:12288
    ds_read_b64_tr_b16 v[230:231], v239 offset:15360
    s_waitcnt lgkmcnt(8)
    v_mfma_f32_16x16x32_bf16 v[176:179], v[0:3], v[232:235], 0
    v_mfma_f32_16x16x32_bf16 v[180:183], v[72:75], v[232:235], 0
    ds_read_b64_tr_b16 v[232:233], v236 offset:24576
    ds_read_b64_tr_b16 v[234:235], v236 offset:27648
    s_add_u32 m0, s55, 75776
    s_mov_b32 s49, 332928
    buffer_load_dwordx4 v246, s[28:31], s49 offen lds
    s_waitcnt lgkmcnt(8)
    v_mfma_f32_16x16x32_bf16 v[184:187], v[0:3], v[216:219], 0
    v_mfma_f32_16x16x32_bf16 v[188:191], v[72:75], v[216:219], 0
    ds_read_b64_tr_b16 v[216:217], v237 offset:24576
    ds_read_b64_tr_b16 v[218:219], v237 offset:27648
    s_waitcnt lgkmcnt(8)
    v_mfma_f32_16x16x32_bf16 v[192:195], v[0:3], v[220:223], 0
    v_mfma_f32_16x16x32_bf16 v[196:199], v[72:75], v[220:223], 0
    ds_read_b64_tr_b16 v[220:221], v238 offset:24576
    ds_read_b64_tr_b16 v[222:223], v238 offset:27648
    s_waitcnt lgkmcnt(8)
    v_mfma_f32_16x16x32_bf16 v[200:203], v[0:3], v[224:227], 0
    v_mfma_f32_16x16x32_bf16 v[204:207], v[72:75], v[224:227], 0
    ds_read_b64_tr_b16 v[224:225], v239 offset:24576
    ds_read_b64_tr_b16 v[226:227], v239 offset:27648
    s_waitcnt lgkmcnt(8)
    v_mfma_f32_16x16x32_bf16 v[208:211], v[0:3], v[228:231], 0
    v_mfma_f32_16x16x32_bf16 v[212:215], v[72:75], v[228:231], 0
    ds_read_b64_tr_b16 v[228:229], v236 offset:24704
    ds_read_b64_tr_b16 v[230:231], v236 offset:27776
    s_waitcnt vmcnt(3)
    s_barrier
    s_waitcnt lgkmcnt(8)
    v_mfma_f32_16x16x32_bf16 v[144:147], v[4:7], v[232:235], v[144:147]
    v_mfma_f32_16x16x32_bf16 v[148:151], v[76:79], v[232:235], v[148:151]
    ds_read_b64_tr_b16 v[232:233], v236 offset:36864
    ds_read_b64_tr_b16 v[234:235], v236 offset:39936
    s_add_u32 m0, s55, 0
    s_mov_b32 s49, 443520
    buffer_load_dwordx4 v244, s[28:31], s49 offen lds
    s_waitcnt lgkmcnt(8)
    v_mfma_f32_16x16x32_bf16 v[152:155], v[4:7], v[216:219], v[152:155]
    v_mfma_f32_16x16x32_bf16 v[156:159], v[76:79], v[216:219], v[156:159]
    ds_read_b64_tr_b16 v[216:217], v237 offset:36864
    ds_read_b64_tr_b16 v[218:219], v237 offset:39936
    s_waitcnt lgkmcnt(8)
    v_mfma_f32_16x16x32_bf16 v[160:163], v[4:7], v[220:223], v[160:163]
    v_mfma_f32_16x16x32_bf16 v[164:167], v[76:79], v[220:223], v[164:167]
    ds_read_b64_tr_b16 v[220:221], v238 offset:36864
    ds_read_b64_tr_b16 v[222:223], v238 offset:39936
    s_add_u32 m0, s55, 1024
    s_mov_b32 s49, 443520
    buffer_load_dwordx4 v245, s[28:31], s49 offen lds
    s_waitcnt lgkmcnt(8)
    v_mfma_f32_16x16x32_bf16 v[168:171], v[4:7], v[224:227], v[168:171]
    v_mfma_f32_16x16x32_bf16 v[172:175], v[76:79], v[224:227], v[172:175]
    ds_read_b64_tr_b16 v[224:225], v239 offset:36864
    ds_read_b64_tr_b16 v[226:227], v239 offset:39936
    s_waitcnt lgkmcnt(8)
    v_mfma_f32_16x16x32_bf16 v[176:179], v[4:7], v[228:231], v[176:179]
    v_mfma_f32_16x16x32_bf16 v[180:183], v[76:79], v[228:231], v[180:183]
    ds_read_b64_tr_b16 v[228:229], v240 offset:0
    ds_read_b64_tr_b16 v[230:231], v240 offset:3072
    s_add_u32 m0, s55, 2048
    s_mov_b32 s49, 443520
    buffer_load_dwordx4 v246, s[28:31], s49 offen lds
    s_waitcnt lgkmcnt(8)
    v_mfma_f32_16x16x32_bf16 v[184:187], v[4:7], v[232:235], v[184:187]
    v_mfma_f32_16x16x32_bf16 v[188:191], v[76:79], v[232:235], v[188:191]
    ds_read_b64_tr_b16 v[232:233], v241 offset:0
    ds_read_b64_tr_b16 v[234:235], v241 offset:3072
    s_waitcnt lgkmcnt(8)
    v_mfma_f32_16x16x32_bf16 v[192:195], v[4:7], v[216:219], v[192:195]
    v_mfma_f32_16x16x32_bf16 v[196:199], v[76:79], v[216:219], v[196:199]
    ds_read_b64_tr_b16 v[216:217], v242 offset:0
    ds_read_b64_tr_b16 v[218:219], v242 offset:3072
    s_waitcnt lgkmcnt(8)
    v_mfma_f32_16x16x32_bf16 v[200:203], v[4:7], v[220:223], v[200:203]
    v_mfma_f32_16x16x32_bf16 v[204:207], v[76:79], v[220:223], v[204:207]
    ds_read_b64_tr_b16 v[220:221], v243 offset:0
    ds_read_b64_tr_b16 v[222:223], v243 offset:3072
    s_waitcnt lgkmcnt(8)
    v_mfma_f32_16x16x32_bf16 v[208:211], v[4:7], v[224:227], v[208:211]
    v_mfma_f32_16x16x32_bf16 v[212:215], v[76:79], v[224:227], v[212:215]
    ds_read_b64_tr_b16 v[224:225], v240 offset:128
    ds_read_b64_tr_b16 v[226:227], v240 offset:3200
    s_waitcnt vmcnt(3)
    s_barrier
    s_waitcnt lgkmcnt(8)
    v_mfma_f32_16x16x32_bf16 v[144:147], v[8:11], v[228:231], v[144:147]
    v_mfma_f32_16x16x32_bf16 v[148:151], v[80:83], v[228:231], v[148:151]
    ds_read_b64_tr_b16 v[228:229], v240 offset:12288
    ds_read_b64_tr_b16 v[230:231], v240 offset:15360
    s_add_u32 m0, s55, 24576
    s_mov_b32 s49, 554112
    buffer_load_dwordx4 v244, s[28:31], s49 offen lds
    s_waitcnt lgkmcnt(8)
    v_mfma_f32_16x16x32_bf16 v[152:155], v[8:11], v[232:235], v[152:155]
    v_mfma_f32_16x16x32_bf16 v[156:159], v[80:83], v[232:235], v[156:159]
    ds_read_b64_tr_b16 v[232:233], v241 offset:12288
    ds_read_b64_tr_b16 v[234:235], v241 offset:15360
    s_waitcnt lgkmcnt(8)
    v_mfma_f32_16x16x32_bf16 v[160:163], v[8:11], v[216:219], v[160:163]
    v_mfma_f32_16x16x32_bf16 v[164:167], v[80:83], v[216:219], v[164:167]
    ds_read_b64_tr_b16 v[216:217], v242 offset:12288
    ds_read_b64_tr_b16 v[218:219], v242 offset:15360
    s_add_u32 m0, s55, 25600
    s_mov_b32 s49, 554112
    buffer_load_dwordx4 v245, s[28:31], s49 offen lds
    s_waitcnt lgkmcnt(8)
    v_mfma_f32_16x16x32_bf16 v[168:171], v[8:11], v[220:223], v[168:171]
    v_mfma_f32_16x16x32_bf16 v[172:175], v[80:83], v[220:223], v[172:175]
    ds_read_b64_tr_b16 v[220:221], v243 offset:12288
    ds_read_b64_tr_b16 v[222:223], v243 offset:15360
    s_waitcnt lgkmcnt(8)
    v_mfma_f32_16x16x32_bf16 v[176:179], v[8:11], v[224:227], v[176:179]
    v_mfma_f32_16x16x32_bf16 v[180:183], v[80:83], v[224:227], v[180:183]
    ds_read_b64_tr_b16 v[224:225], v240 offset:24576
    ds_read_b64_tr_b16 v[226:227], v240 offset:27648
    s_add_u32 m0, s55, 26624
    s_mov_b32 s49, 554112
    buffer_load_dwordx4 v246, s[28:31], s49 offen lds
    s_waitcnt lgkmcnt(8)
    v_mfma_f32_16x16x32_bf16 v[184:187], v[8:11], v[228:231], v[184:187]
    v_mfma_f32_16x16x32_bf16 v[188:191], v[80:83], v[228:231], v[188:191]
    ds_read_b64_tr_b16 v[228:229], v241 offset:24576
    ds_read_b64_tr_b16 v[230:231], v241 offset:27648
    s_waitcnt lgkmcnt(8)
    v_mfma_f32_16x16x32_bf16 v[192:195], v[8:11], v[232:235], v[192:195]
    v_mfma_f32_16x16x32_bf16 v[196:199], v[80:83], v[232:235], v[196:199]
    ds_read_b64_tr_b16 v[232:233], v242 offset:24576
    ds_read_b64_tr_b16 v[234:235], v242 offset:27648
    s_waitcnt lgkmcnt(8)
    v_mfma_f32_16x16x32_bf16 v[200:203], v[8:11], v[216:219], v[200:203]
    v_mfma_f32_16x16x32_bf16 v[204:207], v[80:83], v[216:219], v[204:207]
    ds_read_b64_tr_b16 v[216:217], v243 offset:24576
    ds_read_b64_tr_b16 v[218:219], v243 offset:27648
    s_waitcnt lgkmcnt(8)
    v_mfma_f32_16x16x32_bf16 v[208:211], v[8:11], v[220:223], v[208:211]
    v_mfma_f32_16x16x32_bf16 v[212:215], v[80:83], v[220:223], v[212:215]
    ds_read_b64_tr_b16 v[220:221], v240 offset:24704
    ds_read_b64_tr_b16 v[222:223], v240 offset:27776
    s_waitcnt vmcnt(3)
    s_barrier
    s_waitcnt lgkmcnt(8)
    v_mfma_f32_16x16x32_bf16 v[144:147], v[12:15], v[224:227], v[144:147]
    v_mfma_f32_16x16x32_bf16 v[148:151], v[84:87], v[224:227], v[148:151]
    ds_read_b64_tr_b16 v[224:225], v240 offset:36864
    ds_read_b64_tr_b16 v[226:227], v240 offset:39936
    s_add_u32 m0, s55, 49152
    s_mov_b32 s49, 664704
    buffer_load_dwordx4 v244, s[28:31], s49 offen lds
    s_waitcnt lgkmcnt(8)
    v_mfma_f32_16x16x32_bf16 v[152:155], v[12:15], v[228:231], v[152:155]
    v_mfma_f32_16x16x32_bf16 v[156:159], v[84:87], v[228:231], v[156:159]
    ds_read_b64_tr_b16 v[228:229], v241 offset:36864
    ds_read_b64_tr_b16 v[230:231], v241 offset:39936
    s_waitcnt lgkmcnt(8)
    v_mfma_f32_16x16x32_bf16 v[160:163], v[12:15], v[232:235], v[160:163]
    v_mfma_f32_16x16x32_bf16 v[164:167], v[84:87], v[232:235], v[164:167]
    ds_read_b64_tr_b16 v[232:233], v242 offset:36864
    ds_read_b64_tr_b16 v[234:235], v242 offset:39936
    s_add_u32 m0, s55, 50176
    s_mov_b32 s49, 664704
    buffer_load_dwordx4 v245, s[28:31], s49 offen lds
    s_waitcnt lgkmcnt(8)
    v_mfma_f32_16x16x32_bf16 v[168:171], v[12:15], v[216:219], v[168:171]
    v_mfma_f32_16x16x32_bf16 v[172:175], v[84:87], v[216:219], v[172:175]
    ds_read_b64_tr_b16 v[216:217], v243 offset:36864
    ds_read_b64_tr_b16 v[218:219], v243 offset:39936
    s_waitcnt lgkmcnt(8)
    v_mfma_f32_16x16x32_bf16 v[176:179], v[12:15], v[220:223], v[176:179]
    v_mfma_f32_16x16x32_bf16 v[180:183], v[84:87], v[220:223], v[180:183]
    ds_read_b64_tr_b16 v[220:221], v236 offset:0
    ds_read_b64_tr_b16 v[222:223], v236 offset:3072
    s_add_u32 m0, s55, 51200
    s_mov_b32 s49, 664704
    buffer_load_dwordx4 v246, s[28:31], s49 offen lds
    s_waitcnt lgkmcnt(8)
    v_mfma_f32_16x16x32_bf16 v[184:187], v[12:15], v[224:227], v[184:187]
    v_mfma_f32_16x16x32_bf16 v[188:191], v[84:87], v[224:227], v[188:191]
    ds_read_b64_tr_b16 v[224:225], v237 offset:0
    ds_read_b64_tr_b16 v[226:227], v237 offset:3072
    s_waitcnt lgkmcnt(8)
    v_mfma_f32_16x16x32_bf16 v[192:195], v[12:15], v[228:231], v[192:195]
    v_mfma_f32_16x16x32_bf16 v[196:199], v[84:87], v[228:231], v[196:199]
    ds_read_b64_tr_b16 v[228:229], v238 offset:0
    ds_read_b64_tr_b16 v[230:231], v238 offset:3072
    s_waitcnt lgkmcnt(8)
    v_mfma_f32_16x16x32_bf16 v[200:203], v[12:15], v[232:235], v[200:203]
    v_mfma_f32_16x16x32_bf16 v[204:207], v[84:87], v[232:235], v[204:207]
    ds_read_b64_tr_b16 v[232:233], v239 offset:0
    ds_read_b64_tr_b16 v[234:235], v239 offset:3072
    s_waitcnt lgkmcnt(8)
    v_mfma_f32_16x16x32_bf16 v[208:211], v[12:15], v[216:219], v[208:211]
    v_mfma_f32_16x16x32_bf16 v[212:215], v[84:87], v[216:219], v[212:215]
    ds_read_b64_tr_b16 v[216:217], v236 offset:128
    ds_read_b64_tr_b16 v[218:219], v236 offset:3200
    s_waitcnt vmcnt(3)
    s_barrier
    s_waitcnt lgkmcnt(8)
    v_mfma_f32_16x16x32_bf16 v[144:147], v[16:19], v[220:223], v[144:147]
    v_mfma_f32_16x16x32_bf16 v[148:151], v[88:91], v[220:223], v[148:151]
    ds_read_b64_tr_b16 v[220:221], v236 offset:12288
    ds_read_b64_tr_b16 v[222:223], v236 offset:15360
    s_add_u32 m0, s55, 73728
    s_mov_b32 s49, 775296
    buffer_load_dwordx4 v244, s[28:31], s49 offen lds
    s_waitcnt lgkmcnt(8)
    v_mfma_f32_16x16x32_bf16 v[152:155], v[16:19], v[224:227], v[152:155]
    v_mfma_f32_16x16x32_bf16 v[156:159], v[88:91], v[224:227], v[156:159]
    ds_read_b64_tr_b16 v[224:225], v237 offset:12288
    ds_read_b64_tr_b16 v[226:227], v237 offset:15360
    s_waitcnt lgkmcnt(8)
    v_mfma_f32_16x16x32_bf16 v[160:163], v[16:19], v[228:231], v[160:163]
    v_mfma_f32_16x16x32_bf16 v[164:167], v[88:91], v[228:231], v[164:167]
    ds_read_b64_tr_b16 v[228:229], v238 offset:12288
    ds_read_b64_tr_b16 v[230:231], v238 offset:15360
    s_add_u32 m0, s55, 74752
    s_mov_b32 s49, 775296
    buffer_load_dwordx4 v245, s[28:31], s49 offen lds
    s_waitcnt lgkmcnt(8)
    v_mfma_f32_16x16x32_bf16 v[168:171], v[16:19], v[232:235], v[168:171]
    v_mfma_f32_16x16x32_bf16 v[172:175], v[88:91], v[232:235], v[172:175]
    ds_read_b64_tr_b16 v[232:233], v239 offset:12288
    ds_read_b64_tr_b16 v[234:235], v239 offset:15360
    s_waitcnt lgkmcnt(8)
    v_mfma_f32_16x16x32_bf16 v[176:179], v[16:19], v[216:219], v[176:179]
    v_mfma_f32_16x16x32_bf16 v[180:183], v[88:91], v[216:219], v[180:183]
    ds_read_b64_tr_b16 v[216:217], v236 offset:24576
    ds_read_b64_tr_b16 v[218:219], v236 offset:27648
    s_add_u32 m0, s55, 75776
    s_mov_b32 s49, 775296
    buffer_load_dwordx4 v246, s[28:31], s49 offen lds
    s_waitcnt lgkmcnt(8)
    v_mfma_f32_16x16x32_bf16 v[184:187], v[16:19], v[220:223], v[184:187]
    v_mfma_f32_16x16x32_bf16 v[188:191], v[88:91], v[220:223], v[188:191]
    ds_read_b64_tr_b16 v[220:221], v237 offset:24576
    ds_read_b64_tr_b16 v[222:223], v237 offset:27648
    s_waitcnt lgkmcnt(8)
    v_mfma_f32_16x16x32_bf16 v[192:195], v[16:19], v[224:227], v[192:195]
    v_mfma_f32_16x16x32_bf16 v[196:199], v[88:91], v[224:227], v[196:199]
    ds_read_b64_tr_b16 v[224:225], v238 offset:24576
    ds_read_b64_tr_b16 v[226:227], v238 offset:27648
    s_waitcnt lgkmcnt(8)
    v_mfma_f32_16x16x32_bf16 v[200:203], v[16:19], v[228:231], v[200:203]
    v_mfma_f32_16x16x32_bf16 v[204:207], v[88:91], v[228:231], v[204:207]
    ds_read_b64_tr_b16 v[228:229], v239 offset:24576
    ds_read_b64_tr_b16 v[230:231], v239 offset:27648
    s_waitcnt lgkmcnt(8)
    v_mfma_f32_16x16x32_bf16 v[208:211], v[16:19], v[232:235], v[208:211]
    v_mfma_f32_16x16x32_bf16 v[212:215], v[88:91], v[232:235], v[212:215]
    ds_read_b64_tr_b16 v[232:233], v236 offset:24704
    ds_read_b64_tr_b16 v[234:235], v236 offset:27776
    s_waitcnt vmcnt(3)
    s_barrier
    s_waitcnt lgkmcnt(8)
    v_mfma_f32_16x16x32_bf16 v[144:147], v[20:23], v[216:219], v[144:147]
    v_mfma_f32_16x16x32_bf16 v[148:151], v[92:95], v[216:219], v[148:151]
    ds_read_b64_tr_b16 v[216:217], v236 offset:36864
    ds_read_b64_tr_b16 v[218:219], v236 offset:39936
    s_add_u32 m0, s55, 0
    s_mov_b32 s49, 885888
    buffer_load_dwordx4 v244, s[28:31], s49 offen lds
    s_waitcnt lgkmcnt(8)
    v_mfma_f32_16x16x32_bf16 v[152:155], v[20:23], v[220:223], v[152:155]
    v_mfma_f32_16x16x32_bf16 v[156:159], v[92:95], v[220:223], v[156:159]
    ds_read_b64_tr_b16 v[220:221], v237 offset:36864
    ds_read_b64_tr_b16 v[222:223], v237 offset:39936
    s_waitcnt lgkmcnt(8)
    v_mfma_f32_16x16x32_bf16 v[160:163], v[20:23], v[224:227], v[160:163]
    v_mfma_f32_16x16x32_bf16 v[164:167], v[92:95], v[224:227], v[164:167]
    ds_read_b64_tr_b16 v[224:225], v238 offset:36864
    ds_read_b64_tr_b16 v[226:227], v238 offset:39936
    s_add_u32 m0, s55, 1024
    s_mov_b32 s49, 885888
    buffer_load_dwordx4 v245, s[28:31], s49 offen lds
    s_waitcnt lgkmcnt(8)
    v_mfma_f32_16x16x32_bf16 v[168:171], v[20:23], v[228:231], v[168:171]
    v_mfma_f32_16x16x32_bf16 v[172:175], v[92:95], v[228:231], v[172:175]
    ds_read_b64_tr_b16 v[228:229], v239 offset:36864
    ds_read_b64_tr_b16 v[230:231], v239 offset:39936
    s_waitcnt lgkmcnt(8)
    v_mfma_f32_16x16x32_bf16 v[176:179], v[20:23], v[232:235], v[176:179]
    v_mfma_f32_16x16x32_bf16 v[180:183], v[92:95], v[232:235], v[180:183]
    ds_read_b64_tr_b16 v[232:233], v240 offset:0
    ds_read_b64_tr_b16 v[234:235], v240 offset:3072
    s_add_u32 m0, s55, 2048
    s_mov_b32 s49, 885888
    buffer_load_dwordx4 v246, s[28:31], s49 offen lds
    s_waitcnt lgkmcnt(8)
    v_mfma_f32_16x16x32_bf16 v[184:187], v[20:23], v[216:219], v[184:187]
    v_mfma_f32_16x16x32_bf16 v[188:191], v[92:95], v[216:219], v[188:191]
    ds_read_b64_tr_b16 v[216:217], v241 offset:0
    ds_read_b64_tr_b16 v[218:219], v241 offset:3072
    s_waitcnt lgkmcnt(8)
    v_mfma_f32_16x16x32_bf16 v[192:195], v[20:23], v[220:223], v[192:195]
    v_mfma_f32_16x16x32_bf16 v[196:199], v[92:95], v[220:223], v[196:199]
    ds_read_b64_tr_b16 v[220:221], v242 offset:0
    ds_read_b64_tr_b16 v[222:223], v242 offset:3072
    s_waitcnt lgkmcnt(8)
    v_mfma_f32_16x16x32_bf16 v[200:203], v[20:23], v[224:227], v[200:203]
    v_mfma_f32_16x16x32_bf16 v[204:207], v[92:95], v[224:227], v[204:207]
    ds_read_b64_tr_b16 v[224:225], v243 offset:0
    ds_read_b64_tr_b16 v[226:227], v243 offset:3072
    s_waitcnt lgkmcnt(8)
    v_mfma_f32_16x16x32_bf16 v[208:211], v[20:23], v[228:231], v[208:211]
    v_mfma_f32_16x16x32_bf16 v[212:215], v[92:95], v[228:231], v[212:215]
    ds_read_b64_tr_b16 v[228:229], v240 offset:128
    ds_read_b64_tr_b16 v[230:231], v240 offset:3200
    s_waitcnt vmcnt(3)
    s_barrier
    s_waitcnt lgkmcnt(8)
    v_mfma_f32_16x16x32_bf16 v[144:147], v[24:27], v[232:235], v[144:147]
    v_mfma_f32_16x16x32_bf16 v[148:151], v[96:99], v[232:235], v[148:151]
    ds_read_b64_tr_b16 v[232:233], v240 offset:12288
    ds_read_b64_tr_b16 v[234:235], v240 offset:15360
    s_add_u32 m0, s55, 24576
    s_mov_b32 s49, 996480
    buffer_load_dwordx4 v244, s[28:31], s49 offen lds
    s_waitcnt lgkmcnt(8)
    v_mfma_f32_16x16x32_bf16 v[152:155], v[24:27], v[216:219], v[152:155]
    v_mfma_f32_16x16x32_bf16 v[156:159], v[96:99], v[216:219], v[156:159]
    ds_read_b64_tr_b16 v[216:217], v241 offset:12288
    ds_read_b64_tr_b16 v[218:219], v241 offset:15360
    s_waitcnt lgkmcnt(8)
    v_mfma_f32_16x16x32_bf16 v[160:163], v[24:27], v[220:223], v[160:163]
    v_mfma_f32_16x16x32_bf16 v[164:167], v[96:99], v[220:223], v[164:167]
    ds_read_b64_tr_b16 v[220:221], v242 offset:12288
    ds_read_b64_tr_b16 v[222:223], v242 offset:15360
    s_add_u32 m0, s55, 25600
    s_mov_b32 s49, 996480
    buffer_load_dwordx4 v245, s[28:31], s49 offen lds
    s_waitcnt lgkmcnt(8)
    v_mfma_f32_16x16x32_bf16 v[168:171], v[24:27], v[224:227], v[168:171]
    v_mfma_f32_16x16x32_bf16 v[172:175], v[96:99], v[224:227], v[172:175]
    ds_read_b64_tr_b16 v[224:225], v243 offset:12288
    ds_read_b64_tr_b16 v[226:227], v243 offset:15360
    s_waitcnt lgkmcnt(8)
    v_mfma_f32_16x16x32_bf16 v[176:179], v[24:27], v[228:231], v[176:179]
    v_mfma_f32_16x16x32_bf16 v[180:183], v[96:99], v[228:231], v[180:183]
    ds_read_b64_tr_b16 v[228:229], v240 offset:24576
    ds_read_b64_tr_b16 v[230:231], v240 offset:27648
    s_add_u32 m0, s55, 26624
    s_mov_b32 s49, 996480
    buffer_load_dwordx4 v246, s[28:31], s49 offen lds
    s_waitcnt lgkmcnt(8)
    v_mfma_f32_16x16x32_bf16 v[184:187], v[24:27], v[232:235], v[184:187]
    v_mfma_f32_16x16x32_bf16 v[188:191], v[96:99], v[232:235], v[188:191]
    ds_read_b64_tr_b16 v[232:233], v241 offset:24576
    ds_read_b64_tr_b16 v[234:235], v241 offset:27648
    s_waitcnt lgkmcnt(8)
    v_mfma_f32_16x16x32_bf16 v[192:195], v[24:27], v[216:219], v[192:195]
    v_mfma_f32_16x16x32_bf16 v[196:199], v[96:99], v[216:219], v[196:199]
    ds_read_b64_tr_b16 v[216:217], v242 offset:24576
    ds_read_b64_tr_b16 v[218:219], v242 offset:27648
    s_waitcnt lgkmcnt(8)
    v_mfma_f32_16x16x32_bf16 v[200:203], v[24:27], v[220:223], v[200:203]
    v_mfma_f32_16x16x32_bf16 v[204:207], v[96:99], v[220:223], v[204:207]
    ds_read_b64_tr_b16 v[220:221], v243 offset:24576
    ds_read_b64_tr_b16 v[222:223], v243 offset:27648
    s_waitcnt lgkmcnt(8)
    v_mfma_f32_16x16x32_bf16 v[208:211], v[24:27], v[224:227], v[208:211]
    v_mfma_f32_16x16x32_bf16 v[212:215], v[96:99], v[224:227], v[212:215]
    ds_read_b64_tr_b16 v[224:225], v240 offset:24704
    ds_read_b64_tr_b16 v[226:227], v240 offset:27776
    s_waitcnt vmcnt(3)
    s_barrier
    s_waitcnt lgkmcnt(8)
    v_mfma_f32_16x16x32_bf16 v[144:147], v[28:31], v[228:231], v[144:147]
    v_mfma_f32_16x16x32_bf16 v[148:151], v[100:103], v[228:231], v[148:151]
    ds_read_b64_tr_b16 v[228:229], v240 offset:36864
    ds_read_b64_tr_b16 v[230:231], v240 offset:39936
    s_add_u32 m0, s55, 49152
    s_mov_b32 s49, 1107072
    buffer_load_dwordx4 v244, s[28:31], s49 offen lds
    s_waitcnt lgkmcnt(8)
    v_mfma_f32_16x16x32_bf16 v[152:155], v[28:31], v[232:235], v[152:155]
    v_mfma_f32_16x16x32_bf16 v[156:159], v[100:103], v[232:235], v[156:159]
    ds_read_b64_tr_b16 v[232:233], v241 offset:36864
    ds_read_b64_tr_b16 v[234:235], v241 offset:39936
    s_waitcnt lgkmcnt(8)
    v_mfma_f32_16x16x32_bf16 v[160:163], v[28:31], v[216:219], v[160:163]
    v_mfma_f32_16x16x32_bf16 v[164:167], v[100:103], v[216:219], v[164:167]
    ds_read_b64_tr_b16 v[216:217], v242 offset:36864
    ds_read_b64_tr_b16 v[218:219], v242 offset:39936
    s_add_u32 m0, s55, 50176
    s_mov_b32 s49, 1107072
    buffer_load_dwordx4 v245, s[28:31], s49 offen lds
    s_waitcnt lgkmcnt(8)
    v_mfma_f32_16x16x32_bf16 v[168:171], v[28:31], v[220:223], v[168:171]
    v_mfma_f32_16x16x32_bf16 v[172:175], v[100:103], v[220:223], v[172:175]
    ds_read_b64_tr_b16 v[220:221], v243 offset:36864
    ds_read_b64_tr_b16 v[222:223], v243 offset:39936
    s_waitcnt lgkmcnt(8)
    v_mfma_f32_16x16x32_bf16 v[176:179], v[28:31], v[224:227], v[176:179]
    v_mfma_f32_16x16x32_bf16 v[180:183], v[100:103], v[224:227], v[180:183]
    ds_read_b64_tr_b16 v[224:225], v236 offset:0
    ds_read_b64_tr_b16 v[226:227], v236 offset:3072
    s_add_u32 m0, s55, 51200
    s_mov_b32 s49, 1107072
    buffer_load_dwordx4 v246, s[28:31], s49 offen lds
    s_waitcnt lgkmcnt(8)
    v_mfma_f32_16x16x32_bf16 v[184:187], v[28:31], v[228:231], v[184:187]
    v_mfma_f32_16x16x32_bf16 v[188:191], v[100:103], v[228:231], v[188:191]
    ds_read_b64_tr_b16 v[228:229], v237 offset:0
    ds_read_b64_tr_b16 v[230:231], v237 offset:3072
    s_waitcnt lgkmcnt(8)
    v_mfma_f32_16x16x32_bf16 v[192:195], v[28:31], v[232:235], v[192:195]
    v_mfma_f32_16x16x32_bf16 v[196:199], v[100:103], v[232:235], v[196:199]
    ds_read_b64_tr_b16 v[232:233], v238 offset:0
    ds_read_b64_tr_b16 v[234:235], v238 offset:3072
    s_waitcnt lgkmcnt(8)
    v_mfma_f32_16x16x32_bf16 v[200:203], v[28:31], v[216:219], v[200:203]
    v_mfma_f32_16x16x32_bf16 v[204:207], v[100:103], v[216:219], v[204:207]
    ds_read_b64_tr_b16 v[216:217], v239 offset:0
    ds_read_b64_tr_b16 v[218:219], v239 offset:3072
    s_waitcnt lgkmcnt(8)
    v_mfma_f32_16x16x32_bf16 v[208:211], v[28:31], v[220:223], v[208:211]
    v_mfma_f32_16x16x32_bf16 v[212:215], v[100:103], v[220:223], v[212:215]
    ds_read_b64_tr_b16 v[220:221], v236 offset:128
    ds_read_b64_tr_b16 v[222:223], v236 offset:3200
    s_waitcnt vmcnt(3)
    s_barrier
    s_waitcnt lgkmcnt(8)
    v_mfma_f32_16x16x32_bf16 v[144:147], v[32:35], v[224:227], v[144:147]
    v_mfma_f32_16x16x32_bf16 v[148:151], v[104:107], v[224:227], v[148:151]
    ds_read_b64_tr_b16 v[224:225], v236 offset:12288
    ds_read_b64_tr_b16 v[226:227], v236 offset:15360
    s_add_u32 m0, s55, 73728
    s_mov_b32 s49, 1217664
    buffer_load_dwordx4 v244, s[28:31], s49 offen lds
    s_waitcnt lgkmcnt(8)
    v_mfma_f32_16x16x32_bf16 v[152:155], v[32:35], v[228:231], v[152:155]
    v_mfma_f32_16x16x32_bf16 v[156:159], v[104:107], v[228:231], v[156:159]
    ds_read_b64_tr_b16 v[228:229], v237 offset:12288
    ds_read_b64_tr_b16 v[230:231], v237 offset:15360
    s_waitcnt lgkmcnt(8)
    v_mfma_f32_16x16x32_bf16 v[160:163], v[32:35], v[232:235], v[160:163]
    v_mfma_f32_16x16x32_bf16 v[164:167], v[104:107], v[232:235], v[164:167]
    ds_read_b64_tr_b16 v[232:233], v238 offset:12288
    ds_read_b64_tr_b16 v[234:235], v238 offset:15360
    s_add_u32 m0, s55, 74752
    s_mov_b32 s49, 1217664
    buffer_load_dwordx4 v245, s[28:31], s49 offen lds
    s_waitcnt lgkmcnt(8)
    v_mfma_f32_16x16x32_bf16 v[168:171], v[32:35], v[216:219], v[168:171]
    v_mfma_f32_16x16x32_bf16 v[172:175], v[104:107], v[216:219], v[172:175]
    ds_read_b64_tr_b16 v[216:217], v239 offset:12288
    ds_read_b64_tr_b16 v[218:219], v239 offset:15360
    s_waitcnt lgkmcnt(8)
    v_mfma_f32_16x16x32_bf16 v[176:179], v[32:35], v[220:223], v[176:179]
    v_mfma_f32_16x16x32_bf16 v[180:183], v[104:107], v[220:223], v[180:183]
    ds_read_b64_tr_b16 v[220:221], v236 offset:24576
    ds_read_b64_tr_b16 v[222:223], v236 offset:27648
    s_add_u32 m0, s55, 75776
    s_mov_b32 s49, 1217664
    buffer_load_dwordx4 v246, s[28:31], s49 offen lds
    s_waitcnt lgkmcnt(8)
    v_mfma_f32_16x16x32_bf16 v[184:187], v[32:35], v[224:227], v[184:187]
    v_mfma_f32_16x16x32_bf16 v[188:191], v[104:107], v[224:227], v[188:191]
    ds_read_b64_tr_b16 v[224:225], v237 offset:24576
    ds_read_b64_tr_b16 v[226:227], v237 offset:27648
    s_waitcnt lgkmcnt(8)
    v_mfma_f32_16x16x32_bf16 v[192:195], v[32:35], v[228:231], v[192:195]
    v_mfma_f32_16x16x32_bf16 v[196:199], v[104:107], v[228:231], v[196:199]
    ds_read_b64_tr_b16 v[228:229], v238 offset:24576
    ds_read_b64_tr_b16 v[230:231], v238 offset:27648
    s_waitcnt lgkmcnt(8)
    v_mfma_f32_16x16x32_bf16 v[200:203], v[32:35], v[232:235], v[200:203]
    v_mfma_f32_16x16x32_bf16 v[204:207], v[104:107], v[232:235], v[204:207]
    ds_read_b64_tr_b16 v[232:233], v239 offset:24576
    ds_read_b64_tr_b16 v[234:235], v239 offset:27648
    s_waitcnt lgkmcnt(8)
    v_mfma_f32_16x16x32_bf16 v[208:211], v[32:35], v[216:219], v[208:211]
    v_mfma_f32_16x16x32_bf16 v[212:215], v[104:107], v[216:219], v[212:215]
    ds_read_b64_tr_b16 v[216:217], v236 offset:24704
    ds_read_b64_tr_b16 v[218:219], v236 offset:27776
    s_waitcnt vmcnt(3)
    s_barrier
    s_waitcnt lgkmcnt(8)
    v_mfma_f32_16x16x32_bf16 v[144:147], v[36:39], v[220:223], v[144:147]
    v_mfma_f32_16x16x32_bf16 v[148:151], v[108:111], v[220:223], v[148:151]
    ds_read_b64_tr_b16 v[220:221], v236 offset:36864
    ds_read_b64_tr_b16 v[222:223], v236 offset:39936
    s_add_u32 m0, s55, 0
    s_mov_b32 s49, 1328256
    buffer_load_dwordx4 v244, s[28:31], s49 offen lds
    s_waitcnt lgkmcnt(8)
    v_mfma_f32_16x16x32_bf16 v[152:155], v[36:39], v[224:227], v[152:155]
    v_mfma_f32_16x16x32_bf16 v[156:159], v[108:111], v[224:227], v[156:159]
    ds_read_b64_tr_b16 v[224:225], v237 offset:36864
    ds_read_b64_tr_b16 v[226:227], v237 offset:39936
    s_waitcnt lgkmcnt(8)
    v_mfma_f32_16x16x32_bf16 v[160:163], v[36:39], v[228:231], v[160:163]
    v_mfma_f32_16x16x32_bf16 v[164:167], v[108:111], v[228:231], v[164:167]
    ds_read_b64_tr_b16 v[228:229], v238 offset:36864
    ds_read_b64_tr_b16 v[230:231], v238 offset:39936
    s_add_u32 m0, s55, 1024
    s_mov_b32 s49, 1328256
    buffer_load_dwordx4 v245, s[28:31], s49 offen lds
    s_waitcnt lgkmcnt(8)
    v_mfma_f32_16x16x32_bf16 v[168:171], v[36:39], v[232:235], v[168:171]
    v_mfma_f32_16x16x32_bf16 v[172:175], v[108:111], v[232:235], v[172:175]
    ds_read_b64_tr_b16 v[232:233], v239 offset:36864
    ds_read_b64_tr_b16 v[234:235], v239 offset:39936
    s_waitcnt lgkmcnt(8)
    v_mfma_f32_16x16x32_bf16 v[176:179], v[36:39], v[216:219], v[176:179]
    v_mfma_f32_16x16x32_bf16 v[180:183], v[108:111], v[216:219], v[180:183]
    ds_read_b64_tr_b16 v[216:217], v240 offset:0
    ds_read_b64_tr_b16 v[218:219], v240 offset:3072
    s_add_u32 m0, s55, 2048
    s_mov_b32 s49, 1328256
    buffer_load_dwordx4 v246, s[28:31], s49 offen lds
    s_waitcnt lgkmcnt(8)
    v_mfma_f32_16x16x32_bf16 v[184:187], v[36:39], v[220:223], v[184:187]
    v_mfma_f32_16x16x32_bf16 v[188:191], v[108:111], v[220:223], v[188:191]
    ds_read_b64_tr_b16 v[220:221], v241 offset:0
    ds_read_b64_tr_b16 v[222:223], v241 offset:3072
    s_waitcnt lgkmcnt(8)
    v_mfma_f32_16x16x32_bf16 v[192:195], v[36:39], v[224:227], v[192:195]
    v_mfma_f32_16x16x32_bf16 v[196:199], v[108:111], v[224:227], v[196:199]
    ds_read_b64_tr_b16 v[224:225], v242 offset:0
    ds_read_b64_tr_b16 v[226:227], v242 offset:3072
    s_waitcnt lgkmcnt(8)
    v_mfma_f32_16x16x32_bf16 v[200:203], v[36:39], v[228:231], v[200:203]
    v_mfma_f32_16x16x32_bf16 v[204:207], v[108:111], v[228:231], v[204:207]
    ds_read_b64_tr_b16 v[228:229], v243 offset:0
    ds_read_b64_tr_b16 v[230:231], v243 offset:3072
    s_waitcnt lgkmcnt(8)
    v_mfma_f32_16x16x32_bf16 v[208:211], v[36:39], v[232:235], v[208:211]
    v_mfma_f32_16x16x32_bf16 v[212:215], v[108:111], v[232:235], v[212:215]
    ds_read_b64_tr_b16 v[232:233], v240 offset:128
    ds_read_b64_tr_b16 v[234:235], v240 offset:3200
    s_waitcnt vmcnt(3)
    s_barrier
    s_waitcnt lgkmcnt(8)
    v_mfma_f32_16x16x32_bf16 v[144:147], v[40:43], v[216:219], v[144:147]
    v_mfma_f32_16x16x32_bf16 v[148:151], v[112:115], v[216:219], v[148:151]
    ds_read_b64_tr_b16 v[216:217], v240 offset:12288
    ds_read_b64_tr_b16 v[218:219], v240 offset:15360
    s_add_u32 m0, s55, 24576
    s_mov_b32 s49, 1438848
    buffer_load_dwordx4 v244, s[28:31], s49 offen lds
    s_waitcnt lgkmcnt(8)
    v_mfma_f32_16x16x32_bf16 v[152:155], v[40:43], v[220:223], v[152:155]
    v_mfma_f32_16x16x32_bf16 v[156:159], v[112:115], v[220:223], v[156:159]
    ds_read_b64_tr_b16 v[220:221], v241 offset:12288
    ds_read_b64_tr_b16 v[222:223], v241 offset:15360
    s_waitcnt lgkmcnt(8)
    v_mfma_f32_16x16x32_bf16 v[160:163], v[40:43], v[224:227], v[160:163]
    v_mfma_f32_16x16x32_bf16 v[164:167], v[112:115], v[224:227], v[164:167]
    ds_read_b64_tr_b16 v[224:225], v242 offset:12288
    ds_read_b64_tr_b16 v[226:227], v242 offset:15360
    s_add_u32 m0, s55, 25600
    s_mov_b32 s49, 1438848
    buffer_load_dwordx4 v245, s[28:31], s49 offen lds
    s_waitcnt lgkmcnt(8)
    v_mfma_f32_16x16x32_bf16 v[168:171], v[40:43], v[228:231], v[168:171]
    v_mfma_f32_16x16x32_bf16 v[172:175], v[112:115], v[228:231], v[172:175]
    ds_read_b64_tr_b16 v[228:229], v243 offset:12288
    ds_read_b64_tr_b16 v[230:231], v243 offset:15360
    s_waitcnt lgkmcnt(8)
    v_mfma_f32_16x16x32_bf16 v[176:179], v[40:43], v[232:235], v[176:179]
    v_mfma_f32_16x16x32_bf16 v[180:183], v[112:115], v[232:235], v[180:183]
    ds_read_b64_tr_b16 v[232:233], v240 offset:24576
    ds_read_b64_tr_b16 v[234:235], v240 offset:27648
    s_add_u32 m0, s55, 26624
    s_mov_b32 s49, 1438848
    buffer_load_dwordx4 v246, s[28:31], s49 offen lds
    s_waitcnt lgkmcnt(8)
    v_mfma_f32_16x16x32_bf16 v[184:187], v[40:43], v[216:219], v[184:187]
    v_mfma_f32_16x16x32_bf16 v[188:191], v[112:115], v[216:219], v[188:191]
    ds_read_b64_tr_b16 v[216:217], v241 offset:24576
    ds_read_b64_tr_b16 v[218:219], v241 offset:27648
    s_waitcnt lgkmcnt(8)
    v_mfma_f32_16x16x32_bf16 v[192:195], v[40:43], v[220:223], v[192:195]
    v_mfma_f32_16x16x32_bf16 v[196:199], v[112:115], v[220:223], v[196:199]
    ds_read_b64_tr_b16 v[220:221], v242 offset:24576
    ds_read_b64_tr_b16 v[222:223], v242 offset:27648
    s_waitcnt lgkmcnt(8)
    v_mfma_f32_16x16x32_bf16 v[200:203], v[40:43], v[224:227], v[200:203]
    v_mfma_f32_16x16x32_bf16 v[204:207], v[112:115], v[224:227], v[204:207]
    ds_read_b64_tr_b16 v[224:225], v243 offset:24576
    ds_read_b64_tr_b16 v[226:227], v243 offset:27648
    s_waitcnt lgkmcnt(8)
    v_mfma_f32_16x16x32_bf16 v[208:211], v[40:43], v[228:231], v[208:211]
    v_mfma_f32_16x16x32_bf16 v[212:215], v[112:115], v[228:231], v[212:215]
    ds_read_b64_tr_b16 v[228:229], v240 offset:24704
    ds_read_b64_tr_b16 v[230:231], v240 offset:27776
    s_waitcnt vmcnt(3)
    s_barrier
    s_waitcnt lgkmcnt(8)
    v_mfma_f32_16x16x32_bf16 v[144:147], v[44:47], v[232:235], v[144:147]
    v_mfma_f32_16x16x32_bf16 v[148:151], v[116:119], v[232:235], v[148:151]
    ds_read_b64_tr_b16 v[232:233], v240 offset:36864
    ds_read_b64_tr_b16 v[234:235], v240 offset:39936
    s_add_u32 m0, s55, 49152
    s_mov_b32 s49, 1549440
    buffer_load_dwordx4 v244, s[28:31], s49 offen lds
    s_waitcnt lgkmcnt(8)
    v_mfma_f32_16x16x32_bf16 v[152:155], v[44:47], v[216:219], v[152:155]
    v_mfma_f32_16x16x32_bf16 v[156:159], v[116:119], v[216:219], v[156:159]
    ds_read_b64_tr_b16 v[216:217], v241 offset:36864
    ds_read_b64_tr_b16 v[218:219], v241 offset:39936
    s_waitcnt lgkmcnt(8)
    v_mfma_f32_16x16x32_bf16 v[160:163], v[44:47], v[220:223], v[160:163]
    v_mfma_f32_16x16x32_bf16 v[164:167], v[116:119], v[220:223], v[164:167]
    ds_read_b64_tr_b16 v[220:221], v242 offset:36864
    ds_read_b64_tr_b16 v[222:223], v242 offset:39936
    s_add_u32 m0, s55, 50176
    s_mov_b32 s49, 1549440
    buffer_load_dwordx4 v245, s[28:31], s49 offen lds
    s_waitcnt lgkmcnt(8)
    v_mfma_f32_16x16x32_bf16 v[168:171], v[44:47], v[224:227], v[168:171]
    v_mfma_f32_16x16x32_bf16 v[172:175], v[116:119], v[224:227], v[172:175]
    ds_read_b64_tr_b16 v[224:225], v243 offset:36864
    ds_read_b64_tr_b16 v[226:227], v243 offset:39936
    s_waitcnt lgkmcnt(8)
    v_mfma_f32_16x16x32_bf16 v[176:179], v[44:47], v[228:231], v[176:179]
    v_mfma_f32_16x16x32_bf16 v[180:183], v[116:119], v[228:231], v[180:183]
    ds_read_b64_tr_b16 v[228:229], v236 offset:0
    ds_read_b64_tr_b16 v[230:231], v236 offset:3072
    s_add_u32 m0, s55, 51200
    s_mov_b32 s49, 1549440
    buffer_load_dwordx4 v246, s[28:31], s49 offen lds
    s_waitcnt lgkmcnt(8)
    v_mfma_f32_16x16x32_bf16 v[184:187], v[44:47], v[232:235], v[184:187]
    v_mfma_f32_16x16x32_bf16 v[188:191], v[116:119], v[232:235], v[188:191]
    ds_read_b64_tr_b16 v[232:233], v237 offset:0
    ds_read_b64_tr_b16 v[234:235], v237 offset:3072
    s_waitcnt lgkmcnt(8)
    v_mfma_f32_16x16x32_bf16 v[192:195], v[44:47], v[216:219], v[192:195]
    v_mfma_f32_16x16x32_bf16 v[196:199], v[116:119], v[216:219], v[196:199]
    ds_read_b64_tr_b16 v[216:217], v238 offset:0
    ds_read_b64_tr_b16 v[218:219], v238 offset:3072
    s_waitcnt lgkmcnt(8)
    v_mfma_f32_16x16x32_bf16 v[200:203], v[44:47], v[220:223], v[200:203]
    v_mfma_f32_16x16x32_bf16 v[204:207], v[116:119], v[220:223], v[204:207]
    ds_read_b64_tr_b16 v[220:221], v239 offset:0
    ds_read_b64_tr_b16 v[222:223], v239 offset:3072
    s_waitcnt lgkmcnt(8)
    v_mfma_f32_16x16x32_bf16 v[208:211], v[44:47], v[224:227], v[208:211]
    v_mfma_f32_16x16x32_bf16 v[212:215], v[116:119], v[224:227], v[212:215]
    ds_read_b64_tr_b16 v[224:225], v236 offset:128
    ds_read_b64_tr_b16 v[226:227], v236 offset:3200
    s_waitcnt vmcnt(3)
    s_barrier
    s_waitcnt lgkmcnt(8)
    v_mfma_f32_16x16x32_bf16 v[144:147], v[48:51], v[228:231], v[144:147]
    v_mfma_f32_16x16x32_bf16 v[148:151], v[120:123], v[228:231], v[148:151]
    ds_read_b64_tr_b16 v[228:229], v236 offset:12288
    ds_read_b64_tr_b16 v[230:231], v236 offset:15360
    s_add_u32 m0, s55, 73728
    s_mov_b32 s49, 1660032
    buffer_load_dwordx4 v244, s[28:31], s49 offen lds
    s_waitcnt lgkmcnt(8)
    v_mfma_f32_16x16x32_bf16 v[152:155], v[48:51], v[232:235], v[152:155]
    v_mfma_f32_16x16x32_bf16 v[156:159], v[120:123], v[232:235], v[156:159]
    ds_read_b64_tr_b16 v[232:233], v237 offset:12288
    ds_read_b64_tr_b16 v[234:235], v237 offset:15360
    s_waitcnt lgkmcnt(8)
    v_mfma_f32_16x16x32_bf16 v[160:163], v[48:51], v[216:219], v[160:163]
    v_mfma_f32_16x16x32_bf16 v[164:167], v[120:123], v[216:219], v[164:167]
    ds_read_b64_tr_b16 v[216:217], v238 offset:12288
    ds_read_b64_tr_b16 v[218:219], v238 offset:15360
    s_add_u32 m0, s55, 74752
    s_mov_b32 s49, 1660032
    buffer_load_dwordx4 v245, s[28:31], s49 offen lds
    s_waitcnt lgkmcnt(8)
    v_mfma_f32_16x16x32_bf16 v[168:171], v[48:51], v[220:223], v[168:171]
    v_mfma_f32_16x16x32_bf16 v[172:175], v[120:123], v[220:223], v[172:175]
    ds_read_b64_tr_b16 v[220:221], v239 offset:12288
    ds_read_b64_tr_b16 v[222:223], v239 offset:15360
    s_waitcnt lgkmcnt(8)
    v_mfma_f32_16x16x32_bf16 v[176:179], v[48:51], v[224:227], v[176:179]
    v_mfma_f32_16x16x32_bf16 v[180:183], v[120:123], v[224:227], v[180:183]
    ds_read_b64_tr_b16 v[224:225], v236 offset:24576
    ds_read_b64_tr_b16 v[226:227], v236 offset:27648
    s_add_u32 m0, s55, 75776
    s_mov_b32 s49, 1660032
    buffer_load_dwordx4 v246, s[28:31], s49 offen lds
    s_waitcnt lgkmcnt(8)
    v_mfma_f32_16x16x32_bf16 v[184:187], v[48:51], v[228:231], v[184:187]
    v_mfma_f32_16x16x32_bf16 v[188:191], v[120:123], v[228:231], v[188:191]
    ds_read_b64_tr_b16 v[228:229], v237 offset:24576
    ds_read_b64_tr_b16 v[230:231], v237 offset:27648
    s_waitcnt lgkmcnt(8)
    v_mfma_f32_16x16x32_bf16 v[192:195], v[48:51], v[232:235], v[192:195]
    v_mfma_f32_16x16x32_bf16 v[196:199], v[120:123], v[232:235], v[196:199]
    ds_read_b64_tr_b16 v[232:233], v238 offset:24576
    ds_read_b64_tr_b16 v[234:235], v238 offset:27648
    s_waitcnt lgkmcnt(8)
    v_mfma_f32_16x16x32_bf16 v[200:203], v[48:51], v[216:219], v[200:203]
    v_mfma_f32_16x16x32_bf16 v[204:207], v[120:123], v[216:219], v[204:207]
    ds_read_b64_tr_b16 v[216:217], v239 offset:24576
    ds_read_b64_tr_b16 v[218:219], v239 offset:27648
    s_waitcnt lgkmcnt(8)
    v_mfma_f32_16x16x32_bf16 v[208:211], v[48:51], v[220:223], v[208:211]
    v_mfma_f32_16x16x32_bf16 v[212:215], v[120:123], v[220:223], v[212:215]
    ds_read_b64_tr_b16 v[220:221], v236 offset:24704
    ds_read_b64_tr_b16 v[222:223], v236 offset:27776
    s_waitcnt vmcnt(3)
    s_barrier
    s_waitcnt lgkmcnt(8)
    v_mfma_f32_16x16x32_bf16 v[144:147], v[52:55], v[224:227], v[144:147]
    v_mfma_f32_16x16x32_bf16 v[148:151], v[124:127], v[224:227], v[148:151]
    ds_read_b64_tr_b16 v[224:225], v236 offset:36864
    ds_read_b64_tr_b16 v[226:227], v236 offset:39936
    s_add_u32 m0, s55, 0
    s_mov_b32 s49, 1770624
    buffer_load_dwordx4 v244, s[28:31], s49 offen lds
    s_waitcnt lgkmcnt(8)
    v_mfma_f32_16x16x32_bf16 v[152:155], v[52:55], v[228:231], v[152:155]
    v_mfma_f32_16x16x32_bf16 v[156:159], v[124:127], v[228:231], v[156:159]
    ds_read_b64_tr_b16 v[228:229], v237 offset:36864
    ds_read_b64_tr_b16 v[230:231], v237 offset:39936
    s_waitcnt lgkmcnt(8)
    v_mfma_f32_16x16x32_bf16 v[160:163], v[52:55], v[232:235], v[160:163]
    v_mfma_f32_16x16x32_bf16 v[164:167], v[124:127], v[232:235], v[164:167]
    ds_read_b64_tr_b16 v[232:233], v238 offset:36864
    ds_read_b64_tr_b16 v[234:235], v238 offset:39936
    s_add_u32 m0, s55, 1024
    s_mov_b32 s49, 1770624
    buffer_load_dwordx4 v245, s[28:31], s49 offen lds
    s_waitcnt lgkmcnt(8)
    v_mfma_f32_16x16x32_bf16 v[168:171], v[52:55], v[216:219], v[168:171]
    v_mfma_f32_16x16x32_bf16 v[172:175], v[124:127], v[216:219], v[172:175]
    ds_read_b64_tr_b16 v[216:217], v239 offset:36864
    ds_read_b64_tr_b16 v[218:219], v239 offset:39936
    s_waitcnt lgkmcnt(8)
    v_mfma_f32_16x16x32_bf16 v[176:179], v[52:55], v[220:223], v[176:179]
    v_mfma_f32_16x16x32_bf16 v[180:183], v[124:127], v[220:223], v[180:183]
    ds_read_b64_tr_b16 v[220:221], v240 offset:0
    ds_read_b64_tr_b16 v[222:223], v240 offset:3072
    s_add_u32 m0, s55, 2048
    s_mov_b32 s49, 1770624
    buffer_load_dwordx4 v246, s[28:31], s49 offen lds
    s_waitcnt lgkmcnt(8)
    v_mfma_f32_16x16x32_bf16 v[184:187], v[52:55], v[224:227], v[184:187]
    v_mfma_f32_16x16x32_bf16 v[188:191], v[124:127], v[224:227], v[188:191]
    ds_read_b64_tr_b16 v[224:225], v241 offset:0
    ds_read_b64_tr_b16 v[226:227], v241 offset:3072
    s_waitcnt lgkmcnt(8)
    v_mfma_f32_16x16x32_bf16 v[192:195], v[52:55], v[228:231], v[192:195]
    v_mfma_f32_16x16x32_bf16 v[196:199], v[124:127], v[228:231], v[196:199]
    ds_read_b64_tr_b16 v[228:229], v242 offset:0
    ds_read_b64_tr_b16 v[230:231], v242 offset:3072
    s_waitcnt lgkmcnt(8)
    v_mfma_f32_16x16x32_bf16 v[200:203], v[52:55], v[232:235], v[200:203]
    v_mfma_f32_16x16x32_bf16 v[204:207], v[124:127], v[232:235], v[204:207]
    ds_read_b64_tr_b16 v[232:233], v243 offset:0
    ds_read_b64_tr_b16 v[234:235], v243 offset:3072
    s_waitcnt lgkmcnt(8)
    v_mfma_f32_16x16x32_bf16 v[208:211], v[52:55], v[216:219], v[208:211]
    v_mfma_f32_16x16x32_bf16 v[212:215], v[124:127], v[216:219], v[212:215]
    ds_read_b64_tr_b16 v[216:217], v240 offset:128
    ds_read_b64_tr_b16 v[218:219], v240 offset:3200
    s_waitcnt vmcnt(3)
    s_barrier
    s_waitcnt lgkmcnt(8)
    v_mfma_f32_16x16x32_bf16 v[144:147], v[56:59], v[220:223], v[144:147]
    v_mfma_f32_16x16x32_bf16 v[148:151], v[128:131], v[220:223], v[148:151]
    ds_read_b64_tr_b16 v[220:221], v240 offset:12288
    ds_read_b64_tr_b16 v[222:223], v240 offset:15360
    s_add_u32 m0, s55, 24576
    s_mov_b32 s49, 1881216
    buffer_load_dwordx4 v244, s[28:31], s49 offen lds
    s_waitcnt lgkmcnt(8)
    v_mfma_f32_16x16x32_bf16 v[152:155], v[56:59], v[224:227], v[152:155]
    v_mfma_f32_16x16x32_bf16 v[156:159], v[128:131], v[224:227], v[156:159]
    ds_read_b64_tr_b16 v[224:225], v241 offset:12288
    ds_read_b64_tr_b16 v[226:227], v241 offset:15360
    s_waitcnt lgkmcnt(8)
    v_mfma_f32_16x16x32_bf16 v[160:163], v[56:59], v[228:231], v[160:163]
    v_mfma_f32_16x16x32_bf16 v[164:167], v[128:131], v[228:231], v[164:167]
    ds_read_b64_tr_b16 v[228:229], v242 offset:12288
    ds_read_b64_tr_b16 v[230:231], v242 offset:15360
    s_add_u32 m0, s55, 25600
    s_mov_b32 s49, 1881216
    buffer_load_dwordx4 v245, s[28:31], s49 offen lds
    s_waitcnt lgkmcnt(8)
    v_mfma_f32_16x16x32_bf16 v[168:171], v[56:59], v[232:235], v[168:171]
    v_mfma_f32_16x16x32_bf16 v[172:175], v[128:131], v[232:235], v[172:175]
    ds_read_b64_tr_b16 v[232:233], v243 offset:12288
    ds_read_b64_tr_b16 v[234:235], v243 offset:15360
    s_waitcnt lgkmcnt(8)
    v_mfma_f32_16x16x32_bf16 v[176:179], v[56:59], v[216:219], v[176:179]
    v_mfma_f32_16x16x32_bf16 v[180:183], v[128:131], v[216:219], v[180:183]
    ds_read_b64_tr_b16 v[216:217], v240 offset:24576
    ds_read_b64_tr_b16 v[218:219], v240 offset:27648
    s_add_u32 m0, s55, 26624
    s_mov_b32 s49, 1881216
    buffer_load_dwordx4 v246, s[28:31], s49 offen lds
    s_waitcnt lgkmcnt(8)
    v_mfma_f32_16x16x32_bf16 v[184:187], v[56:59], v[220:223], v[184:187]
    v_mfma_f32_16x16x32_bf16 v[188:191], v[128:131], v[220:223], v[188:191]
    ds_read_b64_tr_b16 v[220:221], v241 offset:24576
    ds_read_b64_tr_b16 v[222:223], v241 offset:27648
    s_waitcnt lgkmcnt(8)
    v_mfma_f32_16x16x32_bf16 v[192:195], v[56:59], v[224:227], v[192:195]
    v_mfma_f32_16x16x32_bf16 v[196:199], v[128:131], v[224:227], v[196:199]
    ds_read_b64_tr_b16 v[224:225], v242 offset:24576
    ds_read_b64_tr_b16 v[226:227], v242 offset:27648
    s_lshl_b32 s46, s43, 2
    s_add_u32 s46, s46, 64
    v_mov_b32 v255, s46
    buffer_load_dword v254, v255, s[16:19], 0 offen sc1
    s_waitcnt lgkmcnt(8)
    v_mfma_f32_16x16x32_bf16 v[200:203], v[56:59], v[228:231], v[200:203]
    v_mfma_f32_16x16x32_bf16 v[204:207], v[128:131], v[228:231], v[204:207]
    ds_read_b64_tr_b16 v[228:229], v243 offset:24576
    ds_read_b64_tr_b16 v[230:231], v243 offset:27648
    s_waitcnt lgkmcnt(8)
    v_mfma_f32_16x16x32_bf16 v[208:211], v[56:59], v[232:235], v[208:211]
    v_mfma_f32_16x16x32_bf16 v[212:215], v[128:131], v[232:235], v[212:215]
    ds_read_b64_tr_b16 v[232:233], v240 offset:24704
    ds_read_b64_tr_b16 v[234:235], v240 offset:27776
    s_waitcnt vmcnt(4)
    s_barrier
    s_waitcnt lgkmcnt(8)
    v_mfma_f32_16x16x32_bf16 v[144:147], v[60:63], v[216:219], v[144:147]
    v_mfma_f32_16x16x32_bf16 v[148:151], v[132:135], v[216:219], v[148:151]
    ds_read_b64_tr_b16 v[216:217], v240 offset:36864
    ds_read_b64_tr_b16 v[218:219], v240 offset:39936
    s_add_u32 m0, s55, 49152
    s_mov_b32 s49, 0
    buffer_load_dwordx4 v244, s[28:31], s49 offen lds
    s_waitcnt lgkmcnt(8)
    v_mfma_f32_16x16x32_bf16 v[152:155], v[60:63], v[220:223], v[152:155]
    v_mfma_f32_16x16x32_bf16 v[156:159], v[132:135], v[220:223], v[156:159]
    ds_read_b64_tr_b16 v[220:221], v241 offset:36864
    ds_read_b64_tr_b16 v[222:223], v241 offset:39936
    s_waitcnt lgkmcnt(8)
    v_mfma_f32_16x16x32_bf16 v[160:163], v[60:63], v[224:227], v[160:163]
    v_mfma_f32_16x16x32_bf16 v[164:167], v[132:135], v[224:227], v[164:167]
    ds_read_b64_tr_b16 v[224:225], v242 offset:36864
    ds_read_b64_tr_b16 v[226:227], v242 offset:39936
    s_add_u32 m0, s55, 50176
    s_mov_b32 s49, 0
    buffer_load_dwordx4 v245, s[28:31], s49 offen lds
    s_waitcnt lgkmcnt(8)
    v_mfma_f32_16x16x32_bf16 v[168:171], v[60:63], v[228:231], v[168:171]
    v_mfma_f32_16x16x32_bf16 v[172:175], v[132:135], v[228:231], v[172:175]
    ds_read_b64_tr_b16 v[228:229], v243 offset:36864
    ds_read_b64_tr_b16 v[230:231], v243 offset:39936
    s_waitcnt lgkmcnt(8)
    v_mfma_f32_16x16x32_bf16 v[176:179], v[60:63], v[232:235], v[176:179]
    v_mfma_f32_16x16x32_bf16 v[180:183], v[132:135], v[232:235], v[180:183]
    ds_read_b64_tr_b16 v[232:233], v236 offset:0
    ds_read_b64_tr_b16 v[234:235], v236 offset:3072
    s_add_u32 m0, s55, 51200
    s_mov_b32 s49, 0
    buffer_load_dwordx4 v246, s[28:31], s49 offen lds
    s_waitcnt lgkmcnt(8)
    v_mfma_f32_16x16x32_bf16 v[184:187], v[60:63], v[216:219], v[184:187]
    v_mfma_f32_16x16x32_bf16 v[188:191], v[132:135], v[216:219], v[188:191]
    ds_read_b64_tr_b16 v[216:217], v237 offset:0
    ds_read_b64_tr_b16 v[218:219], v237 offset:3072
    s_waitcnt lgkmcnt(8)
    v_mfma_f32_16x16x32_bf16 v[192:195], v[60:63], v[220:223], v[192:195]
    v_mfma_f32_16x16x32_bf16 v[196:199], v[132:135], v[220:223], v[196:199]
    ds_read_b64_tr_b16 v[220:221], v238 offset:0
    ds_read_b64_tr_b16 v[222:223], v238 offset:3072
    s_waitcnt lgkmcnt(8)
    v_mfma_f32_16x16x32_bf16 v[200:203], v[60:63], v[224:227], v[200:203]
    v_mfma_f32_16x16x32_bf16 v[204:207], v[132:135], v[224:227], v[204:207]
    ds_read_b64_tr_b16 v[224:225], v239 offset:0
    ds_read_b64_tr_b16 v[226:227], v239 offset:3072
    s_waitcnt lgkmcnt(8)
    v_mfma_f32_16x16x32_bf16 v[208:211], v[60:63], v[228:231], v[208:211]
    v_mfma_f32_16x16x32_bf16 v[212:215], v[132:135], v[228:231], v[212:215]
    ds_read_b64_tr_b16 v[228:229], v236 offset:128
    ds_read_b64_tr_b16 v[230:231], v236 offset:3200
    s_waitcnt vmcnt(4)
    s_barrier
    s_waitcnt lgkmcnt(8)
    v_mfma_f32_16x16x32_bf16 v[144:147], v[64:67], v[232:235], v[144:147]
    v_mfma_f32_16x16x32_bf16 v[148:151], v[136:139], v[232:235], v[148:151]
    ds_read_b64_tr_b16 v[232:233], v236 offset:12288
    ds_read_b64_tr_b16 v[234:235], v236 offset:15360
    s_waitcnt lgkmcnt(8)
    v_mfma_f32_16x16x32_bf16 v[152:155], v[64:67], v[216:219], v[152:155]
    v_mfma_f32_16x16x32_bf16 v[156:159], v[136:139], v[216:219], v[156:159]
    ds_read_b64_tr_b16 v[216:217], v237 offset:12288
    ds_read_b64_tr_b16 v[218:219], v237 offset:15360
    s_waitcnt lgkmcnt(8)
    v_mfma_f32_16x16x32_bf16 v[160:163], v[64:67], v[220:223], v[160:163]
    v_mfma_f32_16x16x32_bf16 v[164:167], v[136:139], v[220:223], v[164:167]
    ds_read_b64_tr_b16 v[220:221], v238 offset:12288
    ds_read_b64_tr_b16 v[222:223], v238 offset:15360
    s_waitcnt lgkmcnt(8)
    v_mfma_f32_16x16x32_bf16 v[168:171], v[64:67], v[224:227], v[168:171]
    v_mfma_f32_16x16x32_bf16 v[172:175], v[136:139], v[224:227], v[172:175]
    ds_read_b64_tr_b16 v[224:225], v239 offset:12288
    ds_read_b64_tr_b16 v[226:227], v239 offset:15360
    s_waitcnt lgkmcnt(8)
    v_mfma_f32_16x16x32_bf16 v[176:179], v[64:67], v[228:231], v[176:179]
    v_mfma_f32_16x16x32_bf16 v[180:183], v[136:139], v[228:231], v[180:183]
    ds_read_b64_tr_b16 v[228:229], v236 offset:24576
    ds_read_b64_tr_b16 v[230:231], v236 offset:27648
    s_waitcnt lgkmcnt(8)
    v_mfma_f32_16x16x32_bf16 v[184:187], v[64:67], v[232:235], v[184:187]
    v_mfma_f32_16x16x32_bf16 v[188:191], v[136:139], v[232:235], v[188:191]
    ds_read_b64_tr_b16 v[232:233], v237 offset:24576
    ds_read_b64_tr_b16 v[234:235], v237 offset:27648
    s_waitcnt lgkmcnt(8)
    v_mfma_f32_16x16x32_bf16 v[192:195], v[64:67], v[216:219], v[192:195]
    v_mfma_f32_16x16x32_bf16 v[196:199], v[136:139], v[216:219], v[196:199]
    ds_read_b64_tr_b16 v[216:217], v238 offset:24576
    ds_read_b64_tr_b16 v[218:219], v238 offset:27648
    s_waitcnt lgkmcnt(8)
    v_mfma_f32_16x16x32_bf16 v[200:203], v[64:67], v[220:223], v[200:203]
    v_mfma_f32_16x16x32_bf16 v[204:207], v[136:139], v[220:223], v[204:207]
    ds_read_b64_tr_b16 v[220:221], v239 offset:24576
    ds_read_b64_tr_b16 v[222:223], v239 offset:27648
    s_waitcnt lgkmcnt(8)
    v_mfma_f32_16x16x32_bf16 v[208:211], v[64:67], v[224:227], v[208:211]
    v_mfma_f32_16x16x32_bf16 v[212:215], v[136:139], v[224:227], v[212:215]
    ds_read_b64_tr_b16 v[224:225], v236 offset:24704
    ds_read_b64_tr_b16 v[226:227], v236 offset:27776
    s_waitcnt vmcnt(0)
    s_barrier
    s_waitcnt lgkmcnt(8)
    v_mfma_f32_16x16x32_bf16 v[144:147], v[68:71], v[228:231], v[144:147]
    v_mfma_f32_16x16x32_bf16 v[148:151], v[140:143], v[228:231], v[148:151]
    ds_read_b64_tr_b16 v[228:229], v236 offset:36864
    ds_read_b64_tr_b16 v[230:231], v236 offset:39936
    s_add_u32 m0, s55, 0
    s_mov_b32 s49, 442368
    buffer_load_dwordx4 v244, s[28:31], s49 offen lds
    s_waitcnt lgkmcnt(8)
    v_mfma_f32_16x16x32_bf16 v[152:155], v[68:71], v[232:235], v[152:155]
    v_mfma_f32_16x16x32_bf16 v[156:159], v[140:143], v[232:235], v[156:159]
    ds_read_b64_tr_b16 v[232:233], v237 offset:36864
    ds_read_b64_tr_b16 v[234:235], v237 offset:39936
    s_waitcnt lgkmcnt(8)
    v_mfma_f32_16x16x32_bf16 v[160:163], v[68:71], v[216:219], v[160:163]
    v_mfma_f32_16x16x32_bf16 v[164:167], v[140:143], v[216:219], v[164:167]
    ds_read_b64_tr_b16 v[216:217], v238 offset:36864
    ds_read_b64_tr_b16 v[218:219], v238 offset:39936
    s_add_u32 m0, s55, 1024
    s_mov_b32 s49, 442368
    buffer_load_dwordx4 v245, s[28:31], s49 offen lds
    s_waitcnt lgkmcnt(8)
    v_mfma_f32_16x16x32_bf16 v[168:171], v[68:71], v[220:223], v[168:171]
    v_mfma_f32_16x16x32_bf16 v[172:175], v[140:143], v[220:223], v[172:175]
    ds_read_b64_tr_b16 v[220:221], v239 offset:36864
    ds_read_b64_tr_b16 v[222:223], v239 offset:39936
    s_waitcnt lgkmcnt(8)
    v_mfma_f32_16x16x32_bf16 v[176:179], v[68:71], v[224:227], v[176:179]
    v_mfma_f32_16x16x32_bf16 v[180:183], v[140:143], v[224:227], v[180:183]
    s_add_u32 m0, s55, 2048
    s_mov_b32 s49, 442368
    buffer_load_dwordx4 v246, s[28:31], s49 offen lds
    s_waitcnt lgkmcnt(6)
    v_mfma_f32_16x16x32_bf16 v[184:187], v[68:71], v[228:231], v[184:187]
    v_mfma_f32_16x16x32_bf16 v[188:191], v[140:143], v[228:231], v[188:191]
    s_waitcnt lgkmcnt(4)
    v_mfma_f32_16x16x32_bf16 v[192:195], v[68:71], v[232:235], v[192:195]
    v_mfma_f32_16x16x32_bf16 v[196:199], v[140:143], v[232:235], v[196:199]
    s_waitcnt lgkmcnt(2)
    v_mfma_f32_16x16x32_bf16 v[200:203], v[68:71], v[216:219], v[200:203]
    v_mfma_f32_16x16x32_bf16 v[204:207], v[140:143], v[216:219], v[204:207]
    s_waitcnt lgkmcnt(0)
    v_mfma_f32_16x16x32_bf16 v[208:211], v[68:71], v[220:223], v[208:211]
    v_mfma_f32_16x16x32_bf16 v[212:215], v[140:143], v[220:223], v[212:215]
    v_lshrrev_b32 v248, 4, v247
    v_lshlrev_b32 v248, 4, v248
    s_lshl_b32 s46, s41, 7
    s_add_u32 s46, s46, 163328
    v_add_u32 v248, s46, v248
    ds_read_b128 v[216:219], v248
    ds_read_b128 v[220:223], v248 offset:64
    s_mov_b32 s47, 0
L_poll_1:
    v_readfirstlane_b32 s46, v254
    s_add_u32 s47, s47, 1
    s_nop 2
    s_cmp_ge_u32 s46, 1
    s_cbranch_scc1 L_pollok_2
    s_cmp_ge_u32 s47, 50000
    s_cbranch_scc1 L_pollok_2
    s_sleep 2
    buffer_load_dword v254, v255, s[16:19], 0 offen sc1
    s_waitcnt vmcnt(0)
    s_branch L_poll_1
L_pollok_2:
    s_waitcnt lgkmcnt(0)
    v_mul_f32 v224, s51, v216
    v_mul_f32 v225, s51, v217
    v_mul_f32 v226, s51, v218
    v_mul_f32 v227, s51, v219
    v_mul_f32 v228, s51, v220
    v_mul_f32 v229, s51, v221
    v_mul_f32 v230, s51, v222
    v_mul_f32 v231, s51, v223
    v_mul_f32 v232, v144, v224
    v_mul_f32 v233, v145, v225
    v_mul_f32 v234, v146, v226
    v_mul_f32 v235, v147, v227
    v_mul_f32 v249, v148, v228
    v_mul_f32 v250, v149, v229
    v_mul_f32 v251, v150, v230
    v_mul_f32 v255, v151, v231
    v_min_f32 v232, 0, v232
    v_min_f32 v233, 0, v233
    v_min_f32 v234, 0, v234
    v_min_f32 v235, 0, v235
    v_min_f32 v249, 0, v249
    v_min_f32 v250, 0, v250
    v_min_f32 v251, 0, v251
    v_min_f32 v255, 0, v255
    v_exp_f32 v232, v232
    v_exp_f32 v233, v233
    v_exp_f32 v234, v234
    v_exp_f32 v235, v235
    v_exp_f32 v249, v249
    v_exp_f32 v250, v250
    v_exp_f32 v251, v251
    v_exp_f32 v255, v255
    v_max_f32 v144, 0, v144
    v_max_f32 v145, 0, v145
    v_max_f32 v146, 0, v146
    v_max_f32 v147, 0, v147
    v_max_f32 v148, 0, v148
    v_max_f32 v149, 0, v149
    v_max_f32 v150, 0, v150
    v_max_f32 v151, 0, v151
    v_add_f32 v232, 0x358637bd, v232
    v_add_f32 v233, 0x358637bd, v233
    v_add_f32 v234, 0x358637bd, v234
    v_add_f32 v235, 0x358637bd, v235
    v_add_f32 v249, 0x358637bd, v249
    v_add_f32 v250, 0x358637bd, v250
    v_add_f32 v251, 0x358637bd, v251
    v_add_f32 v255, 0x358637bd, v255
    v_fma_f32 v144, v144, v216, v232
    v_fma_f32 v145, v145, v217, v233
    v_fma_f32 v146, v146, v218, v234
    v_fma_f32 v147, v147, v219, v235
    v_fma_f32 v148, v148, v220, v249
    v_fma_f32 v149, v149, v221, v250
    v_fma_f32 v150, v150, v222, v251
    v_fma_f32 v151, v151, v223, v255
    v_mul_f32 v232, v152, v224
    v_mul_f32 v233, v153, v225
    v_mul_f32 v234, v154, v226
    v_mul_f32 v235, v155, v227
    v_mul_f32 v249, v156, v228
    v_mul_f32 v250, v157, v229
    v_mul_f32 v251, v158, v230
    v_mul_f32 v255, v159, v231
    v_min_f32 v232, 0, v232
    v_min_f32 v233, 0, v233
    v_min_f32 v234, 0, v234
    v_min_f32 v235, 0, v235
    v_min_f32 v249, 0, v249
    v_min_f32 v250, 0, v250
    v_min_f32 v251, 0, v251
    v_min_f32 v255, 0, v255
    v_exp_f32 v232, v232
    v_exp_f32 v233, v233
    v_exp_f32 v234, v234
    v_exp_f32 v235, v235
    v_exp_f32 v249, v249
    v_exp_f32 v250, v250
    v_exp_f32 v251, v251
    v_exp_f32 v255, v255
    v_max_f32 v152, 0, v152
    v_max_f32 v153, 0, v153
    v_max_f32 v154, 0, v154
    v_max_f32 v155, 0, v155
    v_max_f32 v156, 0, v156
    v_max_f32 v157, 0, v157
    v_max_f32 v158, 0, v158
    v_max_f32 v159, 0, v159
    v_add_f32 v232, 0x358637bd, v232
    v_add_f32 v233, 0x358637bd, v233
    v_add_f32 v234, 0x358637bd, v234
    v_add_f32 v235, 0x358637bd, v235
    v_add_f32 v249, 0x358637bd, v249
    v_add_f32 v250, 0x358637bd, v250
    v_add_f32 v251, 0x358637bd, v251
    v_add_f32 v255, 0x358637bd, v255
    v_fma_f32 v152, v152, v216, v232
    v_fma_f32 v153, v153, v217, v233
    v_fma_f32 v154, v154, v218, v234
    v_fma_f32 v155, v155, v219, v235
    v_fma_f32 v156, v156, v220, v249
    v_fma_f32 v157, v157, v221, v250
    v_fma_f32 v158, v158, v222, v251
    v_fma_f32 v159, v159, v223, v255
    v_mul_f32 v232, v160, v224
    v_mul_f32 v233, v161, v225
    v_mul_f32 v234, v162, v226
    v_mul_f32 v235, v163, v227
    v_mul_f32 v249, v164, v228
    v_mul_f32 v250, v165, v229
    v_mul_f32 v251, v166, v230
    v_mul_f32 v255, v167, v231
    v_min_f32 v232, 0, v232
    v_min_f32 v233, 0, v233
    v_min_f32 v234, 0, v234
    v_min_f32 v235, 0, v235
    v_min_f32 v249, 0, v249
    v_min_f32 v250, 0, v250
    v_min_f32 v251, 0, v251
    v_min_f32 v255, 0, v255
    v_exp_f32 v232, v232
    v_exp_f32 v233, v233
    v_exp_f32 v234, v234
    v_exp_f32 v235, v235
    v_exp_f32 v249, v249
    v_exp_f32 v250, v250
    v_exp_f32 v251, v251
    v_exp_f32 v255, v255
    v_max_f32 v160, 0, v160
    v_max_f32 v161, 0, v161
    v_max_f32 v162, 0, v162
    v_max_f32 v163, 0, v163
    v_max_f32 v164, 0, v164
    v_max_f32 v165, 0, v165
    v_max_f32 v166, 0, v166
    v_max_f32 v167, 0, v167
    v_add_f32 v232, 0x358637bd, v232
    v_add_f32 v233, 0x358637bd, v233
    v_add_f32 v234, 0x358637bd, v234
    v_add_f32 v235, 0x358637bd, v235
    v_add_f32 v249, 0x358637bd, v249
    v_add_f32 v250, 0x358637bd, v250
    v_add_f32 v251, 0x358637bd, v251
    v_add_f32 v255, 0x358637bd, v255
    v_fma_f32 v160, v160, v216, v232
    v_fma_f32 v161, v161, v217, v233
    v_fma_f32 v162, v162, v218, v234
    v_fma_f32 v163, v163, v219, v235
    v_fma_f32 v164, v164, v220, v249
    v_fma_f32 v165, v165, v221, v250
    v_fma_f32 v166, v166, v222, v251
    v_fma_f32 v167, v167, v223, v255
    v_mul_f32 v232, v168, v224
    v_mul_f32 v233, v169, v225
    v_mul_f32 v234, v170, v226
    v_mul_f32 v235, v171, v227
    v_mul_f32 v249, v172, v228
    v_mul_f32 v250, v173, v229
    v_mul_f32 v251, v174, v230
    v_mul_f32 v255, v175, v231
    v_min_f32 v232, 0, v232
    v_min_f32 v233, 0, v233
    v_min_f32 v234, 0, v234
    v_min_f32 v235, 0, v235
    v_min_f32 v249, 0, v249
    v_min_f32 v250, 0, v250
    v_min_f32 v251, 0, v251
    v_min_f32 v255, 0, v255
    v_exp_f32 v232, v232
    v_exp_f32 v233, v233
    v_exp_f32 v234, v234
    v_exp_f32 v235, v235
    v_exp_f32 v249, v249
    v_exp_f32 v250, v250
    v_exp_f32 v251, v251
    v_exp_f32 v255, v255
    v_max_f32 v168, 0, v168
    v_max_f32 v169, 0, v169
    v_max_f32 v170, 0, v170
    v_max_f32 v171, 0, v171
    v_max_f32 v172, 0, v172
    v_max_f32 v173, 0, v173
    v_max_f32 v174, 0, v174
    v_max_f32 v175, 0, v175
    v_add_f32 v232, 0x358637bd, v232
    v_add_f32 v233, 0x358637bd, v233
    v_add_f32 v234, 0x358637bd, v234
    v_add_f32 v235, 0x358637bd, v235
    v_add_f32 v249, 0x358637bd, v249
    v_add_f32 v250, 0x358637bd, v250
    v_add_f32 v251, 0x358637bd, v251
    v_add_f32 v255, 0x358637bd, v255
    v_fma_f32 v168, v168, v216, v232
    v_fma_f32 v169, v169, v217, v233
    v_fma_f32 v170, v170, v218, v234
    v_fma_f32 v171, v171, v219, v235
    v_fma_f32 v172, v172, v220, v249
    v_fma_f32 v173, v173, v221, v250
    v_fma_f32 v174, v174, v222, v251
    v_fma_f32 v175, v175, v223, v255
    v_mul_f32 v232, v176, v224
    v_mul_f32 v233, v177, v225
    v_mul_f32 v234, v178, v226
    v_mul_f32 v235, v179, v227
    v_mul_f32 v249, v180, v228
    v_mul_f32 v250, v181, v229
    v_mul_f32 v251, v182, v230
    v_mul_f32 v255, v183, v231
    v_min_f32 v232, 0, v232
    v_min_f32 v233, 0, v233
    v_min_f32 v234, 0, v234
    v_min_f32 v235, 0, v235
    v_min_f32 v249, 0, v249
    v_min_f32 v250, 0, v250
    v_min_f32 v251, 0, v251
    v_min_f32 v255, 0, v255
    v_exp_f32 v232, v232
    v_exp_f32 v233, v233
    v_exp_f32 v234, v234
    v_exp_f32 v235, v235
    v_exp_f32 v249, v249
    v_exp_f32 v250, v250
    v_exp_f32 v251, v251
    v_exp_f32 v255, v255
    v_max_f32 v176, 0, v176
    v_max_f32 v177, 0, v177
    v_max_f32 v178, 0, v178
    v_max_f32 v179, 0, v179
    v_max_f32 v180, 0, v180
    v_max_f32 v181, 0, v181
    v_max_f32 v182, 0, v182
    v_max_f32 v183, 0, v183
    v_add_f32 v232, 0x358637bd, v232
    v_add_f32 v233, 0x358637bd, v233
    v_add_f32 v234, 0x358637bd, v234
    v_add_f32 v235, 0x358637bd, v235
    v_add_f32 v249, 0x358637bd, v249
    v_add_f32 v250, 0x358637bd, v250
    v_add_f32 v251, 0x358637bd, v251
    v_add_f32 v255, 0x358637bd, v255
    v_fma_f32 v176, v176, v216, v232
    v_fma_f32 v177, v177, v217, v233
    v_fma_f32 v178, v178, v218, v234
    v_fma_f32 v179, v179, v219, v235
    v_fma_f32 v180, v180, v220, v249
    v_fma_f32 v181, v181, v221, v250
    v_fma_f32 v182, v182, v222, v251
    v_fma_f32 v183, v183, v223, v255
    v_mul_f32 v184, v184, v216
    v_mul_f32 v185, v185, v217
    v_mul_f32 v186, v186, v218
    v_mul_f32 v187, v187, v219
    v_mul_f32 v188, v188, v220
    v_mul_f32 v189, v189, v221
    v_mul_f32 v190, v190, v222
    v_mul_f32 v191, v191, v223
    v_mul_f32 v192, v192, v216
    v_mul_f32 v193, v193, v217
    v_mul_f32 v194, v194, v218
    v_mul_f32 v195, v195, v219
    v_mul_f32 v196, v196, v220
    v_mul_f32 v197, v197, v221
    v_mul_f32 v198, v198, v222
    v_mul_f32 v199, v199, v223
    v_mul_f32 v200, v200, v216
    v_mul_f32 v201, v201, v217
    v_mul_f32 v202, v202, v218
    v_mul_f32 v203, v203, v219
    v_mul_f32 v204, v204, v220
    v_mul_f32 v205, v205, v221
    v_mul_f32 v206, v206, v222
    v_mul_f32 v207, v207, v223
    v_mul_f32 v208, v208, v216
    v_mul_f32 v209, v209, v217
    v_mul_f32 v210, v210, v218
    v_mul_f32 v211, v211, v219
    v_mul_f32 v212, v212, v220
    v_mul_f32 v213, v213, v221
    v_mul_f32 v214, v214, v222
    v_mul_f32 v215, v215, v223
    s_mul_i32 s46, s41, 18432
    s_add_u32 s46, s46, 73728
    v_lshl_add_u32 v248, v247, 4, s46
    v_cvt_pk_bf16_f32 v144, v144, v145
    v_cvt_pk_bf16_f32 v145, v146, v147
    v_cvt_pk_bf16_f32 v146, v148, v149
    v_cvt_pk_bf16_f32 v147, v150, v151
    ds_write_b128 v248, v[144:147] offset:0
    v_cvt_pk_bf16_f32 v152, v152, v153
    v_cvt_pk_bf16_f32 v153, v154, v155
    v_cvt_pk_bf16_f32 v154, v156, v157
    v_cvt_pk_bf16_f32 v155, v158, v159
    ds_write_b128 v248, v[152:155] offset:1024
    v_cvt_pk_bf16_f32 v160, v160, v161
    v_cvt_pk_bf16_f32 v161, v162, v163
    v_cvt_pk_bf16_f32 v162, v164, v165
    v_cvt_pk_bf16_f32 v163, v166, v167
    ds_write_b128 v248, v[160:163] offset:2048
    v_cvt_pk_bf16_f32 v168, v168, v169
    v_cvt_pk_bf16_f32 v169, v170, v171
    v_cvt_pk_bf16_f32 v170, v172, v173
    v_cvt_pk_bf16_f32 v171, v174, v175
    ds_write_b128 v248, v[168:171] offset:3072
    v_cvt_pk_bf16_f32 v176, v176, v177
    v_cvt_pk_bf16_f32 v177, v178, v179
    v_cvt_pk_bf16_f32 v178, v180, v181
    v_cvt_pk_bf16_f32 v179, v182, v183
    ds_write_b128 v248, v[176:179] offset:4096
    v_cvt_pk_bf16_f32 v184, v184, v185
    v_cvt_pk_bf16_f32 v185, v186, v187
    v_cvt_pk_bf16_f32 v186, v188, v189
    v_cvt_pk_bf16_f32 v187, v190, v191
    ds_write_b128 v248, v[184:187] offset:9216
    v_cvt_pk_bf16_f32 v192, v192, v193
    v_cvt_pk_bf16_f32 v193, v194, v195
    v_cvt_pk_bf16_f32 v194, v196, v197
    v_cvt_pk_bf16_f32 v195, v198, v199
    ds_write_b128 v248, v[192:195] offset:10240
    v_cvt_pk_bf16_f32 v200, v200, v201
    v_cvt_pk_bf16_f32 v201, v202, v203
    v_cvt_pk_bf16_f32 v202, v204, v205
    v_cvt_pk_bf16_f32 v203, v206, v207
    ds_write_b128 v248, v[200:203] offset:11264
    v_cvt_pk_bf16_f32 v208, v208, v209
    v_cvt_pk_bf16_f32 v209, v210, v211
    v_cvt_pk_bf16_f32 v210, v212, v213
    v_cvt_pk_bf16_f32 v211, v214, v215
    ds_write_b128 v248, v[208:211] offset:12288
    s_waitcnt lgkmcnt(0)
    s_barrier
    v_lshlrev_b32 v248, 4, v247
    v_add_u32 v248, 73728, v248
    v_lshlrev_b32 v249, 2, v247
    v_lshrrev_b32 v250, 4, v247
    v_lshlrev_b32 v250, 2, v250
    v_and_b32 v251, 15, v247
    v_mov_b32 v224, s50
    v_mov_b32 v225, s50
    v_mov_b32 v226, s50
    v_mov_b32 v227, s50
    s_mov_b32 s22, s40
    s_lshl_b32 s46, s22, 10
    v_add_u32 v254, s46, v248
    ds_read_b128 v[144:147], v254 offset:0
    ds_read_b128 v[148:151], v254 offset:18432
    ds_read_b128 v[152:155], v254 offset:36864
    ds_read_b128 v[156:159], v254 offset:55296
    s_add_i32 s48, s22, -1
    s_max_i32 s23, s48, 0
    s_mul_i32 s93, s22, 3
    s_add_u32 s93, s93, 0
    s_cmp_eq_u32 s23, s48
    s_cselect_b32 s93, s93, 0x1fffff
    s_lshl_b32 s93, s93, 10
    s_add_u32 s46, s23, 9
    s_lshl_b32 s46, s46, 10
    v_add_u32 v255, s46, v248
    ds_read_b128 v[160:163], v255 offset:0
    ds_read_b128 v[164:167], v255 offset:18432
    ds_read_b128 v[168:171], v255 offset:36864
    ds_read_b128 v[172:175], v255 offset:55296
    s_add_i32 s48, s22, 0
    s_max_i32 s58, s48, 0
    s_mul_i32 s94, s22, 3
    s_add_u32 s94, s94, 1
    s_cmp_eq_u32 s58, s48
    s_cselect_b32 s94, s94, 0x1fffff
    s_lshl_b32 s94, s94, 10
    s_add_u32 s46, s58, 9
    s_lshl_b32 s46, s46, 10
    v_add_u32 v255, s46, v248
    ds_read_b128 v[176:179], v255 offset:0
    ds_read_b128 v[180:183], v255 offset:18432
    ds_read_b128 v[184:187], v255 offset:36864
    ds_read_b128 v[188:191], v255 offset:55296
    s_add_i32 s48, s22, 1
    s_max_i32 s59, s48, 0
    s_mul_i32 s95, s22, 3
    s_add_u32 s95, s95, 2
    s_cmp_eq_u32 s59, s48
    s_cselect_b32 s95, s95, 0x1fffff
    s_lshl_b32 s95, s95, 10
    s_add_u32 s46, s59, 9
    s_lshl_b32 s46, s46, 10
    v_add_u32 v255, s46, v248
    ds_read_b128 v[192:195], v255 offset:0
    ds_read_b128 v[196:199], v255 offset:18432
    ds_read_b128 v[200:203], v255 offset:36864
    ds_read_b128 v[204:207], v255 offset:55296
    s_lshl_b32 s46, s22, 4
    v_add_u32 v216, s46, v250
    v_mul_u32_u24 v216, 3641, v216
    v_lshrrev_b32 v216, 16, v216
    v_add_u32 v217, s46, v250
    v_add_u32 v217, 1, v217
    v_mul_u32_u24 v217, 3641, v217
    v_lshrrev_b32 v217, 16, v217
    v_add_u32 v218, s46, v250
    v_add_u32 v218, 2, v218
    v_mul_u32_u24 v218, 3641, v218
    v_lshrrev_b32 v218, 16, v218
    v_add_u32 v219, s46, v250
    v_add_u32 v219, 3, v219
    v_mul_u32_u24 v219, 3641, v219
    v_lshrrev_b32 v219, 16, v219
    s_waitcnt lgkmcnt(12)
    v_mfma_f32_16x16x32_bf16 v[212:215], v[144:147], v[224:227], 0
    v_mfma_f32_16x16x32_bf16 v[212:215], v[148:151], v[224:227], v[212:215]
    v_mfma_f32_16x16x32_bf16 v[212:215], v[152:155], v[224:227], v[212:215]
    v_mfma_f32_16x16x32_bf16 v[212:215], v[156:159], v[224:227], v[212:215]
    s_waitcnt lgkmcnt(0)
    v_mfma_f32_16x16x32_bf16 v[228:231], v[144:147], v[160:163], 0
    v_mfma_f32_16x16x32_bf16 v[228:231], v[148:151], v[164:167], v[228:231]
    v_mfma_f32_16x16x32_bf16 v[228:231], v[152:155], v[168:171], v[228:231]
    v_mfma_f32_16x16x32_bf16 v[228:231], v[156:159], v[172:175], v[228:231]
    v_mfma_f32_16x16x32_bf16 v[232:235], v[144:147], v[176:179], 0
    v_mfma_f32_16x16x32_bf16 v[232:235], v[148:151], v[180:183], v[232:235]
    v_mfma_f32_16x16x32_bf16 v[232:235], v[152:155], v[184:187], v[232:235]
    v_mfma_f32_16x16x32_bf16 v[232:235], v[156:159], v[188:191], v[232:235]
    v_mfma_f32_16x16x32_bf16 v[208:211], v[144:147], v[192:195], 0
    v_mfma_f32_16x16x32_bf16 v[208:211], v[148:151], v[196:199], v[208:211]
    v_mfma_f32_16x16x32_bf16 v[208:211], v[152:155], v[200:203], v[208:211]
    v_mfma_f32_16x16x32_bf16 v[208:211], v[156:159], v[204:207], v[208:211]
    s_add_u32 s48, s22, 27
    s_lshl_b32 s48, s48, 10
    s_nop 4
    s_mov_b32 exec_lo, 0x00010001
    s_mov_b32 exec_hi, 0x00010001
    buffer_atomic_add_f32 v212, v249, s[8:11], s48 offen offset:0
    s_mov_b64 exec, -1
    s_mov_b32 exec_lo, 0x00010001
    s_mov_b32 exec_hi, 0x00010001
    buffer_atomic_add_f32 v213, v249, s[8:11], s48 offen offset:256
    s_mov_b64 exec, -1
    s_mov_b32 exec_lo, 0x00010001
    s_mov_b32 exec_hi, 0x00010001
    buffer_atomic_add_f32 v214, v249, s[8:11], s48 offen offset:512
    s_mov_b64 exec, -1
    s_mov_b32 exec_lo, 0x00010001
    s_mov_b32 exec_hi, 0x00010001
    buffer_atomic_add_f32 v215, v249, s[8:11], s48 offen offset:768
    s_mov_b64 exec, -1
    s_lshl_b32 s46, s23, 4
    v_add_u32 v220, s46, v251
    v_mul_u32_u24 v220, 3641, v220
    v_lshrrev_b32 v220, 16, v220
    v_cmp_eq_u32 vcc, v216, v220
    s_nop 1
    v_cndmask_b32 v228, 0, v228, vcc
    s_or_b32 exec_lo, vcc_lo, 1
    s_mov_b32 exec_hi, vcc_hi
    buffer_atomic_add_f32 v228, v249, s[8:11], s93 offen offset:0
    s_mov_b64 exec, -1
    v_cmp_eq_u32 vcc, v217, v220
    s_nop 1
    v_cndmask_b32 v229, 0, v229, vcc
    s_or_b32 exec_lo, vcc_lo, 1
    s_mov_b32 exec_hi, vcc_hi
    buffer_atomic_add_f32 v229, v249, s[8:11], s93 offen offset:256
    s_mov_b64 exec, -1
    v_cmp_eq_u32 vcc, v218, v220
    s_nop 1
    v_cndmask_b32 v230, 0, v230, vcc
    s_or_b32 exec_lo, vcc_lo, 1
    s_mov_b32 exec_hi, vcc_hi
    buffer_atomic_add_f32 v230, v249, s[8:11], s93 offen offset:512
    s_mov_b64 exec, -1
    v_cmp_eq_u32 vcc, v219, v220
    s_nop 1
    v_cndmask_b32 v231, 0, v231, vcc
    s_or_b32 exec_lo, vcc_lo, 1
    s_mov_b32 exec_hi, vcc_hi
    buffer_atomic_add_f32 v231, v249, s[8:11], s93 offen offset:768
    s_mov_b64 exec, -1
    s_lshl_b32 s46, s58, 4
    v_add_u32 v220, s46, v251
    v_mul_u32_u24 v220, 3641, v220
    v_lshrrev_b32 v220, 16, v220
    v_cmp_eq_u32 vcc, v216, v220
    s_nop 1
    v_cndmask_b32 v232, 0, v232, vcc
    s_or_b32 exec_lo, vcc_lo, 1
    s_mov_b32 exec_hi, vcc_hi
    buffer_atomic_add_f32 v232, v249, s[8:11], s94 offen offset:0
    s_mov_b64 exec, -1
    v_cmp_eq_u32 vcc, v217, v220
    s_nop 1
    v_cndmask_b32 v233, 0, v233, vcc
    s_or_b32 exec_lo, vcc_lo, 1
    s_mov_b32 exec_hi, vcc_hi
    buffer_atomic_add_f32 v233, v249, s[8:11], s94 offen offset:256
    s_mov_b64 exec, -1
    v_cmp_eq_u32 vcc, v218, v220
    s_nop 1
    v_cndmask_b32 v234, 0, v234, vcc
    s_or_b32 exec_lo, vcc_lo, 1
    s_mov_b32 exec_hi, vcc_hi
    buffer_atomic_add_f32 v234, v249, s[8:11], s94 offen offset:512
    s_mov_b64 exec, -1
    v_cmp_eq_u32 vcc, v219, v220
    s_nop 1
    v_cndmask_b32 v235, 0, v235, vcc
    s_or_b32 exec_lo, vcc_lo, 1
    s_mov_b32 exec_hi, vcc_hi
    buffer_atomic_add_f32 v235, v249, s[8:11], s94 offen offset:768
    s_mov_b64 exec, -1
    s_lshl_b32 s46, s59, 4
    v_add_u32 v220, s46, v251
    v_mul_u32_u24 v220, 3641, v220
    v_lshrrev_b32 v220, 16, v220
    v_cmp_eq_u32 vcc, v216, v220
    s_nop 1
    v_cndmask_b32 v208, 0, v208, vcc
    s_or_b32 exec_lo, vcc_lo, 1
    s_mov_b32 exec_hi, vcc_hi
    buffer_atomic_add_f32 v208, v249, s[8:11], s95 offen offset:0
    s_mov_b64 exec, -1
    v_cmp_eq_u32 vcc, v217, v220
    s_nop 1
    v_cndmask_b32 v209, 0, v209, vcc
    s_or_b32 exec_lo, vcc_lo, 1
    s_mov_b32 exec_hi, vcc_hi
    buffer_atomic_add_f32 v209, v249, s[8:11], s95 offen offset:256
    s_mov_b64 exec, -1
    v_cmp_eq_u32 vcc, v218, v220
    s_nop 1
    v_cndmask_b32 v210, 0, v210, vcc
    s_or_b32 exec_lo, vcc_lo, 1
    s_mov_b32 exec_hi, vcc_hi
    buffer_atomic_add_f32 v210, v249, s[8:11], s95 offen offset:512
    s_mov_b64 exec, -1
    v_cmp_eq_u32 vcc, v219, v220
    s_nop 1
    v_cndmask_b32 v211, 0, v211, vcc
    s_or_b32 exec_lo, vcc_lo, 1
    s_mov_b32 exec_hi, vcc_hi
    buffer_atomic_add_f32 v211, v249, s[8:11], s95 offen offset:768
    s_mov_b64 exec, -1
    s_barrier
    s_add_u32 m0, s55, 73728
    s_mov_b32 s49, 221184
    buffer_load_dwordx4 v244, s[28:31], s49 offen lds
    s_add_u32 m0, s55, 74752
    s_mov_b32 s49, 221184
    buffer_load_dwordx4 v245, s[28:31], s49 offen lds
    s_add_u32 m0, s55, 75776
    s_mov_b32 s49, 221184
    buffer_load_dwordx4 v246, s[28:31], s49 offen lds
    ds_read_b64_tr_b16 v[224:225], v240 offset:0
    ds_read_b64_tr_b16 v[226:227], v240 offset:3072
    ds_read_b64_tr_b16 v[228:229], v241 offset:0
    ds_read_b64_tr_b16 v[230:231], v241 offset:3072
    ds_read_b64_tr_b16 v[232:233], v242 offset:0
    ds_read_b64_tr_b16 v[234:235], v242 offset:3072
    ds_read_b64_tr_b16 v[216:217], v243 offset:0
    ds_read_b64_tr_b16 v[218:219], v243 offset:3072
    ds_read_b64_tr_b16 v[220:221], v240 offset:128
    ds_read_b64_tr_b16 v[222:223], v240 offset:3200
    s_waitcnt vmcnt(0)
    s_barrier
    s_waitcnt lgkmcnt(8)
    v_mfma_f32_16x16x32_bf16 v[144:147], v[224:227], v[0:3], 0
    v_mfma_f32_16x16x32_bf16 v[148:151], v[224:227], v[72:75], 0
    ds_read_b64_tr_b16 v[224:225], v240 offset:12288
    ds_read_b64_tr_b16 v[226:227], v240 offset:15360
    s_add_u32 m0, s55, 24576
    s_mov_b32 s49, 663552
    buffer_load_dwordx4 v244, s[28:31], s49 offen lds
    s_waitcnt lgkmcnt(8)
    v_mfma_f32_16x16x32_bf16 v[152:155], v[228:231], v[0:3], 0
    v_mfma_f32_16x16x32_bf16 v[156:159], v[228:231], v[72:75], 0
    ds_read_b64_tr_b16 v[228:229], v241 offset:12288
    ds_read_b64_tr_b16 v[230:231], v241 offset:15360
    s_waitcnt lgkmcnt(8)
    v_mfma_f32_16x16x32_bf16 v[160:163], v[232:235], v[0:3], 0
    v_mfma_f32_16x16x32_bf16 v[164:167], v[232:235], v[72:75], 0
    ds_read_b64_tr_b16 v[232:233], v242 offset:12288
    ds_read_b64_tr_b16 v[234:235], v242 offset:15360
    s_add_u32 m0, s55, 25600
    s_mov_b32 s49, 663552
    buffer_load_dwordx4 v245, s[28:31], s49 offen lds
    s_waitcnt lgkmcnt(8)
    v_mfma_f32_16x16x32_bf16 v[168:171], v[216:219], v[0:3], 0
    v_mfma_f32_16x16x32_bf16 v[172:175], v[216:219], v[72:75], 0
    ds_read_b64_tr_b16 v[216:217], v243 offset:12288
    ds_read_b64_tr_b16 v[218:219], v243 offset:15360
    s_waitcnt lgkmcnt(8)
    v_mfma_f32_16x16x32_bf16 v[176:179], v[220:223], v[0:3], 0
    v_mfma_f32_16x16x32_bf16 v[180:183], v[220:223], v[72:75], 0
    ds_read_b64_tr_b16 v[220:221], v240 offset:12416
    ds_read_b64_tr_b16 v[222:223], v240 offset:15488
    s_add_u32 m0, s55, 26624
    s_mov_b32 s49, 663552
    buffer_load_dwordx4 v246, s[28:31], s49 offen lds
    s_waitcnt lgkmcnt(8)
    v_mfma_f32_16x16x32_bf16 v[144:147], v[224:227], v[4:7], v[144:147]
    v_mfma_f32_16x16x32_bf16 v[148:151], v[224:227], v[76:79], v[148:151]
    ds_read_b64_tr_b16 v[224:225], v240 offset:24576
    ds_read_b64_tr_b16 v[226:227], v240 offset:27648
    s_waitcnt lgkmcnt(8)
    v_mfma_f32_16x16x32_bf16 v[152:155], v[228:231], v[4:7], v[152:155]
    v_mfma_f32_16x16x32_bf16 v[156:159], v[228:231], v[76:79], v[156:159]
    ds_read_b64_tr_b16 v[228:229], v241 offset:24576
    ds_read_b64_tr_b16 v[230:231], v241 offset:27648
    s_waitcnt lgkmcnt(8)
    v_mfma_f32_16x16x32_bf16 v[160:163], v[232:235], v[4:7], v[160:163]
    v_mfma_f32_16x16x32_bf16 v[164:167], v[232:235], v[76:79], v[164:167]
    ds_read_b64_tr_b16 v[232:233], v242 offset:24576
    ds_read_b64_tr_b16 v[234:235], v242 offset:27648
    s_waitcnt lgkmcnt(8)
    v_mfma_f32_16x16x32_bf16 v[168:171], v[216:219], v[4:7], v[168:171]
    v_mfma_f32_16x16x32_bf16 v[172:175], v[216:219], v[76:79], v[172:175]
    ds_read_b64_tr_b16 v[216:217], v243 offset:24576
    ds_read_b64_tr_b16 v[218:219], v243 offset:27648
    s_waitcnt lgkmcnt(8)
    v_mfma_f32_16x16x32_bf16 v[176:179], v[220:223], v[4:7], v[176:179]
    v_mfma_f32_16x16x32_bf16 v[180:183], v[220:223], v[76:79], v[180:183]
    ds_read_b64_tr_b16 v[220:221], v240 offset:24704
    ds_read_b64_tr_b16 v[222:223], v240 offset:27776
    s_barrier
    s_waitcnt lgkmcnt(8)
    v_mfma_f32_16x16x32_bf16 v[144:147], v[224:227], v[8:11], v[144:147]
    v_mfma_f32_16x16x32_bf16 v[148:151], v[224:227], v[80:83], v[148:151]
    ds_read_b64_tr_b16 v[224:225], v240 offset:36864
    ds_read_b64_tr_b16 v[226:227], v240 offset:39936
    s_add_u32 m0, s55, 49152
    s_mov_b32 s49, 884736
    buffer_load_dwordx4 v244, s[28:31], s49 offen lds
    s_waitcnt lgkmcnt(8)
    v_mfma_f32_16x16x32_bf16 v[152:155], v[228:231], v[8:11], v[152:155]
    v_mfma_f32_16x16x32_bf16 v[156:159], v[228:231], v[80:83], v[156:159]
    ds_read_b64_tr_b16 v[228:229], v241 offset:36864
    ds_read_b64_tr_b16 v[230:231], v241 offset:39936
    s_waitcnt lgkmcnt(8)
    v_mfma_f32_16x16x32_bf16 v[160:163], v[232:235], v[8:11], v[160:163]
    v_mfma_f32_16x16x32_bf16 v[164:167], v[232:235], v[80:83], v[164:167]
    ds_read_b64_tr_b16 v[232:233], v242 offset:36864
    ds_read_b64_tr_b16 v[234:235], v242 offset:39936
    s_add_u32 m0, s55, 50176
    s_mov_b32 s49, 884736
    buffer_load_dwordx4 v245, s[28:31], s49 offen lds
    s_waitcnt lgkmcnt(8)
    v_mfma_f32_16x16x32_bf16 v[168:171], v[216:219], v[8:11], v[168:171]
    v_mfma_f32_16x16x32_bf16 v[172:175], v[216:219], v[80:83], v[172:175]
    ds_read_b64_tr_b16 v[216:217], v243 offset:36864
    ds_read_b64_tr_b16 v[218:219], v243 offset:39936
    s_waitcnt lgkmcnt(8)
    v_mfma_f32_16x16x32_bf16 v[176:179], v[220:223], v[8:11], v[176:179]
    v_mfma_f32_16x16x32_bf16 v[180:183], v[220:223], v[80:83], v[180:183]
    ds_read_b64_tr_b16 v[220:221], v240 offset:36992
    ds_read_b64_tr_b16 v[222:223], v240 offset:40064
    s_add_u32 m0, s55, 51200
    s_mov_b32 s49, 884736
    buffer_load_dwordx4 v246, s[28:31], s49 offen lds
    s_waitcnt lgkmcnt(8)
    v_mfma_f32_16x16x32_bf16 v[144:147], v[224:227], v[12:15], v[144:147]
    v_mfma_f32_16x16x32_bf16 v[148:151], v[224:227], v[84:87], v[148:151]
    ds_read_b64_tr_b16 v[224:225], v236 offset:0
    ds_read_b64_tr_b16 v[226:227], v236 offset:3072
    s_waitcnt lgkmcnt(8)
    v_mfma_f32_16x16x32_bf16 v[152:155], v[228:231], v[12:15], v[152:155]
    v_mfma_f32_16x16x32_bf16 v[156:159], v[228:231], v[84:87], v[156:159]
    ds_read_b64_tr_b16 v[228:229], v237 offset:0
    ds_read_b64_tr_b16 v[230:231], v237 offset:3072
    s_waitcnt lgkmcnt(8)
    v_mfma_f32_16x16x32_bf16 v[160:163], v[232:235], v[12:15], v[160:163]
    v_mfma_f32_16x16x32_bf16 v[164:167], v[232:235], v[84:87], v[164:167]
    ds_read_b64_tr_b16 v[232:233], v238 offset:0
    ds_read_b64_tr_b16 v[234:235], v238 offset:3072
    s_waitcnt lgkmcnt(8)
    v_mfma_f32_16x16x32_bf16 v[168:171], v[216:219], v[12:15], v[168:171]
    v_mfma_f32_16x16x32_bf16 v[172:175], v[216:219], v[84:87], v[172:175]
    ds_read_b64_tr_b16 v[216:217], v239 offset:0
    ds_read_b64_tr_b16 v[218:219], v239 offset:3072
    s_waitcnt lgkmcnt(8)
    v_mfma_f32_16x16x32_bf16 v[176:179], v[220:223], v[12:15], v[176:179]
    v_mfma_f32_16x16x32_bf16 v[180:183], v[220:223], v[84:87], v[180:183]
    ds_read_b64_tr_b16 v[220:221], v236 offset:128
    ds_read_b64_tr_b16 v[222:223], v236 offset:3200
    s_waitcnt vmcnt(3)
    s_barrier
    s_waitcnt lgkmcnt(8)
    v_mfma_f32_16x16x32_bf16 v[144:147], v[224:227], v[16:19], v[144:147]
    v_mfma_f32_16x16x32_bf16 v[148:151], v[224:227], v[88:91], v[148:151]
    ds_read_b64_tr_b16 v[224:225], v236 offset:12288
    ds_read_b64_tr_b16 v[226:227], v236 offset:15360
    s_add_u32 m0, s55, 73728
    s_mov_b32 s49, 1105920
    buffer_load_dwordx4 v244, s[28:31], s49 offen lds
    s_waitcnt lgkmcnt(8)
    v_mfma_f32_16x16x32_bf16 v[152:155], v[228:231], v[16:19], v[152:155]
    v_mfma_f32_16x16x32_bf16 v[156:159], v[228:231], v[88:91], v[156:159]
    ds_read_b64_tr_b16 v[228:229], v237 offset:12288
    ds_read_b64_tr_b16 v[230:231], v237 offset:15360
    s_waitcnt lgkmcnt(8)
    v_mfma_f32_16x16x32_bf16 v[160:163], v[232:235], v[16:19], v[160:163]
    v_mfma_f32_16x16x32_bf16 v[164:167], v[232:235], v[88:91], v[164:167]
    ds_read_b64_tr_b16 v[232:233], v238 offset:12288
    ds_read_b64_tr_b16 v[234:235], v238 offset:15360
    s_add_u32 m0, s55, 74752
    s_mov_b32 s49, 1105920
    buffer_load_dwordx4 v245, s[28:31], s49 offen lds
    s_waitcnt lgkmcnt(8)
    v_mfma_f32_16x16x32_bf16 v[168:171], v[216:219], v[16:19], v[168:171]
    v_mfma_f32_16x16x32_bf16 v[172:175], v[216:219], v[88:91], v[172:175]
    ds_read_b64_tr_b16 v[216:217], v239 offset:12288
    ds_read_b64_tr_b16 v[218:219], v239 offset:15360
    s_waitcnt lgkmcnt(8)
    v_mfma_f32_16x16x32_bf16 v[176:179], v[220:223], v[16:19], v[176:179]
    v_mfma_f32_16x16x32_bf16 v[180:183], v[220:223], v[88:91], v[180:183]
    ds_read_b64_tr_b16 v[220:221], v236 offset:12416
    ds_read_b64_tr_b16 v[222:223], v236 offset:15488
    s_add_u32 m0, s55, 75776
    s_mov_b32 s49, 1105920
    buffer_load_dwordx4 v246, s[28:31], s49 offen lds
    s_waitcnt lgkmcnt(8)
    v_mfma_f32_16x16x32_bf16 v[144:147], v[224:227], v[20:23], v[144:147]
    v_mfma_f32_16x16x32_bf16 v[148:151], v[224:227], v[92:95], v[148:151]
    ds_read_b64_tr_b16 v[224:225], v236 offset:24576
    ds_read_b64_tr_b16 v[226:227], v236 offset:27648
    s_waitcnt lgkmcnt(8)
    v_mfma_f32_16x16x32_bf16 v[152:155], v[228:231], v[20:23], v[152:155]
    v_mfma_f32_16x16x32_bf16 v[156:159], v[228:231], v[92:95], v[156:159]
    ds_read_b64_tr_b16 v[228:229], v237 offset:24576
    ds_read_b64_tr_b16 v[230:231], v237 offset:27648
    s_lshl_b32 s46, s43, 2
    s_add_u32 s46, s46, 80
    v_mov_b32 v248, 0x7fffff00
    v_mov_b32 v255, s46
    s_lshl_b32 s47, s40, 6
    v_add_u32 v250, s47, v247
    v_cmp_eq_u32 vcc, 0, v250
    v_mov_b32 v251, 1
    s_nop 0
    v_cndmask_b32 v248, v248, v255, vcc
    buffer_atomic_add v251, v248, s[16:19], 0 offen sc1
    s_waitcnt lgkmcnt(8)
    v_mfma_f32_16x16x32_bf16 v[160:163], v[232:235], v[20:23], v[160:163]
    v_mfma_f32_16x16x32_bf16 v[164:167], v[232:235], v[92:95], v[164:167]
    ds_read_b64_tr_b16 v[232:233], v238 offset:24576
    ds_read_b64_tr_b16 v[234:235], v238 offset:27648
    s_waitcnt lgkmcnt(8)
    v_mfma_f32_16x16x32_bf16 v[168:171], v[216:219], v[20:23], v[168:171]
    v_mfma_f32_16x16x32_bf16 v[172:175], v[216:219], v[92:95], v[172:175]
    ds_read_b64_tr_b16 v[216:217], v239 offset:24576
    ds_read_b64_tr_b16 v[218:219], v239 offset:27648
    s_waitcnt lgkmcnt(8)
    v_mfma_f32_16x16x32_bf16 v[176:179], v[220:223], v[20:23], v[176:179]
    v_mfma_f32_16x16x32_bf16 v[180:183], v[220:223], v[92:95], v[180:183]
    ds_read_b64_tr_b16 v[220:221], v236 offset:24704
    ds_read_b64_tr_b16 v[222:223], v236 offset:27776
    s_waitcnt vmcnt(4)
    s_barrier
    s_waitcnt lgkmcnt(8)
    v_mfma_f32_16x16x32_bf16 v[144:147], v[224:227], v[24:27], v[144:147]
    v_mfma_f32_16x16x32_bf16 v[148:151], v[224:227], v[96:99], v[148:151]
    ds_read_b64_tr_b16 v[224:225], v236 offset:36864
    ds_read_b64_tr_b16 v[226:227], v236 offset:39936
    s_add_u32 m0, s55, 0
    s_mov_b32 s49, 1327104
    buffer_load_dwordx4 v244, s[28:31], s49 offen lds
    s_waitcnt lgkmcnt(8)
    v_mfma_f32_16x16x32_bf16 v[152:155], v[228:231], v[24:27], v[152:155]
    v_mfma_f32_16x16x32_bf16 v[156:159], v[228:231], v[96:99], v[156:159]
    ds_read_b64_tr_b16 v[228:229], v237 offset:36864
    ds_read_b64_tr_b16 v[230:231], v237 offset:39936
    s_waitcnt lgkmcnt(8)
    v_mfma_f32_16x16x32_bf16 v[160:163], v[232:235], v[24:27], v[160:163]
    v_mfma_f32_16x16x32_bf16 v[164:167], v[232:235], v[96:99], v[164:167]
    ds_read_b64_tr_b16 v[232:233], v238 offset:36864
    ds_read_b64_tr_b16 v[234:235], v238 offset:39936
    s_add_u32 m0, s55, 1024
    s_mov_b32 s49, 1327104
    buffer_load_dwordx4 v245, s[28:31], s49 offen lds
    s_waitcnt lgkmcnt(8)
    v_mfma_f32_16x16x32_bf16 v[168:171], v[216:219], v[24:27], v[168:171]
    v_mfma_f32_16x16x32_bf16 v[172:175], v[216:219], v[96:99], v[172:175]
    ds_read_b64_tr_b16 v[216:217], v239 offset:36864
    ds_read_b64_tr_b16 v[218:219], v239 offset:39936
    s_waitcnt lgkmcnt(8)
    v_mfma_f32_16x16x32_bf16 v[176:179], v[220:223], v[24:27], v[176:179]
    v_mfma_f32_16x16x32_bf16 v[180:183], v[220:223], v[96:99], v[180:183]
    ds_read_b64_tr_b16 v[220:221], v236 offset:36992
    ds_read_b64_tr_b16 v[222:223], v236 offset:40064
    s_add_u32 m0, s55, 2048
    s_mov_b32 s49, 1327104
    buffer_load_dwordx4 v246, s[28:31], s49 offen lds
    s_waitcnt lgkmcnt(8)
    v_mfma_f32_16x16x32_bf16 v[144:147], v[224:227], v[28:31], v[144:147]
    v_mfma_f32_16x16x32_bf16 v[148:151], v[224:227], v[100:103], v[148:151]
    ds_read_b64_tr_b16 v[224:225], v240 offset:0
    ds_read_b64_tr_b16 v[226:227], v240 offset:3072
    s_waitcnt lgkmcnt(8)
    v_mfma_f32_16x16x32_bf16 v[152:155], v[228:231], v[28:31], v[152:155]
    v_mfma_f32_16x16x32_bf16 v[156:159], v[228:231], v[100:103], v[156:159]
    ds_read_b64_tr_b16 v[228:229], v241 offset:0
    ds_read_b64_tr_b16 v[230:231], v241 offset:3072
    s_waitcnt lgkmcnt(8)
    v_mfma_f32_16x16x32_bf16 v[160:163], v[232:235], v[28:31], v[160:163]
    v_mfma_f32_16x16x32_bf16 v[164:167], v[232:235], v[100:103], v[164:167]
    ds_read_b64_tr_b16 v[232:233], v242 offset:0
    ds_read_b64_tr_b16 v[234:235], v242 offset:3072
    s_waitcnt lgkmcnt(8)
    v_mfma_f32_16x16x32_bf16 v[168:171], v[216:219], v[28:31], v[168:171]
    v_mfma_f32_16x16x32_bf16 v[172:175], v[216:219], v[100:103], v[172:175]
    ds_read_b64_tr_b16 v[216:217], v243 offset:0
    ds_read_b64_tr_b16 v[218:219], v243 offset:3072
    s_waitcnt lgkmcnt(8)
    v_mfma_f32_16x16x32_bf16 v[176:179], v[220:223], v[28:31], v[176:179]
    v_mfma_f32_16x16x32_bf16 v[180:183], v[220:223], v[100:103], v[180:183]
    ds_read_b64_tr_b16 v[220:221], v240 offset:128
    ds_read_b64_tr_b16 v[222:223], v240 offset:3200
    s_waitcnt vmcnt(4)
    s_barrier
    s_waitcnt lgkmcnt(8)
    v_mfma_f32_16x16x32_bf16 v[144:147], v[224:227], v[32:35], v[144:147]
    v_mfma_f32_16x16x32_bf16 v[148:151], v[224:227], v[104:107], v[148:151]
    ds_read_b64_tr_b16 v[224:225], v240 offset:12288
    ds_read_b64_tr_b16 v[226:227], v240 offset:15360
    s_add_u32 m0, s55, 24576
    s_mov_b32 s49, 1548288
    buffer_load_dwordx4 v244, s[28:31], s49 offen lds
    s_waitcnt lgkmcnt(8)
    v_mfma_f32_16x16x32_bf16 v[152:155], v[228:231], v[32:35], v[152:155]
    v_mfma_f32_16x16x32_bf16 v[156:159], v[228:231], v[104:107], v[156:159]
    ds_read_b64_tr_b16 v[228:229], v241 offset:12288
    ds_read_b64_tr_b16 v[230:231], v241 offset:15360
    s_waitcnt lgkmcnt(8)
    v_mfma_f32_16x16x32_bf16 v[160:163], v[232:235], v[32:35], v[160:163]
    v_mfma_f32_16x16x32_bf16 v[164:167], v[232:235], v[104:107], v[164:167]
    ds_read_b64_tr_b16 v[232:233], v242 offset:12288
    ds_read_b64_tr_b16 v[234:235], v242 offset:15360
    s_add_u32 m0, s55, 25600
    s_mov_b32 s49, 1548288
    buffer_load_dwordx4 v245, s[28:31], s49 offen lds
    s_waitcnt lgkmcnt(8)
    v_mfma_f32_16x16x32_bf16 v[168:171], v[216:219], v[32:35], v[168:171]
    v_mfma_f32_16x16x32_bf16 v[172:175], v[216:219], v[104:107], v[172:175]
    ds_read_b64_tr_b16 v[216:217], v243 offset:12288
    ds_read_b64_tr_b16 v[218:219], v243 offset:15360
    s_waitcnt lgkmcnt(8)
    v_mfma_f32_16x16x32_bf16 v[176:179], v[220:223], v[32:35], v[176:179]
    v_mfma_f32_16x16x32_bf16 v[180:183], v[220:223], v[104:107], v[180:183]
    ds_read_b64_tr_b16 v[220:221], v240 offset:12416
    ds_read_b64_tr_b16 v[222:223], v240 offset:15488
    s_add_u32 m0, s55, 26624
    s_mov_b32 s49, 1548288
    buffer_load_dwordx4 v246, s[28:31], s49 offen lds
    s_waitcnt lgkmcnt(8)
    v_mfma_f32_16x16x32_bf16 v[144:147], v[224:227], v[36:39], v[144:147]
    v_mfma_f32_16x16x32_bf16 v[148:151], v[224:227], v[108:111], v[148:151]
    ds_read_b64_tr_b16 v[224:225], v240 offset:24576
    ds_read_b64_tr_b16 v[226:227], v240 offset:27648
    s_waitcnt lgkmcnt(8)
    v_mfma_f32_16x16x32_bf16 v[152:155], v[228:231], v[36:39], v[152:155]
    v_mfma_f32_16x16x32_bf16 v[156:159], v[228:231], v[108:111], v[156:159]
    ds_read_b64_tr_b16 v[228:229], v241 offset:24576
    ds_read_b64_tr_b16 v[230:231], v241 offset:27648
    s_waitcnt lgkmcnt(8)
    v_mfma_f32_16x16x32_bf16 v[160:163], v[232:235], v[36:39], v[160:163]
    v_mfma_f32_16x16x32_bf16 v[164:167], v[232:235], v[108:111], v[164:167]
    ds_read_b64_tr_b16 v[232:233], v242 offset:24576
    ds_read_b64_tr_b16 v[234:235], v242 offset:27648
    s_waitcnt lgkmcnt(8)
    v_mfma_f32_16x16x32_bf16 v[168:171], v[216:219], v[36:39], v[168:171]
    v_mfma_f32_16x16x32_bf16 v[172:175], v[216:219], v[108:111], v[172:175]
    ds_read_b64_tr_b16 v[216:217], v243 offset:24576
    ds_read_b64_tr_b16 v[218:219], v243 offset:27648
    s_waitcnt lgkmcnt(8)
    v_mfma_f32_16x16x32_bf16 v[176:179], v[220:223], v[36:39], v[176:179]
    v_mfma_f32_16x16x32_bf16 v[180:183], v[220:223], v[108:111], v[180:183]
    ds_read_b64_tr_b16 v[220:221], v240 offset:24704
    ds_read_b64_tr_b16 v[222:223], v240 offset:27776
    s_waitcnt vmcnt(3)
    s_barrier
    s_waitcnt lgkmcnt(8)
    v_mfma_f32_16x16x32_bf16 v[144:147], v[224:227], v[40:43], v[144:147]
    v_mfma_f32_16x16x32_bf16 v[148:151], v[224:227], v[112:115], v[148:151]
    ds_read_b64_tr_b16 v[224:225], v240 offset:36864
    ds_read_b64_tr_b16 v[226:227], v240 offset:39936
    s_add_u32 m0, s55, 49152
    s_mov_b32 s49, 1769472
    buffer_load_dwordx4 v244, s[28:31], s49 offen lds
    s_waitcnt lgkmcnt(8)
    v_mfma_f32_16x16x32_bf16 v[152:155], v[228:231], v[40:43], v[152:155]
    v_mfma_f32_16x16x32_bf16 v[156:159], v[228:231], v[112:115], v[156:159]
    ds_read_b64_tr_b16 v[228:229], v241 offset:36864
    ds_read_b64_tr_b16 v[230:231], v241 offset:39936
    s_waitcnt lgkmcnt(8)
    v_mfma_f32_16x16x32_bf16 v[160:163], v[232:235], v[40:43], v[160:163]
    v_mfma_f32_16x16x32_bf16 v[164:167], v[232:235], v[112:115], v[164:167]
    ds_read_b64_tr_b16 v[232:233], v242 offset:36864
    ds_read_b64_tr_b16 v[234:235], v242 offset:39936
    s_add_u32 m0, s55, 50176
    s_mov_b32 s49, 1769472
    buffer_load_dwordx4 v245, s[28:31], s49 offen lds
    s_waitcnt lgkmcnt(8)
    v_mfma_f32_16x16x32_bf16 v[168:171], v[216:219], v[40:43], v[168:171]
    v_mfma_f32_16x16x32_bf16 v[172:175], v[216:219], v[112:115], v[172:175]
    ds_read_b64_tr_b16 v[216:217], v243 offset:36864
    ds_read_b64_tr_b16 v[218:219], v243 offset:39936
    s_waitcnt lgkmcnt(8)
    v_mfma_f32_16x16x32_bf16 v[176:179], v[220:223], v[40:43], v[176:179]
    v_mfma_f32_16x16x32_bf16 v[180:183], v[220:223], v[112:115], v[180:183]
    ds_read_b64_tr_b16 v[220:221], v240 offset:36992
    ds_read_b64_tr_b16 v[222:223], v240 offset:40064
    s_add_u32 m0, s55, 51200
    s_mov_b32 s49, 1769472
    buffer_load_dwordx4 v246, s[28:31], s49 offen lds
    s_waitcnt lgkmcnt(8)
    v_mfma_f32_16x16x32_bf16 v[144:147], v[224:227], v[44:47], v[144:147]
    v_mfma_f32_16x16x32_bf16 v[148:151], v[224:227], v[116:119], v[148:151]
    ds_read_b64_tr_b16 v[224:225], v236 offset:0
    ds_read_b64_tr_b16 v[226:227], v236 offset:3072
    s_waitcnt lgkmcnt(8)
    v_mfma_f32_16x16x32_bf16 v[152:155], v[228:231], v[44:47], v[152:155]
    v_mfma_f32_16x16x32_bf16 v[156:159], v[228:231], v[116:119], v[156:159]
    ds_read_b64_tr_b16 v[228:229], v237 offset:0
    ds_read_b64_tr_b16 v[230:231], v237 offset:3072
    buffer_load_dword v254, v255, s[16:19], 0 offen sc1
    s_waitcnt lgkmcnt(8)
    v_mfma_f32_16x16x32_bf16 v[160:163], v[232:235], v[44:47], v[160:163]
    v_mfma_f32_16x16x32_bf16 v[164:167], v[232:235], v[116:119], v[164:167]
    ds_read_b64_tr_b16 v[232:233], v238 offset:0
    ds_read_b64_tr_b16 v[234:235], v238 offset:3072
    s_waitcnt lgkmcnt(8)
    v_mfma_f32_16x16x32_bf16 v[168:171], v[216:219], v[44:47], v[168:171]
    v_mfma_f32_16x16x32_bf16 v[172:175], v[216:219], v[116:119], v[172:175]
    ds_read_b64_tr_b16 v[216:217], v239 offset:0
    ds_read_b64_tr_b16 v[218:219], v239 offset:3072
    s_waitcnt lgkmcnt(8)
    v_mfma_f32_16x16x32_bf16 v[176:179], v[220:223], v[44:47], v[176:179]
    v_mfma_f32_16x16x32_bf16 v[180:183], v[220:223], v[116:119], v[180:183]
    ds_read_b64_tr_b16 v[220:221], v236 offset:128
    ds_read_b64_tr_b16 v[222:223], v236 offset:3200
    s_waitcnt vmcnt(4)
    s_barrier
    s_waitcnt lgkmcnt(8)
    v_mfma_f32_16x16x32_bf16 v[144:147], v[224:227], v[48:51], v[144:147]
    v_mfma_f32_16x16x32_bf16 v[148:151], v[224:227], v[120:123], v[148:151]
    ds_read_b64_tr_b16 v[224:225], v236 offset:12288
    ds_read_b64_tr_b16 v[226:227], v236 offset:15360
    s_waitcnt lgkmcnt(8)
    v_mfma_f32_16x16x32_bf16 v[152:155], v[228:231], v[48:51], v[152:155]
    v_mfma_f32_16x16x32_bf16 v[156:159], v[228:231], v[120:123], v[156:159]
    ds_read_b64_tr_b16 v[228:229], v237 offset:12288
    ds_read_b64_tr_b16 v[230:231], v237 offset:15360
    s_waitcnt lgkmcnt(8)
    v_mfma_f32_16x16x32_bf16 v[160:163], v[232:235], v[48:51], v[160:163]
    v_mfma_f32_16x16x32_bf16 v[164:167], v[232:235], v[120:123], v[164:167]
    ds_read_b64_tr_b16 v[232:233], v238 offset:12288
    ds_read_b64_tr_b16 v[234:235], v238 offset:15360
    s_waitcnt lgkmcnt(8)
    v_mfma_f32_16x16x32_bf16 v[168:171], v[216:219], v[48:51], v[168:171]
    v_mfma_f32_16x16x32_bf16 v[172:175], v[216:219], v[120:123], v[172:175]
    ds_read_b64_tr_b16 v[216:217], v239 offset:12288
    ds_read_b64_tr_b16 v[218:219], v239 offset:15360
    s_waitcnt lgkmcnt(8)
    v_mfma_f32_16x16x32_bf16 v[176:179], v[220:223], v[48:51], v[176:179]
    v_mfma_f32_16x16x32_bf16 v[180:183], v[220:223], v[120:123], v[180:183]
    ds_read_b64_tr_b16 v[220:221], v236 offset:12416
    ds_read_b64_tr_b16 v[222:223], v236 offset:15488
    s_waitcnt lgkmcnt(8)
    v_mfma_f32_16x16x32_bf16 v[144:147], v[224:227], v[52:55], v[144:147]
    v_mfma_f32_16x16x32_bf16 v[148:151], v[224:227], v[124:127], v[148:151]
    ds_read_b64_tr_b16 v[224:225], v236 offset:24576
    ds_read_b64_tr_b16 v[226:227], v236 offset:27648
    s_waitcnt lgkmcnt(8)
    v_mfma_f32_16x16x32_bf16 v[152:155], v[228:231], v[52:55], v[152:155]
    v_mfma_f32_16x16x32_bf16 v[156:159], v[228:231], v[124:127], v[156:159]
    ds_read_b64_tr_b16 v[228:229], v237 offset:24576
    ds_read_b64_tr_b16 v[230:231], v237 offset:27648
    s_waitcnt lgkmcnt(8)
    v_mfma_f32_16x16x32_bf16 v[160:163], v[232:235], v[52:55], v[160:163]
    v_mfma_f32_16x16x32_bf16 v[164:167], v[232:235], v[124:127], v[164:167]
    ds_read_b64_tr_b16 v[232:233], v238 offset:24576
    ds_read_b64_tr_b16 v[234:235], v238 offset:27648
    s_waitcnt lgkmcnt(8)
    v_mfma_f32_16x16x32_bf16 v[168:171], v[216:219], v[52:55], v[168:171]
    v_mfma_f32_16x16x32_bf16 v[172:175], v[216:219], v[124:127], v[172:175]
    ds_read_b64_tr_b16 v[216:217], v239 offset:24576
    ds_read_b64_tr_b16 v[218:219], v239 offset:27648
    s_waitcnt lgkmcnt(8)
    v_mfma_f32_16x16x32_bf16 v[176:179], v[220:223], v[52:55], v[176:179]
    v_mfma_f32_16x16x32_bf16 v[180:183], v[220:223], v[124:127], v[180:183]
    ds_read_b64_tr_b16 v[220:221], v236 offset:24704
    ds_read_b64_tr_b16 v[222:223], v236 offset:27776
    s_waitcnt vmcnt(1)
    s_barrier
    s_waitcnt lgkmcnt(8)
    v_mfma_f32_16x16x32_bf16 v[144:147], v[224:227], v[56:59], v[144:147]
    v_mfma_f32_16x16x32_bf16 v[148:151], v[224:227], v[128:131], v[148:151]
    ds_read_b64_tr_b16 v[224:225], v236 offset:36864
    ds_read_b64_tr_b16 v[226:227], v236 offset:39936
    s_waitcnt lgkmcnt(8)
    v_mfma_f32_16x16x32_bf16 v[152:155], v[228:231], v[56:59], v[152:155]
    v_mfma_f32_16x16x32_bf16 v[156:159], v[228:231], v[128:131], v[156:159]
    ds_read_b64_tr_b16 v[228:229], v237 offset:36864
    ds_read_b64_tr_b16 v[230:231], v237 offset:39936
    s_waitcnt lgkmcnt(8)
    v_mfma_f32_16x16x32_bf16 v[160:163], v[232:235], v[56:59], v[160:163]
    v_mfma_f32_16x16x32_bf16 v[164:167], v[232:235], v[128:131], v[164:167]
    ds_read_b64_tr_b16 v[232:233], v238 offset:36864
    ds_read_b64_tr_b16 v[234:235], v238 offset:39936
    s_waitcnt lgkmcnt(8)
    v_mfma_f32_16x16x32_bf16 v[168:171], v[216:219], v[56:59], v[168:171]
    v_mfma_f32_16x16x32_bf16 v[172:175], v[216:219], v[128:131], v[172:175]
    ds_read_b64_tr_b16 v[216:217], v239 offset:36864
    ds_read_b64_tr_b16 v[218:219], v239 offset:39936
    s_waitcnt lgkmcnt(8)
    v_mfma_f32_16x16x32_bf16 v[176:179], v[220:223], v[56:59], v[176:179]
    v_mfma_f32_16x16x32_bf16 v[180:183], v[220:223], v[128:131], v[180:183]
    ds_read_b64_tr_b16 v[220:221], v236 offset:36992
    ds_read_b64_tr_b16 v[222:223], v236 offset:40064
    s_waitcnt lgkmcnt(8)
    v_mfma_f32_16x16x32_bf16 v[144:147], v[224:227], v[60:63], v[144:147]
    v_mfma_f32_16x16x32_bf16 v[148:151], v[224:227], v[132:135], v[148:151]
    ds_read_b64_tr_b16 v[224:225], v240 offset:0
    ds_read_b64_tr_b16 v[226:227], v240 offset:3072
    s_waitcnt lgkmcnt(8)
    v_mfma_f32_16x16x32_bf16 v[152:155], v[228:231], v[60:63], v[152:155]
    v_mfma_f32_16x16x32_bf16 v[156:159], v[228:231], v[132:135], v[156:159]
    ds_read_b64_tr_b16 v[228:229], v241 offset:0
    ds_read_b64_tr_b16 v[230:231], v241 offset:3072
    s_waitcnt vmcnt(0)
    v_readfirstlane_b32 s46, v254
    s_mov_b32 s56, 0
    s_nop 2
    s_cmp_lt_u32 s46, 16
    s_cbranch_scc1 L_kv_late_c0
    s_mov_b32 s56, 1
    v_lshlrev_b32 v248, 2, v247
    s_mul_i32 s48, s40, 3072
    buffer_load_dword v184, v248, s[8:11], s48 offen offset:0 sc1
    buffer_load_dword v185, v248, s[8:11], s48 offen offset:256 sc1
    buffer_load_dword v186, v248, s[8:11], s48 offen offset:512 sc1
    buffer_load_dword v187, v248, s[8:11], s48 offen offset:768 sc1
    buffer_load_dword v188, v248, s[8:11], s48 offen offset:1024 sc1
    buffer_load_dword v189, v248, s[8:11], s48 offen offset:1280 sc1
    buffer_load_dword v190, v248, s[8:11], s48 offen offset:1536 sc1
    buffer_load_dword v191, v248, s[8:11], s48 offen offset:1792 sc1
    buffer_load_dword v192, v248, s[8:11], s48 offen offset:2048 sc1
    buffer_load_dword v193, v248, s[8:11], s48 offen offset:2304 sc1
    buffer_load_dword v194, v248, s[8:11], s48 offen offset:2560 sc1
    buffer_load_dword v195, v248, s[8:11], s48 offen offset:2816 sc1
    s_add_u32 s48, s40, 27
    s_lshl_b32 s48, s48, 10
    v_and_b32 v249, 0xc0, v248
    buffer_load_dword v196, v249, s[8:11], s48 offen offset:0 sc1
    buffer_load_dword v197, v249, s[8:11], s48 offen offset:256 sc1
    buffer_load_dword v198, v249, s[8:11], s48 offen offset:512 sc1
    buffer_load_dword v199, v249, s[8:11], s48 offen offset:768 sc1
    s_cmp_lg_u32 s41, 0
    s_cbranch_scc1 L_kvl8a_c0
    s_mov_b32 s22, 8
    s_mul_i32 s48, s22, 3072
    buffer_load_dword v200, v248, s[8:11], s48 offen offset:0 sc1
    buffer_load_dword v201, v248, s[8:11], s48 offen offset:256 sc1
    buffer_load_dword v202, v248, s[8:11], s48 offen offset:512 sc1
    buffer_load_dword v203, v248, s[8:11], s48 offen offset:768 sc1
    buffer_load_dword v204, v248, s[8:11], s48 offen offset:1024 sc1
    buffer_load_dword v205, v248, s[8:11], s48 offen offset:1280 sc1
    buffer_load_dword v206, v248, s[8:11], s48 offen offset:1536 sc1
    buffer_load_dword v207, v248, s[8:11], s48 offen offset:1792 sc1
    buffer_load_dword v208, v248, s[8:11], s48 offen offset:2048 sc1
    buffer_load_dword v209, v248, s[8:11], s48 offen offset:2304 sc1
    buffer_load_dword v210, v248, s[8:11], s48 offen offset:2560 sc1
    buffer_load_dword v211, v248, s[8:11], s48 offen offset:2816 sc1
    s_add_u32 s48, s22, 27
    s_lshl_b32 s48, s48, 10
    v_and_b32 v249, 0xc0, v248
    buffer_load_dword v212, v249, s[8:11], s48 offen offset:0 sc1
    buffer_load_dword v213, v249, s[8:11], s48 offen offset:256 sc1
    buffer_load_dword v214, v249, s[8:11], s48 offen offset:512 sc1
    buffer_load_dword v215, v249, s[8:11], s48 offen offset:768 sc1
L_kvl8a_c0:
L_kv_late_c0:
    s_waitcnt lgkmcnt(8)
    v_mfma_f32_16x16x32_bf16 v[160:163], v[232:235], v[60:63], v[160:163]
    v_mfma_f32_16x16x32_bf16 v[164:167], v[232:235], v[132:135], v[164:167]
    ds_read_b64_tr_b16 v[232:233], v242 offset:0
    ds_read_b64_tr_b16 v[234:235], v242 offset:3072
    s_waitcnt lgkmcnt(8)
    v_mfma_f32_16x16x32_bf16 v[168:171], v[216:219], v[60:63], v[168:171]
    v_mfma_f32_16x16x32_bf16 v[172:175], v[216:219], v[132:135], v[172:175]
    ds_read_b64_tr_b16 v[216:217], v243 offset:0
    ds_read_b64_tr_b16 v[218:219], v243 offset:3072
    s_waitcnt lgkmcnt(8)
    v_mfma_f32_16x16x32_bf16 v[176:179], v[220:223], v[60:63], v[176:179]
    v_mfma_f32_16x16x32_bf16 v[180:183], v[220:223], v[132:135], v[180:183]
    ds_read_b64_tr_b16 v[220:221], v240 offset:128
    ds_read_b64_tr_b16 v[222:223], v240 offset:3200
    s_barrier
    s_waitcnt lgkmcnt(8)
    v_mfma_f32_16x16x32_bf16 v[144:147], v[224:227], v[64:67], v[144:147]
    v_mfma_f32_16x16x32_bf16 v[148:151], v[224:227], v[136:139], v[148:151]
    ds_read_b64_tr_b16 v[224:225], v240 offset:12288
    ds_read_b64_tr_b16 v[226:227], v240 offset:15360
    s_waitcnt lgkmcnt(8)
    v_mfma_f32_16x16x32_bf16 v[152:155], v[228:231], v[64:67], v[152:155]
    v_mfma_f32_16x16x32_bf16 v[156:159], v[228:231], v[136:139], v[156:159]
    ds_read_b64_tr_b16 v[228:229], v241 offset:12288
    ds_read_b64_tr_b16 v[230:231], v241 offset:15360
    s_waitcnt lgkmcnt(8)
    v_mfma_f32_16x16x32_bf16 v[160:163], v[232:235], v[64:67], v[160:163]
    v_mfma_f32_16x16x32_bf16 v[164:167], v[232:235], v[136:139], v[164:167]
    ds_read_b64_tr_b16 v[232:233], v242 offset:12288
    ds_read_b64_tr_b16 v[234:235], v242 offset:15360
    s_waitcnt lgkmcnt(8)
    v_mfma_f32_16x16x32_bf16 v[168:171], v[216:219], v[64:67], v[168:171]
    v_mfma_f32_16x16x32_bf16 v[172:175], v[216:219], v[136:139], v[172:175]
    ds_read_b64_tr_b16 v[216:217], v243 offset:12288
    ds_read_b64_tr_b16 v[218:219], v243 offset:15360
    s_waitcnt lgkmcnt(8)
    v_mfma_f32_16x16x32_bf16 v[176:179], v[220:223], v[64:67], v[176:179]
    v_mfma_f32_16x16x32_bf16 v[180:183], v[220:223], v[136:139], v[180:183]
    ds_read_b64_tr_b16 v[220:221], v240 offset:12416
    ds_read_b64_tr_b16 v[222:223], v240 offset:15488
    s_waitcnt lgkmcnt(8)
    v_mfma_f32_16x16x32_bf16 v[144:147], v[224:227], v[68:71], v[144:147]
    v_mfma_f32_16x16x32_bf16 v[148:151], v[224:227], v[140:143], v[148:151]
    s_waitcnt lgkmcnt(6)
    v_mfma_f32_16x16x32_bf16 v[152:155], v[228:231], v[68:71], v[152:155]
    v_mfma_f32_16x16x32_bf16 v[156:159], v[228:231], v[140:143], v[156:159]
    s_waitcnt lgkmcnt(4)
    v_mfma_f32_16x16x32_bf16 v[160:163], v[232:235], v[68:71], v[160:163]
    v_mfma_f32_16x16x32_bf16 v[164:167], v[232:235], v[140:143], v[164:167]
    s_waitcnt lgkmcnt(2)
    v_mfma_f32_16x16x32_bf16 v[168:171], v[216:219], v[68:71], v[168:171]
    v_mfma_f32_16x16x32_bf16 v[172:175], v[216:219], v[140:143], v[172:175]
    s_waitcnt lgkmcnt(0)
    v_mfma_f32_16x16x32_bf16 v[176:179], v[220:223], v[68:71], v[176:179]
    v_mfma_f32_16x16x32_bf16 v[180:183], v[220:223], v[140:143], v[180:183]
    s_and_b32 s47, s40, 3
    s_mul_i32 s46, s40, 18
    v_add_u32 v248, 0, v247
    v_mul_u32_u24 v249, 2731, v248
    v_lshrrev_b32 v249, 16, v249
    v_mul_u32_u24 v250, 24, v249
    v_sub_u32 v250, v248, v250
    v_lshrrev_b32 v251, 1, v249
    v_add_u32 v251, s47, v251
    v_and_b32 v251, 3, v251
    v_lshlrev_b32 v251, 1, v251
    v_xor_b32 v250, v250, v251
    v_add_u32 v249, s46, v249
    v_mul_u32_u24 v249, 1152, v249
    v_lshl_add_u32 v244, v250, 4, v249
    v_add_u32 v248, 64, v247
    v_mul_u32_u24 v249, 2731, v248
    v_lshrrev_b32 v249, 16, v249
    v_mul_u32_u24 v250, 24, v249
    v_sub_u32 v250, v248, v250
    v_lshrrev_b32 v251, 1, v249
    v_add_u32 v251, s47, v251
    v_and_b32 v251, 3, v251
    v_lshlrev_b32 v251, 1, v251
    v_xor_b32 v250, v250, v251
    v_add_u32 v249, s46, v249
    v_mul_u32_u24 v249, 1152, v249
    v_lshl_add_u32 v245, v250, 4, v249
    v_add_u32 v248, 128, v247
    v_mul_u32_u24 v249, 2731, v248
    v_lshrrev_b32 v249, 16, v249
    v_mul_u32_u24 v250, 24, v249
    v_sub_u32 v250, v248, v250
    v_lshrrev_b32 v251, 1, v249
    v_add_u32 v251, s47, v251
    v_and_b32 v251, 3, v251
    v_lshlrev_b32 v251, 1, v251
    v_xor_b32 v250, v250, v251
    v_add_u32 v249, s46, v249
    v_mul_u32_u24 v249, 1152, v249
    v_lshl_add_u32 v246, v250, 4, v249
    s_mul_i32 s55, s40, 6912
    s_waitcnt lgkmcnt(0)
    s_barrier
    s_cmp_eq_u32 s56, 1
    s_cbranch_scc1 L_kv_have_c0
    s_waitcnt vmcnt(0)
    buffer_load_dword v254, v255, s[16:19], 0 offen sc1
    s_waitcnt vmcnt(0)
    s_mov_b32 s47, 0
L_poll_3:
    v_readfirstlane_b32 s46, v254
    s_add_u32 s47, s47, 1
    s_nop 2
    s_cmp_ge_u32 s46, 16
    s_cbranch_scc1 L_pollok_4
    s_cmp_ge_u32 s47, 50000
    s_cbranch_scc1 L_pollok_4
    s_sleep 2
    buffer_load_dword v254, v255, s[16:19], 0 offen sc1
    s_waitcnt vmcnt(0)
    s_branch L_poll_3
L_pollok_4:
    v_lshlrev_b32 v248, 2, v247
    s_mul_i32 s48, s40, 3072
    buffer_load_dword v184, v248, s[8:11], s48 offen offset:0 sc1
    buffer_load_dword v185, v248, s[8:11], s48 offen offset:256 sc1
    buffer_load_dword v186, v248, s[8:11], s48 offen offset:512 sc1
    buffer_load_dword v187, v248, s[8:11], s48 offen offset:768 sc1
    buffer_load_dword v188, v248, s[8:11], s48 offen offset:1024 sc1
    buffer_load_dword v189, v248, s[8:11], s48 offen offset:1280 sc1
    buffer_load_dword v190, v248, s[8:11], s48 offen offset:1536 sc1
    buffer_load_dword v191, v248, s[8:11], s48 offen offset:1792 sc1
    buffer_load_dword v192, v248, s[8:11], s48 offen offset:2048 sc1
    buffer_load_dword v193, v248, s[8:11], s48 offen offset:2304 sc1
    buffer_load_dword v194, v248, s[8:11], s48 offen offset:2560 sc1
    buffer_load_dword v195, v248, s[8:11], s48 offen offset:2816 sc1
    s_add_u32 s48, s40, 27
    s_lshl_b32 s48, s48, 10
    v_and_b32 v249, 0xc0, v248
    buffer_load_dword v196, v249, s[8:11], s48 offen offset:0 sc1
    buffer_load_dword v197, v249, s[8:11], s48 offen offset:256 sc1
    buffer_load_dword v198, v249, s[8:11], s48 offen offset:512 sc1
    buffer_load_dword v199, v249, s[8:11], s48 offen offset:768 sc1
    s_cmp_lg_u32 s41, 0
    s_cbranch_scc1 L_kvl8b_c0
    s_mov_b32 s22, 8
    s_mul_i32 s48, s22, 3072
    buffer_load_dword v200, v248, s[8:11], s48 offen offset:0 sc1
    buffer_load_dword v201, v248, s[8:11], s48 offen offset:256 sc1
    buffer_load_dword v202, v248, s[8:11], s48 offen offset:512 sc1
    buffer_load_dword v203, v248, s[8:11], s48 offen offset:768 sc1
    buffer_load_dword v204, v248, s[8:11], s48 offen offset:1024 sc1
    buffer_load_dword v205, v248, s[8:11], s48 offen offset:1280 sc1
    buffer_load_dword v206, v248, s[8:11], s48 offen offset:1536 sc1
    buffer_load_dword v207, v248, s[8:11], s48 offen offset:1792 sc1
    buffer_load_dword v208, v248, s[8:11], s48 offen offset:2048 sc1
    buffer_load_dword v209, v248, s[8:11], s48 offen offset:2304 sc1
    buffer_load_dword v210, v248, s[8:11], s48 offen offset:2560 sc1
    buffer_load_dword v211, v248, s[8:11], s48 offen offset:2816 sc1
    s_add_u32 s48, s22, 27
    s_lshl_b32 s48, s48, 10
    v_and_b32 v249, 0xc0, v248
    buffer_load_dword v212, v249, s[8:11], s48 offen offset:0 sc1
    buffer_load_dword v213, v249, s[8:11], s48 offen offset:256 sc1
    buffer_load_dword v214, v249, s[8:11], s48 offen offset:512 sc1
    buffer_load_dword v215, v249, s[8:11], s48 offen offset:768 sc1
L_kvl8b_c0:
L_kv_have_c0:
    v_mul_f32 v216, s51, v252
    v_mul_f32 v217, s51, v253
    s_mul_i32 s46, s41, 9216
    s_add_u32 s46, s46, 98304
    v_lshl_add_u32 v249, v247, 3, s46
    v_mul_f32 v218, v144, v216
    v_mul_f32 v219, v145, v216
    v_mul_f32 v220, v146, v216
    v_mul_f32 v221, v147, v216
    v_mul_f32 v222, v148, v217
    v_mul_f32 v223, v149, v217
    v_mul_f32 v224, v150, v217
    v_mul_f32 v225, v151, v217
    v_min_f32 v218, 0, v218
    v_min_f32 v219, 0, v219
    v_min_f32 v220, 0, v220
    v_min_f32 v221, 0, v221
    v_min_f32 v222, 0, v222
    v_min_f32 v223, 0, v223
    v_min_f32 v224, 0, v224
    v_min_f32 v225, 0, v225
    v_exp_f32 v218, v218
    v_exp_f32 v219, v219
    v_exp_f32 v220, v220
    v_exp_f32 v221, v221
    v_exp_f32 v222, v222
    v_exp_f32 v223, v223
    v_exp_f32 v224, v224
    v_exp_f32 v225, v225
    v_max_f32 v144, 0, v144
    v_max_f32 v145, 0, v145
    v_max_f32 v146, 0, v146
    v_max_f32 v147, 0, v147
    v_max_f32 v148, 0, v148
    v_max_f32 v149, 0, v149
    v_max_f32 v150, 0, v150
    v_max_f32 v151, 0, v151
    v_add_f32 v218, 0x358637bd, v218
    v_add_f32 v219, 0x358637bd, v219
    v_add_f32 v220, 0x358637bd, v220
    v_add_f32 v221, 0x358637bd, v221
    v_add_f32 v222, 0x358637bd, v222
    v_add_f32 v223, 0x358637bd, v223
    v_add_f32 v224, 0x358637bd, v224
    v_add_f32 v225, 0x358637bd, v225
    v_fma_f32 v144, v144, v252, v218
    v_fma_f32 v145, v145, v252, v219
    v_fma_f32 v146, v146, v252, v220
    v_fma_f32 v147, v147, v252, v221
    v_fma_f32 v148, v148, v253, v222
    v_fma_f32 v149, v149, v253, v223
    v_fma_f32 v150, v150, v253, v224
    v_fma_f32 v151, v151, v253, v225
    v_cvt_pk_bf16_f32 v144, v144, v145
    v_cvt_pk_bf16_f32 v145, v146, v147
    ds_write_b64 v249, v[144:145] offset:0
    v_cvt_pk_bf16_f32 v148, v148, v149
    v_cvt_pk_bf16_f32 v149, v150, v151
    ds_write_b64 v249, v[148:149] offset:4608
    s_add_u32 m0, s55, 0
    s_mov_b32 s49, 0
    buffer_load_dwordx4 v244, s[32:35], s49 offen lds
    s_add_u32 m0, s55, 1024
    s_mov_b32 s49, 0
    buffer_load_dwordx4 v245, s[32:35], s49 offen lds
    v_mul_f32 v218, v152, v216
    v_mul_f32 v219, v153, v216
    v_mul_f32 v220, v154, v216
    v_mul_f32 v221, v155, v216
    v_mul_f32 v222, v156, v217
    v_mul_f32 v223, v157, v217
    v_mul_f32 v224, v158, v217
    v_mul_f32 v225, v159, v217
    v_min_f32 v218, 0, v218
    v_min_f32 v219, 0, v219
    v_min_f32 v220, 0, v220
    v_min_f32 v221, 0, v221
    v_min_f32 v222, 0, v222
    v_min_f32 v223, 0, v223
    v_min_f32 v224, 0, v224
    v_min_f32 v225, 0, v225
    v_exp_f32 v218, v218
    v_exp_f32 v219, v219
    v_exp_f32 v220, v220
    v_exp_f32 v221, v221
    v_exp_f32 v222, v222
    v_exp_f32 v223, v223
    v_exp_f32 v224, v224
    v_exp_f32 v225, v225
    v_max_f32 v152, 0, v152
    v_max_f32 v153, 0, v153
    v_max_f32 v154, 0, v154
    v_max_f32 v155, 0, v155
    v_max_f32 v156, 0, v156
    v_max_f32 v157, 0, v157
    v_max_f32 v158, 0, v158
    v_max_f32 v159, 0, v159
    v_add_f32 v218, 0x358637bd, v218
    v_add_f32 v219, 0x358637bd, v219
    v_add_f32 v220, 0x358637bd, v220
    v_add_f32 v221, 0x358637bd, v221
    v_add_f32 v222, 0x358637bd, v222
    v_add_f32 v223, 0x358637bd, v223
    v_add_f32 v224, 0x358637bd, v224
    v_add_f32 v225, 0x358637bd, v225
    v_fma_f32 v152, v152, v252, v218
    v_fma_f32 v153, v153, v252, v219
    v_fma_f32 v154, v154, v252, v220
    v_fma_f32 v155, v155, v252, v221
    v_fma_f32 v156, v156, v253, v222
    v_fma_f32 v157, v157, v253, v223
    v_fma_f32 v158, v158, v253, v224
    v_fma_f32 v159, v159, v253, v225
    v_cvt_pk_bf16_f32 v152, v152, v153
    v_cvt_pk_bf16_f32 v153, v154, v155
    ds_write_b64 v249, v[152:153] offset:512
    v_cvt_pk_bf16_f32 v156, v156, v157
    v_cvt_pk_bf16_f32 v157, v158, v159
    ds_write_b64 v249, v[156:157] offset:5120
    s_add_u32 m0, s55, 2048
    s_mov_b32 s49, 0
    buffer_load_dwordx4 v246, s[32:35], s49 offen lds
    s_add_u32 m0, s55, 3072
    s_mov_b32 s49, 9216
    buffer_load_dwordx4 v244, s[32:35], s49 offen lds
    v_mul_f32 v218, v160, v216
    v_mul_f32 v219, v161, v216
    v_mul_f32 v220, v162, v216
    v_mul_f32 v221, v163, v216
    v_mul_f32 v222, v164, v217
    v_mul_f32 v223, v165, v217
    v_mul_f32 v224, v166, v217
    v_mul_f32 v225, v167, v217
    v_min_f32 v218, 0, v218
    v_min_f32 v219, 0, v219
    v_min_f32 v220, 0, v220
    v_min_f32 v221, 0, v221
    v_min_f32 v222, 0, v222
    v_min_f32 v223, 0, v223
    v_min_f32 v224, 0, v224
    v_min_f32 v225, 0, v225
    v_exp_f32 v218, v218
    v_exp_f32 v219, v219
    v_exp_f32 v220, v220
    v_exp_f32 v221, v221
    v_exp_f32 v222, v222
    v_exp_f32 v223, v223
    v_exp_f32 v224, v224
    v_exp_f32 v225, v225
    v_max_f32 v160, 0, v160
    v_max_f32 v161, 0, v161
    v_max_f32 v162, 0, v162
    v_max_f32 v163, 0, v163
    v_max_f32 v164, 0, v164
    v_max_f32 v165, 0, v165
    v_max_f32 v166, 0, v166
    v_max_f32 v167, 0, v167
    v_add_f32 v218, 0x358637bd, v218
    v_add_f32 v219, 0x358637bd, v219
    v_add_f32 v220, 0x358637bd, v220
    v_add_f32 v221, 0x358637bd, v221
    v_add_f32 v222, 0x358637bd, v222
    v_add_f32 v223, 0x358637bd, v223
    v_add_f32 v224, 0x358637bd, v224
    v_add_f32 v225, 0x358637bd, v225
    v_fma_f32 v160, v160, v252, v218
    v_fma_f32 v161, v161, v252, v219
    v_fma_f32 v162, v162, v252, v220
    v_fma_f32 v163, v163, v252, v221
    v_fma_f32 v164, v164, v253, v222
    v_fma_f32 v165, v165, v253, v223
    v_fma_f32 v166, v166, v253, v224
    v_fma_f32 v167, v167, v253, v225
    v_cvt_pk_bf16_f32 v160, v160, v161
    v_cvt_pk_bf16_f32 v161, v162, v163
    ds_write_b64 v249, v[160:161] offset:1024
    v_cvt_pk_bf16_f32 v164, v164, v165
    v_cvt_pk_bf16_f32 v165, v166, v167
    ds_write_b64 v249, v[164:165] offset:5632
    s_add_u32 m0, s55, 4096
    s_mov_b32 s49, 9216
    buffer_load_dwordx4 v245, s[32:35], s49 offen lds
    s_add_u32 m0, s55, 5120
    s_mov_b32 s49, 9216
    buffer_load_dwordx4 v246, s[32:35], s49 offen lds
    v_mul_f32 v218, v168, v216
    v_mul_f32 v219, v169, v216
    v_mul_f32 v220, v170, v216
    v_mul_f32 v221, v171, v216
    v_mul_f32 v222, v172, v217
    v_mul_f32 v223, v173, v217
    v_mul_f32 v224, v174, v217
    v_mul_f32 v225, v175, v217
    v_min_f32 v218, 0, v218
    v_min_f32 v219, 0, v219
    v_min_f32 v220, 0, v220
    v_min_f32 v221, 0, v221
    v_min_f32 v222, 0, v222
    v_min_f32 v223, 0, v223
    v_min_f32 v224, 0, v224
    v_min_f32 v225, 0, v225
    v_exp_f32 v218, v218
    v_exp_f32 v219, v219
    v_exp_f32 v220, v220
    v_exp_f32 v221, v221
    v_exp_f32 v222, v222
    v_exp_f32 v223, v223
    v_exp_f32 v224, v224
    v_exp_f32 v225, v225
    v_max_f32 v168, 0, v168
    v_max_f32 v169, 0, v169
    v_max_f32 v170, 0, v170
    v_max_f32 v171, 0, v171
    v_max_f32 v172, 0, v172
    v_max_f32 v173, 0, v173
    v_max_f32 v174, 0, v174
    v_max_f32 v175, 0, v175
    v_add_f32 v218, 0x358637bd, v218
    v_add_f32 v219, 0x358637bd, v219
    v_add_f32 v220, 0x358637bd, v220
    v_add_f32 v221, 0x358637bd, v221
    v_add_f32 v222, 0x358637bd, v222
    v_add_f32 v223, 0x358637bd, v223
    v_add_f32 v224, 0x358637bd, v224
    v_add_f32 v225, 0x358637bd, v225
    v_fma_f32 v168, v168, v252, v218
    v_fma_f32 v169, v169, v252, v219
    v_fma_f32 v170, v170, v252, v220
    v_fma_f32 v171, v171, v252, v221
    v_fma_f32 v172, v172, v253, v222
    v_fma_f32 v173, v173, v253, v223
    v_fma_f32 v174, v174, v253, v224
    v_fma_f32 v175, v175, v253, v225
    v_cvt_pk_bf16_f32 v168, v168, v169
    v_cvt_pk_bf16_f32 v169, v170, v171
    ds_write_b64 v249, v[168:169] offset:1536
    v_cvt_pk_bf16_f32 v172, v172, v173
    v_cvt_pk_bf16_f32 v173, v174, v175
    ds_write_b64 v249, v[172:173] offset:6144
    s_mov_b32 exec_hi, 0xffff
    s_add_u32 m0, s55, 6144
    s_mov_b32 s49, 18432
    buffer_load_dwordx4 v244, s[32:35], s49 offen lds
    s_mov_b32 exec_hi, -1
    v_mul_f32 v218, v176, v216
    v_mul_f32 v219, v177, v216
    v_mul_f32 v220, v178, v216
    v_mul_f32 v221, v179, v216
    v_mul_f32 v222, v180, v217
    v_mul_f32 v223, v181, v217
    v_mul_f32 v224, v182, v217
    v_mul_f32 v225, v183, v217
    v_min_f32 v218, 0, v218
    v_min_f32 v219, 0, v219
    v_min_f32 v220, 0, v220
    v_min_f32 v221, 0, v221
    v_min_f32 v222, 0, v222
    v_min_f32 v223, 0, v223
    v_min_f32 v224, 0, v224
    v_min_f32 v225, 0, v225
    v_exp_f32 v218, v218
    v_exp_f32 v219, v219
    v_exp_f32 v220, v220
    v_exp_f32 v221, v221
    v_exp_f32 v222, v222
    v_exp_f32 v223, v223
    v_exp_f32 v224, v224
    v_exp_f32 v225, v225
    v_max_f32 v176, 0, v176
    v_max_f32 v177, 0, v177
    v_max_f32 v178, 0, v178
    v_max_f32 v179, 0, v179
    v_max_f32 v180, 0, v180
    v_max_f32 v181, 0, v181
    v_max_f32 v182, 0, v182
    v_max_f32 v183, 0, v183
    v_add_f32 v218, 0x358637bd, v218
    v_add_f32 v219, 0x358637bd, v219
    v_add_f32 v220, 0x358637bd, v220
    v_add_f32 v221, 0x358637bd, v221
    v_add_f32 v222, 0x358637bd, v222
    v_add_f32 v223, 0x358637bd, v223
    v_add_f32 v224, 0x358637bd, v224
    v_add_f32 v225, 0x358637bd, v225
    v_fma_f32 v176, v176, v252, v218
    v_fma_f32 v177, v177, v252, v219
    v_fma_f32 v178, v178, v252, v220
    v_fma_f32 v179, v179, v252, v221
    v_fma_f32 v180, v180, v253, v222
    v_fma_f32 v181, v181, v253, v223
    v_fma_f32 v182, v182, v253, v224
    v_fma_f32 v183, v183, v253, v225
    v_cvt_pk_bf16_f32 v176, v176, v177
    v_cvt_pk_bf16_f32 v177, v178, v179
    ds_write_b64 v249, v[176:177] offset:2048
    v_cvt_pk_bf16_f32 v180, v180, v181
    v_cvt_pk_bf16_f32 v181, v182, v183
    ds_write_b64 v249, v[180:181] offset:6656
    v_lshrrev_b32 v250, 4, v247
    v_lshlrev_b32 v250, 2, v250
    v_and_b32 v251, 15, v247
    s_waitcnt vmcnt(7)
    s_lshl_b32 s46, s40, 4
    v_add_u32 v24, s46, v250
    v_mul_u32_u24 v24, 3641, v24
    v_lshrrev_b32 v24, 16, v24
    v_add_u32 v25, s46, v250
    v_add_u32 v25, 1, v25
    v_mul_u32_u24 v25, 3641, v25
    v_lshrrev_b32 v25, 16, v25
    v_add_u32 v26, s46, v250
    v_add_u32 v26, 2, v26
    v_mul_u32_u24 v26, 3641, v26
    v_lshrrev_b32 v26, 16, v26
    v_add_u32 v27, s46, v250
    v_add_u32 v27, 3, v27
    v_mul_u32_u24 v27, 3641, v27
    v_lshrrev_b32 v27, 16, v27
    s_mul_i32 s46, s40, 1536
    s_add_u32 s46, s46, 135168
    v_lshl_add_u32 v30, v247, 3, s46
    s_add_u32 s46, s40, 15
    s_lshl_b32 s46, s46, 4
    s_sub_u32 s46, s46, 256
    v_add_u32 v28, s46, v251
    v_and_b32 v28, 0xff, v28
    v_mul_u32_u24 v28, 3641, v28
    v_lshrrev_b32 v28, 16, v28
    v_cmp_eq_u32 vcc, v24, v28
    s_nop 1
    v_cndmask_b32 v32, 0, v196, vcc
    v_cmp_eq_u32 vcc, v25, v28
    s_nop 1
    v_cndmask_b32 v33, 0, v197, vcc
    v_cmp_eq_u32 vcc, v26, v28
    s_nop 1
    v_cndmask_b32 v34, 0, v198, vcc
    v_cmp_eq_u32 vcc, v27, v28
    s_nop 1
    v_cndmask_b32 v35, 0, v199, vcc
    v_cvt_pk_bf16_f32 v36, v184, v185
    v_cvt_pk_bf16_f32 v37, v186, v187
    v_cvt_pk_bf16_f32 v38, v32, v33
    v_cvt_pk_bf16_f32 v39, v34, v35
    ds_write_b64 v30, v[36:37] offset:0
    ds_write_b64 v30, v[38:39] offset:13824
    s_nop 1
    s_add_u32 s46, s40, 16
    s_lshl_b32 s46, s46, 4
    s_sub_u32 s46, s46, 256
    v_add_u32 v28, s46, v251
    v_and_b32 v28, 0xff, v28
    v_mul_u32_u24 v28, 3641, v28
    v_lshrrev_b32 v28, 16, v28
    v_cmp_eq_u32 vcc, v24, v28
    s_nop 1
    v_cndmask_b32 v32, 0, v196, vcc
    v_cmp_eq_u32 vcc, v25, v28
    s_nop 1
    v_cndmask_b32 v33, 0, v197, vcc
    v_cmp_eq_u32 vcc, v26, v28
    s_nop 1
    v_cndmask_b32 v34, 0, v198, vcc
    v_cmp_eq_u32 vcc, v27, v28
    s_nop 1
    v_cndmask_b32 v35, 0, v199, vcc
    v_cvt_pk_bf16_f32 v36, v188, v189
    v_cvt_pk_bf16_f32 v37, v190, v191
    v_cvt_pk_bf16_f32 v38, v32, v33
    v_cvt_pk_bf16_f32 v39, v34, v35
    ds_write_b64 v30, v[36:37] offset:512
    ds_write_b64 v30, v[38:39] offset:14336
    s_nop 1
    s_add_u32 s46, s40, 17
    s_lshl_b32 s46, s46, 4
    s_sub_u32 s46, s46, 256
    v_add_u32 v28, s46, v251
    v_and_b32 v28, 0xff, v28
    v_mul_u32_u24 v28, 3641, v28
    v_lshrrev_b32 v28, 16, v28
    v_cmp_eq_u32 vcc, v24, v28
    s_nop 1
    v_cndmask_b32 v32, 0, v196, vcc
    v_cmp_eq_u32 vcc, v25, v28
    s_nop 1
    v_cndmask_b32 v33, 0, v197, vcc
    v_cmp_eq_u32 vcc, v26, v28
    s_nop 1
    v_cndmask_b32 v34, 0, v198, vcc
    v_cmp_eq_u32 vcc, v27, v28
    s_nop 1
    v_cndmask_b32 v35, 0, v199, vcc
    v_cvt_pk_bf16_f32 v36, v192, v193
    v_cvt_pk_bf16_f32 v37, v194, v195
    v_cvt_pk_bf16_f32 v38, v32, v33
    v_cvt_pk_bf16_f32 v39, v34, v35
    ds_write_b64 v30, v[36:37] offset:1024
    ds_write_b64 v30, v[38:39] offset:14848
    s_nop 1
    s_cmp_lg_u32 s41, 0
    s_cbranch_scc1 L_kvf8_c0
    s_lshl_b32 s46, s22, 4
    v_add_u32 v24, s46, v250
    v_mul_u32_u24 v24, 3641, v24
    v_lshrrev_b32 v24, 16, v24
    v_add_u32 v25, s46, v250
    v_add_u32 v25, 1, v25
    v_mul_u32_u24 v25, 3641, v25
    v_lshrrev_b32 v25, 16, v25
    v_add_u32 v26, s46, v250
    v_add_u32 v26, 2, v26
    v_mul_u32_u24 v26, 3641, v26
    v_lshrrev_b32 v26, 16, v26
    v_add_u32 v27, s46, v250
    v_add_u32 v27, 3, v27
    v_mul_u32_u24 v27, 3641, v27
    v_lshrrev_b32 v27, 16, v27
    s_mul_i32 s46, s22, 1536
    s_add_u32 s46, s46, 135168
    v_lshl_add_u32 v30, v247, 3, s46
    s_add_u32 s46, s22, 15
    s_lshl_b32 s46, s46, 4
    s_sub_u32 s46, s46, 256
    v_add_u32 v28, s46, v251
    v_and_b32 v28, 0xff, v28
    v_mul_u32_u24 v28, 3641, v28
    v_lshrrev_b32 v28, 16, v28
    v_cmp_eq_u32 vcc, v24, v28
    s_nop 1
    v_cndmask_b32 v32, 0, v212, vcc
    v_cmp_eq_u32 vcc, v25, v28
    s_nop 1
    v_cndmask_b32 v33, 0, v213, vcc
    v_cmp_eq_u32 vcc, v26, v28
    s_nop 1
    v_cndmask_b32 v34, 0, v214, vcc
    v_cmp_eq_u32 vcc, v27, v28
    s_nop 1
    v_cndmask_b32 v35, 0, v215, vcc
    v_cvt_pk_bf16_f32 v36, v200, v201
    v_cvt_pk_bf16_f32 v37, v202, v203
    v_cvt_pk_bf16_f32 v38, v32, v33
    v_cvt_pk_bf16_f32 v39, v34, v35
    ds_write_b64 v30, v[36:37] offset:0
    ds_write_b64 v30, v[38:39] offset:13824
    s_nop 1
    s_add_u32 s46, s22, 16
    s_lshl_b32 s46, s46, 4
    s_sub_u32 s46, s46, 256
    v_add_u32 v28, s46, v251
    v_and_b32 v28, 0xff, v28
    v_mul_u32_u24 v28, 3641, v28
    v_lshrrev_b32 v28, 16, v28
    v_cmp_eq_u32 vcc, v24, v28
    s_nop 1
    v_cndmask_b32 v32, 0, v212, vcc
    v_cmp_eq_u32 vcc, v25, v28
    s_nop 1
    v_cndmask_b32 v33, 0, v213, vcc
    v_cmp_eq_u32 vcc, v26, v28
    s_nop 1
    v_cndmask_b32 v34, 0, v214, vcc
    v_cmp_eq_u32 vcc, v27, v28
    s_nop 1
    v_cndmask_b32 v35, 0, v215, vcc
    v_cvt_pk_bf16_f32 v36, v204, v205
    v_cvt_pk_bf16_f32 v37, v206, v207
    v_cvt_pk_bf16_f32 v38, v32, v33
    v_cvt_pk_bf16_f32 v39, v34, v35
    ds_write_b64 v30, v[36:37] offset:512
    ds_write_b64 v30, v[38:39] offset:14336
    s_nop 1
    s_add_u32 s46, s22, 17
    s_lshl_b32 s46, s46, 4
    s_sub_u32 s46, s46, 256
    v_add_u32 v28, s46, v251
    v_and_b32 v28, 0xff, v28
    v_mul_u32_u24 v28, 3641, v28
    v_lshrrev_b32 v28, 16, v28
    v_cmp_eq_u32 vcc, v24, v28
    s_nop 1
    v_cndmask_b32 v32, 0, v212, vcc
    v_cmp_eq_u32 vcc, v25, v28
    s_nop 1
    v_cndmask_b32 v33, 0, v213, vcc
    v_cmp_eq_u32 vcc, v26, v28
    s_nop 1
    v_cndmask_b32 v34, 0, v214, vcc
    v_cmp_eq_u32 vcc, v27, v28
    s_nop 1
    v_cndmask_b32 v35, 0, v215, vcc
    v_cvt_pk_bf16_f32 v36, v208, v209
    v_cvt_pk_bf16_f32 v37, v210, v211
    v_cvt_pk_bf16_f32 v38, v32, v33
    v_cvt_pk_bf16_f32 v39, v34, v35
    ds_write_b64 v30, v[36:37] offset:1024
    ds_write_b64 v30, v[38:39] offset:14848
    s_nop 1
L_kvf8_c0:
    s_waitcnt lgkmcnt(0)
    s_barrier
    s_lshl_b32 s46, s41, 1
    s_add_u32 s46, s46, 0
    s_mul_i32 s46, s46, 4608
    s_add_u32 s46, s46, 98304
    v_lshl_add_u32 v248, v247, 3, s46
    ds_read_b64 v[40:41], v248 offset:0
    ds_read_b64 v[42:43], v248 offset:512
    ds_read_b64 v[44:45], v248 offset:1024
    ds_read_b64 v[46:47], v248 offset:1536
    ds_read_b64 v[48:49], v248 offset:2048
    ds_read_b64 v[50:51], v248 offset:2560
    ds_read_b64 v[52:53], v248 offset:3072
    ds_read_b64 v[54:55], v248 offset:3584
    ds_read_b64 v[56:57], v248 offset:4096
    v_lshlrev_b32 v249, 3, v247
    v_add_u32 v249, 135168, v249
    ds_read_b64 v[60:61], v249 offset:512
    ds_read_b64 v[66:67], v249 offset:14336
    ds_read_b64 v[62:63], v249 offset:1536
    ds_read_b64 v[68:69], v249 offset:15360
    ds_read_b64 v[72:73], v249 offset:1024
    ds_read_b64 v[78:79], v249 offset:14848
    ds_read_b64 v[74:75], v249 offset:2048
    ds_read_b64 v[80:81], v249 offset:15872
    ds_read_b64 v[76:77], v249 offset:3072
    ds_read_b64 v[82:83], v249 offset:16896
    s_waitcnt lgkmcnt(6)
    v_mfma_f32_16x16x16_bf16 v[84:87], v[60:61], v[40:41], 0
    v_mfma_f32_16x16x16_bf16 v[84:87], v[62:63], v[42:43], v[84:87]
    v_mfma_f32_16x16x16_bf16 v[120:123], v[66:67], v[40:41], 0
    v_mfma_f32_16x16x16_bf16 v[120:123], v[68:69], v[42:43], v[120:123]
    ds_read_b64 v[60:61], v249 offset:2560
    ds_read_b64 v[66:67], v249 offset:16384
    ds_read_b64 v[62:63], v249 offset:3584
    ds_read_b64 v[68:69], v249 offset:17408
    ds_read_b64 v[64:65], v249 offset:4608
    ds_read_b64 v[70:71], v249 offset:18432
    s_waitcnt lgkmcnt(6)
    v_mfma_f32_16x16x16_bf16 v[88:91], v[72:73], v[40:41], 0
    v_mfma_f32_16x16x16_bf16 v[88:91], v[74:75], v[42:43], v[88:91]
    v_mfma_f32_16x16x16_bf16 v[88:91], v[76:77], v[44:45], v[88:91]
    v_mfma_f32_16x16x16_bf16 v[124:127], v[78:79], v[40:41], 0
    v_mfma_f32_16x16x16_bf16 v[124:127], v[80:81], v[42:43], v[124:127]
    v_mfma_f32_16x16x16_bf16 v[124:127], v[82:83], v[44:45], v[124:127]
    ds_read_b64 v[72:73], v249 offset:4096
    ds_read_b64 v[78:79], v249 offset:17920
    ds_read_b64 v[74:75], v249 offset:5120
    ds_read_b64 v[80:81], v249 offset:18944
    ds_read_b64 v[76:77], v249 offset:6144
    ds_read_b64 v[82:83], v249 offset:19968
    s_waitcnt lgkmcnt(6)
    v_mfma_f32_16x16x16_bf16 v[92:95], v[60:61], v[42:43], 0
    v_mfma_f32_16x16x16_bf16 v[92:95], v[62:63], v[44:45], v[92:95]
    v_mfma_f32_16x16x16_bf16 v[92:95], v[64:65], v[46:47], v[92:95]
    v_mfma_f32_16x16x16_bf16 v[128:131], v[66:67], v[42:43], 0
    v_mfma_f32_16x16x16_bf16 v[128:131], v[68:69], v[44:45], v[128:131]
    v_mfma_f32_16x16x16_bf16 v[128:131], v[70:71], v[46:47], v[128:131]
    v_add_f32 v120, 0x358637bd, v120
    v_add_f32 v121, 0x358637bd, v121
    v_add_f32 v122, 0x358637bd, v122
    v_add_f32 v123, 0x358637bd, v123
    v_rcp_f32 v120, v120
    v_rcp_f32 v121, v121
    v_rcp_f32 v122, v122
    v_rcp_f32 v123, v123
    ds_read_b64 v[60:61], v249 offset:5632
    ds_read_b64 v[66:67], v249 offset:19456
    ds_read_b64 v[62:63], v249 offset:6656
    ds_read_b64 v[68:69], v249 offset:20480
    ds_read_b64 v[64:65], v249 offset:7680
    ds_read_b64 v[70:71], v249 offset:21504
    s_waitcnt lgkmcnt(6)
    v_mfma_f32_16x16x16_bf16 v[96:99], v[72:73], v[44:45], 0
    v_mfma_f32_16x16x16_bf16 v[96:99], v[74:75], v[46:47], v[96:99]
    v_mfma_f32_16x16x16_bf16 v[96:99], v[76:77], v[48:49], v[96:99]
    v_mfma_f32_16x16x16_bf16 v[132:135], v[78:79], v[44:45], 0
    v_mfma_f32_16x16x16_bf16 v[132:135], v[80:81], v[46:47], v[132:135]
    v_mfma_f32_16x16x16_bf16 v[132:135], v[82:83], v[48:49], v[132:135]
    v_add_f32 v124, 0x358637bd, v124
    v_add_f32 v125, 0x358637bd, v125
    v_add_f32 v126, 0x358637bd, v126
    v_add_f32 v127, 0x358637bd, v127
    v_rcp_f32 v124, v124
    v_rcp_f32 v125, v125
    v_rcp_f32 v126, v126
    v_rcp_f32 v127, v127
    ds_read_b64 v[72:73], v249 offset:7168
    ds_read_b64 v[78:79], v249 offset:20992
    ds_read_b64 v[74:75], v249 offset:8192
    ds_read_b64 v[80:81], v249 offset:22016
    ds_read_b64 v[76:77], v249 offset:9216
    ds_read_b64 v[82:83], v249 offset:23040
    s_waitcnt lgkmcnt(6)
    v_mfma_f32_16x16x16_bf16 v[100:103], v[60:61], v[46:47], 0
    v_mfma_f32_16x16x16_bf16 v[100:103], v[62:63], v[48:49], v[100:103]
    v_mfma_f32_16x16x16_bf16 v[100:103], v[64:65], v[50:51], v[100:103]
    v_mfma_f32_16x16x16_bf16 v[136:139], v[66:67], v[46:47], 0
    v_mfma_f32_16x16x16_bf16 v[136:139], v[68:69], v[48:49], v[136:139]
    v_mfma_f32_16x16x16_bf16 v[136:139], v[70:71], v[50:51], v[136:139]
    v_add_f32 v128, 0x358637bd, v128
    v_add_f32 v129, 0x358637bd, v129
    v_add_f32 v130, 0x358637bd, v130
    v_add_f32 v131, 0x358637bd, v131
    v_rcp_f32 v128, v128
    v_rcp_f32 v129, v129
    v_rcp_f32 v130, v130
    v_rcp_f32 v131, v131
    ds_read_b64 v[60:61], v249 offset:8704
    ds_read_b64 v[66:67], v249 offset:22528
    ds_read_b64 v[62:63], v249 offset:9728
    ds_read_b64 v[68:69], v249 offset:23552
    ds_read_b64 v[64:65], v249 offset:10752
    ds_read_b64 v[70:71], v249 offset:24576
    s_waitcnt lgkmcnt(6)
    v_mfma_f32_16x16x16_bf16 v[104:107], v[72:73], v[48:49], 0
    v_mfma_f32_16x16x16_bf16 v[104:107], v[74:75], v[50:51], v[104:107]
    v_mfma_f32_16x16x16_bf16 v[104:107], v[76:77], v[52:53], v[104:107]
    v_mfma_f32_16x16x16_bf16 v[140:143], v[78:79], v[48:49], 0
    v_mfma_f32_16x16x16_bf16 v[140:143], v[80:81], v[50:51], v[140:143]
    v_mfma_f32_16x16x16_bf16 v[140:143], v[82:83], v[52:53], v[140:143]
    v_add_f32 v132, 0x358637bd, v132
    v_add_f32 v133, 0x358637bd, v133
    v_add_f32 v134, 0x358637bd, v134
    v_add_f32 v135, 0x358637bd, v135
    v_rcp_f32 v132, v132
    v_rcp_f32 v133, v133
    v_rcp_f32 v134, v134
    v_rcp_f32 v135, v135
    ds_read_b64 v[72:73], v249 offset:10240
    ds_read_b64 v[78:79], v249 offset:24064
    ds_read_b64 v[74:75], v249 offset:11264
    ds_read_b64 v[80:81], v249 offset:25088
    ds_read_b64 v[76:77], v249 offset:12288
    ds_read_b64 v[82:83], v249 offset:26112
    s_waitcnt lgkmcnt(6)
    v_mfma_f32_16x16x16_bf16 v[108:111], v[60:61], v[50:51], 0
    v_mfma_f32_16x16x16_bf16 v[108:111], v[62:63], v[52:53], v[108:111]
    v_mfma_f32_16x16x16_bf16 v[108:111], v[64:65], v[54:55], v[108:111]
    v_mfma_f32_16x16x16_bf16 v[144:147], v[66:67], v[50:51], 0
    v_mfma_f32_16x16x16_bf16 v[144:147], v[68:69], v[52:53], v[144:147]
    v_mfma_f32_16x16x16_bf16 v[144:147], v[70:71], v[54:55], v[144:147]
    v_add_f32 v136, 0x358637bd, v136
    v_add_f32 v137, 0x358637bd, v137
    v_add_f32 v138, 0x358637bd, v138
    v_add_f32 v139, 0x358637bd, v139
    v_rcp_f32 v136, v136
    v_rcp_f32 v137, v137
    v_rcp_f32 v138, v138
    v_rcp_f32 v139, v139
    ds_read_b64 v[60:61], v249 offset:11776
    ds_read_b64 v[66:67], v249 offset:25600
    ds_read_b64 v[62:63], v249 offset:12800
    ds_read_b64 v[68:69], v249 offset:26624
    s_waitcnt lgkmcnt(4)
    v_mfma_f32_16x16x16_bf16 v[112:115], v[72:73], v[52:53], 0
    v_mfma_f32_16x16x16_bf16 v[112:115], v[74:75], v[54:55], v[112:115]
    v_mfma_f32_16x16x16_bf16 v[112:115], v[76:77], v[56:57], v[112:115]
    v_mfma_f32_16x16x16_bf16 v[148:151], v[78:79], v[52:53], 0
    v_mfma_f32_16x16x16_bf16 v[148:151], v[80:81], v[54:55], v[148:151]
    v_mfma_f32_16x16x16_bf16 v[148:151], v[82:83], v[56:57], v[148:151]
    v_add_f32 v140, 0x358637bd, v140
    v_add_f32 v141, 0x358637bd, v141
    v_add_f32 v142, 0x358637bd, v142
    v_add_f32 v143, 0x358637bd, v143
    v_rcp_f32 v140, v140
    v_rcp_f32 v141, v141
    v_rcp_f32 v142, v142
    v_rcp_f32 v143, v143
    s_waitcnt lgkmcnt(0)
    v_mfma_f32_16x16x16_bf16 v[116:119], v[60:61], v[54:55], 0
    v_mfma_f32_16x16x16_bf16 v[116:119], v[62:63], v[56:57], v[116:119]
    v_mfma_f32_16x16x16_bf16 v[152:155], v[66:67], v[54:55], 0
    v_mfma_f32_16x16x16_bf16 v[152:155], v[68:69], v[56:57], v[152:155]
    v_add_f32 v144, 0x358637bd, v144
    v_add_f32 v145, 0x358637bd, v145
    v_add_f32 v146, 0x358637bd, v146
    v_add_f32 v147, 0x358637bd, v147
    v_rcp_f32 v144, v144
    v_rcp_f32 v145, v145
    v_rcp_f32 v146, v146
    v_rcp_f32 v147, v147
    s_nop 7
    s_nop 3
    v_add_f32 v148, 0x358637bd, v148
    v_add_f32 v149, 0x358637bd, v149
    v_add_f32 v150, 0x358637bd, v150
    v_add_f32 v151, 0x358637bd, v151
    v_rcp_f32 v148, v148
    v_rcp_f32 v149, v149
    v_rcp_f32 v150, v150
    v_rcp_f32 v151, v151
    v_add_f32 v152, 0x358637bd, v152
    v_add_f32 v153, 0x358637bd, v153
    v_add_f32 v154, 0x358637bd, v154
    v_add_f32 v155, 0x358637bd, v155
    v_rcp_f32 v152, v152
    v_rcp_f32 v153, v153
    v_rcp_f32 v154, v154
    v_rcp_f32 v155, v155
    s_nop 0
    v_mul_f32 v84, v84, v120
    v_mul_f32 v85, v85, v121
    v_mul_f32 v86, v86, v122
    v_mul_f32 v87, v87, v123
    v_cvt_pk_bf16_f32 v156, v84, v85
    v_cvt_pk_bf16_f32 v157, v86, v87
    ds_write_b64 v248, v[156:157] offset:0
    v_mul_f32 v88, v88, v124
    v_mul_f32 v89, v89, v125
    v_mul_f32 v90, v90, v126
    v_mul_f32 v91, v91, v127
    v_cvt_pk_bf16_f32 v158, v88, v89
    v_cvt_pk_bf16_f32 v159, v90, v91
    ds_write_b64 v248, v[158:159] offset:512
    v_mul_f32 v92, v92, v128
    v_mul_f32 v93, v93, v129
    v_mul_f32 v94, v94, v130
    v_mul_f32 v95, v95, v131
    v_cvt_pk_bf16_f32 v160, v92, v93
    v_cvt_pk_bf16_f32 v161, v94, v95
    ds_write_b64 v248, v[160:161] offset:1024
    v_mul_f32 v96, v96, v132
    v_mul_f32 v97, v97, v133
    v_mul_f32 v98, v98, v134
    v_mul_f32 v99, v99, v135
    v_cvt_pk_bf16_f32 v162, v96, v97
    v_cvt_pk_bf16_f32 v163, v98, v99
    ds_write_b64 v248, v[162:163] offset:1536
    v_mul_f32 v100, v100, v136
    v_mul_f32 v101, v101, v137
    v_mul_f32 v102, v102, v138
    v_mul_f32 v103, v103, v139
    v_cvt_pk_bf16_f32 v164, v100, v101
    v_cvt_pk_bf16_f32 v165, v102, v103
    ds_write_b64 v248, v[164:165] offset:2048
    v_mul_f32 v104, v104, v140
    v_mul_f32 v105, v105, v141
    v_mul_f32 v106, v106, v142
    v_mul_f32 v107, v107, v143
    v_cvt_pk_bf16_f32 v166, v104, v105
    v_cvt_pk_bf16_f32 v167, v106, v107
    ds_write_b64 v248, v[166:167] offset:2560
    v_mul_f32 v108, v108, v144
    v_mul_f32 v109, v109, v145
    v_mul_f32 v110, v110, v146
    v_mul_f32 v111, v111, v147
    v_cvt_pk_bf16_f32 v168, v108, v109
    v_cvt_pk_bf16_f32 v169, v110, v111
    ds_write_b64 v248, v[168:169] offset:3072
    v_mul_f32 v112, v112, v148
    v_mul_f32 v113, v113, v149
    v_mul_f32 v114, v114, v150
    v_mul_f32 v115, v115, v151
    v_cvt_pk_bf16_f32 v170, v112, v113
    v_cvt_pk_bf16_f32 v171, v114, v115
    ds_write_b64 v248, v[170:171] offset:3584
    v_mul_f32 v116, v116, v152
    v_mul_f32 v117, v117, v153
    v_mul_f32 v118, v118, v154
    v_mul_f32 v119, v119, v155
    v_cvt_pk_bf16_f32 v172, v116, v117
    v_cvt_pk_bf16_f32 v173, v118, v119
    ds_write_b64 v248, v[172:173] offset:4096
    v_lshrrev_b32 v249, 4, v247
    v_lshlrev_b32 v249, 2, v249
    v_lshrrev_b32 v250, 2, v247
    v_and_b32 v250, 3, v250
    v_add_u32 v249, v249, v250
    v_and_b32 v251, 6, v249
    v_mul_u32_u24 v249, 384, v249
    v_and_b32 v250, 3, v247
    v_lshl_add_u32 v249, v250, 3, v249
    s_waitcnt vmcnt(0) lgkmcnt(0)
    s_barrier
    s_mul_i32 s46, s41, 9216
    s_add_u32 s46, s46, 98304
    v_lshl_add_u32 v248, v247, 3, s46
    ds_read_b64 v[0:1], v248 offset:0
    ds_read_b64 v[2:3], v248 offset:512
    ds_read_b64 v[4:5], v248 offset:1024
    ds_read_b64 v[6:7], v248 offset:1536
    ds_read_b64 v[8:9], v248 offset:2048
    ds_read_b64 v[10:11], v248 offset:2560
    ds_read_b64 v[12:13], v248 offset:3072
    ds_read_b64 v[14:15], v248 offset:3584
    ds_read_b64 v[16:17], v248 offset:4096
    ds_read_b64 v[20:21], v248 offset:4608
    ds_read_b64 v[22:23], v248 offset:5120
    ds_read_b64 v[24:25], v248 offset:5632
    ds_read_b64 v[26:27], v248 offset:6144
    ds_read_b64 v[28:29], v248 offset:6656
    ds_read_b64 v[30:31], v248 offset:7168
    ds_read_b64 v[32:33], v248 offset:7680
    ds_read_b64 v[34:35], v248 offset:8192
    ds_read_b64 v[36:37], v248 offset:8704
    v_xor_b32 v250, 0, v251
    v_lshl_add_u32 v40, v250, 4, v249
    v_add_u32 v44, 55296, v40
    v_xor_b32 v250, 2, v251
    v_lshl_add_u32 v41, v250, 4, v249
    v_add_u32 v45, 55296, v41
    v_xor_b32 v250, 4, v251
    v_lshl_add_u32 v42, v250, 4, v249
    v_add_u32 v46, 55296, v42
    v_xor_b32 v250, 6, v251
    v_lshl_add_u32 v43, v250, 4, v249
    v_add_u32 v47, 55296, v43
    v_and_b32 v249, 15, v247
    v_lshrrev_b32 v250, 5, v247
    v_lshl_add_u32 v249, v250, 4, v249
    v_lshrrev_b32 v250, 4, v247
    v_and_b32 v250, 1, v250
    v_lshl_add_u32 v249, v250, 5, v249
    s_mul_i32 s46, s41, 36864
    v_lshl_add_u32 v48, v249, 4, s46
    ds_read_b64_tr_b16 v[52:53], v40 offset:0
    ds_read_b64_tr_b16 v[54:55], v40 offset:6144
    ds_read_b64_tr_b16 v[56:57], v40 offset:12288
    ds_read_b64_tr_b16 v[58:59], v40 offset:18432
    ds_read_b64_tr_b16 v[60:61], v40 offset:24576
    ds_read_b64_tr_b16 v[62:63], v40 offset:30720
    ds_read_b64_tr_b16 v[64:65], v40 offset:36864
    ds_read_b64_tr_b16 v[66:67], v40 offset:43008
    ds_read_b64_tr_b16 v[68:69], v40 offset:49152
    s_waitcnt lgkmcnt(9)
    s_barrier
    s_add_u32 m0, s55, 55296
    s_mov_b32 s49, 384
    buffer_load_dwordx4 v244, s[32:35], s49 offen lds
    s_add_u32 m0, s55, 56320
    s_mov_b32 s49, 384
    buffer_load_dwordx4 v245, s[32:35], s49 offen lds
    s_add_u32 m0, s55, 57344
    s_mov_b32 s49, 384
    buffer_load_dwordx4 v246, s[32:35], s49 offen lds
    s_add_u32 m0, s55, 58368
    s_mov_b32 s49, 9600
    buffer_load_dwordx4 v244, s[32:35], s49 offen lds
    s_add_u32 m0, s55, 59392
    s_mov_b32 s49, 9600
    buffer_load_dwordx4 v245, s[32:35], s49 offen lds
    s_add_u32 m0, s55, 60416
    s_mov_b32 s49, 9600
    buffer_load_dwordx4 v246, s[32:35], s49 offen lds
    s_mov_b32 exec_hi, 0xffff
    s_add_u32 m0, s55, 61440
    s_mov_b32 s49, 18816
    buffer_load_dwordx4 v244, s[32:35], s49 offen lds
    s_mov_b32 exec_hi, -1
    s_waitcnt lgkmcnt(0)
    v_mfma_f32_16x16x32_bf16 v[108:111], v[52:55], v[0:3], 0
    v_mfma_f32_16x16x32_bf16 v[108:111], v[56:59], v[4:7], v[108:111]
    ds_read_b64_tr_b16 v[70:71], v41 offset:0
    ds_read_b64_tr_b16 v[72:73], v41 offset:6144
    ds_read_b64_tr_b16 v[74:75], v41 offset:12288
    ds_read_b64_tr_b16 v[76:77], v41 offset:18432
    ds_read_b64_tr_b16 v[78:79], v41 offset:24576
    v_mfma_f32_16x16x32_bf16 v[108:111], v[60:63], v[8:11], v[108:111]
    v_mfma_f32_16x16x32_bf16 v[108:111], v[64:67], v[12:15], v[108:111]
    v_mfma_f32_16x16x32_bf16 v[112:115], v[52:55], v[20:23], 0
    v_mfma_f32_16x16x32_bf16 v[112:115], v[56:59], v[24:27], v[112:115]
    ds_read_b64_tr_b16 v[80:81], v41 offset:30720
    ds_read_b64_tr_b16 v[82:83], v41 offset:36864
    ds_read_b64_tr_b16 v[84:85], v41 offset:43008
    ds_read_b64_tr_b16 v[86:87], v41 offset:49152
    v_mfma_f32_16x16x32_bf16 v[112:115], v[60:63], v[28:31], v[112:115]
    v_mfma_f32_16x16x32_bf16 v[112:115], v[64:67], v[32:35], v[112:115]
    s_nop 1
    v_mfma_f32_16x16x16_bf16 v[108:111], v[68:69], v[16:17], v[108:111]
    v_mfma_f32_16x16x16_bf16 v[112:115], v[68:69], v[36:37], v[112:115]
    s_waitcnt lgkmcnt(0)
    v_mfma_f32_16x16x32_bf16 v[116:119], v[70:73], v[0:3], 0
    v_mfma_f32_16x16x32_bf16 v[116:119], v[74:77], v[4:7], v[116:119]
    ds_read_b64_tr_b16 v[88:89], v42 offset:0
    ds_read_b64_tr_b16 v[90:91], v42 offset:6144
    ds_read_b64_tr_b16 v[92:93], v42 offset:12288
    ds_read_b64_tr_b16 v[94:95], v42 offset:18432
    ds_read_b64_tr_b16 v[96:97], v42 offset:24576
    v_mfma_f32_16x16x32_bf16 v[116:119], v[78:81], v[8:11], v[116:119]
    v_mfma_f32_16x16x32_bf16 v[116:119], v[82:85], v[12:15], v[116:119]
    v_mfma_f32_16x16x32_bf16 v[120:123], v[70:73], v[20:23], 0
    v_mfma_f32_16x16x32_bf16 v[120:123], v[74:77], v[24:27], v[120:123]
    ds_read_b64_tr_b16 v[98:99], v42 offset:30720
    ds_read_b64_tr_b16 v[100:101], v42 offset:36864
    ds_read_b64_tr_b16 v[102:103], v42 offset:43008
    ds_read_b64_tr_b16 v[104:105], v42 offset:49152
    v_mfma_f32_16x16x32_bf16 v[120:123], v[78:81], v[28:31], v[120:123]
    v_mfma_f32_16x16x32_bf16 v[120:123], v[82:85], v[32:35], v[120:123]
    s_nop 1
    v_mfma_f32_16x16x16_bf16 v[116:119], v[86:87], v[16:17], v[116:119]
    v_mfma_f32_16x16x16_bf16 v[120:123], v[86:87], v[36:37], v[120:123]
    v_cvt_pk_bf16_f32 v124, v108, v109
    v_cvt_pk_bf16_f32 v125, v110, v111
    v_cvt_pk_bf16_f32 v126, v112, v113
    v_cvt_pk_bf16_f32 v127, v114, v115
    s_mov_b32 s48, 0
    s_nop 0
    v_permlane32_swap_b32 v124, v126
    v_permlane32_swap_b32 v125, v127
    s_nop 0
    buffer_store_dwordx4 v[124:127], v48, s[36:39], s48 offen sc0 sc1
    s_waitcnt lgkmcnt(0)
    v_mfma_f32_16x16x32_bf16 v[108:111], v[88:91], v[0:3], 0
    v_mfma_f32_16x16x32_bf16 v[108:111], v[92:95], v[4:7], v[108:111]
    ds_read_b64_tr_b16 v[52:53], v43 offset:0
    ds_read_b64_tr_b16 v[54:55], v43 offset:6144
    ds_read_b64_tr_b16 v[56:57], v43 offset:12288
    ds_read_b64_tr_b16 v[58:59], v43 offset:18432
    ds_read_b64_tr_b16 v[60:61], v43 offset:24576
    v_mfma_f32_16x16x32_bf16 v[108:111], v[96:99], v[8:11], v[108:111]
    v_mfma_f32_16x16x32_bf16 v[108:111], v[100:103], v[12:15], v[108:111]
    v_mfma_f32_16x16x32_bf16 v[112:115], v[88:91], v[20:23], 0
    v_mfma_f32_16x16x32_bf16 v[112:115], v[92:95], v[24:27], v[112:115]
    ds_read_b64_tr_b16 v[62:63], v43 offset:30720
    ds_read_b64_tr_b16 v[64:65], v43 offset:36864
    ds_read_b64_tr_b16 v[66:67], v43 offset:43008
    ds_read_b64_tr_b16 v[68:69], v43 offset:49152
    v_mfma_f32_16x16x32_bf16 v[112:115], v[96:99], v[28:31], v[112:115]
    v_mfma_f32_16x16x32_bf16 v[112:115], v[100:103], v[32:35], v[112:115]
    s_nop 1
    v_mfma_f32_16x16x16_bf16 v[108:111], v[104:105], v[16:17], v[108:111]
    v_mfma_f32_16x16x16_bf16 v[112:115], v[104:105], v[36:37], v[112:115]
    v_cvt_pk_bf16_f32 v128, v116, v117
    v_cvt_pk_bf16_f32 v129, v118, v119
    v_cvt_pk_bf16_f32 v130, v120, v121
    v_cvt_pk_bf16_f32 v131, v122, v123
    s_mov_b32 s48, 1024
    s_nop 0
    v_permlane32_swap_b32 v128, v130
    v_permlane32_swap_b32 v129, v131
    s_nop 0
    buffer_store_dwordx4 v[128:131], v48, s[36:39], s48 offen sc0 sc1
    s_waitcnt lgkmcnt(0)
    v_mfma_f32_16x16x32_bf16 v[116:119], v[52:55], v[0:3], 0
    v_mfma_f32_16x16x32_bf16 v[116:119], v[56:59], v[4:7], v[116:119]
    ds_read_b64_tr_b16 v[70:71], v40 offset:128
    ds_read_b64_tr_b16 v[72:73], v40 offset:6272
    ds_read_b64_tr_b16 v[74:75], v40 offset:12416
    ds_read_b64_tr_b16 v[76:77], v40 offset:18560
    ds_read_b64_tr_b16 v[78:79], v40 offset:24704
    v_mfma_f32_16x16x32_bf16 v[116:119], v[60:63], v[8:11], v[116:119]
    v_mfma_f32_16x16x32_bf16 v[116:119], v[64:67], v[12:15], v[116:119]
    v_mfma_f32_16x16x32_bf16 v[120:123], v[52:55], v[20:23], 0
    v_mfma_f32_16x16x32_bf16 v[120:123], v[56:59], v[24:27], v[120:123]
    ds_read_b64_tr_b16 v[80:81], v40 offset:30848
    ds_read_b64_tr_b16 v[82:83], v40 offset:36992
    ds_read_b64_tr_b16 v[84:85], v40 offset:43136
    ds_read_b64_tr_b16 v[86:87], v40 offset:49280
    v_mfma_f32_16x16x32_bf16 v[120:123], v[60:63], v[28:31], v[120:123]
    v_mfma_f32_16x16x32_bf16 v[120:123], v[64:67], v[32:35], v[120:123]
    s_nop 1
    v_mfma_f32_16x16x16_bf16 v[116:119], v[68:69], v[16:17], v[116:119]
    v_mfma_f32_16x16x16_bf16 v[120:123], v[68:69], v[36:37], v[120:123]
    v_cvt_pk_bf16_f32 v124, v108, v109
    v_cvt_pk_bf16_f32 v125, v110, v111
    v_cvt_pk_bf16_f32 v126, v112, v113
    v_cvt_pk_bf16_f32 v127, v114, v115
    s_mov_b32 s48, 2048
    s_nop 0
    v_permlane32_swap_b32 v124, v126
    v_permlane32_swap_b32 v125, v127
    s_nop 0
    buffer_store_dwordx4 v[124:127], v48, s[36:39], s48 offen sc0 sc1
    s_waitcnt lgkmcnt(0)
    v_mfma_f32_16x16x32_bf16 v[108:111], v[70:73], v[0:3], 0
    v_mfma_f32_16x16x32_bf16 v[108:111], v[74:77], v[4:7], v[108:111]
    ds_read_b64_tr_b16 v[88:89], v41 offset:128
    ds_read_b64_tr_b16 v[90:91], v41 offset:6272
    ds_read_b64_tr_b16 v[92:93], v41 offset:12416
    ds_read_b64_tr_b16 v[94:95], v41 offset:18560
    ds_read_b64_tr_b16 v[96:97], v41 offset:24704
    v_mfma_f32_16x16x32_bf16 v[108:111], v[78:81], v[8:11], v[108:111]
    v_mfma_f32_16x16x32_bf16 v[108:111], v[82:85], v[12:15], v[108:111]
    v_mfma_f32_16x16x32_bf16 v[112:115], v[70:73], v[20:23], 0
    v_mfma_f32_16x16x32_bf16 v[112:115], v[74:77], v[24:27], v[112:115]
    ds_read_b64_tr_b16 v[98:99], v41 offset:30848
    ds_read_b64_tr_b16 v[100:101], v41 offset:36992
    ds_read_b64_tr_b16 v[102:103], v41 offset:43136
    ds_read_b64_tr_b16 v[104:105], v41 offset:49280
    v_mfma_f32_16x16x32_bf16 v[112:115], v[78:81], v[28:31], v[112:115]
    v_mfma_f32_16x16x32_bf16 v[112:115], v[82:85], v[32:35], v[112:115]
    s_nop 1
    v_mfma_f32_16x16x16_bf16 v[108:111], v[86:87], v[16:17], v[108:111]
    v_mfma_f32_16x16x16_bf16 v[112:115], v[86:87], v[36:37], v[112:115]
    v_cvt_pk_bf16_f32 v128, v116, v117
    v_cvt_pk_bf16_f32 v129, v118, v119
    v_cvt_pk_bf16_f32 v130, v120, v121
    v_cvt_pk_bf16_f32 v131, v122, v123
    s_mov_b32 s48, 3072
    s_nop 0
    v_permlane32_swap_b32 v128, v130
    v_permlane32_swap_b32 v129, v131
    s_nop 0
    buffer_store_dwordx4 v[128:131], v48, s[36:39], s48 offen sc0 sc1
    s_waitcnt vmcnt(4) lgkmcnt(0)
    s_barrier
    s_add_u32 m0, s55, 0
    s_mov_b32 s49, 768
    buffer_load_dwordx4 v244, s[32:35], s49 offen lds
    s_add_u32 m0, s55, 1024
    s_mov_b32 s49, 768
    buffer_load_dwordx4 v245, s[32:35], s49 offen lds
    s_add_u32 m0, s55, 2048
    s_mov_b32 s49, 768
    buffer_load_dwordx4 v246, s[32:35], s49 offen lds
    s_add_u32 m0, s55, 3072
    s_mov_b32 s49, 9984
    buffer_load_dwordx4 v244, s[32:35], s49 offen lds
    s_add_u32 m0, s55, 4096
    s_mov_b32 s49, 9984
    buffer_load_dwordx4 v245, s[32:35], s49 offen lds
    s_add_u32 m0, s55, 5120
    s_mov_b32 s49, 9984
    buffer_load_dwordx4 v246, s[32:35], s49 offen lds
    s_mov_b32 exec_hi, 0xffff
    s_add_u32 m0, s55, 6144
    s_mov_b32 s49, 19200
    buffer_load_dwordx4 v244, s[32:35], s49 offen lds
    s_mov_b32 exec_hi, -1
    v_mfma_f32_16x16x32_bf16 v[116:119], v[88:91], v[0:3], 0
    v_mfma_f32_16x16x32_bf16 v[116:119], v[92:95], v[4:7], v[116:119]
    ds_read_b64_tr_b16 v[52:53], v44 offset:0
    ds_read_b64_tr_b16 v[54:55], v44 offset:6144
    ds_read_b64_tr_b16 v[56:57], v44 offset:12288
    ds_read_b64_tr_b16 v[58:59], v44 offset:18432
    ds_read_b64_tr_b16 v[60:61], v44 offset:24576
    v_mfma_f32_16x16x32_bf16 v[116:119], v[96:99], v[8:11], v[116:119]
    v_mfma_f32_16x16x32_bf16 v[116:119], v[100:103], v[12:15], v[116:119]
    v_mfma_f32_16x16x32_bf16 v[120:123], v[88:91], v[20:23], 0
    v_mfma_f32_16x16x32_bf16 v[120:123], v[92:95], v[24:27], v[120:123]
    ds_read_b64_tr_b16 v[62:63], v44 offset:30720
    ds_read_b64_tr_b16 v[64:65], v44 offset:36864
    ds_read_b64_tr_b16 v[66:67], v44 offset:43008
    ds_read_b64_tr_b16 v[68:69], v44 offset:49152
    v_mfma_f32_16x16x32_bf16 v[120:123], v[96:99], v[28:31], v[120:123]
    v_mfma_f32_16x16x32_bf16 v[120:123], v[100:103], v[32:35], v[120:123]
    s_nop 1
    v_mfma_f32_16x16x16_bf16 v[116:119], v[104:105], v[16:17], v[116:119]
    v_mfma_f32_16x16x16_bf16 v[120:123], v[104:105], v[36:37], v[120:123]
    v_cvt_pk_bf16_f32 v124, v108, v109
    v_cvt_pk_bf16_f32 v125, v110, v111
    v_cvt_pk_bf16_f32 v126, v112, v113
    v_cvt_pk_bf16_f32 v127, v114, v115
    s_mov_b32 s48, 4096
    s_nop 0
    v_permlane32_swap_b32 v124, v126
    v_permlane32_swap_b32 v125, v127
    s_nop 0
    buffer_store_dwordx4 v[124:127], v48, s[36:39], s48 offen sc0 sc1
    s_waitcnt lgkmcnt(0)
    v_mfma_f32_16x16x32_bf16 v[108:111], v[52:55], v[0:3], 0
    v_mfma_f32_16x16x32_bf16 v[108:111], v[56:59], v[4:7], v[108:111]
    ds_read_b64_tr_b16 v[70:71], v45 offset:0
    ds_read_b64_tr_b16 v[72:73], v45 offset:6144
    ds_read_b64_tr_b16 v[74:75], v45 offset:12288
    ds_read_b64_tr_b16 v[76:77], v45 offset:18432
    ds_read_b64_tr_b16 v[78:79], v45 offset:24576
    v_mfma_f32_16x16x32_bf16 v[108:111], v[60:63], v[8:11], v[108:111]
    v_mfma_f32_16x16x32_bf16 v[108:111], v[64:67], v[12:15], v[108:111]
    v_mfma_f32_16x16x32_bf16 v[112:115], v[52:55], v[20:23], 0
    v_mfma_f32_16x16x32_bf16 v[112:115], v[56:59], v[24:27], v[112:115]
    ds_read_b64_tr_b16 v[80:81], v45 offset:30720
    ds_read_b64_tr_b16 v[82:83], v45 offset:36864
    ds_read_b64_tr_b16 v[84:85], v45 offset:43008
    ds_read_b64_tr_b16 v[86:87], v45 offset:49152
    v_mfma_f32_16x16x32_bf16 v[112:115], v[60:63], v[28:31], v[112:115]
    v_mfma_f32_16x16x32_bf16 v[112:115], v[64:67], v[32:35], v[112:115]
    s_nop 1
    v_mfma_f32_16x16x16_bf16 v[108:111], v[68:69], v[16:17], v[108:111]
    v_mfma_f32_16x16x16_bf16 v[112:115], v[68:69], v[36:37], v[112:115]
    v_cvt_pk_bf16_f32 v128, v116, v117
    v_cvt_pk_bf16_f32 v129, v118, v119
    v_cvt_pk_bf16_f32 v130, v120, v121
    v_cvt_pk_bf16_f32 v131, v122, v123
    s_mov_b32 s48, 5120
    s_nop 0
    v_permlane32_swap_b32 v128, v130
    v_permlane32_swap_b32 v129, v131
    s_nop 0
    buffer_store_dwordx4 v[128:131], v48, s[36:39], s48 offen sc0 sc1
    s_waitcnt lgkmcnt(0)
    v_mfma_f32_16x16x32_bf16 v[116:119], v[70:73], v[0:3], 0
    v_mfma_f32_16x16x32_bf16 v[116:119], v[74:77], v[4:7], v[116:119]
    ds_read_b64_tr_b16 v[88:89], v46 offset:0
    ds_read_b64_tr_b16 v[90:91], v46 offset:6144
    ds_read_b64_tr_b16 v[92:93], v46 offset:12288
    ds_read_b64_tr_b16 v[94:95], v46 offset:18432
    ds_read_b64_tr_b16 v[96:97], v46 offset:24576
    v_mfma_f32_16x16x32_bf16 v[116:119], v[78:81], v[8:11], v[116:119]
    v_mfma_f32_16x16x32_bf16 v[116:119], v[82:85], v[12:15], v[116:119]
    v_mfma_f32_16x16x32_bf16 v[120:123], v[70:73], v[20:23], 0
    v_mfma_f32_16x16x32_bf16 v[120:123], v[74:77], v[24:27], v[120:123]
    ds_read_b64_tr_b16 v[98:99], v46 offset:30720
    ds_read_b64_tr_b16 v[100:101], v46 offset:36864
    ds_read_b64_tr_b16 v[102:103], v46 offset:43008
    ds_read_b64_tr_b16 v[104:105], v46 offset:49152
    v_mfma_f32_16x16x32_bf16 v[120:123], v[78:81], v[28:31], v[120:123]
    v_mfma_f32_16x16x32_bf16 v[120:123], v[82:85], v[32:35], v[120:123]
    s_nop 1
    v_mfma_f32_16x16x16_bf16 v[116:119], v[86:87], v[16:17], v[116:119]
    v_mfma_f32_16x16x16_bf16 v[120:123], v[86:87], v[36:37], v[120:123]
    v_cvt_pk_bf16_f32 v124, v108, v109
    v_cvt_pk_bf16_f32 v125, v110, v111
    v_cvt_pk_bf16_f32 v126, v112, v113
    v_cvt_pk_bf16_f32 v127, v114, v115
    s_mov_b32 s48, 12288
    s_nop 0
    v_permlane32_swap_b32 v124, v126
    v_permlane32_swap_b32 v125, v127
    s_nop 0
    buffer_store_dwordx4 v[124:127], v48, s[36:39], s48 offen sc0 sc1
    s_waitcnt lgkmcnt(0)
    v_mfma_f32_16x16x32_bf16 v[108:111], v[88:91], v[0:3], 0
    v_mfma_f32_16x16x32_bf16 v[108:111], v[92:95], v[4:7], v[108:111]
    ds_read_b64_tr_b16 v[52:53], v47 offset:0
    ds_read_b64_tr_b16 v[54:55], v47 offset:6144
    ds_read_b64_tr_b16 v[56:57], v47 offset:12288
    ds_read_b64_tr_b16 v[58:59], v47 offset:18432
    ds_read_b64_tr_b16 v[60:61], v47 offset:24576
    v_mfma_f32_16x16x32_bf16 v[108:111], v[96:99], v[8:11], v[108:111]
    v_mfma_f32_16x16x32_bf16 v[108:111], v[100:103], v[12:15], v[108:111]
    v_mfma_f32_16x16x32_bf16 v[112:115], v[88:91], v[20:23], 0
    v_mfma_f32_16x16x32_bf16 v[112:115], v[92:95], v[24:27], v[112:115]
    ds_read_b64_tr_b16 v[62:63], v47 offset:30720
    ds_read_b64_tr_b16 v[64:65], v47 offset:36864
    ds_read_b64_tr_b16 v[66:67], v47 offset:43008
    ds_read_b64_tr_b16 v[68:69], v47 offset:49152
    v_mfma_f32_16x16x32_bf16 v[112:115], v[96:99], v[28:31], v[112:115]
    v_mfma_f32_16x16x32_bf16 v[112:115], v[100:103], v[32:35], v[112:115]
    s_nop 1
    v_mfma_f32_16x16x16_bf16 v[108:111], v[104:105], v[16:17], v[108:111]
    v_mfma_f32_16x16x16_bf16 v[112:115], v[104:105], v[36:37], v[112:115]
    v_cvt_pk_bf16_f32 v128, v116, v117
    v_cvt_pk_bf16_f32 v129, v118, v119
    v_cvt_pk_bf16_f32 v130, v120, v121
    v_cvt_pk_bf16_f32 v131, v122, v123
    s_mov_b32 s48, 13312
    s_nop 0
    v_permlane32_swap_b32 v128, v130
    v_permlane32_swap_b32 v129, v131
    s_nop 0
    buffer_store_dwordx4 v[128:131], v48, s[36:39], s48 offen sc0 sc1
    s_waitcnt lgkmcnt(0)
    v_mfma_f32_16x16x32_bf16 v[116:119], v[52:55], v[0:3], 0
    v_mfma_f32_16x16x32_bf16 v[116:119], v[56:59], v[4:7], v[116:119]
    ds_read_b64_tr_b16 v[70:71], v44 offset:128
    ds_read_b64_tr_b16 v[72:73], v44 offset:6272
    ds_read_b64_tr_b16 v[74:75], v44 offset:12416
    ds_read_b64_tr_b16 v[76:77], v44 offset:18560
    ds_read_b64_tr_b16 v[78:79], v44 offset:24704
    v_mfma_f32_16x16x32_bf16 v[116:119], v[60:63], v[8:11], v[116:119]
    v_mfma_f32_16x16x32_bf16 v[116:119], v[64:67], v[12:15], v[116:119]
    v_mfma_f32_16x16x32_bf16 v[120:123], v[52:55], v[20:23], 0
    v_mfma_f32_16x16x32_bf16 v[120:123], v[56:59], v[24:27], v[120:123]
    ds_read_b64_tr_b16 v[80:81], v44 offset:30848
    ds_read_b64_tr_b16 v[82:83], v44 offset:36992
    ds_read_b64_tr_b16 v[84:85], v44 offset:43136
    ds_read_b64_tr_b16 v[86:87], v44 offset:49280
    v_mfma_f32_16x16x32_bf16 v[120:123], v[60:63], v[28:31], v[120:123]
    v_mfma_f32_16x16x32_bf16 v[120:123], v[64:67], v[32:35], v[120:123]
    s_nop 1
    v_mfma_f32_16x16x16_bf16 v[116:119], v[68:69], v[16:17], v[116:119]
    v_mfma_f32_16x16x16_bf16 v[120:123], v[68:69], v[36:37], v[120:123]
    v_cvt_pk_bf16_f32 v124, v108, v109
    v_cvt_pk_bf16_f32 v125, v110, v111
    v_cvt_pk_bf16_f32 v126, v112, v113
    v_cvt_pk_bf16_f32 v127, v114, v115
    s_mov_b32 s48, 14336
    s_nop 0
    v_permlane32_swap_b32 v124, v126
    v_permlane32_swap_b32 v125, v127
    s_nop 0
    buffer_store_dwordx4 v[124:127], v48, s[36:39], s48 offen sc0 sc1
    s_waitcnt lgkmcnt(0)
    v_mfma_f32_16x16x32_bf16 v[108:111], v[70:73], v[0:3], 0
    v_mfma_f32_16x16x32_bf16 v[108:111], v[74:77], v[4:7], v[108:111]
    ds_read_b64_tr_b16 v[88:89], v45 offset:128
    ds_read_b64_tr_b16 v[90:91], v45 offset:6272
    ds_read_b64_tr_b16 v[92:93], v45 offset:12416
    ds_read_b64_tr_b16 v[94:95], v45 offset:18560
    ds_read_b64_tr_b16 v[96:97], v45 offset:24704
    v_mfma_f32_16x16x32_bf16 v[108:111], v[78:81], v[8:11], v[108:111]
    v_mfma_f32_16x16x32_bf16 v[108:111], v[82:85], v[12:15], v[108:111]
    v_mfma_f32_16x16x32_bf16 v[112:115], v[70:73], v[20:23], 0
    v_mfma_f32_16x16x32_bf16 v[112:115], v[74:77], v[24:27], v[112:115]
    ds_read_b64_tr_b16 v[98:99], v45 offset:30848
    ds_read_b64_tr_b16 v[100:101], v45 offset:36992
    ds_read_b64_tr_b16 v[102:103], v45 offset:43136
    ds_read_b64_tr_b16 v[104:105], v45 offset:49280
    v_mfma_f32_16x16x32_bf16 v[112:115], v[78:81], v[28:31], v[112:115]
    v_mfma_f32_16x16x32_bf16 v[112:115], v[82:85], v[32:35], v[112:115]
    s_nop 1
    v_mfma_f32_16x16x16_bf16 v[108:111], v[86:87], v[16:17], v[108:111]
    v_mfma_f32_16x16x16_bf16 v[112:115], v[86:87], v[36:37], v[112:115]
    v_cvt_pk_bf16_f32 v128, v116, v117
    v_cvt_pk_bf16_f32 v129, v118, v119
    v_cvt_pk_bf16_f32 v130, v120, v121
    v_cvt_pk_bf16_f32 v131, v122, v123
    s_mov_b32 s48, 15360
    s_nop 0
    v_permlane32_swap_b32 v128, v130
    v_permlane32_swap_b32 v129, v131
    s_nop 0
    buffer_store_dwordx4 v[128:131], v48, s[36:39], s48 offen sc0 sc1
    s_waitcnt vmcnt(6) lgkmcnt(0)
    s_barrier
    v_mfma_f32_16x16x32_bf16 v[116:119], v[88:91], v[0:3], 0
    v_mfma_f32_16x16x32_bf16 v[116:119], v[92:95], v[4:7], v[116:119]
    ds_read_b64_tr_b16 v[52:53], v40 offset:0
    ds_read_b64_tr_b16 v[54:55], v40 offset:6144
    ds_read_b64_tr_b16 v[56:57], v40 offset:12288
    ds_read_b64_tr_b16 v[58:59], v40 offset:18432
    ds_read_b64_tr_b16 v[60:61], v40 offset:24576
    v_mfma_f32_16x16x32_bf16 v[116:119], v[96:99], v[8:11], v[116:119]
    v_mfma_f32_16x16x32_bf16 v[116:119], v[100:103], v[12:15], v[116:119]
    v_mfma_f32_16x16x32_bf16 v[120:123], v[88:91], v[20:23], 0
    v_mfma_f32_16x16x32_bf16 v[120:123], v[92:95], v[24:27], v[120:123]
    ds_read_b64_tr_b16 v[62:63], v40 offset:30720
    ds_read_b64_tr_b16 v[64:65], v40 offset:36864
    ds_read_b64_tr_b16 v[66:67], v40 offset:43008
    ds_read_b64_tr_b16 v[68:69], v40 offset:49152
    v_mfma_f32_16x16x32_bf16 v[120:123], v[96:99], v[28:31], v[120:123]
    v_mfma_f32_16x16x32_bf16 v[120:123], v[100:103], v[32:35], v[120:123]
    s_nop 1
    v_mfma_f32_16x16x16_bf16 v[116:119], v[104:105], v[16:17], v[116:119]
    v_mfma_f32_16x16x16_bf16 v[120:123], v[104:105], v[36:37], v[120:123]
    v_cvt_pk_bf16_f32 v124, v108, v109
    v_cvt_pk_bf16_f32 v125, v110, v111
    v_cvt_pk_bf16_f32 v126, v112, v113
    v_cvt_pk_bf16_f32 v127, v114, v115
    s_mov_b32 s48, 16384
    s_nop 0
    v_permlane32_swap_b32 v124, v126
    v_permlane32_swap_b32 v125, v127
    s_nop 0
    buffer_store_dwordx4 v[124:127], v48, s[36:39], s48 offen sc0 sc1
    s_waitcnt lgkmcnt(0)
    v_mfma_f32_16x16x32_bf16 v[108:111], v[52:55], v[0:3], 0
    v_mfma_f32_16x16x32_bf16 v[108:111], v[56:59], v[4:7], v[108:111]
    ds_read_b64_tr_b16 v[70:71], v41 offset:0
    ds_read_b64_tr_b16 v[72:73], v41 offset:6144
    ds_read_b64_tr_b16 v[74:75], v41 offset:12288
    ds_read_b64_tr_b16 v[76:77], v41 offset:18432
    ds_read_b64_tr_b16 v[78:79], v41 offset:24576
    v_mfma_f32_16x16x32_bf16 v[108:111], v[60:63], v[8:11], v[108:111]
    v_mfma_f32_16x16x32_bf16 v[108:111], v[64:67], v[12:15], v[108:111]
    v_mfma_f32_16x16x32_bf16 v[112:115], v[52:55], v[20:23], 0
    v_mfma_f32_16x16x32_bf16 v[112:115], v[56:59], v[24:27], v[112:115]
    ds_read_b64_tr_b16 v[80:81], v41 offset:30720
    ds_read_b64_tr_b16 v[82:83], v41 offset:36864
    ds_read_b64_tr_b16 v[84:85], v41 offset:43008
    ds_read_b64_tr_b16 v[86:87], v41 offset:49152
    v_mfma_f32_16x16x32_bf16 v[112:115], v[60:63], v[28:31], v[112:115]
    v_mfma_f32_16x16x32_bf16 v[112:115], v[64:67], v[32:35], v[112:115]
    s_nop 1
    v_mfma_f32_16x16x16_bf16 v[108:111], v[68:69], v[16:17], v[108:111]
    v_mfma_f32_16x16x16_bf16 v[112:115], v[68:69], v[36:37], v[112:115]
    v_cvt_pk_bf16_f32 v128, v116, v117
    v_cvt_pk_bf16_f32 v129, v118, v119
    v_cvt_pk_bf16_f32 v130, v120, v121
    v_cvt_pk_bf16_f32 v131, v122, v123
    s_mov_b32 s48, 17408
    s_nop 0
    v_permlane32_swap_b32 v128, v130
    v_permlane32_swap_b32 v129, v131
    s_nop 0
    buffer_store_dwordx4 v[128:131], v48, s[36:39], s48 offen sc0 sc1
    s_waitcnt lgkmcnt(0)
    v_mfma_f32_16x16x32_bf16 v[116:119], v[70:73], v[0:3], 0
    v_mfma_f32_16x16x32_bf16 v[116:119], v[74:77], v[4:7], v[116:119]
    ds_read_b64_tr_b16 v[88:89], v42 offset:0
    ds_read_b64_tr_b16 v[90:91], v42 offset:6144
    ds_read_b64_tr_b16 v[92:93], v42 offset:12288
    ds_read_b64_tr_b16 v[94:95], v42 offset:18432
    ds_read_b64_tr_b16 v[96:97], v42 offset:24576
    v_mfma_f32_16x16x32_bf16 v[116:119], v[78:81], v[8:11], v[116:119]
    v_mfma_f32_16x16x32_bf16 v[116:119], v[82:85], v[12:15], v[116:119]
    v_mfma_f32_16x16x32_bf16 v[120:123], v[70:73], v[20:23], 0
    v_mfma_f32_16x16x32_bf16 v[120:123], v[74:77], v[24:27], v[120:123]
    ds_read_b64_tr_b16 v[98:99], v42 offset:30720
    ds_read_b64_tr_b16 v[100:101], v42 offset:36864
    ds_read_b64_tr_b16 v[102:103], v42 offset:43008
    ds_read_b64_tr_b16 v[104:105], v42 offset:49152
    v_mfma_f32_16x16x32_bf16 v[120:123], v[78:81], v[28:31], v[120:123]
    v_mfma_f32_16x16x32_bf16 v[120:123], v[82:85], v[32:35], v[120:123]
    s_nop 1
    v_mfma_f32_16x16x16_bf16 v[116:119], v[86:87], v[16:17], v[116:119]
    v_mfma_f32_16x16x16_bf16 v[120:123], v[86:87], v[36:37], v[120:123]
    v_cvt_pk_bf16_f32 v124, v108, v109
    v_cvt_pk_bf16_f32 v125, v110, v111
    v_cvt_pk_bf16_f32 v126, v112, v113
    v_cvt_pk_bf16_f32 v127, v114, v115
    s_mov_b32 s48, 24576
    s_nop 0
    v_permlane32_swap_b32 v124, v126
    v_permlane32_swap_b32 v125, v127
    s_nop 0
    buffer_store_dwordx4 v[124:127], v48, s[36:39], s48 offen sc0 sc1
    s_waitcnt lgkmcnt(0)
    v_mfma_f32_16x16x32_bf16 v[108:111], v[88:91], v[0:3], 0
    v_mfma_f32_16x16x32_bf16 v[108:111], v[92:95], v[4:7], v[108:111]
    ds_read_b64_tr_b16 v[52:53], v43 offset:0
    ds_read_b64_tr_b16 v[54:55], v43 offset:6144
    ds_read_b64_tr_b16 v[56:57], v43 offset:12288
    ds_read_b64_tr_b16 v[58:59], v43 offset:18432
    ds_read_b64_tr_b16 v[60:61], v43 offset:24576
    v_mfma_f32_16x16x32_bf16 v[108:111], v[96:99], v[8:11], v[108:111]
    v_mfma_f32_16x16x32_bf16 v[108:111], v[100:103], v[12:15], v[108:111]
    v_mfma_f32_16x16x32_bf16 v[112:115], v[88:91], v[20:23], 0
    v_mfma_f32_16x16x32_bf16 v[112:115], v[92:95], v[24:27], v[112:115]
    ds_read_b64_tr_b16 v[62:63], v43 offset:30720
    ds_read_b64_tr_b16 v[64:65], v43 offset:36864
    ds_read_b64_tr_b16 v[66:67], v43 offset:43008
    ds_read_b64_tr_b16 v[68:69], v43 offset:49152
    v_mfma_f32_16x16x32_bf16 v[112:115], v[96:99], v[28:31], v[112:115]
    v_mfma_f32_16x16x32_bf16 v[112:115], v[100:103], v[32:35], v[112:115]
    s_nop 1
    v_mfma_f32_16x16x16_bf16 v[108:111], v[104:105], v[16:17], v[108:111]
    v_mfma_f32_16x16x16_bf16 v[112:115], v[104:105], v[36:37], v[112:115]
    v_cvt_pk_bf16_f32 v128, v116, v117
    v_cvt_pk_bf16_f32 v129, v118, v119
    v_cvt_pk_bf16_f32 v130, v120, v121
    v_cvt_pk_bf16_f32 v131, v122, v123
    s_mov_b32 s48, 25600
    s_nop 0
    v_permlane32_swap_b32 v128, v130
    v_permlane32_swap_b32 v129, v131
    s_nop 0
    buffer_store_dwordx4 v[128:131], v48, s[36:39], s48 offen sc0 sc1
    s_waitcnt lgkmcnt(0)
    v_mfma_f32_16x16x32_bf16 v[116:119], v[52:55], v[0:3], 0
    v_mfma_f32_16x16x32_bf16 v[116:119], v[56:59], v[4:7], v[116:119]
    ds_read_b64_tr_b16 v[70:71], v40 offset:128
    ds_read_b64_tr_b16 v[72:73], v40 offset:6272
    ds_read_b64_tr_b16 v[74:75], v40 offset:12416
    ds_read_b64_tr_b16 v[76:77], v40 offset:18560
    ds_read_b64_tr_b16 v[78:79], v40 offset:24704
    v_mfma_f32_16x16x32_bf16 v[116:119], v[60:63], v[8:11], v[116:119]
    v_mfma_f32_16x16x32_bf16 v[116:119], v[64:67], v[12:15], v[116:119]
    v_mfma_f32_16x16x32_bf16 v[120:123], v[52:55], v[20:23], 0
    v_mfma_f32_16x16x32_bf16 v[120:123], v[56:59], v[24:27], v[120:123]
    ds_read_b64_tr_b16 v[80:81], v40 offset:30848
    ds_read_b64_tr_b16 v[82:83], v40 offset:36992
    ds_read_b64_tr_b16 v[84:85], v40 offset:43136
    ds_read_b64_tr_b16 v[86:87], v40 offset:49280
    v_mfma_f32_16x16x32_bf16 v[120:123], v[60:63], v[28:31], v[120:123]
    v_mfma_f32_16x16x32_bf16 v[120:123], v[64:67], v[32:35], v[120:123]
    s_nop 1
    v_mfma_f32_16x16x16_bf16 v[116:119], v[68:69], v[16:17], v[116:119]
    v_mfma_f32_16x16x16_bf16 v[120:123], v[68:69], v[36:37], v[120:123]
    v_cvt_pk_bf16_f32 v124, v108, v109
    v_cvt_pk_bf16_f32 v125, v110, v111
    v_cvt_pk_bf16_f32 v126, v112, v113
    v_cvt_pk_bf16_f32 v127, v114, v115
    s_mov_b32 s48, 26624
    s_nop 0
    v_permlane32_swap_b32 v124, v126
    v_permlane32_swap_b32 v125, v127
    s_nop 0
    buffer_store_dwordx4 v[124:127], v48, s[36:39], s48 offen sc0 sc1
    s_waitcnt lgkmcnt(0)
    v_mfma_f32_16x16x32_bf16 v[108:111], v[70:73], v[0:3], 0
    v_mfma_f32_16x16x32_bf16 v[108:111], v[74:77], v[4:7], v[108:111]
    ds_read_b64_tr_b16 v[88:89], v41 offset:128
    ds_read_b64_tr_b16 v[90:91], v41 offset:6272
    ds_read_b64_tr_b16 v[92:93], v41 offset:12416
    ds_read_b64_tr_b16 v[94:95], v41 offset:18560
    ds_read_b64_tr_b16 v[96:97], v41 offset:24704
    v_mfma_f32_16x16x32_bf16 v[108:111], v[78:81], v[8:11], v[108:111]
    v_mfma_f32_16x16x32_bf16 v[108:111], v[82:85], v[12:15], v[108:111]
    v_mfma_f32_16x16x32_bf16 v[112:115], v[70:73], v[20:23], 0
    v_mfma_f32_16x16x32_bf16 v[112:115], v[74:77], v[24:27], v[112:115]
    ds_read_b64_tr_b16 v[98:99], v41 offset:30848
    ds_read_b64_tr_b16 v[100:101], v41 offset:36992
    ds_read_b64_tr_b16 v[102:103], v41 offset:43136
    ds_read_b64_tr_b16 v[104:105], v41 offset:49280
    v_mfma_f32_16x16x32_bf16 v[112:115], v[78:81], v[28:31], v[112:115]
    v_mfma_f32_16x16x32_bf16 v[112:115], v[82:85], v[32:35], v[112:115]
    s_nop 1
    v_mfma_f32_16x16x16_bf16 v[108:111], v[86:87], v[16:17], v[108:111]
    v_mfma_f32_16x16x16_bf16 v[112:115], v[86:87], v[36:37], v[112:115]
    v_cvt_pk_bf16_f32 v128, v116, v117
    v_cvt_pk_bf16_f32 v129, v118, v119
    v_cvt_pk_bf16_f32 v130, v120, v121
    v_cvt_pk_bf16_f32 v131, v122, v123
    s_mov_b32 s48, 27648
    s_nop 0
    v_permlane32_swap_b32 v128, v130
    v_permlane32_swap_b32 v129, v131
    s_nop 0
    buffer_store_dwordx4 v[128:131], v48, s[36:39], s48 offen sc0 sc1
    s_waitcnt lgkmcnt(0)
    v_mfma_f32_16x16x32_bf16 v[116:119], v[88:91], v[0:3], 0
    v_mfma_f32_16x16x32_bf16 v[116:119], v[92:95], v[4:7], v[116:119]
    v_mfma_f32_16x16x32_bf16 v[116:119], v[96:99], v[8:11], v[116:119]
    v_mfma_f32_16x16x32_bf16 v[116:119], v[100:103], v[12:15], v[116:119]
    v_mfma_f32_16x16x32_bf16 v[120:123], v[88:91], v[20:23], 0
    v_mfma_f32_16x16x32_bf16 v[120:123], v[92:95], v[24:27], v[120:123]
    v_mfma_f32_16x16x32_bf16 v[120:123], v[96:99], v[28:31], v[120:123]
    v_mfma_f32_16x16x32_bf16 v[120:123], v[100:103], v[32:35], v[120:123]
    s_nop 1
    v_mfma_f32_16x16x16_bf16 v[116:119], v[104:105], v[16:17], v[116:119]
    v_mfma_f32_16x16x16_bf16 v[120:123], v[104:105], v[36:37], v[120:123]
    v_cvt_pk_bf16_f32 v124, v108, v109
    v_cvt_pk_bf16_f32 v125, v110, v111
    v_cvt_pk_bf16_f32 v126, v112, v113
    v_cvt_pk_bf16_f32 v127, v114, v115
    s_mov_b32 s48, 28672
    s_nop 0
    v_permlane32_swap_b32 v124, v126
    v_permlane32_swap_b32 v125, v127
    s_nop 0
    buffer_store_dwordx4 v[124:127], v48, s[36:39], s48 offen sc0 sc1
    s_nop 7
    s_nop 1
    v_cvt_pk_bf16_f32 v128, v116, v117
    v_cvt_pk_bf16_f32 v129, v118, v119
    v_cvt_pk_bf16_f32 v130, v120, v121
    v_cvt_pk_bf16_f32 v131, v122, v123
    s_mov_b32 s48, 29696
    s_nop 0
    v_permlane32_swap_b32 v128, v130
    v_permlane32_swap_b32 v129, v131
    s_nop 0
    buffer_store_dwordx4 v[128:131], v48, s[36:39], s48 offen sc0 sc1
    s_waitcnt vmcnt(0) lgkmcnt(0)
    v_mbcnt_lo_u32_b32 v1, -1, 0
    v_mbcnt_hi_u32_b32 v1, -1, v1
    s_load_dwordx2 s[4:5], s[0:1], 0
    s_load_dwordx4 s[12:15], s[0:1], 48
    s_load_dwordx2 s[20:21], s[0:1], 64
    s_barrier
    s_waitcnt lgkmcnt(0)
    s_mov_b32 s16, s14
    s_and_b32 s17, s15, 0xffff
    s_mov_b32 s18, 0x100
    s_mov_b32 s19, 0x20000
    s_lshl_b32 s47, s44, 7
    s_add_u32 s47, s47, 46137344
    s_add_u32 s36, s20, s47
    s_addc_u32 s37, s21, 0
    s_and_b32 s37, s37, 0xffff
    s_mov_b32 s38, 64
    s_mov_b32 s39, 0x20000
    v_mov_b32 v6, 240
    s_mov_b32 s47, 0
L_tag_a0:
    buffer_load_dword v5, v6, s[16:19], 0 offen sc1
    s_waitcnt vmcnt(0)
    v_readfirstlane_b32 s58, v5
    s_add_u32 s47, s47, 1
    s_nop 2
    s_cmp_lg_u32 s58, 0
    s_cbranch_scc1 L_tagok_a0
    s_cmp_lt_u32 s47, 200000
    s_cbranch_scc1 L_tag_a0
L_tagok_a0:
    s_cmp_lg_u32 s40, 0
    s_cbranch_scc1 L_t_nosig_a0
    s_add_u32 s46, s43, 12
    s_lshl_b32 s46, s46, 2
    v_mov_b32 v4, s58
    v_mov_b32 v5, s46
    s_mov_b64 exec, 1
    buffer_store_dword v4, v5, s[36:39], 0 offen sc0 sc1
    s_mov_b64 exec, -1
L_t_nosig_a0:
    s_endpgm
L_att1:
    v_and_b32 v247, 63, v0
    v_mov_b32 v144, v0
    s_lshl_b32 s46, s44, 7
    s_lshl_b32 s47, s40, 4
    s_add_u32 s46, s46, s47
    s_mul_i32 s46, s46, 1152
    v_lshrrev_b32 v248, 3, v247
    v_mul_u32_u24 v249, 1152, v248
    v_add_u32 v249, s46, v249
    v_lshrrev_b32 v250, 4, v247
    v_and_b32 v251, 7, v247
    v_xor_b32 v252, v251, v250
    v_lshl_add_u32 v252, v252, 4, v249
    v_add_u32 v250, 4, v250
    v_xor_b32 v253, v251, v250
    v_lshl_add_u32 v253, v253, 4, v249
    v_add_u32 v253, 9216, v253
    s_lshl_b32 s52, s40, 11
    s_add_u32 s52, s52, 65536
    s_add_u32 m0, s52, 0
    s_movk_i32 s49, 0
    buffer_load_dwordx4 v252, s[24:27], s49 offen lds
    s_add_u32 m0, s52, 1024
    s_movk_i32 s49, 0
    buffer_load_dwordx4 v253, s[24:27], s49 offen lds
    s_add_u32 m0, s52, 16384
    s_movk_i32 s49, 128
    buffer_load_dwordx4 v252, s[24:27], s49 offen lds
    s_add_u32 m0, s52, 17408
    s_movk_i32 s49, 128
    buffer_load_dwordx4 v253, s[24:27], s49 offen lds
    s_add_u32 m0, s52, 32768
    s_movk_i32 s49, 256
    buffer_load_dwordx4 v252, s[24:27], s49 offen lds
    s_add_u32 m0, s52, 33792
    s_movk_i32 s49, 256
    buffer_load_dwordx4 v253, s[24:27], s49 offen lds
    s_add_u32 m0, s52, 49152
    s_movk_i32 s49, 384
    buffer_load_dwordx4 v252, s[24:27], s49 offen lds
    s_add_u32 m0, s52, 50176
    s_movk_i32 s49, 384
    buffer_load_dwordx4 v253, s[24:27], s49 offen lds
    s_add_u32 m0, s52, 65536
    s_movk_i32 s49, 512
    buffer_load_dwordx4 v252, s[24:27], s49 offen lds
    s_add_u32 m0, s52, 66560
    s_movk_i32 s49, 512
    buffer_load_dwordx4 v253, s[24:27], s49 offen lds
    s_add_u32 m0, s52, 81920
    s_movk_i32 s49, 640
    buffer_load_dwordx4 v252, s[24:27], s49 offen lds
    s_add_u32 m0, s52, 82944
    s_movk_i32 s49, 640
    buffer_load_dwordx4 v253, s[24:27], s49 offen lds
    s_mov_b32 s28, s6
    s_and_b32 s29, s7, 0xffff
    s_mov_b32 s30, 0x1e6000
    s_mov_b32 s31, 0x20000
    s_mul_i32 s46, s43, 165888
    s_add_u32 s32, s8, s46
    s_addc_u32 s33, s9, 0
    s_and_b32 s33, s33, 0xffff
    s_sub_u32 s34, 0xa2000, s46
    s_mov_b32 s35, 0x20000
    s_and_b32 s46, s44, 7
    s_lshl_b32 s46, s46, 3
    s_add_u32 s46, s46, s40
    s_mul_i32 s47, s46, 9
    v_mul_u32_u24 v251, 2428, v247
    v_lshrrev_b32 v251, 16, v251
    v_mul_u32_u24 v248, 27, v251
    v_sub_u32 v250, v247, v248
    v_mul_u32_u24 v248, 21846, v250
    v_lshrrev_b32 v248, 16, v248
    v_mul_u32_u24 v249, 3, v248
    v_sub_u32 v249, v250, v249
    v_add_u32 v248, s47, v248
    v_mul_u32_u24 v248, 3456, v248
    v_lshl_add_u32 v248, v249, 7, v248
    v_mul_u32_u24 v251, 1152, v251
    v_add_u32 v248, v248, v251
    s_lshl_b32 s47, s43, 8
    s_add_u32 s47, s47, 1152
    v_add_u32 v248, s47, v248
    v_mov_b32 v250, 0x7fffff00
    v_cmp_gt_u32 vcc, 54, v247
    s_nop 1
    v_cndmask_b32 v248, v250, v248, vcc
    buffer_load_dword v254, v248, s[28:31], 0 offen
    s_lshr_b32 s46, s41, 1
    s_lshl_b32 s46, s46, 4
    s_and_b32 s47, s41, 1
    s_lshl_b32 s47, s47, 2
    s_add_u32 s46, s46, s47
    s_lshl_b32 s47, s43, 8
    v_add_u32 v248, 0, v247
    v_mul_u32_u24 v249, 2731, v248
    v_lshrrev_b32 v249, 16, v249
    v_mul_u32_u24 v250, 24, v249
    v_sub_u32 v250, v248, v250
    v_and_b32 v251, 6, v249
    v_xor_b32 v250, v250, v251
    v_lshrrev_b32 v251, 2, v249
    v_lshlrev_b32 v251, 3, v251
    v_and_b32 v249, 3, v249
    v_add_u32 v249, v249, v251
    v_add_u32 v249, s46, v249
    v_mul_u32_u24 v249, 3456, v249
    v_lshl_add_u32 v249, v250, 4, v249
    v_add_u32 v244, s47, v249
    v_add_u32 v248, 64, v247
    v_mul_u32_u24 v249, 2731, v248
    v_lshrrev_b32 v249, 16, v249
    v_mul_u32_u24 v250, 24, v249
    v_sub_u32 v250, v248, v250
    v_and_b32 v251, 6, v249
    v_xor_b32 v250, v250, v251
    v_lshrrev_b32 v251, 2, v249
    v_lshlrev_b32 v251, 3, v251
    v_and_b32 v249, 3, v249
    v_add_u32 v249, v249, v251
    v_add_u32 v249, s46, v249
    v_mul_u32_u24 v249, 3456, v249
    v_lshl_add_u32 v249, v250, 4, v249
    v_add_u32 v245, s47, v249
    v_add_u32 v248, 128, v247
    v_mul_u32_u24 v249, 2731, v248
    v_lshrrev_b32 v249, 16, v249
    v_mul_u32_u24 v250, 24, v249
    v_sub_u32 v250, v248, v250
    v_and_b32 v251, 6, v249
    v_xor_b32 v250, v250, v251
    v_lshrrev_b32 v251, 2, v249
    v_lshlrev_b32 v251, 3, v251
    v_and_b32 v249, 3, v249
    v_add_u32 v249, v249, v251
    v_add_u32 v249, s46, v249
    v_mul_u32_u24 v249, 3456, v249
    v_lshl_add_u32 v249, v250, 4, v249
    v_add_u32 v246, s47, v249
    s_mul_i32 s55, s41, 3072
    s_add_u32 s55, s55, 12288
    s_add_u32 s46, s43, 12
    s_mul_i32 s46, s46, 2359296
    s_mul_i32 s47, s44, 147456
    s_add_u32 s46, s46, s47
    s_add_u32 s36, s20, s46
    s_addc_u32 s37, s21, 0
    s_and_b32 s37, s37, 0xffff
    s_sub_u32 s38, 0x2400000, s46
    s_mov_b32 s39, 0x20000
    s_mul_i32 s46, s43, 36864
    s_add_u32 s46, s46, 41943040
    s_add_u32 s8, s20, s46
    s_addc_u32 s9, s21, 0
    s_and_b32 s9, s9, 0xffff
    s_mov_b32 s10, 36864
    s_mov_b32 s11, 0x20000
    s_mov_b32 s16, s18
    s_and_b32 s17, s19, 0xffff
    s_mov_b32 s18, 0x100
    s_mov_b32 s19, 0x20000
    s_cmp_lg_u32 s44, 0
    s_cbranch_scc1 L_att_nozero_c1
    v_mov_b32 v148, 0
    v_mov_b32 v149, 0
    v_mov_b32 v150, 0
    v_mov_b32 v151, 0
    v_lshlrev_b32 v145, 4, v144
    s_mov_b32 s49, 0
    buffer_store_dwordx4 v[148:151], v145, s[8:11], s49 offen sc0 sc1
    s_mov_b32 s49, 8192
    buffer_store_dwordx4 v[148:151], v145, s[8:11], s49 offen sc0 sc1
    s_mov_b32 s49, 16384
    buffer_store_dwordx4 v[148:151], v145, s[8:11], s49 offen sc0 sc1
    s_mov_b32 s49, 24576
    buffer_store_dwordx4 v[148:151], v145, s[8:11], s49 offen sc0 sc1
    s_mov_b32 s49, 32768
    buffer_store_dwordx4 v[148:151], v145, s[8:11], s49 offen sc0 sc1
    s_waitcnt vmcnt(0)
    s_barrier
    v_mov_b32 v146, 1
    s_lshl_b32 s46, s43, 2
    s_add_u32 s46, s46, 64
    v_mov_b32 v147, 0x7fffff00
    v_mov_b32 v148, s46
    v_cmp_eq_u32 vcc, 0, v144
    s_nop 1
    v_cndmask_b32 v147, v147, v148, vcc
    buffer_atomic_add v146, v147, s[16:19], 0 offen sc1
    s_waitcnt vmcnt(0)
L_att_nozero_c1:
    v_lshrrev_b32 v248, 4, v247
    v_lshrrev_b32 v249, 1, v248
    v_lshlrev_b32 v249, 4, v249
    v_and_b32 v250, 1, v248
    v_lshlrev_b32 v250, 2, v250
    v_add_u32 v249, v249, v250
    v_lshrrev_b32 v250, 2, v247
    v_and_b32 v250, 3, v250
    v_add_u32 v249, v249, v250
    v_and_b32 v251, 6, v249
    v_mul_u32_u24 v249, 384, v249
    v_and_b32 v250, 3, v247
    v_lshl_add_u32 v249, v250, 3, v249
    s_lshl_b32 s46, s43, 1
    s_add_u32 s46, s46, 0
    s_and_b32 s47, s46, 7
    s_lshr_b32 s46, s46, 3
    s_lshl_b32 s46, s46, 7
    v_xor_b32 v250, s47, v251
    v_lshl_add_u32 v250, v250, 4, v249
    v_add_u32 v236, s46, v250
    v_add_u32 v240, 49152, v236
    s_lshl_b32 s46, s43, 1
    s_add_u32 s46, s46, 2
    s_and_b32 s47, s46, 7
    s_lshr_b32 s46, s46, 3
    s_lshl_b32 s46, s46, 7
    v_xor_b32 v250, s47, v251
    v_lshl_add_u32 v250, v250, 4, v249
    v_add_u32 v237, s46, v250
    v_add_u32 v241, 49152, v237
    s_lshl_b32 s46, s43, 1
    s_add_u32 s46, s46, 4
    s_and_b32 s47, s46, 7
    s_lshr_b32 s46, s46, 3
    s_lshl_b32 s46, s46, 7
    v_xor_b32 v250, s47, v251
    v_lshl_add_u32 v250, v250, 4, v249
    v_add_u32 v238, s46, v250
    v_add_u32 v242, 49152, v238
    s_lshl_b32 s46, s43, 1
    s_add_u32 s46, s46, 6
    s_and_b32 s47, s46, 7
    s_lshr_b32 s46, s46, 3
    s_lshl_b32 s46, s46, 7
    v_xor_b32 v250, s47, v251
    v_lshl_add_u32 v250, v250, 4, v249
    v_add_u32 v239, s46, v250
    v_add_u32 v243, 49152, v239
    v_and_b32 v249, 15, v247
    v_lshrrev_b32 v250, 1, v249
    v_xor_b32 v250, v250, v248
    v_lshlrev_b32 v250, 4, v250
    s_lshl_b32 s46, s41, 5
    v_add_u32 v251, s46, v249
    v_lshl_add_u32 v250, v251, 7, v250
    v_add_u32 v152, 65536, v250
    v_xor_b32 v153, 64, v152
    v_add_u32 v154, 0x10000, v152
    v_add_u32 v155, 0x10000, v153
    v_lshlrev_b32 v156, 2, v251
    v_add_u32 v156, 162816, v156
    v_mov_b32 v160, 0
    v_mov_b32 v161, 0
    v_mov_b32 v162, 0
    v_mov_b32 v163, 0
    s_waitcnt vmcnt(7)
    s_barrier
    ds_read_b128 v[72:75], v152 offset:2048
    ds_read_b128 v[76:79], v153 offset:2048
    ds_read_b128 v[80:83], v152 offset:18432
    ds_read_b128 v[84:87], v153 offset:18432
    ds_read_b128 v[88:91], v152 offset:34816
    ds_read_b128 v[92:95], v153 offset:34816
    ds_read_b128 v[0:3], v152 offset:0
    ds_read_b128 v[4:7], v153 offset:0
    ds_read_b128 v[8:11], v152 offset:16384
    ds_read_b128 v[12:15], v153 offset:16384
    ds_read_b128 v[16:19], v152 offset:32768
    ds_read_b128 v[20:23], v153 offset:32768
    s_waitcnt lgkmcnt(11)
    v_dot2_f32_bf16 v160, v72, s50, v160
    v_dot2_f32_bf16 v162, v72, v72, v162
    v_dot2_f32_bf16 v161, v73, s50, v161
    v_dot2_f32_bf16 v163, v73, v73, v163
    v_dot2_f32_bf16 v160, v74, s50, v160
    v_dot2_f32_bf16 v162, v74, v74, v162
    v_dot2_f32_bf16 v161, v75, s50, v161
    v_dot2_f32_bf16 v163, v75, v75, v163
    s_waitcnt lgkmcnt(10)
    v_dot2_f32_bf16 v160, v76, s50, v160
    v_dot2_f32_bf16 v162, v76, v76, v162
    v_dot2_f32_bf16 v161, v77, s50, v161
    v_dot2_f32_bf16 v163, v77, v77, v163
    v_dot2_f32_bf16 v160, v78, s50, v160
    v_dot2_f32_bf16 v162, v78, v78, v162
    v_dot2_f32_bf16 v161, v79, s50, v161
    v_dot2_f32_bf16 v163, v79, v79, v163
    s_waitcnt lgkmcnt(9)
    v_dot2_f32_bf16 v160, v80, s50, v160
    v_dot2_f32_bf16 v162, v80, v80, v162
    v_dot2_f32_bf16 v161, v81, s50, v161
    v_dot2_f32_bf16 v163, v81, v81, v163
    v_dot2_f32_bf16 v160, v82, s50, v160
    v_dot2_f32_bf16 v162, v82, v82, v162
    v_dot2_f32_bf16 v161, v83, s50, v161
    v_dot2_f32_bf16 v163, v83, v83, v163
    s_waitcnt lgkmcnt(8)
    v_dot2_f32_bf16 v160, v84, s50, v160
    v_dot2_f32_bf16 v162, v84, v84, v162
    v_dot2_f32_bf16 v161, v85, s50, v161
    v_dot2_f32_bf16 v163, v85, v85, v163
    v_dot2_f32_bf16 v160, v86, s50, v160
    v_dot2_f32_bf16 v162, v86, v86, v162
    v_dot2_f32_bf16 v161, v87, s50, v161
    v_dot2_f32_bf16 v163, v87, v87, v163
    s_waitcnt lgkmcnt(7)
    v_dot2_f32_bf16 v160, v88, s50, v160
    v_dot2_f32_bf16 v162, v88, v88, v162
    v_dot2_f32_bf16 v161, v89, s50, v161
    v_dot2_f32_bf16 v163, v89, v89, v163
    v_dot2_f32_bf16 v160, v90, s50, v160
    v_dot2_f32_bf16 v162, v90, v90, v162
    v_dot2_f32_bf16 v161, v91, s50, v161
    v_dot2_f32_bf16 v163, v91, v91, v163
    s_waitcnt lgkmcnt(6)
    v_dot2_f32_bf16 v160, v92, s50, v160
    v_dot2_f32_bf16 v162, v92, v92, v162
    v_dot2_f32_bf16 v161, v93, s50, v161
    v_dot2_f32_bf16 v163, v93, v93, v163
    v_dot2_f32_bf16 v160, v94, s50, v160
    v_dot2_f32_bf16 v162, v94, v94, v162
    v_dot2_f32_bf16 v161, v95, s50, v161
    v_dot2_f32_bf16 v163, v95, v95, v163
    s_waitcnt lgkmcnt(0)
    s_waitcnt vmcnt(1)
    s_barrier
    s_add_u32 m0, s52, 0
    s_movk_i32 s49, 768
    buffer_load_dwordx4 v252, s[24:27], s49 offen lds
    s_add_u32 m0, s52, 1024
    s_movk_i32 s49, 768
    buffer_load_dwordx4 v253, s[24:27], s49 offen lds
    s_add_u32 m0, s52, 16384
    s_movk_i32 s49, 896
    buffer_load_dwordx4 v252, s[24:27], s49 offen lds
    s_add_u32 m0, s52, 17408
    s_movk_i32 s49, 896
    buffer_load_dwordx4 v253, s[24:27], s49 offen lds
    s_add_u32 m0, s52, 32768
    s_movk_i32 s49, 1024
    buffer_load_dwordx4 v252, s[24:27], s49 offen lds
    s_add_u32 m0, s52, 33792
    s_movk_i32 s49, 1024
    buffer_load_dwordx4 v253, s[24:27], s49 offen lds
    s_add_u32 m0, s55, 0
    s_mov_b32 s49, 2304
    buffer_load_dwordx4 v244, s[28:31], s49 offen lds
    s_add_u32 m0, s55, 1024
    s_mov_b32 s49, 2304
    buffer_load_dwordx4 v245, s[28:31], s49 offen lds
    s_add_u32 m0, s55, 2048
    s_mov_b32 s49, 2304
    buffer_load_dwordx4 v246, s[28:31], s49 offen lds
    ds_read_b128 v[96:99], v152 offset:51200
    ds_read_b128 v[100:103], v153 offset:51200
    ds_read_b128 v[104:107], v154 offset:2048
    ds_read_b128 v[108:111], v155 offset:2048
    ds_read_b128 v[112:115], v154 offset:18432
    ds_read_b128 v[116:119], v155 offset:18432
    ds_read_b128 v[24:27], v152 offset:49152
    ds_read_b128 v[28:31], v153 offset:49152
    ds_read_b128 v[32:35], v154 offset:0
    ds_read_b128 v[36:39], v155 offset:0
    ds_read_b128 v[40:43], v154 offset:16384
    ds_read_b128 v[44:47], v155 offset:16384
    s_waitcnt lgkmcnt(11)
    v_dot2_f32_bf16 v160, v96, s50, v160
    v_dot2_f32_bf16 v162, v96, v96, v162
    v_dot2_f32_bf16 v161, v97, s50, v161
    v_dot2_f32_bf16 v163, v97, v97, v163
    v_dot2_f32_bf16 v160, v98, s50, v160
    v_dot2_f32_bf16 v162, v98, v98, v162
    v_dot2_f32_bf16 v161, v99, s50, v161
    v_dot2_f32_bf16 v163, v99, v99, v163
    s_waitcnt lgkmcnt(10)
    v_dot2_f32_bf16 v160, v100, s50, v160
    v_dot2_f32_bf16 v162, v100, v100, v162
    v_dot2_f32_bf16 v161, v101, s50, v161
    v_dot2_f32_bf16 v163, v101, v101, v163
    v_dot2_f32_bf16 v160, v102, s50, v160
    v_dot2_f32_bf16 v162, v102, v102, v162
    v_dot2_f32_bf16 v161, v103, s50, v161
    v_dot2_f32_bf16 v163, v103, v103, v163
    s_waitcnt lgkmcnt(9)
    v_dot2_f32_bf16 v160, v104, s50, v160
    v_dot2_f32_bf16 v162, v104, v104, v162
    v_dot2_f32_bf16 v161, v105, s50, v161
    v_dot2_f32_bf16 v163, v105, v105, v163
    v_dot2_f32_bf16 v160, v106, s50, v160
    v_dot2_f32_bf16 v162, v106, v106, v162
    v_dot2_f32_bf16 v161, v107, s50, v161
    v_dot2_f32_bf16 v163, v107, v107, v163
    s_waitcnt lgkmcnt(8)
    v_dot2_f32_bf16 v160, v108, s50, v160
    v_dot2_f32_bf16 v162, v108, v108, v162
    v_dot2_f32_bf16 v161, v109, s50, v161
    v_dot2_f32_bf16 v163, v109, v109, v163
    v_dot2_f32_bf16 v160, v110, s50, v160
    v_dot2_f32_bf16 v162, v110, v110, v162
    v_dot2_f32_bf16 v161, v111, s50, v161
    v_dot2_f32_bf16 v163, v111, v111, v163
    s_waitcnt lgkmcnt(7)
    v_dot2_f32_bf16 v160, v112, s50, v160
    v_dot2_f32_bf16 v162, v112, v112, v162
    v_dot2_f32_bf16 v161, v113, s50, v161
    v_dot2_f32_bf16 v163, v113, v113, v163
    v_dot2_f32_bf16 v160, v114, s50, v160
    v_dot2_f32_bf16 v162, v114, v114, v162
    v_dot2_f32_bf16 v161, v115, s50, v161
    v_dot2_f32_bf16 v163, v115, v115, v163
    s_waitcnt lgkmcnt(6)
    v_dot2_f32_bf16 v160, v116, s50, v160
    v_dot2_f32_bf16 v162, v116, v116, v162
    v_dot2_f32_bf16 v161, v117, s50, v161
    v_dot2_f32_bf16 v163, v117, v117, v163
    v_dot2_f32_bf16 v160, v118, s50, v160
    v_dot2_f32_bf16 v162, v118, v118, v162
    v_dot2_f32_bf16 v161, v119, s50, v161
    v_dot2_f32_bf16 v163, v119, v119, v163
    s_waitcnt lgkmcnt(0)
    s_waitcnt vmcnt(3)
    s_barrier
    ds_read_b128 v[120:123], v152 offset:2048
    ds_read_b128 v[124:127], v153 offset:2048
    ds_read_b128 v[128:131], v152 offset:18432
    ds_read_b128 v[132:135], v153 offset:18432
    ds_read_b128 v[136:139], v152 offset:34816
    ds_read_b128 v[140:143], v153 offset:34816
    ds_read_b128 v[48:51], v152 offset:0
    ds_read_b128 v[52:55], v153 offset:0
    ds_read_b128 v[56:59], v152 offset:16384
    ds_read_b128 v[60:63], v153 offset:16384
    ds_read_b128 v[64:67], v152 offset:32768
    ds_read_b128 v[68:71], v153 offset:32768
    s_waitcnt lgkmcnt(11)
    v_dot2_f32_bf16 v160, v120, s50, v160
    v_dot2_f32_bf16 v162, v120, v120, v162
    v_dot2_f32_bf16 v161, v121, s50, v161
    v_dot2_f32_bf16 v163, v121, v121, v163
    v_dot2_f32_bf16 v160, v122, s50, v160
    v_dot2_f32_bf16 v162, v122, v122, v162
    v_dot2_f32_bf16 v161, v123, s50, v161
    v_dot2_f32_bf16 v163, v123, v123, v163
    s_waitcnt lgkmcnt(10)
    v_dot2_f32_bf16 v160, v124, s50, v160
    v_dot2_f32_bf16 v162, v124, v124, v162
    v_dot2_f32_bf16 v161, v125, s50, v161
    v_dot2_f32_bf16 v163, v125, v125, v163
    v_dot2_f32_bf16 v160, v126, s50, v160
    v_dot2_f32_bf16 v162, v126, v126, v162
    v_dot2_f32_bf16 v161, v127, s50, v161
    v_dot2_f32_bf16 v163, v127, v127, v163
    s_waitcnt lgkmcnt(9)
    v_dot2_f32_bf16 v160, v128, s50, v160
    v_dot2_f32_bf16 v162, v128, v128, v162
    v_dot2_f32_bf16 v161, v129, s50, v161
    v_dot2_f32_bf16 v163, v129, v129, v163
    v_dot2_f32_bf16 v160, v130, s50, v160
    v_dot2_f32_bf16 v162, v130, v130, v162
    v_dot2_f32_bf16 v161, v131, s50, v161
    v_dot2_f32_bf16 v163, v131, v131, v163
    s_waitcnt lgkmcnt(8)
    v_dot2_f32_bf16 v160, v132, s50, v160
    v_dot2_f32_bf16 v162, v132, v132, v162
    v_dot2_f32_bf16 v161, v133, s50, v161
    v_dot2_f32_bf16 v163, v133, v133, v163
    v_dot2_f32_bf16 v160, v134, s50, v160
    v_dot2_f32_bf16 v162, v134, v134, v162
    v_dot2_f32_bf16 v161, v135, s50, v161
    v_dot2_f32_bf16 v163, v135, v135, v163
    s_waitcnt lgkmcnt(7)
    v_dot2_f32_bf16 v160, v136, s50, v160
    v_dot2_f32_bf16 v162, v136, v136, v162
    v_dot2_f32_bf16 v161, v137, s50, v161
    v_dot2_f32_bf16 v163, v137, v137, v163
    v_dot2_f32_bf16 v160, v138, s50, v160
    v_dot2_f32_bf16 v162, v138, v138, v162
    v_dot2_f32_bf16 v161, v139, s50, v161
    v_dot2_f32_bf16 v163, v139, v139, v163
    s_waitcnt lgkmcnt(6)
    v_dot2_f32_bf16 v160, v140, s50, v160
    v_dot2_f32_bf16 v162, v140, v140, v162
    v_dot2_f32_bf16 v161, v141, s50, v161
    v_dot2_f32_bf16 v163, v141, v141, v163
    v_dot2_f32_bf16 v160, v142, s50, v160
    v_dot2_f32_bf16 v162, v142, v142, v162
    v_dot2_f32_bf16 v161, v143, s50, v161
    v_dot2_f32_bf16 v163, v143, v143, v163
    s_waitcnt lgkmcnt(0)
    s_add_u32 m0, s55, 24576
    s_mov_b32 s49, 112896
    buffer_load_dwordx4 v244, s[28:31], s49 offen lds
    s_add_u32 m0, s55, 25600
    s_mov_b32 s49, 112896
    buffer_load_dwordx4 v245, s[28:31], s49 offen lds
    s_add_u32 m0, s55, 26624
    s_mov_b32 s49, 112896
    buffer_load_dwordx4 v246, s[28:31], s49 offen lds
    s_and_b32 s46, s44, 7
    s_lshl_b32 s46, s46, 3
    s_add_u32 s46, s46, s40
    s_mul_i32 s47, s46, 9
    v_mul_u32_u24 v248, 21846, v247
    v_lshrrev_b32 v248, 16, v248
    v_mul_u32_u24 v249, 3, v248
    v_sub_u32 v249, v247, v249
    v_add_u32 v248, s47, v248
    v_mul_u32_u24 v248, 3456, v248
    v_lshl_add_u32 v248, v249, 7, v248
    s_lshl_b32 s47, s43, 8
    v_add_u32 v248, s47, v248
    v_mov_b32 v250, 0x7fffff00
    v_cmp_gt_u32 vcc, 27, v247
    s_nop 1
    v_cndmask_b32 v248, v250, v248, vcc
    buffer_load_dword v254, v248, s[28:31], 0 offen
    s_mul_i32 s46, s46, 2688
    v_lshl_add_u32 v248, v247, 7, s46
    v_cmp_gt_u32 vcc, 21, v247
    s_nop 1
    v_cndmask_b32 v248, v250, v248, vcc
    buffer_load_dword v254, v248, s[32:35], 0 offen
    s_nop 1
    v_add_f32 v160, v160, v161
    v_add_f32 v162, v162, v163
    v_mov_b32 v161, v160
    s_nop 1
    v_permlane16_swap_b32 v160, v161
    s_nop 1
    v_add_f32 v160, v160, v161
    v_mov_b32 v161, v160
    s_nop 1
    v_permlane32_swap_b32 v160, v161
    s_nop 1
    v_add_f32 v160, v160, v161
    v_mov_b32 v163, v162
    s_nop 1
    v_permlane16_swap_b32 v162, v163
    s_nop 1
    v_add_f32 v162, v162, v163
    v_mov_b32 v163, v162
    s_nop 1
    v_permlane32_swap_b32 v162, v163
    s_nop 1
    v_add_f32 v162, v162, v163
    v_mul_f32 v160, 0x3ae38e39, v160
    v_mul_f32 v162, 0x3ae38e39, v162
    v_fma_f32 v162, -v160, v160, v162
    v_max_f32 v162, 0, v162
    v_add_f32 v162, 0x3727c5ac, v162
    v_sub_f32 v160, 0, v160
    v_rsq_f32 v253, v162
    s_nop 0
    ds_write_b32 v156, v160 offset:64
    ds_write_b32 v156, v253 offset:576
    s_waitcnt lgkmcnt(0)
    s_barrier
    s_add_u32 m0, s55, 49152
    s_mov_b32 s49, 223488
    buffer_load_dwordx4 v244, s[28:31], s49 offen lds
    s_add_u32 m0, s55, 50176
    s_mov_b32 s49, 223488
    buffer_load_dwordx4 v245, s[28:31], s49 offen lds
    s_add_u32 m0, s55, 51200
    s_mov_b32 s49, 223488
    buffer_load_dwordx4 v246, s[28:31], s49 offen lds
    ds_read_b32 v161, v156 offset:0
    ds_read_b32 v252, v156 offset:512
    v_dot2_f32_bf16 v168, v72, s53, v160
    v_dot2_f32_bf16 v169, v72, s54, v160
    v_dot2_f32_bf16 v170, v73, s53, v160
    v_dot2_f32_bf16 v171, v73, s54, v160
    v_dot2_f32_bf16 v172, v74, s53, v160
    v_dot2_f32_bf16 v173, v74, s54, v160
    v_dot2_f32_bf16 v174, v75, s53, v160
    v_dot2_f32_bf16 v175, v75, s54, v160
    s_nop 0
    v_cvt_pk_bf16_f32 v72, v168, v169
    v_cvt_pk_bf16_f32 v73, v170, v171
    v_cvt_pk_bf16_f32 v74, v172, v173
    v_cvt_pk_bf16_f32 v75, v174, v175
    v_dot2_f32_bf16 v168, v76, s53, v160
    v_dot2_f32_bf16 v169, v76, s54, v160
    v_dot2_f32_bf16 v170, v77, s53, v160
    v_dot2_f32_bf16 v171, v77, s54, v160
    v_dot2_f32_bf16 v172, v78, s53, v160
    v_dot2_f32_bf16 v173, v78, s54, v160
    v_dot2_f32_bf16 v174, v79, s53, v160
    v_dot2_f32_bf16 v175, v79, s54, v160
    s_nop 0
    v_cvt_pk_bf16_f32 v76, v168, v169
    v_cvt_pk_bf16_f32 v77, v170, v171
    v_cvt_pk_bf16_f32 v78, v172, v173
    v_cvt_pk_bf16_f32 v79, v174, v175
    v_dot2_f32_bf16 v168, v80, s53, v160
    v_dot2_f32_bf16 v169, v80, s54, v160
    v_dot2_f32_bf16 v170, v81, s53, v160
    v_dot2_f32_bf16 v171, v81, s54, v160
    v_dot2_f32_bf16 v172, v82, s53, v160
    v_dot2_f32_bf16 v173, v82, s54, v160
    v_dot2_f32_bf16 v174, v83, s53, v160
    v_dot2_f32_bf16 v175, v83, s54, v160
    s_nop 0
    v_cvt_pk_bf16_f32 v80, v168, v169
    v_cvt_pk_bf16_f32 v81, v170, v171
    v_cvt_pk_bf16_f32 v82, v172, v173
    v_cvt_pk_bf16_f32 v83, v174, v175
    v_dot2_f32_bf16 v168, v84, s53, v160
    v_dot2_f32_bf16 v169, v84, s54, v160
    v_dot2_f32_bf16 v170, v85, s53, v160
    v_dot2_f32_bf16 v171, v85, s54, v160
    v_dot2_f32_bf16 v172, v86, s53, v160
    v_dot2_f32_bf16 v173, v86, s54, v160
    v_dot2_f32_bf16 v174, v87, s53, v160
    v_dot2_f32_bf16 v175, v87, s54, v160
    s_nop 0
    v_cvt_pk_bf16_f32 v84, v168, v169
    v_cvt_pk_bf16_f32 v85, v170, v171
    v_cvt_pk_bf16_f32 v86, v172, v173
    v_cvt_pk_bf16_f32 v87, v174, v175
    v_dot2_f32_bf16 v168, v88, s53, v160
    v_dot2_f32_bf16 v169, v88, s54, v160
    v_dot2_f32_bf16 v170, v89, s53, v160
    v_dot2_f32_bf16 v171, v89, s54, v160
    v_dot2_f32_bf16 v172, v90, s53, v160
    v_dot2_f32_bf16 v173, v90, s54, v160
    v_dot2_f32_bf16 v174, v91, s53, v160
    v_dot2_f32_bf16 v175, v91, s54, v160
    s_nop 0
    v_cvt_pk_bf16_f32 v88, v168, v169
    v_cvt_pk_bf16_f32 v89, v170, v171
    v_cvt_pk_bf16_f32 v90, v172, v173
    v_cvt_pk_bf16_f32 v91, v174, v175
    v_dot2_f32_bf16 v168, v92, s53, v160
    v_dot2_f32_bf16 v169, v92, s54, v160
    v_dot2_f32_bf16 v170, v93, s53, v160
    v_dot2_f32_bf16 v171, v93, s54, v160
    v_dot2_f32_bf16 v172, v94, s53, v160
    v_dot2_f32_bf16 v173, v94, s54, v160
    v_dot2_f32_bf16 v174, v95, s53, v160
    v_dot2_f32_bf16 v175, v95, s54, v160
    s_nop 0
    v_cvt_pk_bf16_f32 v92, v168, v169
    v_cvt_pk_bf16_f32 v93, v170, v171
    v_cvt_pk_bf16_f32 v94, v172, v173
    v_cvt_pk_bf16_f32 v95, v174, v175
    v_dot2_f32_bf16 v168, v96, s53, v160
    v_dot2_f32_bf16 v169, v96, s54, v160
    v_dot2_f32_bf16 v170, v97, s53, v160
    v_dot2_f32_bf16 v171, v97, s54, v160
    v_dot2_f32_bf16 v172, v98, s53, v160
    v_dot2_f32_bf16 v173, v98, s54, v160
    v_dot2_f32_bf16 v174, v99, s53, v160
    v_dot2_f32_bf16 v175, v99, s54, v160
    s_nop 0
    v_cvt_pk_bf16_f32 v96, v168, v169
    v_cvt_pk_bf16_f32 v97, v170, v171
    v_cvt_pk_bf16_f32 v98, v172, v173
    v_cvt_pk_bf16_f32 v99, v174, v175
    v_dot2_f32_bf16 v168, v100, s53, v160
    v_dot2_f32_bf16 v169, v100, s54, v160
    v_dot2_f32_bf16 v170, v101, s53, v160
    v_dot2_f32_bf16 v171, v101, s54, v160
    v_dot2_f32_bf16 v172, v102, s53, v160
    v_dot2_f32_bf16 v173, v102, s54, v160
    v_dot2_f32_bf16 v174, v103, s53, v160
    v_dot2_f32_bf16 v175, v103, s54, v160
    s_nop 0
    v_cvt_pk_bf16_f32 v100, v168, v169
    v_cvt_pk_bf16_f32 v101, v170, v171
    v_cvt_pk_bf16_f32 v102, v172, v173
    v_cvt_pk_bf16_f32 v103, v174, v175
    v_dot2_f32_bf16 v168, v104, s53, v160
    v_dot2_f32_bf16 v169, v104, s54, v160
    v_dot2_f32_bf16 v170, v105, s53, v160
    v_dot2_f32_bf16 v171, v105, s54, v160
    v_dot2_f32_bf16 v172, v106, s53, v160
    v_dot2_f32_bf16 v173, v106, s54, v160
    v_dot2_f32_bf16 v174, v107, s53, v160
    v_dot2_f32_bf16 v175, v107, s54, v160
    s_nop 0
    v_cvt_pk_bf16_f32 v104, v168, v169
    v_cvt_pk_bf16_f32 v105, v170, v171
    v_cvt_pk_bf16_f32 v106, v172, v173
    v_cvt_pk_bf16_f32 v107, v174, v175
    v_dot2_f32_bf16 v168, v108, s53, v160
    v_dot2_f32_bf16 v169, v108, s54, v160
    v_dot2_f32_bf16 v170, v109, s53, v160
    v_dot2_f32_bf16 v171, v109, s54, v160
    v_dot2_f32_bf16 v172, v110, s53, v160
    v_dot2_f32_bf16 v173, v110, s54, v160
    v_dot2_f32_bf16 v174, v111, s53, v160
    v_dot2_f32_bf16 v175, v111, s54, v160
    s_nop 0
    v_cvt_pk_bf16_f32 v108, v168, v169
    v_cvt_pk_bf16_f32 v109, v170, v171
    v_cvt_pk_bf16_f32 v110, v172, v173
    v_cvt_pk_bf16_f32 v111, v174, v175
    v_dot2_f32_bf16 v168, v112, s53, v160
    v_dot2_f32_bf16 v169, v112, s54, v160
    v_dot2_f32_bf16 v170, v113, s53, v160
    v_dot2_f32_bf16 v171, v113, s54, v160
    v_dot2_f32_bf16 v172, v114, s53, v160
    v_dot2_f32_bf16 v173, v114, s54, v160
    v_dot2_f32_bf16 v174, v115, s53, v160
    v_dot2_f32_bf16 v175, v115, s54, v160
    s_nop 0
    v_cvt_pk_bf16_f32 v112, v168, v169
    v_cvt_pk_bf16_f32 v113, v170, v171
    v_cvt_pk_bf16_f32 v114, v172, v173
    v_cvt_pk_bf16_f32 v115, v174, v175
    v_dot2_f32_bf16 v168, v116, s53, v160
    v_dot2_f32_bf16 v169, v116, s54, v160
    v_dot2_f32_bf16 v170, v117, s53, v160
    v_dot2_f32_bf16 v171, v117, s54, v160
    v_dot2_f32_bf16 v172, v118, s53, v160
    v_dot2_f32_bf16 v173, v118, s54, v160
    v_dot2_f32_bf16 v174, v119, s53, v160
    v_dot2_f32_bf16 v175, v119, s54, v160
    s_nop 0
    v_cvt_pk_bf16_f32 v116, v168, v169
    v_cvt_pk_bf16_f32 v117, v170, v171
    v_cvt_pk_bf16_f32 v118, v172, v173
    v_cvt_pk_bf16_f32 v119, v174, v175
    v_dot2_f32_bf16 v168, v120, s53, v160
    v_dot2_f32_bf16 v169, v120, s54, v160
    v_dot2_f32_bf16 v170, v121, s53, v160
    v_dot2_f32_bf16 v171, v121, s54, v160
    v_dot2_f32_bf16 v172, v122, s53, v160
    v_dot2_f32_bf16 v173, v122, s54, v160
    v_dot2_f32_bf16 v174, v123, s53, v160
    v_dot2_f32_bf16 v175, v123, s54, v160
    s_nop 0
    v_cvt_pk_bf16_f32 v120, v168, v169
    v_cvt_pk_bf16_f32 v121, v170, v171
    v_cvt_pk_bf16_f32 v122, v172, v173
    v_cvt_pk_bf16_f32 v123, v174, v175
    v_dot2_f32_bf16 v168, v124, s53, v160
    v_dot2_f32_bf16 v169, v124, s54, v160
    v_dot2_f32_bf16 v170, v125, s53, v160
    v_dot2_f32_bf16 v171, v125, s54, v160
    v_dot2_f32_bf16 v172, v126, s53, v160
    v_dot2_f32_bf16 v173, v126, s54, v160
    v_dot2_f32_bf16 v174, v127, s53, v160
    v_dot2_f32_bf16 v175, v127, s54, v160
    s_nop 0
    v_cvt_pk_bf16_f32 v124, v168, v169
    v_cvt_pk_bf16_f32 v125, v170, v171
    v_cvt_pk_bf16_f32 v126, v172, v173
    v_cvt_pk_bf16_f32 v127, v174, v175
    v_dot2_f32_bf16 v168, v128, s53, v160
    v_dot2_f32_bf16 v169, v128, s54, v160
    v_dot2_f32_bf16 v170, v129, s53, v160
    v_dot2_f32_bf16 v171, v129, s54, v160
    v_dot2_f32_bf16 v172, v130, s53, v160
    v_dot2_f32_bf16 v173, v130, s54, v160
    v_dot2_f32_bf16 v174, v131, s53, v160
    v_dot2_f32_bf16 v175, v131, s54, v160
    s_nop 0
    v_cvt_pk_bf16_f32 v128, v168, v169
    v_cvt_pk_bf16_f32 v129, v170, v171
    v_cvt_pk_bf16_f32 v130, v172, v173
    v_cvt_pk_bf16_f32 v131, v174, v175
    v_dot2_f32_bf16 v168, v132, s53, v160
    v_dot2_f32_bf16 v169, v132, s54, v160
    v_dot2_f32_bf16 v170, v133, s53, v160
    v_dot2_f32_bf16 v171, v133, s54, v160
    v_dot2_f32_bf16 v172, v134, s53, v160
    v_dot2_f32_bf16 v173, v134, s54, v160
    v_dot2_f32_bf16 v174, v135, s53, v160
    v_dot2_f32_bf16 v175, v135, s54, v160
    s_nop 0
    v_cvt_pk_bf16_f32 v132, v168, v169
    v_cvt_pk_bf16_f32 v133, v170, v171
    v_cvt_pk_bf16_f32 v134, v172, v173
    v_cvt_pk_bf16_f32 v135, v174, v175
    v_dot2_f32_bf16 v168, v136, s53, v160
    v_dot2_f32_bf16 v169, v136, s54, v160
    v_dot2_f32_bf16 v170, v137, s53, v160
    v_dot2_f32_bf16 v171, v137, s54, v160
    v_dot2_f32_bf16 v172, v138, s53, v160
    v_dot2_f32_bf16 v173, v138, s54, v160
    v_dot2_f32_bf16 v174, v139, s53, v160
    v_dot2_f32_bf16 v175, v139, s54, v160
    s_nop 0
    v_cvt_pk_bf16_f32 v136, v168, v169
    v_cvt_pk_bf16_f32 v137, v170, v171
    v_cvt_pk_bf16_f32 v138, v172, v173
    v_cvt_pk_bf16_f32 v139, v174, v175
    v_dot2_f32_bf16 v168, v140, s53, v160
    v_dot2_f32_bf16 v169, v140, s54, v160
    v_dot2_f32_bf16 v170, v141, s53, v160
    v_dot2_f32_bf16 v171, v141, s54, v160
    v_dot2_f32_bf16 v172, v142, s53, v160
    v_dot2_f32_bf16 v173, v142, s54, v160
    v_dot2_f32_bf16 v174, v143, s53, v160
    v_dot2_f32_bf16 v175, v143, s54, v160
    s_nop 0
    v_cvt_pk_bf16_f32 v140, v168, v169
    v_cvt_pk_bf16_f32 v141, v170, v171
    v_cvt_pk_bf16_f32 v142, v172, v173
    v_cvt_pk_bf16_f32 v143, v174, v175
    s_waitcnt lgkmcnt(0)
    v_dot2_f32_bf16 v168, v0, s53, v161
    v_dot2_f32_bf16 v169, v0, s54, v161
    v_dot2_f32_bf16 v170, v1, s53, v161
    v_dot2_f32_bf16 v171, v1, s54, v161
    v_dot2_f32_bf16 v172, v2, s53, v161
    v_dot2_f32_bf16 v173, v2, s54, v161
    v_dot2_f32_bf16 v174, v3, s53, v161
    v_dot2_f32_bf16 v175, v3, s54, v161
    s_nop 0
    v_cvt_pk_bf16_f32 v0, v168, v169
    v_cvt_pk_bf16_f32 v1, v170, v171
    v_cvt_pk_bf16_f32 v2, v172, v173
    v_cvt_pk_bf16_f32 v3, v174, v175
    v_dot2_f32_bf16 v168, v4, s53, v161
    v_dot2_f32_bf16 v169, v4, s54, v161
    v_dot2_f32_bf16 v170, v5, s53, v161
    v_dot2_f32_bf16 v171, v5, s54, v161
    v_dot2_f32_bf16 v172, v6, s53, v161
    v_dot2_f32_bf16 v173, v6, s54, v161
    v_dot2_f32_bf16 v174, v7, s53, v161
    v_dot2_f32_bf16 v175, v7, s54, v161
    s_nop 0
    v_cvt_pk_bf16_f32 v4, v168, v169
    v_cvt_pk_bf16_f32 v5, v170, v171
    v_cvt_pk_bf16_f32 v6, v172, v173
    v_cvt_pk_bf16_f32 v7, v174, v175
    v_dot2_f32_bf16 v168, v8, s53, v161
    v_dot2_f32_bf16 v169, v8, s54, v161
    v_dot2_f32_bf16 v170, v9, s53, v161
    v_dot2_f32_bf16 v171, v9, s54, v161
    v_dot2_f32_bf16 v172, v10, s53, v161
    v_dot2_f32_bf16 v173, v10, s54, v161
    v_dot2_f32_bf16 v174, v11, s53, v161
    v_dot2_f32_bf16 v175, v11, s54, v161
    s_nop 0
    v_cvt_pk_bf16_f32 v8, v168, v169
    v_cvt_pk_bf16_f32 v9, v170, v171
    v_cvt_pk_bf16_f32 v10, v172, v173
    v_cvt_pk_bf16_f32 v11, v174, v175
    v_dot2_f32_bf16 v168, v12, s53, v161
    v_dot2_f32_bf16 v169, v12, s54, v161
    v_dot2_f32_bf16 v170, v13, s53, v161
    v_dot2_f32_bf16 v171, v13, s54, v161
    v_dot2_f32_bf16 v172, v14, s53, v161
    v_dot2_f32_bf16 v173, v14, s54, v161
    v_dot2_f32_bf16 v174, v15, s53, v161
    v_dot2_f32_bf16 v175, v15, s54, v161
    s_nop 0
    v_cvt_pk_bf16_f32 v12, v168, v169
    v_cvt_pk_bf16_f32 v13, v170, v171
    v_cvt_pk_bf16_f32 v14, v172, v173
    v_cvt_pk_bf16_f32 v15, v174, v175
    v_dot2_f32_bf16 v168, v16, s53, v161
    v_dot2_f32_bf16 v169, v16, s54, v161
    v_dot2_f32_bf16 v170, v17, s53, v161
    v_dot2_f32_bf16 v171, v17, s54, v161
    v_dot2_f32_bf16 v172, v18, s53, v161
    v_dot2_f32_bf16 v173, v18, s54, v161
    v_dot2_f32_bf16 v174, v19, s53, v161
    v_dot2_f32_bf16 v175, v19, s54, v161
    s_nop 0
    v_cvt_pk_bf16_f32 v16, v168, v169
    v_cvt_pk_bf16_f32 v17, v170, v171
    v_cvt_pk_bf16_f32 v18, v172, v173
    v_cvt_pk_bf16_f32 v19, v174, v175
    v_dot2_f32_bf16 v168, v20, s53, v161
    v_dot2_f32_bf16 v169, v20, s54, v161
    v_dot2_f32_bf16 v170, v21, s53, v161
    v_dot2_f32_bf16 v171, v21, s54, v161
    v_dot2_f32_bf16 v172, v22, s53, v161
    v_dot2_f32_bf16 v173, v22, s54, v161
    v_dot2_f32_bf16 v174, v23, s53, v161
    v_dot2_f32_bf16 v175, v23, s54, v161
    s_nop 0
    v_cvt_pk_bf16_f32 v20, v168, v169
    v_cvt_pk_bf16_f32 v21, v170, v171
    v_cvt_pk_bf16_f32 v22, v172, v173
    v_cvt_pk_bf16_f32 v23, v174, v175
    v_dot2_f32_bf16 v168, v24, s53, v161
    v_dot2_f32_bf16 v169, v24, s54, v161
    v_dot2_f32_bf16 v170, v25, s53, v161
    v_dot2_f32_bf16 v171, v25, s54, v161
    v_dot2_f32_bf16 v172, v26, s53, v161
    v_dot2_f32_bf16 v173, v26, s54, v161
    v_dot2_f32_bf16 v174, v27, s53, v161
    v_dot2_f32_bf16 v175, v27, s54, v161
    s_nop 0
    v_cvt_pk_bf16_f32 v24, v168, v169
    v_cvt_pk_bf16_f32 v25, v170, v171
    v_cvt_pk_bf16_f32 v26, v172, v173
    v_cvt_pk_bf16_f32 v27, v174, v175
    v_dot2_f32_bf16 v168, v28, s53, v161
    v_dot2_f32_bf16 v169, v28, s54, v161
    v_dot2_f32_bf16 v170, v29, s53, v161
    v_dot2_f32_bf16 v171, v29, s54, v161
    v_dot2_f32_bf16 v172, v30, s53, v161
    v_dot2_f32_bf16 v173, v30, s54, v161
    v_dot2_f32_bf16 v174, v31, s53, v161
    v_dot2_f32_bf16 v175, v31, s54, v161
    s_nop 0
    v_cvt_pk_bf16_f32 v28, v168, v169
    v_cvt_pk_bf16_f32 v29, v170, v171
    v_cvt_pk_bf16_f32 v30, v172, v173
    v_cvt_pk_bf16_f32 v31, v174, v175
    v_dot2_f32_bf16 v168, v32, s53, v161
    v_dot2_f32_bf16 v169, v32, s54, v161
    v_dot2_f32_bf16 v170, v33, s53, v161
    v_dot2_f32_bf16 v171, v33, s54, v161
    v_dot2_f32_bf16 v172, v34, s53, v161
    v_dot2_f32_bf16 v173, v34, s54, v161
    v_dot2_f32_bf16 v174, v35, s53, v161
    v_dot2_f32_bf16 v175, v35, s54, v161
    s_nop 0
    v_cvt_pk_bf16_f32 v32, v168, v169
    v_cvt_pk_bf16_f32 v33, v170, v171
    v_cvt_pk_bf16_f32 v34, v172, v173
    v_cvt_pk_bf16_f32 v35, v174, v175
    v_dot2_f32_bf16 v168, v36, s53, v161
    v_dot2_f32_bf16 v169, v36, s54, v161
    v_dot2_f32_bf16 v170, v37, s53, v161
    v_dot2_f32_bf16 v171, v37, s54, v161
    v_dot2_f32_bf16 v172, v38, s53, v161
    v_dot2_f32_bf16 v173, v38, s54, v161
    v_dot2_f32_bf16 v174, v39, s53, v161
    v_dot2_f32_bf16 v175, v39, s54, v161
    s_nop 0
    v_cvt_pk_bf16_f32 v36, v168, v169
    v_cvt_pk_bf16_f32 v37, v170, v171
    v_cvt_pk_bf16_f32 v38, v172, v173
    v_cvt_pk_bf16_f32 v39, v174, v175
    v_dot2_f32_bf16 v168, v40, s53, v161
    v_dot2_f32_bf16 v169, v40, s54, v161
    v_dot2_f32_bf16 v170, v41, s53, v161
    v_dot2_f32_bf16 v171, v41, s54, v161
    v_dot2_f32_bf16 v172, v42, s53, v161
    v_dot2_f32_bf16 v173, v42, s54, v161
    v_dot2_f32_bf16 v174, v43, s53, v161
    v_dot2_f32_bf16 v175, v43, s54, v161
    s_nop 0
    v_cvt_pk_bf16_f32 v40, v168, v169
    v_cvt_pk_bf16_f32 v41, v170, v171
    v_cvt_pk_bf16_f32 v42, v172, v173
    v_cvt_pk_bf16_f32 v43, v174, v175
    v_dot2_f32_bf16 v168, v44, s53, v161
    v_dot2_f32_bf16 v169, v44, s54, v161
    v_dot2_f32_bf16 v170, v45, s53, v161
    v_dot2_f32_bf16 v171, v45, s54, v161
    v_dot2_f32_bf16 v172, v46, s53, v161
    v_dot2_f32_bf16 v173, v46, s54, v161
    v_dot2_f32_bf16 v174, v47, s53, v161
    v_dot2_f32_bf16 v175, v47, s54, v161
    s_nop 0
    v_cvt_pk_bf16_f32 v44, v168, v169
    v_cvt_pk_bf16_f32 v45, v170, v171
    v_cvt_pk_bf16_f32 v46, v172, v173
    v_cvt_pk_bf16_f32 v47, v174, v175
    v_dot2_f32_bf16 v168, v48, s53, v161
    v_dot2_f32_bf16 v169, v48, s54, v161
    v_dot2_f32_bf16 v170, v49, s53, v161
    v_dot2_f32_bf16 v171, v49, s54, v161
    v_dot2_f32_bf16 v172, v50, s53, v161
    v_dot2_f32_bf16 v173, v50, s54, v161
    v_dot2_f32_bf16 v174, v51, s53, v161
    v_dot2_f32_bf16 v175, v51, s54, v161
    s_nop 0
    v_cvt_pk_bf16_f32 v48, v168, v169
    v_cvt_pk_bf16_f32 v49, v170, v171
    v_cvt_pk_bf16_f32 v50, v172, v173
    v_cvt_pk_bf16_f32 v51, v174, v175
    v_dot2_f32_bf16 v168, v52, s53, v161
    v_dot2_f32_bf16 v169, v52, s54, v161
    v_dot2_f32_bf16 v170, v53, s53, v161
    v_dot2_f32_bf16 v171, v53, s54, v161
    v_dot2_f32_bf16 v172, v54, s53, v161
    v_dot2_f32_bf16 v173, v54, s54, v161
    v_dot2_f32_bf16 v174, v55, s53, v161
    v_dot2_f32_bf16 v175, v55, s54, v161
    s_nop 0
    v_cvt_pk_bf16_f32 v52, v168, v169
    v_cvt_pk_bf16_f32 v53, v170, v171
    v_cvt_pk_bf16_f32 v54, v172, v173
    v_cvt_pk_bf16_f32 v55, v174, v175
    v_dot2_f32_bf16 v168, v56, s53, v161
    v_dot2_f32_bf16 v169, v56, s54, v161
    v_dot2_f32_bf16 v170, v57, s53, v161
    v_dot2_f32_bf16 v171, v57, s54, v161
    v_dot2_f32_bf16 v172, v58, s53, v161
    v_dot2_f32_bf16 v173, v58, s54, v161
    v_dot2_f32_bf16 v174, v59, s53, v161
    v_dot2_f32_bf16 v175, v59, s54, v161
    s_nop 0
    v_cvt_pk_bf16_f32 v56, v168, v169
    v_cvt_pk_bf16_f32 v57, v170, v171
    v_cvt_pk_bf16_f32 v58, v172, v173
    v_cvt_pk_bf16_f32 v59, v174, v175
    v_dot2_f32_bf16 v168, v60, s53, v161
    v_dot2_f32_bf16 v169, v60, s54, v161
    v_dot2_f32_bf16 v170, v61, s53, v161
    v_dot2_f32_bf16 v171, v61, s54, v161
    v_dot2_f32_bf16 v172, v62, s53, v161
    v_dot2_f32_bf16 v173, v62, s54, v161
    v_dot2_f32_bf16 v174, v63, s53, v161
    v_dot2_f32_bf16 v175, v63, s54, v161
    s_nop 0
    v_cvt_pk_bf16_f32 v60, v168, v169
    v_cvt_pk_bf16_f32 v61, v170, v171
    v_cvt_pk_bf16_f32 v62, v172, v173
    v_cvt_pk_bf16_f32 v63, v174, v175
    v_dot2_f32_bf16 v168, v64, s53, v161
    v_dot2_f32_bf16 v169, v64, s54, v161
    v_dot2_f32_bf16 v170, v65, s53, v161
    v_dot2_f32_bf16 v171, v65, s54, v161
    v_dot2_f32_bf16 v172, v66, s53, v161
    v_dot2_f32_bf16 v173, v66, s54, v161
    v_dot2_f32_bf16 v174, v67, s53, v161
    v_dot2_f32_bf16 v175, v67, s54, v161
    s_nop 0
    v_cvt_pk_bf16_f32 v64, v168, v169
    v_cvt_pk_bf16_f32 v65, v170, v171
    v_cvt_pk_bf16_f32 v66, v172, v173
    v_cvt_pk_bf16_f32 v67, v174, v175
    v_dot2_f32_bf16 v168, v68, s53, v161
    v_dot2_f32_bf16 v169, v68, s54, v161
    v_dot2_f32_bf16 v170, v69, s53, v161
    v_dot2_f32_bf16 v171, v69, s54, v161
    v_dot2_f32_bf16 v172, v70, s53, v161
    v_dot2_f32_bf16 v173, v70, s54, v161
    v_dot2_f32_bf16 v174, v71, s53, v161
    v_dot2_f32_bf16 v175, v71, s54, v161
    s_nop 0
    v_cvt_pk_bf16_f32 v68, v168, v169
    v_cvt_pk_bf16_f32 v69, v170, v171
    v_cvt_pk_bf16_f32 v70, v172, v173
    v_cvt_pk_bf16_f32 v71, v174, v175
    s_waitcnt vmcnt(8)
    s_barrier
    ds_read_b64_tr_b16 v[216:217], v237 offset:128
    ds_read_b64_tr_b16 v[218:219], v237 offset:3200
    ds_read_b64_tr_b16 v[220:221], v238 offset:128
    ds_read_b64_tr_b16 v[222:223], v238 offset:3200
    ds_read_b64_tr_b16 v[224:225], v239 offset:128
    ds_read_b64_tr_b16 v[226:227], v239 offset:3200
    ds_read_b64_tr_b16 v[228:229], v236 offset:256
    ds_read_b64_tr_b16 v[230:231], v236 offset:3328
    ds_read_b64_tr_b16 v[232:233], v236 offset:12416
    ds_read_b64_tr_b16 v[234:235], v236 offset:15488
    s_waitcnt vmcnt(5)
    s_barrier
    s_waitcnt lgkmcnt(8)
    v_mfma_f32_16x16x32_bf16 v[144:147], v[0:3], v[216:219], 0
    v_mfma_f32_16x16x32_bf16 v[148:151], v[72:75], v[216:219], 0
    ds_read_b64_tr_b16 v[216:217], v237 offset:12416
    ds_read_b64_tr_b16 v[218:219], v237 offset:15488
    s_waitcnt lgkmcnt(8)
    v_mfma_f32_16x16x32_bf16 v[152:155], v[0:3], v[220:223], 0
    v_mfma_f32_16x16x32_bf16 v[156:159], v[72:75], v[220:223], 0
    ds_read_b64_tr_b16 v[220:221], v238 offset:12416
    ds_read_b64_tr_b16 v[222:223], v238 offset:15488
    s_add_u32 m0, s55, 73728
    s_mov_b32 s49, 334080
    buffer_load_dwordx4 v244, s[28:31], s49 offen lds
    s_waitcnt lgkmcnt(8)
    v_mfma_f32_16x16x32_bf16 v[160:163], v[0:3], v[224:227], 0
    v_mfma_f32_16x16x32_bf16 v[164:167], v[72:75], v[224:227], 0
    ds_read_b64_tr_b16 v[224:225], v239 offset:12416
    ds_read_b64_tr_b16 v[226:227], v239 offset:15488
    s_waitcnt lgkmcnt(8)
    v_mfma_f32_16x16x32_bf16 v[168:171], v[0:3], v[228:231], 0
    v_mfma_f32_16x16x32_bf16 v[172:175], v[72:75], v[228:231], 0
    ds_read_b64_tr_b16 v[228:229], v236 offset:12544
    ds_read_b64_tr_b16 v[230:231], v236 offset:15616
    s_add_u32 m0, s55, 74752
    s_mov_b32 s49, 334080
    buffer_load_dwordx4 v245, s[28:31], s49 offen lds
    s_waitcnt lgkmcnt(8)
    v_mfma_f32_16x16x32_bf16 v[176:179], v[0:3], v[232:235], 0
    v_mfma_f32_16x16x32_bf16 v[180:183], v[72:75], v[232:235], 0
    ds_read_b64_tr_b16 v[232:233], v237 offset:24704
    ds_read_b64_tr_b16 v[234:235], v237 offset:27776
    s_waitcnt lgkmcnt(8)
    v_mfma_f32_16x16x32_bf16 v[184:187], v[0:3], v[216:219], 0
    v_mfma_f32_16x16x32_bf16 v[188:191], v[72:75], v[216:219], 0
    ds_read_b64_tr_b16 v[216:217], v238 offset:24704
    ds_read_b64_tr_b16 v[218:219], v238 offset:27776
    s_add_u32 m0, s55, 75776
    s_mov_b32 s49, 334080
    buffer_load_dwordx4 v246, s[28:31], s49 offen lds
    s_waitcnt lgkmcnt(8)
    v_mfma_f32_16x16x32_bf16 v[192:195], v[0:3], v[220:223], 0
    v_mfma_f32_16x16x32_bf16 v[196:199], v[72:75], v[220:223], 0
    ds_read_b64_tr_b16 v[220:221], v239 offset:24704
    ds_read_b64_tr_b16 v[222:223], v239 offset:27776
    s_waitcnt lgkmcnt(8)
    v_mfma_f32_16x16x32_bf16 v[200:203], v[0:3], v[224:227], 0
    v_mfma_f32_16x16x32_bf16 v[204:207], v[72:75], v[224:227], 0
    ds_read_b64_tr_b16 v[224:225], v236 offset:24832
    ds_read_b64_tr_b16 v[226:227], v236 offset:27904
    s_waitcnt lgkmcnt(8)
    v_mfma_f32_16x16x32_bf16 v[208:211], v[0:3], v[228:231], 0
    v_mfma_f32_16x16x32_bf16 v[212:215], v[72:75], v[228:231], 0
    ds_read_b64_tr_b16 v[228:229], v236 offset:36992
    ds_read_b64_tr_b16 v[230:231], v236 offset:40064
    s_waitcnt vmcnt(3)
    s_barrier
    s_waitcnt lgkmcnt(8)
    v_mfma_f32_16x16x32_bf16 v[144:147], v[4:7], v[232:235], v[144:147]
    v_mfma_f32_16x16x32_bf16 v[148:151], v[76:79], v[232:235], v[148:151]
    ds_read_b64_tr_b16 v[232:233], v237 offset:36992
    ds_read_b64_tr_b16 v[234:235], v237 offset:40064
    s_waitcnt lgkmcnt(8)
    v_mfma_f32_16x16x32_bf16 v[152:155], v[4:7], v[216:219], v[152:155]
    v_mfma_f32_16x16x32_bf16 v[156:159], v[76:79], v[216:219], v[156:159]
    ds_read_b64_tr_b16 v[216:217], v238 offset:36992
    ds_read_b64_tr_b16 v[218:219], v238 offset:40064
    s_add_u32 m0, s55, 0
    s_mov_b32 s49, 444672
    buffer_load_dwordx4 v244, s[28:31], s49 offen lds
    s_waitcnt lgkmcnt(8)
    v_mfma_f32_16x16x32_bf16 v[160:163], v[4:7], v[220:223], v[160:163]
    v_mfma_f32_16x16x32_bf16 v[164:167], v[76:79], v[220:223], v[164:167]
    ds_read_b64_tr_b16 v[220:221], v239 offset:36992
    ds_read_b64_tr_b16 v[222:223], v239 offset:40064
    s_waitcnt lgkmcnt(8)
    v_mfma_f32_16x16x32_bf16 v[168:171], v[4:7], v[224:227], v[168:171]
    v_mfma_f32_16x16x32_bf16 v[172:175], v[76:79], v[224:227], v[172:175]
    ds_read_b64_tr_b16 v[224:225], v236 offset:37120
    ds_read_b64_tr_b16 v[226:227], v236 offset:40192
    s_add_u32 m0, s55, 1024
    s_mov_b32 s49, 444672
    buffer_load_dwordx4 v245, s[28:31], s49 offen lds
    s_waitcnt lgkmcnt(8)
    v_mfma_f32_16x16x32_bf16 v[176:179], v[4:7], v[228:231], v[176:179]
    v_mfma_f32_16x16x32_bf16 v[180:183], v[76:79], v[228:231], v[180:183]
    ds_read_b64_tr_b16 v[228:229], v241 offset:128
    ds_read_b64_tr_b16 v[230:231], v241 offset:3200
    s_waitcnt lgkmcnt(8)
    v_mfma_f32_16x16x32_bf16 v[184:187], v[4:7], v[232:235], v[184:187]
    v_mfma_f32_16x16x32_bf16 v[188:191], v[76:79], v[232:235], v[188:191]
    ds_read_b64_tr_b16 v[232:233], v242 offset:128
    ds_read_b64_tr_b16 v[234:235], v242 offset:3200
    s_add_u32 m0, s55, 2048
    s_mov_b32 s49, 444672
    buffer_load_dwordx4 v246, s[28:31], s49 offen lds
    s_waitcnt lgkmcnt(8)
    v_mfma_f32_16x16x32_bf16 v[192:195], v[4:7], v[216:219], v[192:195]
    v_mfma_f32_16x16x32_bf16 v[196:199], v[76:79], v[216:219], v[196:199]
    ds_read_b64_tr_b16 v[216:217], v243 offset:128
    ds_read_b64_tr_b16 v[218:219], v243 offset:3200
    s_waitcnt lgkmcnt(8)
    v_mfma_f32_16x16x32_bf16 v[200:203], v[4:7], v[220:223], v[200:203]
    v_mfma_f32_16x16x32_bf16 v[204:207], v[76:79], v[220:223], v[204:207]
    ds_read_b64_tr_b16 v[220:221], v240 offset:256
    ds_read_b64_tr_b16 v[222:223], v240 offset:3328
    s_waitcnt lgkmcnt(8)
    v_mfma_f32_16x16x32_bf16 v[208:211], v[4:7], v[224:227], v[208:211]
    v_mfma_f32_16x16x32_bf16 v[212:215], v[76:79], v[224:227], v[212:215]
    ds_read_b64_tr_b16 v[224:225], v240 offset:12416
    ds_read_b64_tr_b16 v[226:227], v240 offset:15488
    s_waitcnt vmcnt(3)
    s_barrier
    s_waitcnt lgkmcnt(8)
    v_mfma_f32_16x16x32_bf16 v[144:147], v[8:11], v[228:231], v[144:147]
    v_mfma_f32_16x16x32_bf16 v[148:151], v[80:83], v[228:231], v[148:151]
    ds_read_b64_tr_b16 v[228:229], v241 offset:12416
    ds_read_b64_tr_b16 v[230:231], v241 offset:15488
    s_waitcnt lgkmcnt(8)
    v_mfma_f32_16x16x32_bf16 v[152:155], v[8:11], v[232:235], v[152:155]
    v_mfma_f32_16x16x32_bf16 v[156:159], v[80:83], v[232:235], v[156:159]
    ds_read_b64_tr_b16 v[232:233], v242 offset:12416
    ds_read_b64_tr_b16 v[234:235], v242 offset:15488
    s_add_u32 m0, s55, 24576
    s_mov_b32 s49, 555264
    buffer_load_dwordx4 v244, s[28:31], s49 offen lds
    s_waitcnt lgkmcnt(8)
    v_mfma_f32_16x16x32_bf16 v[160:163], v[8:11], v[216:219], v[160:163]
    v_mfma_f32_16x16x32_bf16 v[164:167], v[80:83], v[216:219], v[164:167]
    ds_read_b64_tr_b16 v[216:217], v243 offset:12416
    ds_read_b64_tr_b16 v[218:219], v243 offset:15488
    s_waitcnt lgkmcnt(8)
    v_mfma_f32_16x16x32_bf16 v[168:171], v[8:11], v[220:223], v[168:171]
    v_mfma_f32_16x16x32_bf16 v[172:175], v[80:83], v[220:223], v[172:175]
    ds_read_b64_tr_b16 v[220:221], v240 offset:12544
    ds_read_b64_tr_b16 v[222:223], v240 offset:15616
    s_add_u32 m0, s55, 25600
    s_mov_b32 s49, 555264
    buffer_load_dwordx4 v245, s[28:31], s49 offen lds
    s_waitcnt lgkmcnt(8)
    v_mfma_f32_16x16x32_bf16 v[176:179], v[8:11], v[224:227], v[176:179]
    v_mfma_f32_16x16x32_bf16 v[180:183], v[80:83], v[224:227], v[180:183]
    ds_read_b64_tr_b16 v[224:225], v241 offset:24704
    ds_read_b64_tr_b16 v[226:227], v241 offset:27776
    s_waitcnt lgkmcnt(8)
    v_mfma_f32_16x16x32_bf16 v[184:187], v[8:11], v[228:231], v[184:187]
    v_mfma_f32_16x16x32_bf16 v[188:191], v[80:83], v[228:231], v[188:191]
    ds_read_b64_tr_b16 v[228:229], v242 offset:24704
    ds_read_b64_tr_b16 v[230:231], v242 offset:27776
    s_add_u32 m0, s55, 26624
    s_mov_b32 s49, 555264
    buffer_load_dwordx4 v246, s[28:31], s49 offen lds
    s_waitcnt lgkmcnt(8)
    v_mfma_f32_16x16x32_bf16 v[192:195], v[8:11], v[232:235], v[192:195]
    v_mfma_f32_16x16x32_bf16 v[196:199], v[80:83], v[232:235], v[196:199]
    ds_read_b64_tr_b16 v[232:233], v243 offset:24704
    ds_read_b64_tr_b16 v[234:235], v243 offset:27776
    s_waitcnt lgkmcnt(8)
    v_mfma_f32_16x16x32_bf16 v[200:203], v[8:11], v[216:219], v[200:203]
    v_mfma_f32_16x16x32_bf16 v[204:207], v[80:83], v[216:219], v[204:207]
    ds_read_b64_tr_b16 v[216:217], v240 offset:24832
    ds_read_b64_tr_b16 v[218:219], v240 offset:27904
    s_waitcnt lgkmcnt(8)
    v_mfma_f32_16x16x32_bf16 v[208:211], v[8:11], v[220:223], v[208:211]
    v_mfma_f32_16x16x32_bf16 v[212:215], v[80:83], v[220:223], v[212:215]
    ds_read_b64_tr_b16 v[220:221], v240 offset:36992
    ds_read_b64_tr_b16 v[222:223], v240 offset:40064
    s_waitcnt vmcnt(3)
    s_barrier
    s_waitcnt lgkmcnt(8)
    v_mfma_f32_16x16x32_bf16 v[144:147], v[12:15], v[224:227], v[144:147]
    v_mfma_f32_16x16x32_bf16 v[148:151], v[84:87], v[224:227], v[148:151]
    ds_read_b64_tr_b16 v[224:225], v241 offset:36992
    ds_read_b64_tr_b16 v[226:227], v241 offset:40064
    s_waitcnt lgkmcnt(8)
    v_mfma_f32_16x16x32_bf16 v[152:155], v[12:15], v[228:231], v[152:155]
    v_mfma_f32_16x16x32_bf16 v[156:159], v[84:87], v[228:231], v[156:159]
    ds_read_b64_tr_b16 v[228:229], v242 offset:36992
    ds_read_b64_tr_b16 v[230:231], v242 offset:40064
    s_add_u32 m0, s55, 49152
    s_mov_b32 s49, 665856
    buffer_load_dwordx4 v244, s[28:31], s49 offen lds
    s_waitcnt lgkmcnt(8)
    v_mfma_f32_16x16x32_bf16 v[160:163], v[12:15], v[232:235], v[160:163]
    v_mfma_f32_16x16x32_bf16 v[164:167], v[84:87], v[232:235], v[164:167]
    ds_read_b64_tr_b16 v[232:233], v243 offset:36992
    ds_read_b64_tr_b16 v[234:235], v243 offset:40064
    s_waitcnt lgkmcnt(8)
    v_mfma_f32_16x16x32_bf16 v[168:171], v[12:15], v[216:219], v[168:171]
    v_mfma_f32_16x16x32_bf16 v[172:175], v[84:87], v[216:219], v[172:175]
    ds_read_b64_tr_b16 v[216:217], v240 offset:37120
    ds_read_b64_tr_b16 v[218:219], v240 offset:40192
    s_add_u32 m0, s55, 50176
    s_mov_b32 s49, 665856
    buffer_load_dwordx4 v245, s[28:31], s49 offen lds
    s_waitcnt lgkmcnt(8)
    v_mfma_f32_16x16x32_bf16 v[176:179], v[12:15], v[220:223], v[176:179]
    v_mfma_f32_16x16x32_bf16 v[180:183], v[84:87], v[220:223], v[180:183]
    ds_read_b64_tr_b16 v[220:221], v237 offset:128
    ds_read_b64_tr_b16 v[222:223], v237 offset:3200
    s_waitcnt lgkmcnt(8)
    v_mfma_f32_16x16x32_bf16 v[184:187], v[12:15], v[224:227], v[184:187]
    v_mfma_f32_16x16x32_bf16 v[188:191], v[84:87], v[224:227], v[188:191]
    ds_read_b64_tr_b16 v[224:225], v238 offset:128
    ds_read_b64_tr_b16 v[226:227], v238 offset:3200
    s_add_u32 m0, s55, 51200
    s_mov_b32 s49, 665856
    buffer_load_dwordx4 v246, s[28:31], s49 offen lds
    s_waitcnt lgkmcnt(8)
    v_mfma_f32_16x16x32_bf16 v[192:195], v[12:15], v[228:231], v[192:195]
    v_mfma_f32_16x16x32_bf16 v[196:199], v[84:87], v[228:231], v[196:199]
    ds_read_b64_tr_b16 v[228:229], v239 offset:128
    ds_read_b64_tr_b16 v[230:231], v239 offset:3200
    s_waitcnt lgkmcnt(8)
    v_mfma_f32_16x16x32_bf16 v[200:203], v[12:15], v[232:235], v[200:203]
    v_mfma_f32_16x16x32_bf16 v[204:207], v[84:87], v[232:235], v[204:207]
    ds_read_b64_tr_b16 v[232:233], v236 offset:256
    ds_read_b64_tr_b16 v[234:235], v236 offset:3328
    s_waitcnt lgkmcnt(8)
    v_mfma_f32_16x16x32_bf16 v[208:211], v[12:15], v[216:219], v[208:211]
    v_mfma_f32_16x16x32_bf16 v[212:215], v[84:87], v[216:219], v[212:215]
    ds_read_b64_tr_b16 v[216:217], v236 offset:12416
    ds_read_b64_tr_b16 v[218:219], v236 offset:15488
    s_waitcnt vmcnt(3)
    s_barrier
    s_waitcnt lgkmcnt(8)
    v_mfma_f32_16x16x32_bf16 v[144:147], v[16:19], v[220:223], v[144:147]
    v_mfma_f32_16x16x32_bf16 v[148:151], v[88:91], v[220:223], v[148:151]
    ds_read_b64_tr_b16 v[220:221], v237 offset:12416
    ds_read_b64_tr_b16 v[222:223], v237 offset:15488
    s_waitcnt lgkmcnt(8)
    v_mfma_f32_16x16x32_bf16 v[152:155], v[16:19], v[224:227], v[152:155]
    v_mfma_f32_16x16x32_bf16 v[156:159], v[88:91], v[224:227], v[156:159]
    ds_read_b64_tr_b16 v[224:225], v238 offset:12416
    ds_read_b64_tr_b16 v[226:227], v238 offset:15488
    s_add_u32 m0, s55, 73728
    s_mov_b32 s49, 776448
    buffer_load_dwordx4 v244, s[28:31], s49 offen lds
    s_waitcnt lgkmcnt(8)
    v_mfma_f32_16x16x32_bf16 v[160:163], v[16:19], v[228:231], v[160:163]
    v_mfma_f32_16x16x32_bf16 v[164:167], v[88:91], v[228:231], v[164:167]
    ds_read_b64_tr_b16 v[228:229], v239 offset:12416
    ds_read_b64_tr_b16 v[230:231], v239 offset:15488
    s_waitcnt lgkmcnt(8)
    v_mfma_f32_16x16x32_bf16 v[168:171], v[16:19], v[232:235], v[168:171]
    v_mfma_f32_16x16x32_bf16 v[172:175], v[88:91], v[232:235], v[172:175]
    ds_read_b64_tr_b16 v[232:233], v236 offset:12544
    ds_read_b64_tr_b16 v[234:235], v236 offset:15616
    s_add_u32 m0, s55, 74752
    s_mov_b32 s49, 776448
    buffer_load_dwordx4 v245, s[28:31], s49 offen lds
    s_waitcnt lgkmcnt(8)
    v_mfma_f32_16x16x32_bf16 v[176:179], v[16:19], v[216:219], v[176:179]
    v_mfma_f32_16x16x32_bf16 v[180:183], v[88:91], v[216:219], v[180:183]
    ds_read_b64_tr_b16 v[216:217], v237 offset:24704
    ds_read_b64_tr_b16 v[218:219], v237 offset:27776
    s_waitcnt lgkmcnt(8)
    v_mfma_f32_16x16x32_bf16 v[184:187], v[16:19], v[220:223], v[184:187]
    v_mfma_f32_16x16x32_bf16 v[188:191], v[88:91], v[220:223], v[188:191]
    ds_read_b64_tr_b16 v[220:221], v238 offset:24704
    ds_read_b64_tr_b16 v[222:223], v238 offset:27776
    s_add_u32 m0, s55, 75776
    s_mov_b32 s49, 776448
    buffer_load_dwordx4 v246, s[28:31], s49 offen lds
    s_waitcnt lgkmcnt(8)
    v_mfma_f32_16x16x32_bf16 v[192:195], v[16:19], v[224:227], v[192:195]
    v_mfma_f32_16x16x32_bf16 v[196:199], v[88:91], v[224:227], v[196:199]
    ds_read_b64_tr_b16 v[224:225], v239 offset:24704
    ds_read_b64_tr_b16 v[226:227], v239 offset:27776
    s_waitcnt lgkmcnt(8)
    v_mfma_f32_16x16x32_bf16 v[200:203], v[16:19], v[228:231], v[200:203]
    v_mfma_f32_16x16x32_bf16 v[204:207], v[88:91], v[228:231], v[204:207]
    ds_read_b64_tr_b16 v[228:229], v236 offset:24832
    ds_read_b64_tr_b16 v[230:231], v236 offset:27904
    s_waitcnt lgkmcnt(8)
    v_mfma_f32_16x16x32_bf16 v[208:211], v[16:19], v[232:235], v[208:211]
    v_mfma_f32_16x16x32_bf16 v[212:215], v[88:91], v[232:235], v[212:215]
    ds_read_b64_tr_b16 v[232:233], v236 offset:36992
    ds_read_b64_tr_b16 v[234:235], v236 offset:40064
    s_waitcnt vmcnt(3)
    s_barrier
    s_waitcnt lgkmcnt(8)
    v_mfma_f32_16x16x32_bf16 v[144:147], v[20:23], v[216:219], v[144:147]
    v_mfma_f32_16x16x32_bf16 v[148:151], v[92:95], v[216:219], v[148:151]
    ds_read_b64_tr_b16 v[216:217], v237 offset:36992
    ds_read_b64_tr_b16 v[218:219], v237 offset:40064
    s_waitcnt lgkmcnt(8)
    v_mfma_f32_16x16x32_bf16 v[152:155], v[20:23], v[220:223], v[152:155]
    v_mfma_f32_16x16x32_bf16 v[156:159], v[92:95], v[220:223], v[156:159]
    ds_read_b64_tr_b16 v[220:221], v238 offset:36992
    ds_read_b64_tr_b16 v[222:223], v238 offset:40064
    s_add_u32 m0, s55, 0
    s_mov_b32 s49, 887040
    buffer_load_dwordx4 v244, s[28:31], s49 offen lds
    s_waitcnt lgkmcnt(8)
    v_mfma_f32_16x16x32_bf16 v[160:163], v[20:23], v[224:227], v[160:163]
    v_mfma_f32_16x16x32_bf16 v[164:167], v[92:95], v[224:227], v[164:167]
    ds_read_b64_tr_b16 v[224:225], v239 offset:36992
    ds_read_b64_tr_b16 v[226:227], v239 offset:40064
    s_waitcnt lgkmcnt(8)
    v_mfma_f32_16x16x32_bf16 v[168:171], v[20:23], v[228:231], v[168:171]
    v_mfma_f32_16x16x32_bf16 v[172:175], v[92:95], v[228:231], v[172:175]
    ds_read_b64_tr_b16 v[228:229], v236 offset:37120
    ds_read_b64_tr_b16 v[230:231], v236 offset:40192
    s_add_u32 m0, s55, 1024
    s_mov_b32 s49, 887040
    buffer_load_dwordx4 v245, s[28:31], s49 offen lds
    s_waitcnt lgkmcnt(8)
    v_mfma_f32_16x16x32_bf16 v[176:179], v[20:23], v[232:235], v[176:179]
    v_mfma_f32_16x16x32_bf16 v[180:183], v[92:95], v[232:235], v[180:183]
    ds_read_b64_tr_b16 v[232:233], v241 offset:128
    ds_read_b64_tr_b16 v[234:235], v241 offset:3200
    s_waitcnt lgkmcnt(8)
    v_mfma_f32_16x16x32_bf16 v[184:187], v[20:23], v[216:219], v[184:187]
    v_mfma_f32_16x16x32_bf16 v[188:191], v[92:95], v[216:219], v[188:191]
    ds_read_b64_tr_b16 v[216:217], v242 offset:128
    ds_read_b64_tr_b16 v[218:219], v242 offset:3200
    s_add_u32 m0, s55, 2048
    s_mov_b32 s49, 887040
    buffer_load_dwordx4 v246, s[28:31], s49 offen lds
    s_waitcnt lgkmcnt(8)
    v_mfma_f32_16x16x32_bf16 v[192:195], v[20:23], v[220:223], v[192:195]
    v_mfma_f32_16x16x32_bf16 v[196:199], v[92:95], v[220:223], v[196:199]
    ds_read_b64_tr_b16 v[220:221], v243 offset:128
    ds_read_b64_tr_b16 v[222:223], v243 offset:3200
    s_waitcnt lgkmcnt(8)
    v_mfma_f32_16x16x32_bf16 v[200:203], v[20:23], v[224:227], v[200:203]
    v_mfma_f32_16x16x32_bf16 v[204:207], v[92:95], v[224:227], v[204:207]
    ds_read_b64_tr_b16 v[224:225], v240 offset:256
    ds_read_b64_tr_b16 v[226:227], v240 offset:3328
    s_waitcnt lgkmcnt(8)
    v_mfma_f32_16x16x32_bf16 v[208:211], v[20:23], v[228:231], v[208:211]
    v_mfma_f32_16x16x32_bf16 v[212:215], v[92:95], v[228:231], v[212:215]
    ds_read_b64_tr_b16 v[228:229], v240 offset:12416
    ds_read_b64_tr_b16 v[230:231], v240 offset:15488
    s_waitcnt vmcnt(3)
    s_barrier
    s_waitcnt lgkmcnt(8)
    v_mfma_f32_16x16x32_bf16 v[144:147], v[24:27], v[232:235], v[144:147]
    v_mfma_f32_16x16x32_bf16 v[148:151], v[96:99], v[232:235], v[148:151]
    ds_read_b64_tr_b16 v[232:233], v241 offset:12416
    ds_read_b64_tr_b16 v[234:235], v241 offset:15488
    s_waitcnt lgkmcnt(8)
    v_mfma_f32_16x16x32_bf16 v[152:155], v[24:27], v[216:219], v[152:155]
    v_mfma_f32_16x16x32_bf16 v[156:159], v[96:99], v[216:219], v[156:159]
    ds_read_b64_tr_b16 v[216:217], v242 offset:12416
    ds_read_b64_tr_b16 v[218:219], v242 offset:15488
    s_add_u32 m0, s55, 24576
    s_mov_b32 s49, 997632
    buffer_load_dwordx4 v244, s[28:31], s49 offen lds
    s_waitcnt lgkmcnt(8)
    v_mfma_f32_16x16x32_bf16 v[160:163], v[24:27], v[220:223], v[160:163]
    v_mfma_f32_16x16x32_bf16 v[164:167], v[96:99], v[220:223], v[164:167]
    ds_read_b64_tr_b16 v[220:221], v243 offset:12416
    ds_read_b64_tr_b16 v[222:223], v243 offset:15488
    s_waitcnt lgkmcnt(8)
    v_mfma_f32_16x16x32_bf16 v[168:171], v[24:27], v[224:227], v[168:171]
    v_mfma_f32_16x16x32_bf16 v[172:175], v[96:99], v[224:227], v[172:175]
    ds_read_b64_tr_b16 v[224:225], v240 offset:12544
    ds_read_b64_tr_b16 v[226:227], v240 offset:15616
    s_add_u32 m0, s55, 25600
    s_mov_b32 s49, 997632
    buffer_load_dwordx4 v245, s[28:31], s49 offen lds
    s_waitcnt lgkmcnt(8)
    v_mfma_f32_16x16x32_bf16 v[176:179], v[24:27], v[228:231], v[176:179]
    v_mfma_f32_16x16x32_bf16 v[180:183], v[96:99], v[228:231], v[180:183]
    ds_read_b64_tr_b16 v[228:229], v241 offset:24704
    ds_read_b64_tr_b16 v[230:231], v241 offset:27776
    s_waitcnt lgkmcnt(8)
    v_mfma_f32_16x16x32_bf16 v[184:187], v[24:27], v[232:235], v[184:187]
    v_mfma_f32_16x16x32_bf16 v[188:191], v[96:99], v[232:235], v[188:191]
    ds_read_b64_tr_b16 v[232:233], v242 offset:24704
    ds_read_b64_tr_b16 v[234:235], v242 offset:27776
    s_add_u32 m0, s55, 26624
    s_mov_b32 s49, 997632
    buffer_load_dwordx4 v246, s[28:31], s49 offen lds
    s_waitcnt lgkmcnt(8)
    v_mfma_f32_16x16x32_bf16 v[192:195], v[24:27], v[216:219], v[192:195]
    v_mfma_f32_16x16x32_bf16 v[196:199], v[96:99], v[216:219], v[196:199]
    ds_read_b64_tr_b16 v[216:217], v243 offset:24704
    ds_read_b64_tr_b16 v[218:219], v243 offset:27776
    s_waitcnt lgkmcnt(8)
    v_mfma_f32_16x16x32_bf16 v[200:203], v[24:27], v[220:223], v[200:203]
    v_mfma_f32_16x16x32_bf16 v[204:207], v[96:99], v[220:223], v[204:207]
    ds_read_b64_tr_b16 v[220:221], v240 offset:24832
    ds_read_b64_tr_b16 v[222:223], v240 offset:27904
    s_waitcnt lgkmcnt(8)
    v_mfma_f32_16x16x32_bf16 v[208:211], v[24:27], v[224:227], v[208:211]
    v_mfma_f32_16x16x32_bf16 v[212:215], v[96:99], v[224:227], v[212:215]
    ds_read_b64_tr_b16 v[224:225], v240 offset:36992
    ds_read_b64_tr_b16 v[226:227], v240 offset:40064
    s_waitcnt vmcnt(3)
    s_barrier
    s_waitcnt lgkmcnt(8)
    v_mfma_f32_16x16x32_bf16 v[144:147], v[28:31], v[228:231], v[144:147]
    v_mfma_f32_16x16x32_bf16 v[148:151], v[100:103], v[228:231], v[148:151]
    ds_read_b64_tr_b16 v[228:229], v241 offset:36992
    ds_read_b64_tr_b16 v[230:231], v241 offset:40064
    s_waitcnt lgkmcnt(8)
    v_mfma_f32_16x16x32_bf16 v[152:155], v[28:31], v[232:235], v[152:155]
    v_mfma_f32_16x16x32_bf16 v[156:159], v[100:103], v[232:235], v[156:159]
    ds_read_b64_tr_b16 v[232:233], v242 offset:36992
    ds_read_b64_tr_b16 v[234:235], v242 offset:40064
    s_add_u32 m0, s55, 49152
    s_mov_b32 s49, 1108224
    buffer_load_dwordx4 v244, s[28:31], s49 offen lds
    s_waitcnt lgkmcnt(8)
    v_mfma_f32_16x16x32_bf16 v[160:163], v[28:31], v[216:219], v[160:163]
    v_mfma_f32_16x16x32_bf16 v[164:167], v[100:103], v[216:219], v[164:167]
    ds_read_b64_tr_b16 v[216:217], v243 offset:36992
    ds_read_b64_tr_b16 v[218:219], v243 offset:40064
    s_waitcnt lgkmcnt(8)
    v_mfma_f32_16x16x32_bf16 v[168:171], v[28:31], v[220:223], v[168:171]
    v_mfma_f32_16x16x32_bf16 v[172:175], v[100:103], v[220:223], v[172:175]
    ds_read_b64_tr_b16 v[220:221], v240 offset:37120
    ds_read_b64_tr_b16 v[222:223], v240 offset:40192
    s_add_u32 m0, s55, 50176
    s_mov_b32 s49, 1108224
    buffer_load_dwordx4 v245, s[28:31], s49 offen lds
    s_waitcnt lgkmcnt(8)
    v_mfma_f32_16x16x32_bf16 v[176:179], v[28:31], v[224:227], v[176:179]
    v_mfma_f32_16x16x32_bf16 v[180:183], v[100:103], v[224:227], v[180:183]
    ds_read_b64_tr_b16 v[224:225], v237 offset:128
    ds_read_b64_tr_b16 v[226:227], v237 offset:3200
    s_waitcnt lgkmcnt(8)
    v_mfma_f32_16x16x32_bf16 v[184:187], v[28:31], v[228:231], v[184:187]
    v_mfma_f32_16x16x32_bf16 v[188:191], v[100:103], v[228:231], v[188:191]
    ds_read_b64_tr_b16 v[228:229], v238 offset:128
    ds_read_b64_tr_b16 v[230:231], v238 offset:3200
    s_add_u32 m0, s55, 51200
    s_mov_b32 s49, 1108224
    buffer_load_dwordx4 v246, s[28:31], s49 offen lds
    s_waitcnt lgkmcnt(8)
    v_mfma_f32_16x16x32_bf16 v[192:195], v[28:31], v[232:235], v[192:195]
    v_mfma_f32_16x16x32_bf16 v[196:199], v[100:103], v[232:235], v[196:199]
    ds_read_b64_tr_b16 v[232:233], v239 offset:128
    ds_read_b64_tr_b16 v[234:235], v239 offset:3200
    s_waitcnt lgkmcnt(8)
    v_mfma_f32_16x16x32_bf16 v[200:203], v[28:31], v[216:219], v[200:203]
    v_mfma_f32_16x16x32_bf16 v[204:207], v[100:103], v[216:219], v[204:207]
    ds_read_b64_tr_b16 v[216:217], v236 offset:256
    ds_read_b64_tr_b16 v[218:219], v236 offset:3328
    s_waitcnt lgkmcnt(8)
    v_mfma_f32_16x16x32_bf16 v[208:211], v[28:31], v[220:223], v[208:211]
    v_mfma_f32_16x16x32_bf16 v[212:215], v[100:103], v[220:223], v[212:215]
    ds_read_b64_tr_b16 v[220:221], v236 offset:12416
    ds_read_b64_tr_b16 v[222:223], v236 offset:15488
    s_waitcnt vmcnt(3)
    s_barrier
    s_waitcnt lgkmcnt(8)
    v_mfma_f32_16x16x32_bf16 v[144:147], v[32:35], v[224:227], v[144:147]
    v_mfma_f32_16x16x32_bf16 v[148:151], v[104:107], v[224:227], v[148:151]
    ds_read_b64_tr_b16 v[224:225], v237 offset:12416
    ds_read_b64_tr_b16 v[226:227], v237 offset:15488
    s_waitcnt lgkmcnt(8)
    v_mfma_f32_16x16x32_bf16 v[152:155], v[32:35], v[228:231], v[152:155]
    v_mfma_f32_16x16x32_bf16 v[156:159], v[104:107], v[228:231], v[156:159]
    ds_read_b64_tr_b16 v[228:229], v238 offset:12416
    ds_read_b64_tr_b16 v[230:231], v238 offset:15488
    s_add_u32 m0, s55, 73728
    s_mov_b32 s49, 1218816
    buffer_load_dwordx4 v244, s[28:31], s49 offen lds
    s_waitcnt lgkmcnt(8)
    v_mfma_f32_16x16x32_bf16 v[160:163], v[32:35], v[232:235], v[160:163]
    v_mfma_f32_16x16x32_bf16 v[164:167], v[104:107], v[232:235], v[164:167]
    ds_read_b64_tr_b16 v[232:233], v239 offset:12416
    ds_read_b64_tr_b16 v[234:235], v239 offset:15488
    s_waitcnt lgkmcnt(8)
    v_mfma_f32_16x16x32_bf16 v[168:171], v[32:35], v[216:219], v[168:171]
    v_mfma_f32_16x16x32_bf16 v[172:175], v[104:107], v[216:219], v[172:175]
    ds_read_b64_tr_b16 v[216:217], v236 offset:12544
    ds_read_b64_tr_b16 v[218:219], v236 offset:15616
    s_add_u32 m0, s55, 74752
    s_mov_b32 s49, 1218816
    buffer_load_dwordx4 v245, s[28:31], s49 offen lds
    s_waitcnt lgkmcnt(8)
    v_mfma_f32_16x16x32_bf16 v[176:179], v[32:35], v[220:223], v[176:179]
    v_mfma_f32_16x16x32_bf16 v[180:183], v[104:107], v[220:223], v[180:183]
    ds_read_b64_tr_b16 v[220:221], v237 offset:24704
    ds_read_b64_tr_b16 v[222:223], v237 offset:27776
    s_waitcnt lgkmcnt(8)
    v_mfma_f32_16x16x32_bf16 v[184:187], v[32:35], v[224:227], v[184:187]
    v_mfma_f32_16x16x32_bf16 v[188:191], v[104:107], v[224:227], v[188:191]
    ds_read_b64_tr_b16 v[224:225], v238 offset:24704
    ds_read_b64_tr_b16 v[226:227], v238 offset:27776
    s_add_u32 m0, s55, 75776
    s_mov_b32 s49, 1218816
    buffer_load_dwordx4 v246, s[28:31], s49 offen lds
    s_waitcnt lgkmcnt(8)
    v_mfma_f32_16x16x32_bf16 v[192:195], v[32:35], v[228:231], v[192:195]
    v_mfma_f32_16x16x32_bf16 v[196:199], v[104:107], v[228:231], v[196:199]
    ds_read_b64_tr_b16 v[228:229], v239 offset:24704
    ds_read_b64_tr_b16 v[230:231], v239 offset:27776
    s_waitcnt lgkmcnt(8)
    v_mfma_f32_16x16x32_bf16 v[200:203], v[32:35], v[232:235], v[200:203]
    v_mfma_f32_16x16x32_bf16 v[204:207], v[104:107], v[232:235], v[204:207]
    ds_read_b64_tr_b16 v[232:233], v236 offset:24832
    ds_read_b64_tr_b16 v[234:235], v236 offset:27904
    s_waitcnt lgkmcnt(8)
    v_mfma_f32_16x16x32_bf16 v[208:211], v[32:35], v[216:219], v[208:211]
    v_mfma_f32_16x16x32_bf16 v[212:215], v[104:107], v[216:219], v[212:215]
    ds_read_b64_tr_b16 v[216:217], v236 offset:36992
    ds_read_b64_tr_b16 v[218:219], v236 offset:40064
    s_waitcnt vmcnt(3)
    s_barrier
    s_waitcnt lgkmcnt(8)
    v_mfma_f32_16x16x32_bf16 v[144:147], v[36:39], v[220:223], v[144:147]
    v_mfma_f32_16x16x32_bf16 v[148:151], v[108:111], v[220:223], v[148:151]
    ds_read_b64_tr_b16 v[220:221], v237 offset:36992
    ds_read_b64_tr_b16 v[222:223], v237 offset:40064
    s_waitcnt lgkmcnt(8)
    v_mfma_f32_16x16x32_bf16 v[152:155], v[36:39], v[224:227], v[152:155]
    v_mfma_f32_16x16x32_bf16 v[156:159], v[108:111], v[224:227], v[156:159]
    ds_read_b64_tr_b16 v[224:225], v238 offset:36992
    ds_read_b64_tr_b16 v[226:227], v238 offset:40064
    s_add_u32 m0, s55, 0
    s_mov_b32 s49, 1329408
    buffer_load_dwordx4 v244, s[28:31], s49 offen lds
    s_waitcnt lgkmcnt(8)
    v_mfma_f32_16x16x32_bf16 v[160:163], v[36:39], v[228:231], v[160:163]
    v_mfma_f32_16x16x32_bf16 v[164:167], v[108:111], v[228:231], v[164:167]
    ds_read_b64_tr_b16 v[228:229], v239 offset:36992
    ds_read_b64_tr_b16 v[230:231], v239 offset:40064
    s_waitcnt lgkmcnt(8)
    v_mfma_f32_16x16x32_bf16 v[168:171], v[36:39], v[232:235], v[168:171]
    v_mfma_f32_16x16x32_bf16 v[172:175], v[108:111], v[232:235], v[172:175]
    ds_read_b64_tr_b16 v[232:233], v236 offset:37120
    ds_read_b64_tr_b16 v[234:235], v236 offset:40192
    s_add_u32 m0, s55, 1024
    s_mov_b32 s49, 1329408
    buffer_load_dwordx4 v245, s[28:31], s49 offen lds
    s_waitcnt lgkmcnt(8)
    v_mfma_f32_16x16x32_bf16 v[176:179], v[36:39], v[216:219], v[176:179]
    v_mfma_f32_16x16x32_bf16 v[180:183], v[108:111], v[216:219], v[180:183]
    ds_read_b64_tr_b16 v[216:217], v241 offset:128
    ds_read_b64_tr_b16 v[218:219], v241 offset:3200
    s_waitcnt lgkmcnt(8)
    v_mfma_f32_16x16x32_bf16 v[184:187], v[36:39], v[220:223], v[184:187]
    v_mfma_f32_16x16x32_bf16 v[188:191], v[108:111], v[220:223], v[188:191]
    ds_read_b64_tr_b16 v[220:221], v242 offset:128
    ds_read_b64_tr_b16 v[222:223], v242 offset:3200
    s_add_u32 m0, s55, 2048
    s_mov_b32 s49, 1329408
    buffer_load_dwordx4 v246, s[28:31], s49 offen lds
    s_waitcnt lgkmcnt(8)
    v_mfma_f32_16x16x32_bf16 v[192:195], v[36:39], v[224:227], v[192:195]
    v_mfma_f32_16x16x32_bf16 v[196:199], v[108:111], v[224:227], v[196:199]
    ds_read_b64_tr_b16 v[224:225], v243 offset:128
    ds_read_b64_tr_b16 v[226:227], v243 offset:3200
    s_waitcnt lgkmcnt(8)
    v_mfma_f32_16x16x32_bf16 v[200:203], v[36:39], v[228:231], v[200:203]
    v_mfma_f32_16x16x32_bf16 v[204:207], v[108:111], v[228:231], v[204:207]
    ds_read_b64_tr_b16 v[228:229], v240 offset:256
    ds_read_b64_tr_b16 v[230:231], v240 offset:3328
    s_waitcnt lgkmcnt(8)
    v_mfma_f32_16x16x32_bf16 v[208:211], v[36:39], v[232:235], v[208:211]
    v_mfma_f32_16x16x32_bf16 v[212:215], v[108:111], v[232:235], v[212:215]
    ds_read_b64_tr_b16 v[232:233], v240 offset:12416
    ds_read_b64_tr_b16 v[234:235], v240 offset:15488
    s_waitcnt vmcnt(3)
    s_barrier
    s_waitcnt lgkmcnt(8)
    v_mfma_f32_16x16x32_bf16 v[144:147], v[40:43], v[216:219], v[144:147]
    v_mfma_f32_16x16x32_bf16 v[148:151], v[112:115], v[216:219], v[148:151]
    ds_read_b64_tr_b16 v[216:217], v241 offset:12416
    ds_read_b64_tr_b16 v[218:219], v241 offset:15488
    s_waitcnt lgkmcnt(8)
    v_mfma_f32_16x16x32_bf16 v[152:155], v[40:43], v[220:223], v[152:155]
    v_mfma_f32_16x16x32_bf16 v[156:159], v[112:115], v[220:223], v[156:159]
    ds_read_b64_tr_b16 v[220:221], v242 offset:12416
    ds_read_b64_tr_b16 v[222:223], v242 offset:15488
    s_add_u32 m0, s55, 24576
    s_mov_b32 s49, 1440000
    buffer_load_dwordx4 v244, s[28:31], s49 offen lds
    s_waitcnt lgkmcnt(8)
    v_mfma_f32_16x16x32_bf16 v[160:163], v[40:43], v[224:227], v[160:163]
    v_mfma_f32_16x16x32_bf16 v[164:167], v[112:115], v[224:227], v[164:167]
    ds_read_b64_tr_b16 v[224:225], v243 offset:12416
    ds_read_b64_tr_b16 v[226:227], v243 offset:15488
    s_waitcnt lgkmcnt(8)
    v_mfma_f32_16x16x32_bf16 v[168:171], v[40:43], v[228:231], v[168:171]
    v_mfma_f32_16x16x32_bf16 v[172:175], v[112:115], v[228:231], v[172:175]
    ds_read_b64_tr_b16 v[228:229], v240 offset:12544
    ds_read_b64_tr_b16 v[230:231], v240 offset:15616
    s_add_u32 m0, s55, 25600
    s_mov_b32 s49, 1440000
    buffer_load_dwordx4 v245, s[28:31], s49 offen lds
    s_waitcnt lgkmcnt(8)
    v_mfma_f32_16x16x32_bf16 v[176:179], v[40:43], v[232:235], v[176:179]
    v_mfma_f32_16x16x32_bf16 v[180:183], v[112:115], v[232:235], v[180:183]
    ds_read_b64_tr_b16 v[232:233], v241 offset:24704
    ds_read_b64_tr_b16 v[234:235], v241 offset:27776
    s_waitcnt lgkmcnt(8)
    v_mfma_f32_16x16x32_bf16 v[184:187], v[40:43], v[216:219], v[184:187]
    v_mfma_f32_16x16x32_bf16 v[188:191], v[112:115], v[216:219], v[188:191]
    ds_read_b64_tr_b16 v[216:217], v242 offset:24704
    ds_read_b64_tr_b16 v[218:219], v242 offset:27776
    s_add_u32 m0, s55, 26624
    s_mov_b32 s49, 1440000
    buffer_load_dwordx4 v246, s[28:31], s49 offen lds
    s_waitcnt lgkmcnt(8)
    v_mfma_f32_16x16x32_bf16 v[192:195], v[40:43], v[220:223], v[192:195]
    v_mfma_f32_16x16x32_bf16 v[196:199], v[112:115], v[220:223], v[196:199]
    ds_read_b64_tr_b16 v[220:221], v243 offset:24704
    ds_read_b64_tr_b16 v[222:223], v243 offset:27776
    s_waitcnt lgkmcnt(8)
    v_mfma_f32_16x16x32_bf16 v[200:203], v[40:43], v[224:227], v[200:203]
    v_mfma_f32_16x16x32_bf16 v[204:207], v[112:115], v[224:227], v[204:207]
    ds_read_b64_tr_b16 v[224:225], v240 offset:24832
    ds_read_b64_tr_b16 v[226:227], v240 offset:27904
    s_waitcnt lgkmcnt(8)
    v_mfma_f32_16x16x32_bf16 v[208:211], v[40:43], v[228:231], v[208:211]
    v_mfma_f32_16x16x32_bf16 v[212:215], v[112:115], v[228:231], v[212:215]
    ds_read_b64_tr_b16 v[228:229], v240 offset:36992
    ds_read_b64_tr_b16 v[230:231], v240 offset:40064
    s_waitcnt vmcnt(3)
    s_barrier
    s_waitcnt lgkmcnt(8)
    v_mfma_f32_16x16x32_bf16 v[144:147], v[44:47], v[232:235], v[144:147]
    v_mfma_f32_16x16x32_bf16 v[148:151], v[116:119], v[232:235], v[148:151]
    ds_read_b64_tr_b16 v[232:233], v241 offset:36992
    ds_read_b64_tr_b16 v[234:235], v241 offset:40064
    s_waitcnt lgkmcnt(8)
    v_mfma_f32_16x16x32_bf16 v[152:155], v[44:47], v[216:219], v[152:155]
    v_mfma_f32_16x16x32_bf16 v[156:159], v[116:119], v[216:219], v[156:159]
    ds_read_b64_tr_b16 v[216:217], v242 offset:36992
    ds_read_b64_tr_b16 v[218:219], v242 offset:40064
    s_add_u32 m0, s55, 49152
    s_mov_b32 s49, 1550592
    buffer_load_dwordx4 v244, s[28:31], s49 offen lds
    s_waitcnt lgkmcnt(8)
    v_mfma_f32_16x16x32_bf16 v[160:163], v[44:47], v[220:223], v[160:163]
    v_mfma_f32_16x16x32_bf16 v[164:167], v[116:119], v[220:223], v[164:167]
    ds_read_b64_tr_b16 v[220:221], v243 offset:36992
    ds_read_b64_tr_b16 v[222:223], v243 offset:40064
    s_waitcnt lgkmcnt(8)
    v_mfma_f32_16x16x32_bf16 v[168:171], v[44:47], v[224:227], v[168:171]
    v_mfma_f32_16x16x32_bf16 v[172:175], v[116:119], v[224:227], v[172:175]
    ds_read_b64_tr_b16 v[224:225], v240 offset:37120
    ds_read_b64_tr_b16 v[226:227], v240 offset:40192
    s_add_u32 m0, s55, 50176
    s_mov_b32 s49, 1550592
    buffer_load_dwordx4 v245, s[28:31], s49 offen lds
    s_waitcnt lgkmcnt(8)
    v_mfma_f32_16x16x32_bf16 v[176:179], v[44:47], v[228:231], v[176:179]
    v_mfma_f32_16x16x32_bf16 v[180:183], v[116:119], v[228:231], v[180:183]
    ds_read_b64_tr_b16 v[228:229], v237 offset:128
    ds_read_b64_tr_b16 v[230:231], v237 offset:3200
    s_waitcnt lgkmcnt(8)
    v_mfma_f32_16x16x32_bf16 v[184:187], v[44:47], v[232:235], v[184:187]
    v_mfma_f32_16x16x32_bf16 v[188:191], v[116:119], v[232:235], v[188:191]
    ds_read_b64_tr_b16 v[232:233], v238 offset:128
    ds_read_b64_tr_b16 v[234:235], v238 offset:3200
    s_add_u32 m0, s55, 51200
    s_mov_b32 s49, 1550592
    buffer_load_dwordx4 v246, s[28:31], s49 offen lds
    s_waitcnt lgkmcnt(8)
    v_mfma_f32_16x16x32_bf16 v[192:195], v[44:47], v[216:219], v[192:195]
    v_mfma_f32_16x16x32_bf16 v[196:199], v[116:119], v[216:219], v[196:199]
    ds_read_b64_tr_b16 v[216:217], v239 offset:128
    ds_read_b64_tr_b16 v[218:219], v239 offset:3200
    s_waitcnt lgkmcnt(8)
    v_mfma_f32_16x16x32_bf16 v[200:203], v[44:47], v[220:223], v[200:203]
    v_mfma_f32_16x16x32_bf16 v[204:207], v[116:119], v[220:223], v[204:207]
    ds_read_b64_tr_b16 v[220:221], v236 offset:256
    ds_read_b64_tr_b16 v[222:223], v236 offset:3328
    s_waitcnt lgkmcnt(8)
    v_mfma_f32_16x16x32_bf16 v[208:211], v[44:47], v[224:227], v[208:211]
    v_mfma_f32_16x16x32_bf16 v[212:215], v[116:119], v[224:227], v[212:215]
    ds_read_b64_tr_b16 v[224:225], v236 offset:12416
    ds_read_b64_tr_b16 v[226:227], v236 offset:15488
    s_waitcnt vmcnt(3)
    s_barrier
    s_waitcnt lgkmcnt(8)
    v_mfma_f32_16x16x32_bf16 v[144:147], v[48:51], v[228:231], v[144:147]
    v_mfma_f32_16x16x32_bf16 v[148:151], v[120:123], v[228:231], v[148:151]
    ds_read_b64_tr_b16 v[228:229], v237 offset:12416
    ds_read_b64_tr_b16 v[230:231], v237 offset:15488
    s_waitcnt lgkmcnt(8)
    v_mfma_f32_16x16x32_bf16 v[152:155], v[48:51], v[232:235], v[152:155]
    v_mfma_f32_16x16x32_bf16 v[156:159], v[120:123], v[232:235], v[156:159]
    ds_read_b64_tr_b16 v[232:233], v238 offset:12416
    ds_read_b64_tr_b16 v[234:235], v238 offset:15488
    s_add_u32 m0, s55, 73728
    s_mov_b32 s49, 1661184
    buffer_load_dwordx4 v244, s[28:31], s49 offen lds
    s_waitcnt lgkmcnt(8)
    v_mfma_f32_16x16x32_bf16 v[160:163], v[48:51], v[216:219], v[160:163]
    v_mfma_f32_16x16x32_bf16 v[164:167], v[120:123], v[216:219], v[164:167]
    ds_read_b64_tr_b16 v[216:217], v239 offset:12416
    ds_read_b64_tr_b16 v[218:219], v239 offset:15488
    s_waitcnt lgkmcnt(8)
    v_mfma_f32_16x16x32_bf16 v[168:171], v[48:51], v[220:223], v[168:171]
    v_mfma_f32_16x16x32_bf16 v[172:175], v[120:123], v[220:223], v[172:175]
    ds_read_b64_tr_b16 v[220:221], v236 offset:12544
    ds_read_b64_tr_b16 v[222:223], v236 offset:15616
    s_add_u32 m0, s55, 74752
    s_mov_b32 s49, 1661184
    buffer_load_dwordx4 v245, s[28:31], s49 offen lds
    s_waitcnt lgkmcnt(8)
    v_mfma_f32_16x16x32_bf16 v[176:179], v[48:51], v[224:227], v[176:179]
    v_mfma_f32_16x16x32_bf16 v[180:183], v[120:123], v[224:227], v[180:183]
    ds_read_b64_tr_b16 v[224:225], v237 offset:24704
    ds_read_b64_tr_b16 v[226:227], v237 offset:27776
    s_waitcnt lgkmcnt(8)
    v_mfma_f32_16x16x32_bf16 v[184:187], v[48:51], v[228:231], v[184:187]
    v_mfma_f32_16x16x32_bf16 v[188:191], v[120:123], v[228:231], v[188:191]
    ds_read_b64_tr_b16 v[228:229], v238 offset:24704
    ds_read_b64_tr_b16 v[230:231], v238 offset:27776
    s_add_u32 m0, s55, 75776
    s_mov_b32 s49, 1661184
    buffer_load_dwordx4 v246, s[28:31], s49 offen lds
    s_waitcnt lgkmcnt(8)
    v_mfma_f32_16x16x32_bf16 v[192:195], v[48:51], v[232:235], v[192:195]
    v_mfma_f32_16x16x32_bf16 v[196:199], v[120:123], v[232:235], v[196:199]
    ds_read_b64_tr_b16 v[232:233], v239 offset:24704
    ds_read_b64_tr_b16 v[234:235], v239 offset:27776
    s_waitcnt lgkmcnt(8)
    v_mfma_f32_16x16x32_bf16 v[200:203], v[48:51], v[216:219], v[200:203]
    v_mfma_f32_16x16x32_bf16 v[204:207], v[120:123], v[216:219], v[204:207]
    ds_read_b64_tr_b16 v[216:217], v236 offset:24832
    ds_read_b64_tr_b16 v[218:219], v236 offset:27904
    s_waitcnt lgkmcnt(8)
    v_mfma_f32_16x16x32_bf16 v[208:211], v[48:51], v[220:223], v[208:211]
    v_mfma_f32_16x16x32_bf16 v[212:215], v[120:123], v[220:223], v[212:215]
    ds_read_b64_tr_b16 v[220:221], v236 offset:36992
    ds_read_b64_tr_b16 v[222:223], v236 offset:40064
    s_waitcnt vmcnt(3)
    s_barrier
    s_waitcnt lgkmcnt(8)
    v_mfma_f32_16x16x32_bf16 v[144:147], v[52:55], v[224:227], v[144:147]
    v_mfma_f32_16x16x32_bf16 v[148:151], v[124:127], v[224:227], v[148:151]
    ds_read_b64_tr_b16 v[224:225], v237 offset:36992
    ds_read_b64_tr_b16 v[226:227], v237 offset:40064
    s_waitcnt lgkmcnt(8)
    v_mfma_f32_16x16x32_bf16 v[152:155], v[52:55], v[228:231], v[152:155]
    v_mfma_f32_16x16x32_bf16 v[156:159], v[124:127], v[228:231], v[156:159]
    ds_read_b64_tr_b16 v[228:229], v238 offset:36992
    ds_read_b64_tr_b16 v[230:231], v238 offset:40064
    s_add_u32 m0, s55, 0
    s_mov_b32 s49, 1771776
    buffer_load_dwordx4 v244, s[28:31], s49 offen lds
    s_waitcnt lgkmcnt(8)
    v_mfma_f32_16x16x32_bf16 v[160:163], v[52:55], v[232:235], v[160:163]
    v_mfma_f32_16x16x32_bf16 v[164:167], v[124:127], v[232:235], v[164:167]
    ds_read_b64_tr_b16 v[232:233], v239 offset:36992
    ds_read_b64_tr_b16 v[234:235], v239 offset:40064
    s_waitcnt lgkmcnt(8)
    v_mfma_f32_16x16x32_bf16 v[168:171], v[52:55], v[216:219], v[168:171]
    v_mfma_f32_16x16x32_bf16 v[172:175], v[124:127], v[216:219], v[172:175]
    ds_read_b64_tr_b16 v[216:217], v236 offset:37120
    ds_read_b64_tr_b16 v[218:219], v236 offset:40192
    s_add_u32 m0, s55, 1024
    s_mov_b32 s49, 1771776
    buffer_load_dwordx4 v245, s[28:31], s49 offen lds
    s_waitcnt lgkmcnt(8)
    v_mfma_f32_16x16x32_bf16 v[176:179], v[52:55], v[220:223], v[176:179]
    v_mfma_f32_16x16x32_bf16 v[180:183], v[124:127], v[220:223], v[180:183]
    ds_read_b64_tr_b16 v[220:221], v241 offset:128
    ds_read_b64_tr_b16 v[222:223], v241 offset:3200
    s_waitcnt lgkmcnt(8)
    v_mfma_f32_16x16x32_bf16 v[184:187], v[52:55], v[224:227], v[184:187]
    v_mfma_f32_16x16x32_bf16 v[188:191], v[124:127], v[224:227], v[188:191]
    ds_read_b64_tr_b16 v[224:225], v242 offset:128
    ds_read_b64_tr_b16 v[226:227], v242 offset:3200
    s_add_u32 m0, s55, 2048
    s_mov_b32 s49, 1771776
    buffer_load_dwordx4 v246, s[28:31], s49 offen lds
    s_waitcnt lgkmcnt(8)
    v_mfma_f32_16x16x32_bf16 v[192:195], v[52:55], v[228:231], v[192:195]
    v_mfma_f32_16x16x32_bf16 v[196:199], v[124:127], v[228:231], v[196:199]
    ds_read_b64_tr_b16 v[228:229], v243 offset:128
    ds_read_b64_tr_b16 v[230:231], v243 offset:3200
    s_waitcnt lgkmcnt(8)
    v_mfma_f32_16x16x32_bf16 v[200:203], v[52:55], v[232:235], v[200:203]
    v_mfma_f32_16x16x32_bf16 v[204:207], v[124:127], v[232:235], v[204:207]
    ds_read_b64_tr_b16 v[232:233], v240 offset:256
    ds_read_b64_tr_b16 v[234:235], v240 offset:3328
    s_waitcnt lgkmcnt(8)
    v_mfma_f32_16x16x32_bf16 v[208:211], v[52:55], v[216:219], v[208:211]
    v_mfma_f32_16x16x32_bf16 v[212:215], v[124:127], v[216:219], v[212:215]
    ds_read_b64_tr_b16 v[216:217], v240 offset:12416
    ds_read_b64_tr_b16 v[218:219], v240 offset:15488
    s_waitcnt vmcnt(3)
    s_barrier
    s_waitcnt lgkmcnt(8)
    v_mfma_f32_16x16x32_bf16 v[144:147], v[56:59], v[220:223], v[144:147]
    v_mfma_f32_16x16x32_bf16 v[148:151], v[128:131], v[220:223], v[148:151]
    ds_read_b64_tr_b16 v[220:221], v241 offset:12416
    ds_read_b64_tr_b16 v[222:223], v241 offset:15488
    s_waitcnt lgkmcnt(8)
    v_mfma_f32_16x16x32_bf16 v[152:155], v[56:59], v[224:227], v[152:155]
    v_mfma_f32_16x16x32_bf16 v[156:159], v[128:131], v[224:227], v[156:159]
    ds_read_b64_tr_b16 v[224:225], v242 offset:12416
    ds_read_b64_tr_b16 v[226:227], v242 offset:15488
    s_add_u32 m0, s55, 24576
    s_mov_b32 s49, 1882368
    buffer_load_dwordx4 v244, s[28:31], s49 offen lds
    s_waitcnt lgkmcnt(8)
    v_mfma_f32_16x16x32_bf16 v[160:163], v[56:59], v[228:231], v[160:163]
    v_mfma_f32_16x16x32_bf16 v[164:167], v[128:131], v[228:231], v[164:167]
    ds_read_b64_tr_b16 v[228:229], v243 offset:12416
    ds_read_b64_tr_b16 v[230:231], v243 offset:15488
    s_waitcnt lgkmcnt(8)
    v_mfma_f32_16x16x32_bf16 v[168:171], v[56:59], v[232:235], v[168:171]
    v_mfma_f32_16x16x32_bf16 v[172:175], v[128:131], v[232:235], v[172:175]
    ds_read_b64_tr_b16 v[232:233], v240 offset:12544
    ds_read_b64_tr_b16 v[234:235], v240 offset:15616
    s_add_u32 m0, s55, 25600
    s_mov_b32 s49, 1882368
    buffer_load_dwordx4 v245, s[28:31], s49 offen lds
    s_waitcnt lgkmcnt(8)
    v_mfma_f32_16x16x32_bf16 v[176:179], v[56:59], v[216:219], v[176:179]
    v_mfma_f32_16x16x32_bf16 v[180:183], v[128:131], v[216:219], v[180:183]
    ds_read_b64_tr_b16 v[216:217], v241 offset:24704
    ds_read_b64_tr_b16 v[218:219], v241 offset:27776
    s_waitcnt lgkmcnt(8)
    v_mfma_f32_16x16x32_bf16 v[184:187], v[56:59], v[220:223], v[184:187]
    v_mfma_f32_16x16x32_bf16 v[188:191], v[128:131], v[220:223], v[188:191]
    ds_read_b64_tr_b16 v[220:221], v242 offset:24704
    ds_read_b64_tr_b16 v[222:223], v242 offset:27776
    s_add_u32 m0, s55, 26624
    s_mov_b32 s49, 1882368
    buffer_load_dwordx4 v246, s[28:31], s49 offen lds
    s_waitcnt lgkmcnt(8)
    v_mfma_f32_16x16x32_bf16 v[192:195], v[56:59], v[224:227], v[192:195]
    v_mfma_f32_16x16x32_bf16 v[196:199], v[128:131], v[224:227], v[196:199]
    ds_read_b64_tr_b16 v[224:225], v243 offset:24704
    ds_read_b64_tr_b16 v[226:227], v243 offset:27776
    s_lshl_b32 s46, s43, 2
    s_add_u32 s46, s46, 64
    v_mov_b32 v255, s46
    buffer_load_dword v254, v255, s[16:19], 0 offen sc1
    s_waitcnt lgkmcnt(8)
    v_mfma_f32_16x16x32_bf16 v[200:203], v[56:59], v[228:231], v[200:203]
    v_mfma_f32_16x16x32_bf16 v[204:207], v[128:131], v[228:231], v[204:207]
    ds_read_b64_tr_b16 v[228:229], v240 offset:24832
    ds_read_b64_tr_b16 v[230:231], v240 offset:27904
    s_waitcnt lgkmcnt(8)
    v_mfma_f32_16x16x32_bf16 v[208:211], v[56:59], v[232:235], v[208:211]
    v_mfma_f32_16x16x32_bf16 v[212:215], v[128:131], v[232:235], v[212:215]
    ds_read_b64_tr_b16 v[232:233], v240 offset:36992
    ds_read_b64_tr_b16 v[234:235], v240 offset:40064
    s_waitcnt vmcnt(4)
    s_barrier
    s_waitcnt lgkmcnt(8)
    v_mfma_f32_16x16x32_bf16 v[144:147], v[60:63], v[216:219], v[144:147]
    v_mfma_f32_16x16x32_bf16 v[148:151], v[132:135], v[216:219], v[148:151]
    ds_read_b64_tr_b16 v[216:217], v241 offset:36992
    ds_read_b64_tr_b16 v[218:219], v241 offset:40064
    s_waitcnt lgkmcnt(8)
    v_mfma_f32_16x16x32_bf16 v[152:155], v[60:63], v[220:223], v[152:155]
    v_mfma_f32_16x16x32_bf16 v[156:159], v[132:135], v[220:223], v[156:159]
    ds_read_b64_tr_b16 v[220:221], v242 offset:36992
    ds_read_b64_tr_b16 v[222:223], v242 offset:40064
    s_add_u32 m0, s55, 49152
    s_mov_b32 s49, 110592
    buffer_load_dwordx4 v244, s[28:31], s49 offen lds
    s_waitcnt lgkmcnt(8)
    v_mfma_f32_16x16x32_bf16 v[160:163], v[60:63], v[224:227], v[160:163]
    v_mfma_f32_16x16x32_bf16 v[164:167], v[132:135], v[224:227], v[164:167]
    ds_read_b64_tr_b16 v[224:225], v243 offset:36992
    ds_read_b64_tr_b16 v[226:227], v243 offset:40064
    s_waitcnt lgkmcnt(8)
    v_mfma_f32_16x16x32_bf16 v[168:171], v[60:63], v[228:231], v[168:171]
    v_mfma_f32_16x16x32_bf16 v[172:175], v[132:135], v[228:231], v[172:175]
    ds_read_b64_tr_b16 v[228:229], v240 offset:37120
    ds_read_b64_tr_b16 v[230:231], v240 offset:40192
    s_add_u32 m0, s55, 50176
    s_mov_b32 s49, 110592
    buffer_load_dwordx4 v245, s[28:31], s49 offen lds
    s_waitcnt lgkmcnt(8)
    v_mfma_f32_16x16x32_bf16 v[176:179], v[60:63], v[232:235], v[176:179]
    v_mfma_f32_16x16x32_bf16 v[180:183], v[132:135], v[232:235], v[180:183]
    ds_read_b64_tr_b16 v[232:233], v237 offset:128
    ds_read_b64_tr_b16 v[234:235], v237 offset:3200
    s_waitcnt lgkmcnt(8)
    v_mfma_f32_16x16x32_bf16 v[184:187], v[60:63], v[216:219], v[184:187]
    v_mfma_f32_16x16x32_bf16 v[188:191], v[132:135], v[216:219], v[188:191]
    ds_read_b64_tr_b16 v[216:217], v238 offset:128
    ds_read_b64_tr_b16 v[218:219], v238 offset:3200
    s_add_u32 m0, s55, 51200
    s_mov_b32 s49, 110592
    buffer_load_dwordx4 v246, s[28:31], s49 offen lds
    s_waitcnt lgkmcnt(8)
    v_mfma_f32_16x16x32_bf16 v[192:195], v[60:63], v[220:223], v[192:195]
    v_mfma_f32_16x16x32_bf16 v[196:199], v[132:135], v[220:223], v[196:199]
    ds_read_b64_tr_b16 v[220:221], v239 offset:128
    ds_read_b64_tr_b16 v[222:223], v239 offset:3200
    s_waitcnt lgkmcnt(8)
    v_mfma_f32_16x16x32_bf16 v[200:203], v[60:63], v[224:227], v[200:203]
    v_mfma_f32_16x16x32_bf16 v[204:207], v[132:135], v[224:227], v[204:207]
    ds_read_b64_tr_b16 v[224:225], v236 offset:256
    ds_read_b64_tr_b16 v[226:227], v236 offset:3328
    s_waitcnt lgkmcnt(8)
    v_mfma_f32_16x16x32_bf16 v[208:211], v[60:63], v[228:231], v[208:211]
    v_mfma_f32_16x16x32_bf16 v[212:215], v[132:135], v[228:231], v[212:215]
    ds_read_b64_tr_b16 v[228:229], v236 offset:12416
    ds_read_b64_tr_b16 v[230:231], v236 offset:15488
    s_waitcnt vmcnt(4)
    s_barrier
    s_waitcnt lgkmcnt(8)
    v_mfma_f32_16x16x32_bf16 v[144:147], v[64:67], v[232:235], v[144:147]
    v_mfma_f32_16x16x32_bf16 v[148:151], v[136:139], v[232:235], v[148:151]
    ds_read_b64_tr_b16 v[232:233], v237 offset:12416
    ds_read_b64_tr_b16 v[234:235], v237 offset:15488
    s_waitcnt lgkmcnt(8)
    v_mfma_f32_16x16x32_bf16 v[152:155], v[64:67], v[216:219], v[152:155]
    v_mfma_f32_16x16x32_bf16 v[156:159], v[136:139], v[216:219], v[156:159]
    ds_read_b64_tr_b16 v[216:217], v238 offset:12416
    ds_read_b64_tr_b16 v[218:219], v238 offset:15488
    s_waitcnt lgkmcnt(8)
    v_mfma_f32_16x16x32_bf16 v[160:163], v[64:67], v[220:223], v[160:163]
    v_mfma_f32_16x16x32_bf16 v[164:167], v[136:139], v[220:223], v[164:167]
    ds_read_b64_tr_b16 v[220:221], v239 offset:12416
    ds_read_b64_tr_b16 v[222:223], v239 offset:15488
    s_waitcnt lgkmcnt(8)
    v_mfma_f32_16x16x32_bf16 v[168:171], v[64:67], v[224:227], v[168:171]
    v_mfma_f32_16x16x32_bf16 v[172:175], v[136:139], v[224:227], v[172:175]
    ds_read_b64_tr_b16 v[224:225], v236 offset:12544
    ds_read_b64_tr_b16 v[226:227], v236 offset:15616
    s_waitcnt lgkmcnt(8)
    v_mfma_f32_16x16x32_bf16 v[176:179], v[64:67], v[228:231], v[176:179]
    v_mfma_f32_16x16x32_bf16 v[180:183], v[136:139], v[228:231], v[180:183]
    ds_read_b64_tr_b16 v[228:229], v237 offset:24704
    ds_read_b64_tr_b16 v[230:231], v237 offset:27776
    s_waitcnt lgkmcnt(8)
    v_mfma_f32_16x16x32_bf16 v[184:187], v[64:67], v[232:235], v[184:187]
    v_mfma_f32_16x16x32_bf16 v[188:191], v[136:139], v[232:235], v[188:191]
    ds_read_b64_tr_b16 v[232:233], v238 offset:24704
    ds_read_b64_tr_b16 v[234:235], v238 offset:27776
    s_waitcnt lgkmcnt(8)
    v_mfma_f32_16x16x32_bf16 v[192:195], v[64:67], v[216:219], v[192:195]
    v_mfma_f32_16x16x32_bf16 v[196:199], v[136:139], v[216:219], v[196:199]
    ds_read_b64_tr_b16 v[216:217], v239 offset:24704
    ds_read_b64_tr_b16 v[218:219], v239 offset:27776
    s_waitcnt lgkmcnt(8)
    v_mfma_f32_16x16x32_bf16 v[200:203], v[64:67], v[220:223], v[200:203]
    v_mfma_f32_16x16x32_bf16 v[204:207], v[136:139], v[220:223], v[204:207]
    ds_read_b64_tr_b16 v[220:221], v236 offset:24832
    ds_read_b64_tr_b16 v[222:223], v236 offset:27904
    s_waitcnt lgkmcnt(8)
    v_mfma_f32_16x16x32_bf16 v[208:211], v[64:67], v[224:227], v[208:211]
    v_mfma_f32_16x16x32_bf16 v[212:215], v[136:139], v[224:227], v[212:215]
    ds_read_b64_tr_b16 v[224:225], v236 offset:36992
    ds_read_b64_tr_b16 v[226:227], v236 offset:40064
    s_waitcnt vmcnt(0)
    s_barrier
    s_waitcnt lgkmcnt(8)
    v_mfma_f32_16x16x32_bf16 v[144:147], v[68:71], v[228:231], v[144:147]
    v_mfma_f32_16x16x32_bf16 v[148:151], v[140:143], v[228:231], v[148:151]
    ds_read_b64_tr_b16 v[228:229], v237 offset:36992
    ds_read_b64_tr_b16 v[230:231], v237 offset:40064
    s_waitcnt lgkmcnt(8)
    v_mfma_f32_16x16x32_bf16 v[152:155], v[68:71], v[232:235], v[152:155]
    v_mfma_f32_16x16x32_bf16 v[156:159], v[140:143], v[232:235], v[156:159]
    ds_read_b64_tr_b16 v[232:233], v238 offset:36992
    ds_read_b64_tr_b16 v[234:235], v238 offset:40064
    s_add_u32 m0, s55, 0
    s_mov_b32 s49, 552960
    buffer_load_dwordx4 v244, s[28:31], s49 offen lds
    s_waitcnt lgkmcnt(8)
    v_mfma_f32_16x16x32_bf16 v[160:163], v[68:71], v[216:219], v[160:163]
    v_mfma_f32_16x16x32_bf16 v[164:167], v[140:143], v[216:219], v[164:167]
    ds_read_b64_tr_b16 v[216:217], v239 offset:36992
    ds_read_b64_tr_b16 v[218:219], v239 offset:40064
    s_waitcnt lgkmcnt(8)
    v_mfma_f32_16x16x32_bf16 v[168:171], v[68:71], v[220:223], v[168:171]
    v_mfma_f32_16x16x32_bf16 v[172:175], v[140:143], v[220:223], v[172:175]
    ds_read_b64_tr_b16 v[220:221], v236 offset:37120
    ds_read_b64_tr_b16 v[222:223], v236 offset:40192
    s_add_u32 m0, s55, 1024
    s_mov_b32 s49, 552960
    buffer_load_dwordx4 v245, s[28:31], s49 offen lds
    s_waitcnt lgkmcnt(8)
    v_mfma_f32_16x16x32_bf16 v[176:179], v[68:71], v[224:227], v[176:179]
    v_mfma_f32_16x16x32_bf16 v[180:183], v[140:143], v[224:227], v[180:183]
    s_waitcnt lgkmcnt(6)
    v_mfma_f32_16x16x32_bf16 v[184:187], v[68:71], v[228:231], v[184:187]
    v_mfma_f32_16x16x32_bf16 v[188:191], v[140:143], v[228:231], v[188:191]
    s_add_u32 m0, s55, 2048
    s_mov_b32 s49, 552960
    buffer_load_dwordx4 v246, s[28:31], s49 offen lds
    s_waitcnt lgkmcnt(4)
    v_mfma_f32_16x16x32_bf16 v[192:195], v[68:71], v[232:235], v[192:195]
    v_mfma_f32_16x16x32_bf16 v[196:199], v[140:143], v[232:235], v[196:199]
    s_waitcnt lgkmcnt(2)
    v_mfma_f32_16x16x32_bf16 v[200:203], v[68:71], v[216:219], v[200:203]
    v_mfma_f32_16x16x32_bf16 v[204:207], v[140:143], v[216:219], v[204:207]
    s_waitcnt lgkmcnt(0)
    v_mfma_f32_16x16x32_bf16 v[208:211], v[68:71], v[220:223], v[208:211]
    v_mfma_f32_16x16x32_bf16 v[212:215], v[140:143], v[220:223], v[212:215]
    v_lshrrev_b32 v248, 4, v247
    v_lshlrev_b32 v248, 4, v248
    s_lshl_b32 s46, s41, 7
    s_add_u32 s46, s46, 163328
    v_add_u32 v248, s46, v248
    ds_read_b128 v[216:219], v248
    ds_read_b128 v[220:223], v248 offset:64
    s_mov_b32 s47, 0
L_poll_5:
    v_readfirstlane_b32 s46, v254
    s_add_u32 s47, s47, 1
    s_nop 2
    s_cmp_ge_u32 s46, 1
    s_cbranch_scc1 L_pollok_6
    s_cmp_ge_u32 s47, 50000
    s_cbranch_scc1 L_pollok_6
    s_sleep 2
    buffer_load_dword v254, v255, s[16:19], 0 offen sc1
    s_waitcnt vmcnt(0)
    s_branch L_poll_5
L_pollok_6:
    s_waitcnt lgkmcnt(0)
    v_mul_f32 v224, s51, v216
    v_mul_f32 v225, s51, v217
    v_mul_f32 v226, s51, v218
    v_mul_f32 v227, s51, v219
    v_mul_f32 v228, s51, v220
    v_mul_f32 v229, s51, v221
    v_mul_f32 v230, s51, v222
    v_mul_f32 v231, s51, v223
    v_mul_f32 v232, v144, v224
    v_mul_f32 v233, v145, v225
    v_mul_f32 v234, v146, v226
    v_mul_f32 v235, v147, v227
    v_mul_f32 v249, v148, v228
    v_mul_f32 v250, v149, v229
    v_mul_f32 v251, v150, v230
    v_mul_f32 v255, v151, v231
    v_min_f32 v232, 0, v232
    v_min_f32 v233, 0, v233
    v_min_f32 v234, 0, v234
    v_min_f32 v235, 0, v235
    v_min_f32 v249, 0, v249
    v_min_f32 v250, 0, v250
    v_min_f32 v251, 0, v251
    v_min_f32 v255, 0, v255
    v_exp_f32 v232, v232
    v_exp_f32 v233, v233
    v_exp_f32 v234, v234
    v_exp_f32 v235, v235
    v_exp_f32 v249, v249
    v_exp_f32 v250, v250
    v_exp_f32 v251, v251
    v_exp_f32 v255, v255
    v_max_f32 v144, 0, v144
    v_max_f32 v145, 0, v145
    v_max_f32 v146, 0, v146
    v_max_f32 v147, 0, v147
    v_max_f32 v148, 0, v148
    v_max_f32 v149, 0, v149
    v_max_f32 v150, 0, v150
    v_max_f32 v151, 0, v151
    v_add_f32 v232, 0x358637bd, v232
    v_add_f32 v233, 0x358637bd, v233
    v_add_f32 v234, 0x358637bd, v234
    v_add_f32 v235, 0x358637bd, v235
    v_add_f32 v249, 0x358637bd, v249
    v_add_f32 v250, 0x358637bd, v250
    v_add_f32 v251, 0x358637bd, v251
    v_add_f32 v255, 0x358637bd, v255
    v_fma_f32 v144, v144, v216, v232
    v_fma_f32 v145, v145, v217, v233
    v_fma_f32 v146, v146, v218, v234
    v_fma_f32 v147, v147, v219, v235
    v_fma_f32 v148, v148, v220, v249
    v_fma_f32 v149, v149, v221, v250
    v_fma_f32 v150, v150, v222, v251
    v_fma_f32 v151, v151, v223, v255
    v_mul_f32 v232, v152, v224
    v_mul_f32 v233, v153, v225
    v_mul_f32 v234, v154, v226
    v_mul_f32 v235, v155, v227
    v_mul_f32 v249, v156, v228
    v_mul_f32 v250, v157, v229
    v_mul_f32 v251, v158, v230
    v_mul_f32 v255, v159, v231
    v_min_f32 v232, 0, v232
    v_min_f32 v233, 0, v233
    v_min_f32 v234, 0, v234
    v_min_f32 v235, 0, v235
    v_min_f32 v249, 0, v249
    v_min_f32 v250, 0, v250
    v_min_f32 v251, 0, v251
    v_min_f32 v255, 0, v255
    v_exp_f32 v232, v232
    v_exp_f32 v233, v233
    v_exp_f32 v234, v234
    v_exp_f32 v235, v235
    v_exp_f32 v249, v249
    v_exp_f32 v250, v250
    v_exp_f32 v251, v251
    v_exp_f32 v255, v255
    v_max_f32 v152, 0, v152
    v_max_f32 v153, 0, v153
    v_max_f32 v154, 0, v154
    v_max_f32 v155, 0, v155
    v_max_f32 v156, 0, v156
    v_max_f32 v157, 0, v157
    v_max_f32 v158, 0, v158
    v_max_f32 v159, 0, v159
    v_add_f32 v232, 0x358637bd, v232
    v_add_f32 v233, 0x358637bd, v233
    v_add_f32 v234, 0x358637bd, v234
    v_add_f32 v235, 0x358637bd, v235
    v_add_f32 v249, 0x358637bd, v249
    v_add_f32 v250, 0x358637bd, v250
    v_add_f32 v251, 0x358637bd, v251
    v_add_f32 v255, 0x358637bd, v255
    v_fma_f32 v152, v152, v216, v232
    v_fma_f32 v153, v153, v217, v233
    v_fma_f32 v154, v154, v218, v234
    v_fma_f32 v155, v155, v219, v235
    v_fma_f32 v156, v156, v220, v249
    v_fma_f32 v157, v157, v221, v250
    v_fma_f32 v158, v158, v222, v251
    v_fma_f32 v159, v159, v223, v255
    v_mul_f32 v232, v160, v224
    v_mul_f32 v233, v161, v225
    v_mul_f32 v234, v162, v226
    v_mul_f32 v235, v163, v227
    v_mul_f32 v249, v164, v228
    v_mul_f32 v250, v165, v229
    v_mul_f32 v251, v166, v230
    v_mul_f32 v255, v167, v231
    v_min_f32 v232, 0, v232
    v_min_f32 v233, 0, v233
    v_min_f32 v234, 0, v234
    v_min_f32 v235, 0, v235
    v_min_f32 v249, 0, v249
    v_min_f32 v250, 0, v250
    v_min_f32 v251, 0, v251
    v_min_f32 v255, 0, v255
    v_exp_f32 v232, v232
    v_exp_f32 v233, v233
    v_exp_f32 v234, v234
    v_exp_f32 v235, v235
    v_exp_f32 v249, v249
    v_exp_f32 v250, v250
    v_exp_f32 v251, v251
    v_exp_f32 v255, v255
    v_max_f32 v160, 0, v160
    v_max_f32 v161, 0, v161
    v_max_f32 v162, 0, v162
    v_max_f32 v163, 0, v163
    v_max_f32 v164, 0, v164
    v_max_f32 v165, 0, v165
    v_max_f32 v166, 0, v166
    v_max_f32 v167, 0, v167
    v_add_f32 v232, 0x358637bd, v232
    v_add_f32 v233, 0x358637bd, v233
    v_add_f32 v234, 0x358637bd, v234
    v_add_f32 v235, 0x358637bd, v235
    v_add_f32 v249, 0x358637bd, v249
    v_add_f32 v250, 0x358637bd, v250
    v_add_f32 v251, 0x358637bd, v251
    v_add_f32 v255, 0x358637bd, v255
    v_fma_f32 v160, v160, v216, v232
    v_fma_f32 v161, v161, v217, v233
    v_fma_f32 v162, v162, v218, v234
    v_fma_f32 v163, v163, v219, v235
    v_fma_f32 v164, v164, v220, v249
    v_fma_f32 v165, v165, v221, v250
    v_fma_f32 v166, v166, v222, v251
    v_fma_f32 v167, v167, v223, v255
    v_mul_f32 v232, v168, v224
    v_mul_f32 v233, v169, v225
    v_mul_f32 v234, v170, v226
    v_mul_f32 v235, v171, v227
    v_mul_f32 v249, v172, v228
    v_mul_f32 v250, v173, v229
    v_mul_f32 v251, v174, v230
    v_mul_f32 v255, v175, v231
    v_min_f32 v232, 0, v232
    v_min_f32 v233, 0, v233
    v_min_f32 v234, 0, v234
    v_min_f32 v235, 0, v235
    v_min_f32 v249, 0, v249
    v_min_f32 v250, 0, v250
    v_min_f32 v251, 0, v251
    v_min_f32 v255, 0, v255
    v_exp_f32 v232, v232
    v_exp_f32 v233, v233
    v_exp_f32 v234, v234
    v_exp_f32 v235, v235
    v_exp_f32 v249, v249
    v_exp_f32 v250, v250
    v_exp_f32 v251, v251
    v_exp_f32 v255, v255
    v_max_f32 v168, 0, v168
    v_max_f32 v169, 0, v169
    v_max_f32 v170, 0, v170
    v_max_f32 v171, 0, v171
    v_max_f32 v172, 0, v172
    v_max_f32 v173, 0, v173
    v_max_f32 v174, 0, v174
    v_max_f32 v175, 0, v175
    v_add_f32 v232, 0x358637bd, v232
    v_add_f32 v233, 0x358637bd, v233
    v_add_f32 v234, 0x358637bd, v234
    v_add_f32 v235, 0x358637bd, v235
    v_add_f32 v249, 0x358637bd, v249
    v_add_f32 v250, 0x358637bd, v250
    v_add_f32 v251, 0x358637bd, v251
    v_add_f32 v255, 0x358637bd, v255
    v_fma_f32 v168, v168, v216, v232
    v_fma_f32 v169, v169, v217, v233
    v_fma_f32 v170, v170, v218, v234
    v_fma_f32 v171, v171, v219, v235
    v_fma_f32 v172, v172, v220, v249
    v_fma_f32 v173, v173, v221, v250
    v_fma_f32 v174, v174, v222, v251
    v_fma_f32 v175, v175, v223, v255
    v_mul_f32 v176, v176, v216
    v_mul_f32 v177, v177, v217
    v_mul_f32 v178, v178, v218
    v_mul_f32 v179, v179, v219
    v_mul_f32 v180, v180, v220
    v_mul_f32 v181, v181, v221
    v_mul_f32 v182, v182, v222
    v_mul_f32 v183, v183, v223
    v_mul_f32 v184, v184, v216
    v_mul_f32 v185, v185, v217
    v_mul_f32 v186, v186, v218
    v_mul_f32 v187, v187, v219
    v_mul_f32 v188, v188, v220
    v_mul_f32 v189, v189, v221
    v_mul_f32 v190, v190, v222
    v_mul_f32 v191, v191, v223
    v_mul_f32 v192, v192, v216
    v_mul_f32 v193, v193, v217
    v_mul_f32 v194, v194, v218
    v_mul_f32 v195, v195, v219
    v_mul_f32 v196, v196, v220
    v_mul_f32 v197, v197, v221
    v_mul_f32 v198, v198, v222
    v_mul_f32 v199, v199, v223
    v_mul_f32 v200, v200, v216
    v_mul_f32 v201, v201, v217
    v_mul_f32 v202, v202, v218
    v_mul_f32 v203, v203, v219
    v_mul_f32 v204, v204, v220
    v_mul_f32 v205, v205, v221
    v_mul_f32 v206, v206, v222
    v_mul_f32 v207, v207, v223
    v_mul_f32 v208, v208, v216
    v_mul_f32 v209, v209, v217
    v_mul_f32 v210, v210, v218
    v_mul_f32 v211, v211, v219
    v_mul_f32 v212, v212, v220
    v_mul_f32 v213, v213, v221
    v_mul_f32 v214, v214, v222
    v_mul_f32 v215, v215, v223
    s_mul_i32 s46, s41, 18432
    s_add_u32 s46, s46, 73728
    v_lshl_add_u32 v248, v247, 4, s46
    v_cvt_pk_bf16_f32 v144, v144, v145
    v_cvt_pk_bf16_f32 v145, v146, v147
    v_cvt_pk_bf16_f32 v146, v148, v149
    v_cvt_pk_bf16_f32 v147, v150, v151
    ds_write_b128 v248, v[144:147] offset:5120
    v_cvt_pk_bf16_f32 v152, v152, v153
    v_cvt_pk_bf16_f32 v153, v154, v155
    v_cvt_pk_bf16_f32 v154, v156, v157
    v_cvt_pk_bf16_f32 v155, v158, v159
    ds_write_b128 v248, v[152:155] offset:6144
    v_cvt_pk_bf16_f32 v160, v160, v161
    v_cvt_pk_bf16_f32 v161, v162, v163
    v_cvt_pk_bf16_f32 v162, v164, v165
    v_cvt_pk_bf16_f32 v163, v166, v167
    ds_write_b128 v248, v[160:163] offset:7168
    v_cvt_pk_bf16_f32 v168, v168, v169
    v_cvt_pk_bf16_f32 v169, v170, v171
    v_cvt_pk_bf16_f32 v170, v172, v173
    v_cvt_pk_bf16_f32 v171, v174, v175
    ds_write_b128 v248, v[168:171] offset:8192
    v_cvt_pk_bf16_f32 v176, v176, v177
    v_cvt_pk_bf16_f32 v177, v178, v179
    v_cvt_pk_bf16_f32 v178, v180, v181
    v_cvt_pk_bf16_f32 v179, v182, v183
    ds_write_b128 v248, v[176:179] offset:13312
    v_cvt_pk_bf16_f32 v184, v184, v185
    v_cvt_pk_bf16_f32 v185, v186, v187
    v_cvt_pk_bf16_f32 v186, v188, v189
    v_cvt_pk_bf16_f32 v187, v190, v191
    ds_write_b128 v248, v[184:187] offset:14336
    v_cvt_pk_bf16_f32 v192, v192, v193
    v_cvt_pk_bf16_f32 v193, v194, v195
    v_cvt_pk_bf16_f32 v194, v196, v197
    v_cvt_pk_bf16_f32 v195, v198, v199
    ds_write_b128 v248, v[192:195] offset:15360
    v_cvt_pk_bf16_f32 v200, v200, v201
    v_cvt_pk_bf16_f32 v201, v202, v203
    v_cvt_pk_bf16_f32 v202, v204, v205
    v_cvt_pk_bf16_f32 v203, v206, v207
    ds_write_b128 v248, v[200:203] offset:16384
    v_cvt_pk_bf16_f32 v208, v208, v209
    v_cvt_pk_bf16_f32 v209, v210, v211
    v_cvt_pk_bf16_f32 v210, v212, v213
    v_cvt_pk_bf16_f32 v211, v214, v215
    ds_write_b128 v248, v[208:211] offset:17408
    s_waitcnt lgkmcnt(0)
    s_barrier
    v_lshlrev_b32 v248, 4, v247
    v_add_u32 v248, 73728, v248
    v_lshlrev_b32 v249, 2, v247
    v_lshrrev_b32 v250, 4, v247
    v_lshlrev_b32 v250, 2, v250
    v_and_b32 v251, 15, v247
    v_mov_b32 v224, s50
    v_mov_b32 v225, s50
    v_mov_b32 v226, s50
    v_mov_b32 v227, s50
    s_mov_b32 s22, s40
    s_lshl_b32 s46, s22, 10
    v_add_u32 v254, s46, v248
    ds_read_b128 v[144:147], v254 offset:0
    ds_read_b128 v[148:151], v254 offset:18432
    ds_read_b128 v[152:155], v254 offset:36864
    ds_read_b128 v[156:159], v254 offset:55296
    s_add_i32 s48, s22, -1
    s_max_i32 s23, s48, 0
    s_mul_i32 s93, s22, 3
    s_add_u32 s93, s93, 0
    s_cmp_eq_u32 s23, s48
    s_cselect_b32 s93, s93, 0x1fffff
    s_lshl_b32 s93, s93, 10
    s_add_u32 s46, s23, 9
    s_lshl_b32 s46, s46, 10
    v_add_u32 v255, s46, v248
    ds_read_b128 v[160:163], v255 offset:0
    ds_read_b128 v[164:167], v255 offset:18432
    ds_read_b128 v[168:171], v255 offset:36864
    ds_read_b128 v[172:175], v255 offset:55296
    s_add_i32 s48, s22, 0
    s_max_i32 s58, s48, 0
    s_mul_i32 s94, s22, 3
    s_add_u32 s94, s94, 1
    s_cmp_eq_u32 s58, s48
    s_cselect_b32 s94, s94, 0x1fffff
    s_lshl_b32 s94, s94, 10
    s_add_u32 s46, s58, 9
    s_lshl_b32 s46, s46, 10
    v_add_u32 v255, s46, v248
    ds_read_b128 v[176:179], v255 offset:0
    ds_read_b128 v[180:183], v255 offset:18432
    ds_read_b128 v[184:187], v255 offset:36864
    ds_read_b128 v[188:191], v255 offset:55296
    s_add_i32 s48, s22, 1
    s_max_i32 s59, s48, 0
    s_mul_i32 s95, s22, 3
    s_add_u32 s95, s95, 2
    s_cmp_eq_u32 s59, s48
    s_cselect_b32 s95, s95, 0x1fffff
    s_lshl_b32 s95, s95, 10
    s_add_u32 s46, s59, 9
    s_lshl_b32 s46, s46, 10
    v_add_u32 v255, s46, v248
    ds_read_b128 v[192:195], v255 offset:0
    ds_read_b128 v[196:199], v255 offset:18432
    ds_read_b128 v[200:203], v255 offset:36864
    ds_read_b128 v[204:207], v255 offset:55296
    s_lshl_b32 s46, s22, 4
    v_add_u32 v216, s46, v250
    v_mul_u32_u24 v216, 3641, v216
    v_lshrrev_b32 v216, 16, v216
    v_add_u32 v217, s46, v250
    v_add_u32 v217, 1, v217
    v_mul_u32_u24 v217, 3641, v217
    v_lshrrev_b32 v217, 16, v217
    v_add_u32 v218, s46, v250
    v_add_u32 v218, 2, v218
    v_mul_u32_u24 v218, 3641, v218
    v_lshrrev_b32 v218, 16, v218
    v_add_u32 v219, s46, v250
    v_add_u32 v219, 3, v219
    v_mul_u32_u24 v219, 3641, v219
    v_lshrrev_b32 v219, 16, v219
    s_waitcnt lgkmcnt(12)
    v_mfma_f32_16x16x32_bf16 v[212:215], v[144:147], v[224:227], 0
    v_mfma_f32_16x16x32_bf16 v[212:215], v[148:151], v[224:227], v[212:215]
    v_mfma_f32_16x16x32_bf16 v[212:215], v[152:155], v[224:227], v[212:215]
    v_mfma_f32_16x16x32_bf16 v[212:215], v[156:159], v[224:227], v[212:215]
    s_waitcnt lgkmcnt(0)
    v_mfma_f32_16x16x32_bf16 v[228:231], v[144:147], v[160:163], 0
    v_mfma_f32_16x16x32_bf16 v[228:231], v[148:151], v[164:167], v[228:231]
    v_mfma_f32_16x16x32_bf16 v[228:231], v[152:155], v[168:171], v[228:231]
    v_mfma_f32_16x16x32_bf16 v[228:231], v[156:159], v[172:175], v[228:231]
    v_mfma_f32_16x16x32_bf16 v[232:235], v[144:147], v[176:179], 0
    v_mfma_f32_16x16x32_bf16 v[232:235], v[148:151], v[180:183], v[232:235]
    v_mfma_f32_16x16x32_bf16 v[232:235], v[152:155], v[184:187], v[232:235]
    v_mfma_f32_16x16x32_bf16 v[232:235], v[156:159], v[188:191], v[232:235]
    v_mfma_f32_16x16x32_bf16 v[208:211], v[144:147], v[192:195], 0
    v_mfma_f32_16x16x32_bf16 v[208:211], v[148:151], v[196:199], v[208:211]
    v_mfma_f32_16x16x32_bf16 v[208:211], v[152:155], v[200:203], v[208:211]
    v_mfma_f32_16x16x32_bf16 v[208:211], v[156:159], v[204:207], v[208:211]
    s_add_u32 s48, s22, 27
    s_lshl_b32 s48, s48, 10
    s_nop 4
    s_mov_b32 exec_lo, 0x00010001
    s_mov_b32 exec_hi, 0x00010001
    buffer_atomic_add_f32 v212, v249, s[8:11], s48 offen offset:0
    s_mov_b64 exec, -1
    s_mov_b32 exec_lo, 0x00010001
    s_mov_b32 exec_hi, 0x00010001
    buffer_atomic_add_f32 v213, v249, s[8:11], s48 offen offset:256
    s_mov_b64 exec, -1
    s_mov_b32 exec_lo, 0x00010001
    s_mov_b32 exec_hi, 0x00010001
    buffer_atomic_add_f32 v214, v249, s[8:11], s48 offen offset:512
    s_mov_b64 exec, -1
    s_mov_b32 exec_lo, 0x00010001
    s_mov_b32 exec_hi, 0x00010001
    buffer_atomic_add_f32 v215, v249, s[8:11], s48 offen offset:768
    s_mov_b64 exec, -1
    s_lshl_b32 s46, s23, 4
    v_add_u32 v220, s46, v251
    v_mul_u32_u24 v220, 3641, v220
    v_lshrrev_b32 v220, 16, v220
    v_cmp_eq_u32 vcc, v216, v220
    s_nop 1
    v_cndmask_b32 v228, 0, v228, vcc
    s_or_b32 exec_lo, vcc_lo, 1
    s_mov_b32 exec_hi, vcc_hi
    buffer_atomic_add_f32 v228, v249, s[8:11], s93 offen offset:0
    s_mov_b64 exec, -1
    v_cmp_eq_u32 vcc, v217, v220
    s_nop 1
    v_cndmask_b32 v229, 0, v229, vcc
    s_or_b32 exec_lo, vcc_lo, 1
    s_mov_b32 exec_hi, vcc_hi
    buffer_atomic_add_f32 v229, v249, s[8:11], s93 offen offset:256
    s_mov_b64 exec, -1
    v_cmp_eq_u32 vcc, v218, v220
    s_nop 1
    v_cndmask_b32 v230, 0, v230, vcc
    s_or_b32 exec_lo, vcc_lo, 1
    s_mov_b32 exec_hi, vcc_hi
    buffer_atomic_add_f32 v230, v249, s[8:11], s93 offen offset:512
    s_mov_b64 exec, -1
    v_cmp_eq_u32 vcc, v219, v220
    s_nop 1
    v_cndmask_b32 v231, 0, v231, vcc
    s_or_b32 exec_lo, vcc_lo, 1
    s_mov_b32 exec_hi, vcc_hi
    buffer_atomic_add_f32 v231, v249, s[8:11], s93 offen offset:768
    s_mov_b64 exec, -1
    s_lshl_b32 s46, s58, 4
    v_add_u32 v220, s46, v251
    v_mul_u32_u24 v220, 3641, v220
    v_lshrrev_b32 v220, 16, v220
    v_cmp_eq_u32 vcc, v216, v220
    s_nop 1
    v_cndmask_b32 v232, 0, v232, vcc
    s_or_b32 exec_lo, vcc_lo, 1
    s_mov_b32 exec_hi, vcc_hi
    buffer_atomic_add_f32 v232, v249, s[8:11], s94 offen offset:0
    s_mov_b64 exec, -1
    v_cmp_eq_u32 vcc, v217, v220
    s_nop 1
    v_cndmask_b32 v233, 0, v233, vcc
    s_or_b32 exec_lo, vcc_lo, 1
    s_mov_b32 exec_hi, vcc_hi
    buffer_atomic_add_f32 v233, v249, s[8:11], s94 offen offset:256
    s_mov_b64 exec, -1
    v_cmp_eq_u32 vcc, v218, v220
    s_nop 1
    v_cndmask_b32 v234, 0, v234, vcc
    s_or_b32 exec_lo, vcc_lo, 1
    s_mov_b32 exec_hi, vcc_hi
    buffer_atomic_add_f32 v234, v249, s[8:11], s94 offen offset:512
    s_mov_b64 exec, -1
    v_cmp_eq_u32 vcc, v219, v220
    s_nop 1
    v_cndmask_b32 v235, 0, v235, vcc
    s_or_b32 exec_lo, vcc_lo, 1
    s_mov_b32 exec_hi, vcc_hi
    buffer_atomic_add_f32 v235, v249, s[8:11], s94 offen offset:768
    s_mov_b64 exec, -1
    s_lshl_b32 s46, s59, 4
    v_add_u32 v220, s46, v251
    v_mul_u32_u24 v220, 3641, v220
    v_lshrrev_b32 v220, 16, v220
    v_cmp_eq_u32 vcc, v216, v220
    s_nop 1
    v_cndmask_b32 v208, 0, v208, vcc
    s_or_b32 exec_lo, vcc_lo, 1
    s_mov_b32 exec_hi, vcc_hi
    buffer_atomic_add_f32 v208, v249, s[8:11], s95 offen offset:0
    s_mov_b64 exec, -1
    v_cmp_eq_u32 vcc, v217, v220
    s_nop 1
    v_cndmask_b32 v209, 0, v209, vcc
    s_or_b32 exec_lo, vcc_lo, 1
    s_mov_b32 exec_hi, vcc_hi
    buffer_atomic_add_f32 v209, v249, s[8:11], s95 offen offset:256
    s_mov_b64 exec, -1
    v_cmp_eq_u32 vcc, v218, v220
    s_nop 1
    v_cndmask_b32 v210, 0, v210, vcc
    s_or_b32 exec_lo, vcc_lo, 1
    s_mov_b32 exec_hi, vcc_hi
    buffer_atomic_add_f32 v210, v249, s[8:11], s95 offen offset:512
    s_mov_b64 exec, -1
    v_cmp_eq_u32 vcc, v219, v220
    s_nop 1
    v_cndmask_b32 v211, 0, v211, vcc
    s_or_b32 exec_lo, vcc_lo, 1
    s_mov_b32 exec_hi, vcc_hi
    buffer_atomic_add_f32 v211, v249, s[8:11], s95 offen offset:768
    s_mov_b64 exec, -1
    s_cmp_eq_u32 s41, 0
    s_cbranch_scc1 L_kv8_rd_c1
    v_add_u32 v254, 8192, v248
    ds_read_b128 v[144:147], v254 offset:0
    ds_read_b128 v[148:151], v254 offset:18432
    ds_read_b128 v[152:155], v254 offset:36864
    ds_read_b128 v[156:159], v254 offset:55296
    s_add_u32 s56, s41, 6
    s_min_u32 s56, s56, 8
    s_add_u32 s46, s56, 9
    s_lshl_b32 s46, s46, 10
    v_add_u32 v255, s46, v248
    ds_read_b128 v[160:163], v255 offset:0
    ds_read_b128 v[164:167], v255 offset:18432
    ds_read_b128 v[168:171], v255 offset:36864
    ds_read_b128 v[172:175], v255 offset:55296
    s_waitcnt lgkmcnt(0)
L_kv8_rd_c1:
    s_barrier
    s_add_u32 m0, s55, 73728
    s_mov_b32 s49, 331776
    buffer_load_dwordx4 v244, s[28:31], s49 offen lds
    s_add_u32 m0, s55, 74752
    s_mov_b32 s49, 331776
    buffer_load_dwordx4 v245, s[28:31], s49 offen lds
    s_add_u32 m0, s55, 75776
    s_mov_b32 s49, 331776
    buffer_load_dwordx4 v246, s[28:31], s49 offen lds
    s_cmp_eq_u32 s41, 0
    s_cbranch_scc1 L_kv8_done_c1
    s_mov_b32 s22, 8
    s_lshl_b32 s46, s22, 4
    v_add_u32 v216, s46, v250
    v_mul_u32_u24 v216, 3641, v216
    v_lshrrev_b32 v216, 16, v216
    v_add_u32 v217, s46, v250
    v_add_u32 v217, 1, v217
    v_mul_u32_u24 v217, 3641, v217
    v_lshrrev_b32 v217, 16, v217
    v_add_u32 v218, s46, v250
    v_add_u32 v218, 2, v218
    v_mul_u32_u24 v218, 3641, v218
    v_lshrrev_b32 v218, 16, v218
    v_add_u32 v219, s46, v250
    v_add_u32 v219, 3, v219
    v_mul_u32_u24 v219, 3641, v219
    v_lshrrev_b32 v219, 16, v219
    s_cmp_eq_u32 s41, 3
    s_cbranch_scc1 L_kv8_z_c1
    s_add_u32 s93, s41, 23
    s_lshl_b32 s93, s93, 10
    v_mfma_f32_16x16x32_bf16 v[228:231], v[144:147], v[160:163], 0
    v_mfma_f32_16x16x32_bf16 v[228:231], v[148:151], v[164:167], v[228:231]
    v_mfma_f32_16x16x32_bf16 v[228:231], v[152:155], v[168:171], v[228:231]
    v_mfma_f32_16x16x32_bf16 v[228:231], v[156:159], v[172:175], v[228:231]
    s_nop 7
    s_nop 1
    s_lshl_b32 s46, s56, 4
    v_add_u32 v220, s46, v251
    v_mul_u32_u24 v220, 3641, v220
    v_lshrrev_b32 v220, 16, v220
    v_cmp_eq_u32 vcc, v216, v220
    s_nop 1
    v_cndmask_b32 v228, 0, v228, vcc
    s_or_b32 exec_lo, vcc_lo, 1
    s_mov_b32 exec_hi, vcc_hi
    buffer_atomic_add_f32 v228, v249, s[8:11], s93 offen offset:0
    s_mov_b64 exec, -1
    v_cmp_eq_u32 vcc, v217, v220
    s_nop 1
    v_cndmask_b32 v229, 0, v229, vcc
    s_or_b32 exec_lo, vcc_lo, 1
    s_mov_b32 exec_hi, vcc_hi
    buffer_atomic_add_f32 v229, v249, s[8:11], s93 offen offset:256
    s_mov_b64 exec, -1
    v_cmp_eq_u32 vcc, v218, v220
    s_nop 1
    v_cndmask_b32 v230, 0, v230, vcc
    s_or_b32 exec_lo, vcc_lo, 1
    s_mov_b32 exec_hi, vcc_hi
    buffer_atomic_add_f32 v230, v249, s[8:11], s93 offen offset:512
    s_mov_b64 exec, -1
    v_cmp_eq_u32 vcc, v219, v220
    s_nop 1
    v_cndmask_b32 v231, 0, v231, vcc
    s_or_b32 exec_lo, vcc_lo, 1
    s_mov_b32 exec_hi, vcc_hi
    buffer_atomic_add_f32 v231, v249, s[8:11], s93 offen offset:768
    s_mov_b64 exec, -1
    s_branch L_kv8_done_c1
L_kv8_z_c1:
    v_mfma_f32_16x16x32_bf16 v[228:231], v[144:147], v[224:227], 0
    v_mfma_f32_16x16x32_bf16 v[228:231], v[148:151], v[224:227], v[228:231]
    v_mfma_f32_16x16x32_bf16 v[228:231], v[152:155], v[224:227], v[228:231]
    v_mfma_f32_16x16x32_bf16 v[228:231], v[156:159], v[224:227], v[228:231]
    s_mov_b32 s93, 35840
    s_nop 7
    s_nop 1
    s_mov_b32 exec_lo, 0x00010001
    s_mov_b32 exec_hi, 0x00010001
    buffer_atomic_add_f32 v228, v249, s[8:11], s93 offen offset:0
    s_mov_b64 exec, -1
    s_mov_b32 exec_lo, 0x00010001
    s_mov_b32 exec_hi, 0x00010001
    buffer_atomic_add_f32 v229, v249, s[8:11], s93 offen offset:256
    s_mov_b64 exec, -1
    s_mov_b32 exec_lo, 0x00010001
    s_mov_b32 exec_hi, 0x00010001
    buffer_atomic_add_f32 v230, v249, s[8:11], s93 offen offset:512
    s_mov_b64 exec, -1
    s_mov_b32 exec_lo, 0x00010001
    s_mov_b32 exec_hi, 0x00010001
    buffer_atomic_add_f32 v231, v249, s[8:11], s93 offen offset:768
    s_mov_b64 exec, -1
L_kv8_done_c1:
    ds_read_b64_tr_b16 v[224:225], v241 offset:128
    ds_read_b64_tr_b16 v[226:227], v241 offset:3200
    ds_read_b64_tr_b16 v[228:229], v242 offset:128
    ds_read_b64_tr_b16 v[230:231], v242 offset:3200
    ds_read_b64_tr_b16 v[232:233], v243 offset:128
    ds_read_b64_tr_b16 v[234:235], v243 offset:3200
    ds_read_b64_tr_b16 v[216:217], v240 offset:256
    ds_read_b64_tr_b16 v[218:219], v240 offset:3328
    ds_read_b64_tr_b16 v[220:221], v241 offset:12416
    ds_read_b64_tr_b16 v[222:223], v241 offset:15488
    s_waitcnt vmcnt(0)
    s_barrier
    s_waitcnt lgkmcnt(8)
    v_mfma_f32_16x16x32_bf16 v[144:147], v[224:227], v[0:3], 0
    v_mfma_f32_16x16x32_bf16 v[148:151], v[224:227], v[72:75], 0
    ds_read_b64_tr_b16 v[224:225], v242 offset:12416
    ds_read_b64_tr_b16 v[226:227], v242 offset:15488
    s_waitcnt lgkmcnt(8)
    v_mfma_f32_16x16x32_bf16 v[152:155], v[228:231], v[0:3], 0
    v_mfma_f32_16x16x32_bf16 v[156:159], v[228:231], v[72:75], 0
    ds_read_b64_tr_b16 v[228:229], v243 offset:12416
    ds_read_b64_tr_b16 v[230:231], v243 offset:15488
    s_add_u32 m0, s55, 24576
    s_mov_b32 s49, 774144
    buffer_load_dwordx4 v244, s[28:31], s49 offen lds
    s_waitcnt lgkmcnt(8)
    v_mfma_f32_16x16x32_bf16 v[160:163], v[232:235], v[0:3], 0
    v_mfma_f32_16x16x32_bf16 v[164:167], v[232:235], v[72:75], 0
    ds_read_b64_tr_b16 v[232:233], v240 offset:12544
    ds_read_b64_tr_b16 v[234:235], v240 offset:15616
    s_waitcnt lgkmcnt(8)
    v_mfma_f32_16x16x32_bf16 v[168:171], v[216:219], v[0:3], 0
    v_mfma_f32_16x16x32_bf16 v[172:175], v[216:219], v[72:75], 0
    ds_read_b64_tr_b16 v[216:217], v241 offset:24704
    ds_read_b64_tr_b16 v[218:219], v241 offset:27776
    s_add_u32 m0, s55, 25600
    s_mov_b32 s49, 774144
    buffer_load_dwordx4 v245, s[28:31], s49 offen lds
    s_waitcnt lgkmcnt(8)
    v_mfma_f32_16x16x32_bf16 v[144:147], v[220:223], v[4:7], v[144:147]
    v_mfma_f32_16x16x32_bf16 v[148:151], v[220:223], v[76:79], v[148:151]
    ds_read_b64_tr_b16 v[220:221], v242 offset:24704
    ds_read_b64_tr_b16 v[222:223], v242 offset:27776
    s_waitcnt lgkmcnt(8)
    v_mfma_f32_16x16x32_bf16 v[152:155], v[224:227], v[4:7], v[152:155]
    v_mfma_f32_16x16x32_bf16 v[156:159], v[224:227], v[76:79], v[156:159]
    ds_read_b64_tr_b16 v[224:225], v243 offset:24704
    ds_read_b64_tr_b16 v[226:227], v243 offset:27776
    s_add_u32 m0, s55, 26624
    s_mov_b32 s49, 774144
    buffer_load_dwordx4 v246, s[28:31], s49 offen lds
    s_waitcnt lgkmcnt(8)
    v_mfma_f32_16x16x32_bf16 v[160:163], v[228:231], v[4:7], v[160:163]
    v_mfma_f32_16x16x32_bf16 v[164:167], v[228:231], v[76:79], v[164:167]
    ds_read_b64_tr_b16 v[228:229], v240 offset:24832
    ds_read_b64_tr_b16 v[230:231], v240 offset:27904
    s_waitcnt lgkmcnt(8)
    v_mfma_f32_16x16x32_bf16 v[168:171], v[232:235], v[4:7], v[168:171]
    v_mfma_f32_16x16x32_bf16 v[172:175], v[232:235], v[76:79], v[172:175]
    ds_read_b64_tr_b16 v[232:233], v241 offset:36992
    ds_read_b64_tr_b16 v[234:235], v241 offset:40064
    s_barrier
    s_waitcnt lgkmcnt(8)
    v_mfma_f32_16x16x32_bf16 v[144:147], v[216:219], v[8:11], v[144:147]
    v_mfma_f32_16x16x32_bf16 v[148:151], v[216:219], v[80:83], v[148:151]
    ds_read_b64_tr_b16 v[216:217], v242 offset:36992
    ds_read_b64_tr_b16 v[218:219], v242 offset:40064
    s_waitcnt lgkmcnt(8)
    v_mfma_f32_16x16x32_bf16 v[152:155], v[220:223], v[8:11], v[152:155]
    v_mfma_f32_16x16x32_bf16 v[156:159], v[220:223], v[80:83], v[156:159]
    ds_read_b64_tr_b16 v[220:221], v243 offset:36992
    ds_read_b64_tr_b16 v[222:223], v243 offset:40064
    s_add_u32 m0, s55, 49152
    s_mov_b32 s49, 995328
    buffer_load_dwordx4 v244, s[28:31], s49 offen lds
    s_waitcnt lgkmcnt(8)
    v_mfma_f32_16x16x32_bf16 v[160:163], v[224:227], v[8:11], v[160:163]
    v_mfma_f32_16x16x32_bf16 v[164:167], v[224:227], v[80:83], v[164:167]
    ds_read_b64_tr_b16 v[224:225], v240 offset:37120
    ds_read_b64_tr_b16 v[226:227], v240 offset:40192
    s_waitcnt lgkmcnt(8)
    v_mfma_f32_16x16x32_bf16 v[168:171], v[228:231], v[8:11], v[168:171]
    v_mfma_f32_16x16x32_bf16 v[172:175], v[228:231], v[80:83], v[172:175]
    ds_read_b64_tr_b16 v[228:229], v237 offset:128
    ds_read_b64_tr_b16 v[230:231], v237 offset:3200
    s_add_u32 m0, s55, 50176
    s_mov_b32 s49, 995328
    buffer_load_dwordx4 v245, s[28:31], s49 offen lds
    s_waitcnt lgkmcnt(8)
    v_mfma_f32_16x16x32_bf16 v[144:147], v[232:235], v[12:15], v[144:147]
    v_mfma_f32_16x16x32_bf16 v[148:151], v[232:235], v[84:87], v[148:151]
    ds_read_b64_tr_b16 v[232:233], v238 offset:128
    ds_read_b64_tr_b16 v[234:235], v238 offset:3200
    s_waitcnt lgkmcnt(8)
    v_mfma_f32_16x16x32_bf16 v[152:155], v[216:219], v[12:15], v[152:155]
    v_mfma_f32_16x16x32_bf16 v[156:159], v[216:219], v[84:87], v[156:159]
    ds_read_b64_tr_b16 v[216:217], v239 offset:128
    ds_read_b64_tr_b16 v[218:219], v239 offset:3200
    s_add_u32 m0, s55, 51200
    s_mov_b32 s49, 995328
    buffer_load_dwordx4 v246, s[28:31], s49 offen lds
    s_waitcnt lgkmcnt(8)
    v_mfma_f32_16x16x32_bf16 v[160:163], v[220:223], v[12:15], v[160:163]
    v_mfma_f32_16x16x32_bf16 v[164:167], v[220:223], v[84:87], v[164:167]
    ds_read_b64_tr_b16 v[220:221], v236 offset:256
    ds_read_b64_tr_b16 v[222:223], v236 offset:3328
    s_waitcnt lgkmcnt(8)
    v_mfma_f32_16x16x32_bf16 v[168:171], v[224:227], v[12:15], v[168:171]
    v_mfma_f32_16x16x32_bf16 v[172:175], v[224:227], v[84:87], v[172:175]
    ds_read_b64_tr_b16 v[224:225], v237 offset:12416
    ds_read_b64_tr_b16 v[226:227], v237 offset:15488
    s_waitcnt vmcnt(3)
    s_barrier
    s_waitcnt lgkmcnt(8)
    v_mfma_f32_16x16x32_bf16 v[144:147], v[228:231], v[16:19], v[144:147]
    v_mfma_f32_16x16x32_bf16 v[148:151], v[228:231], v[88:91], v[148:151]
    ds_read_b64_tr_b16 v[228:229], v238 offset:12416
    ds_read_b64_tr_b16 v[230:231], v238 offset:15488
    s_waitcnt lgkmcnt(8)
    v_mfma_f32_16x16x32_bf16 v[152:155], v[232:235], v[16:19], v[152:155]
    v_mfma_f32_16x16x32_bf16 v[156:159], v[232:235], v[88:91], v[156:159]
    ds_read_b64_tr_b16 v[232:233], v239 offset:12416
    ds_read_b64_tr_b16 v[234:235], v239 offset:15488
    s_add_u32 m0, s55, 73728
    s_mov_b32 s49, 1216512
    buffer_load_dwordx4 v244, s[28:31], s49 offen lds
    s_waitcnt lgkmcnt(8)
    v_mfma_f32_16x16x32_bf16 v[160:163], v[216:219], v[16:19], v[160:163]
    v_mfma_f32_16x16x32_bf16 v[164:167], v[216:219], v[88:91], v[164:167]
    ds_read_b64_tr_b16 v[216:217], v236 offset:12544
    ds_read_b64_tr_b16 v[218:219], v236 offset:15616
    s_waitcnt lgkmcnt(8)
    v_mfma_f32_16x16x32_bf16 v[168:171], v[220:223], v[16:19], v[168:171]
    v_mfma_f32_16x16x32_bf16 v[172:175], v[220:223], v[88:91], v[172:175]
    ds_read_b64_tr_b16 v[220:221], v237 offset:24704
    ds_read_b64_tr_b16 v[222:223], v237 offset:27776
    s_add_u32 m0, s55, 74752
    s_mov_b32 s49, 1216512
    buffer_load_dwordx4 v245, s[28:31], s49 offen lds
    s_waitcnt lgkmcnt(8)
    v_mfma_f32_16x16x32_bf16 v[144:147], v[224:227], v[20:23], v[144:147]
    v_mfma_f32_16x16x32_bf16 v[148:151], v[224:227], v[92:95], v[148:151]
    ds_read_b64_tr_b16 v[224:225], v238 offset:24704
    ds_read_b64_tr_b16 v[226:227], v238 offset:27776
    s_waitcnt lgkmcnt(8)
    v_mfma_f32_16x16x32_bf16 v[152:155], v[228:231], v[20:23], v[152:155]
    v_mfma_f32_16x16x32_bf16 v[156:159], v[228:231], v[92:95], v[156:159]
    ds_read_b64_tr_b16 v[228:229], v239 offset:24704
    ds_read_b64_tr_b16 v[230:231], v239 offset:27776
    s_add_u32 m0, s55, 75776
    s_mov_b32 s49, 1216512
    buffer_load_dwordx4 v246, s[28:31], s49 offen lds
    s_waitcnt lgkmcnt(8)
    v_mfma_f32_16x16x32_bf16 v[160:163], v[232:235], v[20:23], v[160:163]
    v_mfma_f32_16x16x32_bf16 v[164:167], v[232:235], v[92:95], v[164:167]
    ds_read_b64_tr_b16 v[232:233], v236 offset:24832
    ds_read_b64_tr_b16 v[234:235], v236 offset:27904
    s_lshl_b32 s46, s43, 2
    s_add_u32 s46, s46, 80
    v_mov_b32 v248, 0x7fffff00
    v_mov_b32 v255, s46
    s_lshl_b32 s47, s40, 6
    v_add_u32 v250, s47, v247
    v_cmp_eq_u32 vcc, 0, v250
    v_mov_b32 v251, 1
    s_nop 0
    v_cndmask_b32 v248, v248, v255, vcc
    buffer_atomic_add v251, v248, s[16:19], 0 offen sc1
    s_waitcnt lgkmcnt(8)
    v_mfma_f32_16x16x32_bf16 v[168:171], v[216:219], v[20:23], v[168:171]
    v_mfma_f32_16x16x32_bf16 v[172:175], v[216:219], v[92:95], v[172:175]
    ds_read_b64_tr_b16 v[216:217], v237 offset:36992
    ds_read_b64_tr_b16 v[218:219], v237 offset:40064
    s_waitcnt vmcnt(4)
    s_barrier
    s_waitcnt lgkmcnt(8)
    v_mfma_f32_16x16x32_bf16 v[144:147], v[220:223], v[24:27], v[144:147]
    v_mfma_f32_16x16x32_bf16 v[148:151], v[220:223], v[96:99], v[148:151]
    ds_read_b64_tr_b16 v[220:221], v238 offset:36992
    ds_read_b64_tr_b16 v[222:223], v238 offset:40064
    s_waitcnt lgkmcnt(8)
    v_mfma_f32_16x16x32_bf16 v[152:155], v[224:227], v[24:27], v[152:155]
    v_mfma_f32_16x16x32_bf16 v[156:159], v[224:227], v[96:99], v[156:159]
    ds_read_b64_tr_b16 v[224:225], v239 offset:36992
    ds_read_b64_tr_b16 v[226:227], v239 offset:40064
    s_add_u32 m0, s55, 0
    s_mov_b32 s49, 1437696
    buffer_load_dwordx4 v244, s[28:31], s49 offen lds
    s_waitcnt lgkmcnt(8)
    v_mfma_f32_16x16x32_bf16 v[160:163], v[228:231], v[24:27], v[160:163]
    v_mfma_f32_16x16x32_bf16 v[164:167], v[228:231], v[96:99], v[164:167]
    ds_read_b64_tr_b16 v[228:229], v236 offset:37120
    ds_read_b64_tr_b16 v[230:231], v236 offset:40192
    s_waitcnt lgkmcnt(8)
    v_mfma_f32_16x16x32_bf16 v[168:171], v[232:235], v[24:27], v[168:171]
    v_mfma_f32_16x16x32_bf16 v[172:175], v[232:235], v[96:99], v[172:175]
    ds_read_b64_tr_b16 v[232:233], v241 offset:128
    ds_read_b64_tr_b16 v[234:235], v241 offset:3200
    s_add_u32 m0, s55, 1024
    s_mov_b32 s49, 1437696
    buffer_load_dwordx4 v245, s[28:31], s49 offen lds
    s_waitcnt lgkmcnt(8)
    v_mfma_f32_16x16x32_bf16 v[144:147], v[216:219], v[28:31], v[144:147]
    v_mfma_f32_16x16x32_bf16 v[148:151], v[216:219], v[100:103], v[148:151]
    ds_read_b64_tr_b16 v[216:217], v242 offset:128
    ds_read_b64_tr_b16 v[218:219], v242 offset:3200
    s_waitcnt lgkmcnt(8)
    v_mfma_f32_16x16x32_bf16 v[152:155], v[220:223], v[28:31], v[152:155]
    v_mfma_f32_16x16x32_bf16 v[156:159], v[220:223], v[100:103], v[156:159]
    ds_read_b64_tr_b16 v[220:221], v243 offset:128
    ds_read_b64_tr_b16 v[222:223], v243 offset:3200
    s_add_u32 m0, s55, 2048
    s_mov_b32 s49, 1437696
    buffer_load_dwordx4 v246, s[28:31], s49 offen lds
    s_waitcnt lgkmcnt(8)
    v_mfma_f32_16x16x32_bf16 v[160:163], v[224:227], v[28:31], v[160:163]
    v_mfma_f32_16x16x32_bf16 v[164:167], v[224:227], v[100:103], v[164:167]
    ds_read_b64_tr_b16 v[224:225], v240 offset:256
    ds_read_b64_tr_b16 v[226:227], v240 offset:3328
    s_waitcnt lgkmcnt(8)
    v_mfma_f32_16x16x32_bf16 v[168:171], v[228:231], v[28:31], v[168:171]
    v_mfma_f32_16x16x32_bf16 v[172:175], v[228:231], v[100:103], v[172:175]
    ds_read_b64_tr_b16 v[228:229], v241 offset:12416
    ds_read_b64_tr_b16 v[230:231], v241 offset:15488
    s_waitcnt vmcnt(4)
    s_barrier
    s_waitcnt lgkmcnt(8)
    v_mfma_f32_16x16x32_bf16 v[144:147], v[232:235], v[32:35], v[144:147]
    v_mfma_f32_16x16x32_bf16 v[148:151], v[232:235], v[104:107], v[148:151]
    ds_read_b64_tr_b16 v[232:233], v242 offset:12416
    ds_read_b64_tr_b16 v[234:235], v242 offset:15488
    s_waitcnt lgkmcnt(8)
    v_mfma_f32_16x16x32_bf16 v[152:155], v[216:219], v[32:35], v[152:155]
    v_mfma_f32_16x16x32_bf16 v[156:159], v[216:219], v[104:107], v[156:159]
    ds_read_b64_tr_b16 v[216:217], v243 offset:12416
    ds_read_b64_tr_b16 v[218:219], v243 offset:15488
    s_add_u32 m0, s55, 24576
    s_mov_b32 s49, 1658880
    buffer_load_dwordx4 v244, s[28:31], s49 offen lds
    s_waitcnt lgkmcnt(8)
    v_mfma_f32_16x16x32_bf16 v[160:163], v[220:223], v[32:35], v[160:163]
    v_mfma_f32_16x16x32_bf16 v[164:167], v[220:223], v[104:107], v[164:167]
    ds_read_b64_tr_b16 v[220:221], v240 offset:12544
    ds_read_b64_tr_b16 v[222:223], v240 offset:15616
    s_waitcnt lgkmcnt(8)
    v_mfma_f32_16x16x32_bf16 v[168:171], v[224:227], v[32:35], v[168:171]
    v_mfma_f32_16x16x32_bf16 v[172:175], v[224:227], v[104:107], v[172:175]
    ds_read_b64_tr_b16 v[224:225], v241 offset:24704
    ds_read_b64_tr_b16 v[226:227], v241 offset:27776
    s_add_u32 m0, s55, 25600
    s_mov_b32 s49, 1658880
    buffer_load_dwordx4 v245, s[28:31], s49 offen lds
    s_waitcnt lgkmcnt(8)
    v_mfma_f32_16x16x32_bf16 v[144:147], v[228:231], v[36:39], v[144:147]
    v_mfma_f32_16x16x32_bf16 v[148:151], v[228:231], v[108:111], v[148:151]
    ds_read_b64_tr_b16 v[228:229], v242 offset:24704
    ds_read_b64_tr_b16 v[230:231], v242 offset:27776
    s_waitcnt lgkmcnt(8)
    v_mfma_f32_16x16x32_bf16 v[152:155], v[232:235], v[36:39], v[152:155]
    v_mfma_f32_16x16x32_bf16 v[156:159], v[232:235], v[108:111], v[156:159]
    ds_read_b64_tr_b16 v[232:233], v243 offset:24704
    ds_read_b64_tr_b16 v[234:235], v243 offset:27776
    s_add_u32 m0, s55, 26624
    s_mov_b32 s49, 1658880
    buffer_load_dwordx4 v246, s[28:31], s49 offen lds
    s_waitcnt lgkmcnt(8)
    v_mfma_f32_16x16x32_bf16 v[160:163], v[216:219], v[36:39], v[160:163]
    v_mfma_f32_16x16x32_bf16 v[164:167], v[216:219], v[108:111], v[164:167]
    ds_read_b64_tr_b16 v[216:217], v240 offset:24832
    ds_read_b64_tr_b16 v[218:219], v240 offset:27904
    s_waitcnt lgkmcnt(8)
    v_mfma_f32_16x16x32_bf16 v[168:171], v[220:223], v[36:39], v[168:171]
    v_mfma_f32_16x16x32_bf16 v[172:175], v[220:223], v[108:111], v[172:175]
    ds_read_b64_tr_b16 v[220:221], v241 offset:36992
    ds_read_b64_tr_b16 v[222:223], v241 offset:40064
    s_waitcnt vmcnt(3)
    s_barrier
    s_waitcnt lgkmcnt(8)
    v_mfma_f32_16x16x32_bf16 v[144:147], v[224:227], v[40:43], v[144:147]
    v_mfma_f32_16x16x32_bf16 v[148:151], v[224:227], v[112:115], v[148:151]
    ds_read_b64_tr_b16 v[224:225], v242 offset:36992
    ds_read_b64_tr_b16 v[226:227], v242 offset:40064
    s_waitcnt lgkmcnt(8)
    v_mfma_f32_16x16x32_bf16 v[152:155], v[228:231], v[40:43], v[152:155]
    v_mfma_f32_16x16x32_bf16 v[156:159], v[228:231], v[112:115], v[156:159]
    ds_read_b64_tr_b16 v[228:229], v243 offset:36992
    ds_read_b64_tr_b16 v[230:231], v243 offset:40064
    s_add_u32 m0, s55, 49152
    s_mov_b32 s49, 1880064
    buffer_load_dwordx4 v244, s[28:31], s49 offen lds
    s_waitcnt lgkmcnt(8)
    v_mfma_f32_16x16x32_bf16 v[160:163], v[232:235], v[40:43], v[160:163]
    v_mfma_f32_16x16x32_bf16 v[164:167], v[232:235], v[112:115], v[164:167]
    ds_read_b64_tr_b16 v[232:233], v240 offset:37120
    ds_read_b64_tr_b16 v[234:235], v240 offset:40192
    s_waitcnt lgkmcnt(8)
    v_mfma_f32_16x16x32_bf16 v[168:171], v[216:219], v[40:43], v[168:171]
    v_mfma_f32_16x16x32_bf16 v[172:175], v[216:219], v[112:115], v[172:175]
    ds_read_b64_tr_b16 v[216:217], v237 offset:128
    ds_read_b64_tr_b16 v[218:219], v237 offset:3200
    s_add_u32 m0, s55, 50176
    s_mov_b32 s49, 1880064
    buffer_load_dwordx4 v245, s[28:31], s49 offen lds
    s_waitcnt lgkmcnt(8)
    v_mfma_f32_16x16x32_bf16 v[144:147], v[220:223], v[44:47], v[144:147]
    v_mfma_f32_16x16x32_bf16 v[148:151], v[220:223], v[116:119], v[148:151]
    ds_read_b64_tr_b16 v[220:221], v238 offset:128
    ds_read_b64_tr_b16 v[222:223], v238 offset:3200
    s_waitcnt lgkmcnt(8)
    v_mfma_f32_16x16x32_bf16 v[152:155], v[224:227], v[44:47], v[152:155]
    v_mfma_f32_16x16x32_bf16 v[156:159], v[224:227], v[116:119], v[156:159]
    ds_read_b64_tr_b16 v[224:225], v239 offset:128
    ds_read_b64_tr_b16 v[226:227], v239 offset:3200
    s_add_u32 m0, s55, 51200
    s_mov_b32 s49, 1880064
    buffer_load_dwordx4 v246, s[28:31], s49 offen lds
    s_waitcnt lgkmcnt(8)
    v_mfma_f32_16x16x32_bf16 v[160:163], v[228:231], v[44:47], v[160:163]
    v_mfma_f32_16x16x32_bf16 v[164:167], v[228:231], v[116:119], v[164:167]
    ds_read_b64_tr_b16 v[228:229], v236 offset:256
    ds_read_b64_tr_b16 v[230:231], v236 offset:3328
    buffer_load_dword v254, v255, s[16:19], 0 offen sc1
    s_waitcnt lgkmcnt(8)
    v_mfma_f32_16x16x32_bf16 v[168:171], v[232:235], v[44:47], v[168:171]
    v_mfma_f32_16x16x32_bf16 v[172:175], v[232:235], v[116:119], v[172:175]
    ds_read_b64_tr_b16 v[232:233], v237 offset:12416
    ds_read_b64_tr_b16 v[234:235], v237 offset:15488
    s_waitcnt vmcnt(4)
    s_barrier
    s_waitcnt lgkmcnt(8)
    v_mfma_f32_16x16x32_bf16 v[144:147], v[216:219], v[48:51], v[144:147]
    v_mfma_f32_16x16x32_bf16 v[148:151], v[216:219], v[120:123], v[148:151]
    ds_read_b64_tr_b16 v[216:217], v238 offset:12416
    ds_read_b64_tr_b16 v[218:219], v238 offset:15488
    s_waitcnt lgkmcnt(8)
    v_mfma_f32_16x16x32_bf16 v[152:155], v[220:223], v[48:51], v[152:155]
    v_mfma_f32_16x16x32_bf16 v[156:159], v[220:223], v[120:123], v[156:159]
    ds_read_b64_tr_b16 v[220:221], v239 offset:12416
    ds_read_b64_tr_b16 v[222:223], v239 offset:15488
    s_waitcnt lgkmcnt(8)
    v_mfma_f32_16x16x32_bf16 v[160:163], v[224:227], v[48:51], v[160:163]
    v_mfma_f32_16x16x32_bf16 v[164:167], v[224:227], v[120:123], v[164:167]
    ds_read_b64_tr_b16 v[224:225], v236 offset:12544
    ds_read_b64_tr_b16 v[226:227], v236 offset:15616
    s_waitcnt lgkmcnt(8)
    v_mfma_f32_16x16x32_bf16 v[168:171], v[228:231], v[48:51], v[168:171]
    v_mfma_f32_16x16x32_bf16 v[172:175], v[228:231], v[120:123], v[172:175]
    ds_read_b64_tr_b16 v[228:229], v237 offset:24704
    ds_read_b64_tr_b16 v[230:231], v237 offset:27776
    s_waitcnt lgkmcnt(8)
    v_mfma_f32_16x16x32_bf16 v[144:147], v[232:235], v[52:55], v[144:147]
    v_mfma_f32_16x16x32_bf16 v[148:151], v[232:235], v[124:127], v[148:151]
    ds_read_b64_tr_b16 v[232:233], v238 offset:24704
    ds_read_b64_tr_b16 v[234:235], v238 offset:27776
    s_waitcnt lgkmcnt(8)
    v_mfma_f32_16x16x32_bf16 v[152:155], v[216:219], v[52:55], v[152:155]
    v_mfma_f32_16x16x32_bf16 v[156:159], v[216:219], v[124:127], v[156:159]
    ds_read_b64_tr_b16 v[216:217], v239 offset:24704
    ds_read_b64_tr_b16 v[218:219], v239 offset:27776
    s_waitcnt lgkmcnt(8)
    v_mfma_f32_16x16x32_bf16 v[160:163], v[220:223], v[52:55], v[160:163]
    v_mfma_f32_16x16x32_bf16 v[164:167], v[220:223], v[124:127], v[164:167]
    ds_read_b64_tr_b16 v[220:221], v236 offset:24832
    ds_read_b64_tr_b16 v[222:223], v236 offset:27904
    s_waitcnt lgkmcnt(8)
    v_mfma_f32_16x16x32_bf16 v[168:171], v[224:227], v[52:55], v[168:171]
    v_mfma_f32_16x16x32_bf16 v[172:175], v[224:227], v[124:127], v[172:175]
    ds_read_b64_tr_b16 v[224:225], v237 offset:36992
    ds_read_b64_tr_b16 v[226:227], v237 offset:40064
    s_waitcnt vmcnt(1)
    s_barrier
    s_waitcnt lgkmcnt(8)
    v_mfma_f32_16x16x32_bf16 v[144:147], v[228:231], v[56:59], v[144:147]
    v_mfma_f32_16x16x32_bf16 v[148:151], v[228:231], v[128:131], v[148:151]
    ds_read_b64_tr_b16 v[228:229], v238 offset:36992
    ds_read_b64_tr_b16 v[230:231], v238 offset:40064
    s_waitcnt lgkmcnt(8)
    v_mfma_f32_16x16x32_bf16 v[152:155], v[232:235], v[56:59], v[152:155]
    v_mfma_f32_16x16x32_bf16 v[156:159], v[232:235], v[128:131], v[156:159]
    ds_read_b64_tr_b16 v[232:233], v239 offset:36992
    ds_read_b64_tr_b16 v[234:235], v239 offset:40064
    s_waitcnt lgkmcnt(8)
    v_mfma_f32_16x16x32_bf16 v[160:163], v[216:219], v[56:59], v[160:163]
    v_mfma_f32_16x16x32_bf16 v[164:167], v[216:219], v[128:131], v[164:167]
    ds_read_b64_tr_b16 v[216:217], v236 offset:37120
    ds_read_b64_tr_b16 v[218:219], v236 offset:40192
    s_waitcnt lgkmcnt(8)
    v_mfma_f32_16x16x32_bf16 v[168:171], v[220:223], v[56:59], v[168:171]
    v_mfma_f32_16x16x32_bf16 v[172:175], v[220:223], v[128:131], v[172:175]
    ds_read_b64_tr_b16 v[220:221], v241 offset:128
    ds_read_b64_tr_b16 v[222:223], v241 offset:3200
    s_waitcnt lgkmcnt(8)
    v_mfma_f32_16x16x32_bf16 v[144:147], v[224:227], v[60:63], v[144:147]
    v_mfma_f32_16x16x32_bf16 v[148:151], v[224:227], v[132:135], v[148:151]
    ds_read_b64_tr_b16 v[224:225], v242 offset:128
    ds_read_b64_tr_b16 v[226:227], v242 offset:3200
    s_waitcnt lgkmcnt(8)
    v_mfma_f32_16x16x32_bf16 v[152:155], v[228:231], v[60:63], v[152:155]
    v_mfma_f32_16x16x32_bf16 v[156:159], v[228:231], v[132:135], v[156:159]
    ds_read_b64_tr_b16 v[228:229], v243 offset:128
    ds_read_b64_tr_b16 v[230:231], v243 offset:3200
    s_waitcnt lgkmcnt(8)
    v_mfma_f32_16x16x32_bf16 v[160:163], v[232:235], v[60:63], v[160:163]
    v_mfma_f32_16x16x32_bf16 v[164:167], v[232:235], v[132:135], v[164:167]
    ds_read_b64_tr_b16 v[232:233], v240 offset:256
    ds_read_b64_tr_b16 v[234:235], v240 offset:3328
    s_waitcnt vmcnt(0)
    v_readfirstlane_b32 s46, v254
    s_mov_b32 s56, 0
    s_nop 2
    s_cmp_lt_u32 s46, 16
    s_cbranch_scc1 L_kv_late_c1
    s_mov_b32 s56, 1
    v_lshlrev_b32 v248, 2, v247
    s_mul_i32 s48, s40, 3072
    buffer_load_dword v184, v248, s[8:11], s48 offen offset:0 sc1
    buffer_load_dword v185, v248, s[8:11], s48 offen offset:256 sc1
    buffer_load_dword v186, v248, s[8:11], s48 offen offset:512 sc1
    buffer_load_dword v187, v248, s[8:11], s48 offen offset:768 sc1
    buffer_load_dword v188, v248, s[8:11], s48 offen offset:1024 sc1
    buffer_load_dword v189, v248, s[8:11], s48 offen offset:1280 sc1
    buffer_load_dword v190, v248, s[8:11], s48 offen offset:1536 sc1
    buffer_load_dword v191, v248, s[8:11], s48 offen offset:1792 sc1
    buffer_load_dword v192, v248, s[8:11], s48 offen offset:2048 sc1
    buffer_load_dword v193, v248, s[8:11], s48 offen offset:2304 sc1
    buffer_load_dword v194, v248, s[8:11], s48 offen offset:2560 sc1
    buffer_load_dword v195, v248, s[8:11], s48 offen offset:2816 sc1
    s_add_u32 s48, s40, 27
    s_lshl_b32 s48, s48, 10
    v_and_b32 v249, 0xc0, v248
    buffer_load_dword v196, v249, s[8:11], s48 offen offset:0 sc1
    buffer_load_dword v197, v249, s[8:11], s48 offen offset:256 sc1
    buffer_load_dword v198, v249, s[8:11], s48 offen offset:512 sc1
    buffer_load_dword v199, v249, s[8:11], s48 offen offset:768 sc1
L_kv_late_c1:
    s_waitcnt lgkmcnt(8)
    v_mfma_f32_16x16x32_bf16 v[168:171], v[216:219], v[60:63], v[168:171]
    v_mfma_f32_16x16x32_bf16 v[172:175], v[216:219], v[132:135], v[172:175]
    ds_read_b64_tr_b16 v[216:217], v241 offset:12416
    ds_read_b64_tr_b16 v[218:219], v241 offset:15488
    s_barrier
    s_waitcnt lgkmcnt(8)
    v_mfma_f32_16x16x32_bf16 v[144:147], v[220:223], v[64:67], v[144:147]
    v_mfma_f32_16x16x32_bf16 v[148:151], v[220:223], v[136:139], v[148:151]
    ds_read_b64_tr_b16 v[220:221], v242 offset:12416
    ds_read_b64_tr_b16 v[222:223], v242 offset:15488
    s_waitcnt lgkmcnt(8)
    v_mfma_f32_16x16x32_bf16 v[152:155], v[224:227], v[64:67], v[152:155]
    v_mfma_f32_16x16x32_bf16 v[156:159], v[224:227], v[136:139], v[156:159]
    ds_read_b64_tr_b16 v[224:225], v243 offset:12416
    ds_read_b64_tr_b16 v[226:227], v243 offset:15488
    s_waitcnt lgkmcnt(8)
    v_mfma_f32_16x16x32_bf16 v[160:163], v[228:231], v[64:67], v[160:163]
    v_mfma_f32_16x16x32_bf16 v[164:167], v[228:231], v[136:139], v[164:167]
    ds_read_b64_tr_b16 v[228:229], v240 offset:12544
    ds_read_b64_tr_b16 v[230:231], v240 offset:15616
    s_waitcnt lgkmcnt(8)
    v_mfma_f32_16x16x32_bf16 v[168:171], v[232:235], v[64:67], v[168:171]
    v_mfma_f32_16x16x32_bf16 v[172:175], v[232:235], v[136:139], v[172:175]
    s_waitcnt lgkmcnt(6)
    v_mfma_f32_16x16x32_bf16 v[144:147], v[216:219], v[68:71], v[144:147]
    v_mfma_f32_16x16x32_bf16 v[148:151], v[216:219], v[140:143], v[148:151]
    s_waitcnt lgkmcnt(4)
    v_mfma_f32_16x16x32_bf16 v[152:155], v[220:223], v[68:71], v[152:155]
    v_mfma_f32_16x16x32_bf16 v[156:159], v[220:223], v[140:143], v[156:159]
    s_waitcnt lgkmcnt(2)
    v_mfma_f32_16x16x32_bf16 v[160:163], v[224:227], v[68:71], v[160:163]
    v_mfma_f32_16x16x32_bf16 v[164:167], v[224:227], v[140:143], v[164:167]
    s_waitcnt lgkmcnt(0)
    v_mfma_f32_16x16x32_bf16 v[168:171], v[228:231], v[68:71], v[168:171]
    v_mfma_f32_16x16x32_bf16 v[172:175], v[228:231], v[140:143], v[172:175]
    s_and_b32 s47, s40, 3
    s_mul_i32 s46, s40, 18
    v_add_u32 v248, 0, v247
    v_mul_u32_u24 v249, 2731, v248
    v_lshrrev_b32 v249, 16, v249
    v_mul_u32_u24 v250, 24, v249
    v_sub_u32 v250, v248, v250
    v_lshrrev_b32 v251, 1, v249
    v_add_u32 v251, s47, v251
    v_and_b32 v251, 3, v251
    v_lshlrev_b32 v251, 1, v251
    v_xor_b32 v250, v250, v251
    v_add_u32 v249, s46, v249
    v_mul_u32_u24 v249, 1152, v249
    v_lshl_add_u32 v244, v250, 4, v249
    v_add_u32 v248, 64, v247
    v_mul_u32_u24 v249, 2731, v248
    v_lshrrev_b32 v249, 16, v249
    v_mul_u32_u24 v250, 24, v249
    v_sub_u32 v250, v248, v250
    v_lshrrev_b32 v251, 1, v249
    v_add_u32 v251, s47, v251
    v_and_b32 v251, 3, v251
    v_lshlrev_b32 v251, 1, v251
    v_xor_b32 v250, v250, v251
    v_add_u32 v249, s46, v249
    v_mul_u32_u24 v249, 1152, v249
    v_lshl_add_u32 v245, v250, 4, v249
    v_add_u32 v248, 128, v247
    v_mul_u32_u24 v249, 2731, v248
    v_lshrrev_b32 v249, 16, v249
    v_mul_u32_u24 v250, 24, v249
    v_sub_u32 v250, v248, v250
    v_lshrrev_b32 v251, 1, v249
    v_add_u32 v251, s47, v251
    v_and_b32 v251, 3, v251
    v_lshlrev_b32 v251, 1, v251
    v_xor_b32 v250, v250, v251
    v_add_u32 v249, s46, v249
    v_mul_u32_u24 v249, 1152, v249
    v_lshl_add_u32 v246, v250, 4, v249
    s_mul_i32 s55, s40, 6912
    s_waitcnt lgkmcnt(0)
    s_barrier
    s_cmp_eq_u32 s56, 1
    s_cbranch_scc1 L_kv_have_c1
    s_waitcnt vmcnt(0)
    buffer_load_dword v254, v255, s[16:19], 0 offen sc1
    s_waitcnt vmcnt(0)
    s_mov_b32 s47, 0
L_poll_7:
    v_readfirstlane_b32 s46, v254
    s_add_u32 s47, s47, 1
    s_nop 2
    s_cmp_ge_u32 s46, 16
    s_cbranch_scc1 L_pollok_8
    s_cmp_ge_u32 s47, 50000
    s_cbranch_scc1 L_pollok_8
    s_sleep 2
    buffer_load_dword v254, v255, s[16:19], 0 offen sc1
    s_waitcnt vmcnt(0)
    s_branch L_poll_7
L_pollok_8:
    v_lshlrev_b32 v248, 2, v247
    s_mul_i32 s48, s40, 3072
    buffer_load_dword v184, v248, s[8:11], s48 offen offset:0 sc1
    buffer_load_dword v185, v248, s[8:11], s48 offen offset:256 sc1
    buffer_load_dword v186, v248, s[8:11], s48 offen offset:512 sc1
    buffer_load_dword v187, v248, s[8:11], s48 offen offset:768 sc1
    buffer_load_dword v188, v248, s[8:11], s48 offen offset:1024 sc1
    buffer_load_dword v189, v248, s[8:11], s48 offen offset:1280 sc1
    buffer_load_dword v190, v248, s[8:11], s48 offen offset:1536 sc1
    buffer_load_dword v191, v248, s[8:11], s48 offen offset:1792 sc1
    buffer_load_dword v192, v248, s[8:11], s48 offen offset:2048 sc1
    buffer_load_dword v193, v248, s[8:11], s48 offen offset:2304 sc1
    buffer_load_dword v194, v248, s[8:11], s48 offen offset:2560 sc1
    buffer_load_dword v195, v248, s[8:11], s48 offen offset:2816 sc1
    s_add_u32 s48, s40, 27
    s_lshl_b32 s48, s48, 10
    v_and_b32 v249, 0xc0, v248
    buffer_load_dword v196, v249, s[8:11], s48 offen offset:0 sc1
    buffer_load_dword v197, v249, s[8:11], s48 offen offset:256 sc1
    buffer_load_dword v198, v249, s[8:11], s48 offen offset:512 sc1
    buffer_load_dword v199, v249, s[8:11], s48 offen offset:768 sc1
L_kv_have_c1:
    v_mul_f32 v216, s51, v252
    v_mul_f32 v217, s51, v253
    s_mul_i32 s46, s41, 9216
    s_add_u32 s46, s46, 98304
    v_lshl_add_u32 v249, v247, 3, s46
    v_mul_f32 v218, v144, v216
    v_mul_f32 v219, v145, v216
    v_mul_f32 v220, v146, v216
    v_mul_f32 v221, v147, v216
    v_mul_f32 v222, v148, v217
    v_mul_f32 v223, v149, v217
    v_mul_f32 v224, v150, v217
    v_mul_f32 v225, v151, v217
    v_min_f32 v218, 0, v218
    v_min_f32 v219, 0, v219
    v_min_f32 v220, 0, v220
    v_min_f32 v221, 0, v221
    v_min_f32 v222, 0, v222
    v_min_f32 v223, 0, v223
    v_min_f32 v224, 0, v224
    v_min_f32 v225, 0, v225
    v_exp_f32 v218, v218
    v_exp_f32 v219, v219
    v_exp_f32 v220, v220
    v_exp_f32 v221, v221
    v_exp_f32 v222, v222
    v_exp_f32 v223, v223
    v_exp_f32 v224, v224
    v_exp_f32 v225, v225
    v_max_f32 v144, 0, v144
    v_max_f32 v145, 0, v145
    v_max_f32 v146, 0, v146
    v_max_f32 v147, 0, v147
    v_max_f32 v148, 0, v148
    v_max_f32 v149, 0, v149
    v_max_f32 v150, 0, v150
    v_max_f32 v151, 0, v151
    v_add_f32 v218, 0x358637bd, v218
    v_add_f32 v219, 0x358637bd, v219
    v_add_f32 v220, 0x358637bd, v220
    v_add_f32 v221, 0x358637bd, v221
    v_add_f32 v222, 0x358637bd, v222
    v_add_f32 v223, 0x358637bd, v223
    v_add_f32 v224, 0x358637bd, v224
    v_add_f32 v225, 0x358637bd, v225
    v_fma_f32 v144, v144, v252, v218
    v_fma_f32 v145, v145, v252, v219
    v_fma_f32 v146, v146, v252, v220
    v_fma_f32 v147, v147, v252, v221
    v_fma_f32 v148, v148, v253, v222
    v_fma_f32 v149, v149, v253, v223
    v_fma_f32 v150, v150, v253, v224
    v_fma_f32 v151, v151, v253, v225
    v_cvt_pk_bf16_f32 v144, v144, v145
    v_cvt_pk_bf16_f32 v145, v146, v147
    ds_write_b64 v249, v[144:145] offset:2560
    v_cvt_pk_bf16_f32 v148, v148, v149
    v_cvt_pk_bf16_f32 v149, v150, v151
    ds_write_b64 v249, v[148:149] offset:7168
    s_add_u32 m0, s55, 0
    s_mov_b32 s49, 0
    buffer_load_dwordx4 v244, s[32:35], s49 offen lds
    s_add_u32 m0, s55, 1024
    s_mov_b32 s49, 0
    buffer_load_dwordx4 v245, s[32:35], s49 offen lds
    v_mul_f32 v218, v152, v216
    v_mul_f32 v219, v153, v216
    v_mul_f32 v220, v154, v216
    v_mul_f32 v221, v155, v216
    v_mul_f32 v222, v156, v217
    v_mul_f32 v223, v157, v217
    v_mul_f32 v224, v158, v217
    v_mul_f32 v225, v159, v217
    v_min_f32 v218, 0, v218
    v_min_f32 v219, 0, v219
    v_min_f32 v220, 0, v220
    v_min_f32 v221, 0, v221
    v_min_f32 v222, 0, v222
    v_min_f32 v223, 0, v223
    v_min_f32 v224, 0, v224
    v_min_f32 v225, 0, v225
    v_exp_f32 v218, v218
    v_exp_f32 v219, v219
    v_exp_f32 v220, v220
    v_exp_f32 v221, v221
    v_exp_f32 v222, v222
    v_exp_f32 v223, v223
    v_exp_f32 v224, v224
    v_exp_f32 v225, v225
    v_max_f32 v152, 0, v152
    v_max_f32 v153, 0, v153
    v_max_f32 v154, 0, v154
    v_max_f32 v155, 0, v155
    v_max_f32 v156, 0, v156
    v_max_f32 v157, 0, v157
    v_max_f32 v158, 0, v158
    v_max_f32 v159, 0, v159
    v_add_f32 v218, 0x358637bd, v218
    v_add_f32 v219, 0x358637bd, v219
    v_add_f32 v220, 0x358637bd, v220
    v_add_f32 v221, 0x358637bd, v221
    v_add_f32 v222, 0x358637bd, v222
    v_add_f32 v223, 0x358637bd, v223
    v_add_f32 v224, 0x358637bd, v224
    v_add_f32 v225, 0x358637bd, v225
    v_fma_f32 v152, v152, v252, v218
    v_fma_f32 v153, v153, v252, v219
    v_fma_f32 v154, v154, v252, v220
    v_fma_f32 v155, v155, v252, v221
    v_fma_f32 v156, v156, v253, v222
    v_fma_f32 v157, v157, v253, v223
    v_fma_f32 v158, v158, v253, v224
    v_fma_f32 v159, v159, v253, v225
    v_cvt_pk_bf16_f32 v152, v152, v153
    v_cvt_pk_bf16_f32 v153, v154, v155
    ds_write_b64 v249, v[152:153] offset:3072
    v_cvt_pk_bf16_f32 v156, v156, v157
    v_cvt_pk_bf16_f32 v157, v158, v159
    ds_write_b64 v249, v[156:157] offset:7680
    s_add_u32 m0, s55, 2048
    s_mov_b32 s49, 0
    buffer_load_dwordx4 v246, s[32:35], s49 offen lds
    s_add_u32 m0, s55, 3072
    s_mov_b32 s49, 9216
    buffer_load_dwordx4 v244, s[32:35], s49 offen lds
    v_mul_f32 v218, v160, v216
    v_mul_f32 v219, v161, v216
    v_mul_f32 v220, v162, v216
    v_mul_f32 v221, v163, v216
    v_mul_f32 v222, v164, v217
    v_mul_f32 v223, v165, v217
    v_mul_f32 v224, v166, v217
    v_mul_f32 v225, v167, v217
    v_min_f32 v218, 0, v218
    v_min_f32 v219, 0, v219
    v_min_f32 v220, 0, v220
    v_min_f32 v221, 0, v221
    v_min_f32 v222, 0, v222
    v_min_f32 v223, 0, v223
    v_min_f32 v224, 0, v224
    v_min_f32 v225, 0, v225
    v_exp_f32 v218, v218
    v_exp_f32 v219, v219
    v_exp_f32 v220, v220
    v_exp_f32 v221, v221
    v_exp_f32 v222, v222
    v_exp_f32 v223, v223
    v_exp_f32 v224, v224
    v_exp_f32 v225, v225
    v_max_f32 v160, 0, v160
    v_max_f32 v161, 0, v161
    v_max_f32 v162, 0, v162
    v_max_f32 v163, 0, v163
    v_max_f32 v164, 0, v164
    v_max_f32 v165, 0, v165
    v_max_f32 v166, 0, v166
    v_max_f32 v167, 0, v167
    v_add_f32 v218, 0x358637bd, v218
    v_add_f32 v219, 0x358637bd, v219
    v_add_f32 v220, 0x358637bd, v220
    v_add_f32 v221, 0x358637bd, v221
    v_add_f32 v222, 0x358637bd, v222
    v_add_f32 v223, 0x358637bd, v223
    v_add_f32 v224, 0x358637bd, v224
    v_add_f32 v225, 0x358637bd, v225
    v_fma_f32 v160, v160, v252, v218
    v_fma_f32 v161, v161, v252, v219
    v_fma_f32 v162, v162, v252, v220
    v_fma_f32 v163, v163, v252, v221
    v_fma_f32 v164, v164, v253, v222
    v_fma_f32 v165, v165, v253, v223
    v_fma_f32 v166, v166, v253, v224
    v_fma_f32 v167, v167, v253, v225
    v_cvt_pk_bf16_f32 v160, v160, v161
    v_cvt_pk_bf16_f32 v161, v162, v163
    ds_write_b64 v249, v[160:161] offset:3584
    v_cvt_pk_bf16_f32 v164, v164, v165
    v_cvt_pk_bf16_f32 v165, v166, v167
    ds_write_b64 v249, v[164:165] offset:8192
    s_add_u32 m0, s55, 4096
    s_mov_b32 s49, 9216
    buffer_load_dwordx4 v245, s[32:35], s49 offen lds
    s_add_u32 m0, s55, 5120
    s_mov_b32 s49, 9216
    buffer_load_dwordx4 v246, s[32:35], s49 offen lds
    v_mul_f32 v218, v168, v216
    v_mul_f32 v219, v169, v216
    v_mul_f32 v220, v170, v216
    v_mul_f32 v221, v171, v216
    v_mul_f32 v222, v172, v217
    v_mul_f32 v223, v173, v217
    v_mul_f32 v224, v174, v217
    v_mul_f32 v225, v175, v217
    v_min_f32 v218, 0, v218
    v_min_f32 v219, 0, v219
    v_min_f32 v220, 0, v220
    v_min_f32 v221, 0, v221
    v_min_f32 v222, 0, v222
    v_min_f32 v223, 0, v223
    v_min_f32 v224, 0, v224
    v_min_f32 v225, 0, v225
    v_exp_f32 v218, v218
    v_exp_f32 v219, v219
    v_exp_f32 v220, v220
    v_exp_f32 v221, v221
    v_exp_f32 v222, v222
    v_exp_f32 v223, v223
    v_exp_f32 v224, v224
    v_exp_f32 v225, v225
    v_max_f32 v168, 0, v168
    v_max_f32 v169, 0, v169
    v_max_f32 v170, 0, v170
    v_max_f32 v171, 0, v171
    v_max_f32 v172, 0, v172
    v_max_f32 v173, 0, v173
    v_max_f32 v174, 0, v174
    v_max_f32 v175, 0, v175
    v_add_f32 v218, 0x358637bd, v218
    v_add_f32 v219, 0x358637bd, v219
    v_add_f32 v220, 0x358637bd, v220
    v_add_f32 v221, 0x358637bd, v221
    v_add_f32 v222, 0x358637bd, v222
    v_add_f32 v223, 0x358637bd, v223
    v_add_f32 v224, 0x358637bd, v224
    v_add_f32 v225, 0x358637bd, v225
    v_fma_f32 v168, v168, v252, v218
    v_fma_f32 v169, v169, v252, v219
    v_fma_f32 v170, v170, v252, v220
    v_fma_f32 v171, v171, v252, v221
    v_fma_f32 v172, v172, v253, v222
    v_fma_f32 v173, v173, v253, v223
    v_fma_f32 v174, v174, v253, v224
    v_fma_f32 v175, v175, v253, v225
    v_cvt_pk_bf16_f32 v168, v168, v169
    v_cvt_pk_bf16_f32 v169, v170, v171
    ds_write_b64 v249, v[168:169] offset:4096
    v_cvt_pk_bf16_f32 v172, v172, v173
    v_cvt_pk_bf16_f32 v173, v174, v175
    ds_write_b64 v249, v[172:173] offset:8704
    s_mov_b32 exec_hi, 0xffff
    s_add_u32 m0, s55, 6144
    s_mov_b32 s49, 18432
    buffer_load_dwordx4 v244, s[32:35], s49 offen lds
    s_mov_b32 exec_hi, -1
    v_lshrrev_b32 v250, 4, v247
    v_lshlrev_b32 v250, 2, v250
    v_and_b32 v251, 15, v247
    s_waitcnt vmcnt(7)
    s_lshl_b32 s46, s40, 4
    v_add_u32 v24, s46, v250
    v_mul_u32_u24 v24, 3641, v24
    v_lshrrev_b32 v24, 16, v24
    v_add_u32 v25, s46, v250
    v_add_u32 v25, 1, v25
    v_mul_u32_u24 v25, 3641, v25
    v_lshrrev_b32 v25, 16, v25
    v_add_u32 v26, s46, v250
    v_add_u32 v26, 2, v26
    v_mul_u32_u24 v26, 3641, v26
    v_lshrrev_b32 v26, 16, v26
    v_add_u32 v27, s46, v250
    v_add_u32 v27, 3, v27
    v_mul_u32_u24 v27, 3641, v27
    v_lshrrev_b32 v27, 16, v27
    s_mul_i32 s46, s40, 1536
    s_add_u32 s46, s46, 135168
    v_lshl_add_u32 v30, v247, 3, s46
    s_add_u32 s46, s40, 15
    s_lshl_b32 s46, s46, 4
    s_sub_u32 s46, s46, 256
    v_add_u32 v28, s46, v251
    v_and_b32 v28, 0xff, v28
    v_mul_u32_u24 v28, 3641, v28
    v_lshrrev_b32 v28, 16, v28
    v_cmp_eq_u32 vcc, v24, v28
    s_nop 1
    v_cndmask_b32 v32, 0, v196, vcc
    v_cmp_eq_u32 vcc, v25, v28
    s_nop 1
    v_cndmask_b32 v33, 0, v197, vcc
    v_cmp_eq_u32 vcc, v26, v28
    s_nop 1
    v_cndmask_b32 v34, 0, v198, vcc
    v_cmp_eq_u32 vcc, v27, v28
    s_nop 1
    v_cndmask_b32 v35, 0, v199, vcc
    v_cvt_pk_bf16_f32 v36, v184, v185
    v_cvt_pk_bf16_f32 v37, v186, v187
    v_cvt_pk_bf16_f32 v38, v32, v33
    v_cvt_pk_bf16_f32 v39, v34, v35
    ds_write_b64 v30, v[36:37] offset:0
    ds_write_b64 v30, v[38:39] offset:13824
    s_nop 1
    s_add_u32 s46, s40, 16
    s_lshl_b32 s46, s46, 4
    s_sub_u32 s46, s46, 256
    v_add_u32 v28, s46, v251
    v_and_b32 v28, 0xff, v28
    v_mul_u32_u24 v28, 3641, v28
    v_lshrrev_b32 v28, 16, v28
    v_cmp_eq_u32 vcc, v24, v28
    s_nop 1
    v_cndmask_b32 v32, 0, v196, vcc
    v_cmp_eq_u32 vcc, v25, v28
    s_nop 1
    v_cndmask_b32 v33, 0, v197, vcc
    v_cmp_eq_u32 vcc, v26, v28
    s_nop 1
    v_cndmask_b32 v34, 0, v198, vcc
    v_cmp_eq_u32 vcc, v27, v28
    s_nop 1
    v_cndmask_b32 v35, 0, v199, vcc
    v_cvt_pk_bf16_f32 v36, v188, v189
    v_cvt_pk_bf16_f32 v37, v190, v191
    v_cvt_pk_bf16_f32 v38, v32, v33
    v_cvt_pk_bf16_f32 v39, v34, v35
    ds_write_b64 v30, v[36:37] offset:512
    ds_write_b64 v30, v[38:39] offset:14336
    s_nop 1
    s_add_u32 s46, s40, 17
    s_lshl_b32 s46, s46, 4
    s_sub_u32 s46, s46, 256
    v_add_u32 v28, s46, v251
    v_and_b32 v28, 0xff, v28
    v_mul_u32_u24 v28, 3641, v28
    v_lshrrev_b32 v28, 16, v28
    v_cmp_eq_u32 vcc, v24, v28
    s_nop 1
    v_cndmask_b32 v32, 0, v196, vcc
    v_cmp_eq_u32 vcc, v25, v28
    s_nop 1
    v_cndmask_b32 v33, 0, v197, vcc
    v_cmp_eq_u32 vcc, v26, v28
    s_nop 1
    v_cndmask_b32 v34, 0, v198, vcc
    v_cmp_eq_u32 vcc, v27, v28
    s_nop 1
    v_cndmask_b32 v35, 0, v199, vcc
    v_cvt_pk_bf16_f32 v36, v192, v193
    v_cvt_pk_bf16_f32 v37, v194, v195
    v_cvt_pk_bf16_f32 v38, v32, v33
    v_cvt_pk_bf16_f32 v39, v34, v35
    ds_write_b64 v30, v[36:37] offset:1024
    ds_write_b64 v30, v[38:39] offset:14848
    s_nop 1
    s_waitcnt lgkmcnt(0)
    s_barrier
    s_lshl_b32 s46, s41, 1
    s_add_u32 s46, s46, 1
    s_mul_i32 s46, s46, 4608
    s_add_u32 s46, s46, 98304
    v_lshl_add_u32 v248, v247, 3, s46
    ds_read_b64 v[40:41], v248 offset:0
    ds_read_b64 v[42:43], v248 offset:512
    ds_read_b64 v[44:45], v248 offset:1024
    ds_read_b64 v[46:47], v248 offset:1536
    ds_read_b64 v[48:49], v248 offset:2048
    ds_read_b64 v[50:51], v248 offset:2560
    ds_read_b64 v[52:53], v248 offset:3072
    ds_read_b64 v[54:55], v248 offset:3584
    ds_read_b64 v[56:57], v248 offset:4096
    v_lshlrev_b32 v249, 3, v247
    v_add_u32 v249, 135168, v249
    ds_read_b64 v[60:61], v249 offset:512
    ds_read_b64 v[66:67], v249 offset:14336
    ds_read_b64 v[62:63], v249 offset:1536
    ds_read_b64 v[68:69], v249 offset:15360
    ds_read_b64 v[72:73], v249 offset:1024
    ds_read_b64 v[78:79], v249 offset:14848
    ds_read_b64 v[74:75], v249 offset:2048
    ds_read_b64 v[80:81], v249 offset:15872
    ds_read_b64 v[76:77], v249 offset:3072
    ds_read_b64 v[82:83], v249 offset:16896
    s_waitcnt lgkmcnt(6)
    v_mfma_f32_16x16x16_bf16 v[84:87], v[60:61], v[40:41], 0
    v_mfma_f32_16x16x16_bf16 v[84:87], v[62:63], v[42:43], v[84:87]
    v_mfma_f32_16x16x16_bf16 v[120:123], v[66:67], v[40:41], 0
    v_mfma_f32_16x16x16_bf16 v[120:123], v[68:69], v[42:43], v[120:123]
    ds_read_b64 v[60:61], v249 offset:2560
    ds_read_b64 v[66:67], v249 offset:16384
    ds_read_b64 v[62:63], v249 offset:3584
    ds_read_b64 v[68:69], v249 offset:17408
    ds_read_b64 v[64:65], v249 offset:4608
    ds_read_b64 v[70:71], v249 offset:18432
    s_waitcnt lgkmcnt(6)
    v_mfma_f32_16x16x16_bf16 v[88:91], v[72:73], v[40:41], 0
    v_mfma_f32_16x16x16_bf16 v[88:91], v[74:75], v[42:43], v[88:91]
    v_mfma_f32_16x16x16_bf16 v[88:91], v[76:77], v[44:45], v[88:91]
    v_mfma_f32_16x16x16_bf16 v[124:127], v[78:79], v[40:41], 0
    v_mfma_f32_16x16x16_bf16 v[124:127], v[80:81], v[42:43], v[124:127]
    v_mfma_f32_16x16x16_bf16 v[124:127], v[82:83], v[44:45], v[124:127]
    ds_read_b64 v[72:73], v249 offset:4096
    ds_read_b64 v[78:79], v249 offset:17920
    ds_read_b64 v[74:75], v249 offset:5120
    ds_read_b64 v[80:81], v249 offset:18944
    ds_read_b64 v[76:77], v249 offset:6144
    ds_read_b64 v[82:83], v249 offset:19968
    s_waitcnt lgkmcnt(6)
    v_mfma_f32_16x16x16_bf16 v[92:95], v[60:61], v[42:43], 0
    v_mfma_f32_16x16x16_bf16 v[92:95], v[62:63], v[44:45], v[92:95]
    v_mfma_f32_16x16x16_bf16 v[92:95], v[64:65], v[46:47], v[92:95]
    v_mfma_f32_16x16x16_bf16 v[128:131], v[66:67], v[42:43], 0
    v_mfma_f32_16x16x16_bf16 v[128:131], v[68:69], v[44:45], v[128:131]
    v_mfma_f32_16x16x16_bf16 v[128:131], v[70:71], v[46:47], v[128:131]
    v_add_f32 v120, 0x358637bd, v120
    v_add_f32 v121, 0x358637bd, v121
    v_add_f32 v122, 0x358637bd, v122
    v_add_f32 v123, 0x358637bd, v123
    v_rcp_f32 v120, v120
    v_rcp_f32 v121, v121
    v_rcp_f32 v122, v122
    v_rcp_f32 v123, v123
    ds_read_b64 v[60:61], v249 offset:5632
    ds_read_b64 v[66:67], v249 offset:19456
    ds_read_b64 v[62:63], v249 offset:6656
    ds_read_b64 v[68:69], v249 offset:20480
    ds_read_b64 v[64:65], v249 offset:7680
    ds_read_b64 v[70:71], v249 offset:21504
    s_waitcnt lgkmcnt(6)
    v_mfma_f32_16x16x16_bf16 v[96:99], v[72:73], v[44:45], 0
    v_mfma_f32_16x16x16_bf16 v[96:99], v[74:75], v[46:47], v[96:99]
    v_mfma_f32_16x16x16_bf16 v[96:99], v[76:77], v[48:49], v[96:99]
    v_mfma_f32_16x16x16_bf16 v[132:135], v[78:79], v[44:45], 0
    v_mfma_f32_16x16x16_bf16 v[132:135], v[80:81], v[46:47], v[132:135]
    v_mfma_f32_16x16x16_bf16 v[132:135], v[82:83], v[48:49], v[132:135]
    v_add_f32 v124, 0x358637bd, v124
    v_add_f32 v125, 0x358637bd, v125
    v_add_f32 v126, 0x358637bd, v126
    v_add_f32 v127, 0x358637bd, v127
    v_rcp_f32 v124, v124
    v_rcp_f32 v125, v125
    v_rcp_f32 v126, v126
    v_rcp_f32 v127, v127
    ds_read_b64 v[72:73], v249 offset:7168
    ds_read_b64 v[78:79], v249 offset:20992
    ds_read_b64 v[74:75], v249 offset:8192
    ds_read_b64 v[80:81], v249 offset:22016
    ds_read_b64 v[76:77], v249 offset:9216
    ds_read_b64 v[82:83], v249 offset:23040
    s_waitcnt lgkmcnt(6)
    v_mfma_f32_16x16x16_bf16 v[100:103], v[60:61], v[46:47], 0
    v_mfma_f32_16x16x16_bf16 v[100:103], v[62:63], v[48:49], v[100:103]
    v_mfma_f32_16x16x16_bf16 v[100:103], v[64:65], v[50:51], v[100:103]
    v_mfma_f32_16x16x16_bf16 v[136:139], v[66:67], v[46:47], 0
    v_mfma_f32_16x16x16_bf16 v[136:139], v[68:69], v[48:49], v[136:139]
    v_mfma_f32_16x16x16_bf16 v[136:139], v[70:71], v[50:51], v[136:139]
    v_add_f32 v128, 0x358637bd, v128
    v_add_f32 v129, 0x358637bd, v129
    v_add_f32 v130, 0x358637bd, v130
    v_add_f32 v131, 0x358637bd, v131
    v_rcp_f32 v128, v128
    v_rcp_f32 v129, v129
    v_rcp_f32 v130, v130
    v_rcp_f32 v131, v131
    ds_read_b64 v[60:61], v249 offset:8704
    ds_read_b64 v[66:67], v249 offset:22528
    ds_read_b64 v[62:63], v249 offset:9728
    ds_read_b64 v[68:69], v249 offset:23552
    ds_read_b64 v[64:65], v249 offset:10752
    ds_read_b64 v[70:71], v249 offset:24576
    s_waitcnt lgkmcnt(6)
    v_mfma_f32_16x16x16_bf16 v[104:107], v[72:73], v[48:49], 0
    v_mfma_f32_16x16x16_bf16 v[104:107], v[74:75], v[50:51], v[104:107]
    v_mfma_f32_16x16x16_bf16 v[104:107], v[76:77], v[52:53], v[104:107]
    v_mfma_f32_16x16x16_bf16 v[140:143], v[78:79], v[48:49], 0
    v_mfma_f32_16x16x16_bf16 v[140:143], v[80:81], v[50:51], v[140:143]
    v_mfma_f32_16x16x16_bf16 v[140:143], v[82:83], v[52:53], v[140:143]
    v_add_f32 v132, 0x358637bd, v132
    v_add_f32 v133, 0x358637bd, v133
    v_add_f32 v134, 0x358637bd, v134
    v_add_f32 v135, 0x358637bd, v135
    v_rcp_f32 v132, v132
    v_rcp_f32 v133, v133
    v_rcp_f32 v134, v134
    v_rcp_f32 v135, v135
    ds_read_b64 v[72:73], v249 offset:10240
    ds_read_b64 v[78:79], v249 offset:24064
    ds_read_b64 v[74:75], v249 offset:11264
    ds_read_b64 v[80:81], v249 offset:25088
    ds_read_b64 v[76:77], v249 offset:12288
    ds_read_b64 v[82:83], v249 offset:26112
    s_waitcnt lgkmcnt(6)
    v_mfma_f32_16x16x16_bf16 v[108:111], v[60:61], v[50:51], 0
    v_mfma_f32_16x16x16_bf16 v[108:111], v[62:63], v[52:53], v[108:111]
    v_mfma_f32_16x16x16_bf16 v[108:111], v[64:65], v[54:55], v[108:111]
    v_mfma_f32_16x16x16_bf16 v[144:147], v[66:67], v[50:51], 0
    v_mfma_f32_16x16x16_bf16 v[144:147], v[68:69], v[52:53], v[144:147]
    v_mfma_f32_16x16x16_bf16 v[144:147], v[70:71], v[54:55], v[144:147]
    v_add_f32 v136, 0x358637bd, v136
    v_add_f32 v137, 0x358637bd, v137
    v_add_f32 v138, 0x358637bd, v138
    v_add_f32 v139, 0x358637bd, v139
    v_rcp_f32 v136, v136
    v_rcp_f32 v137, v137
    v_rcp_f32 v138, v138
    v_rcp_f32 v139, v139
    ds_read_b64 v[60:61], v249 offset:11776
    ds_read_b64 v[66:67], v249 offset:25600
    ds_read_b64 v[62:63], v249 offset:12800
    ds_read_b64 v[68:69], v249 offset:26624
    s_waitcnt lgkmcnt(4)
    v_mfma_f32_16x16x16_bf16 v[112:115], v[72:73], v[52:53], 0
    v_mfma_f32_16x16x16_bf16 v[112:115], v[74:75], v[54:55], v[112:115]
    v_mfma_f32_16x16x16_bf16 v[112:115], v[76:77], v[56:57], v[112:115]
    v_mfma_f32_16x16x16_bf16 v[148:151], v[78:79], v[52:53], 0
    v_mfma_f32_16x16x16_bf16 v[148:151], v[80:81], v[54:55], v[148:151]
    v_mfma_f32_16x16x16_bf16 v[148:151], v[82:83], v[56:57], v[148:151]
    v_add_f32 v140, 0x358637bd, v140
    v_add_f32 v141, 0x358637bd, v141
    v_add_f32 v142, 0x358637bd, v142
    v_add_f32 v143, 0x358637bd, v143
    v_rcp_f32 v140, v140
    v_rcp_f32 v141, v141
    v_rcp_f32 v142, v142
    v_rcp_f32 v143, v143
    s_waitcnt lgkmcnt(0)
    v_mfma_f32_16x16x16_bf16 v[116:119], v[60:61], v[54:55], 0
    v_mfma_f32_16x16x16_bf16 v[116:119], v[62:63], v[56:57], v[116:119]
    v_mfma_f32_16x16x16_bf16 v[152:155], v[66:67], v[54:55], 0
    v_mfma_f32_16x16x16_bf16 v[152:155], v[68:69], v[56:57], v[152:155]
    v_add_f32 v144, 0x358637bd, v144
    v_add_f32 v145, 0x358637bd, v145
    v_add_f32 v146, 0x358637bd, v146
    v_add_f32 v147, 0x358637bd, v147
    v_rcp_f32 v144, v144
    v_rcp_f32 v145, v145
    v_rcp_f32 v146, v146
    v_rcp_f32 v147, v147
    s_nop 7
    s_nop 3
    v_add_f32 v148, 0x358637bd, v148
    v_add_f32 v149, 0x358637bd, v149
    v_add_f32 v150, 0x358637bd, v150
    v_add_f32 v151, 0x358637bd, v151
    v_rcp_f32 v148, v148
    v_rcp_f32 v149, v149
    v_rcp_f32 v150, v150
    v_rcp_f32 v151, v151
    v_add_f32 v152, 0x358637bd, v152
    v_add_f32 v153, 0x358637bd, v153
    v_add_f32 v154, 0x358637bd, v154
    v_add_f32 v155, 0x358637bd, v155
    v_rcp_f32 v152, v152
    v_rcp_f32 v153, v153
    v_rcp_f32 v154, v154
    v_rcp_f32 v155, v155
    s_nop 0
    v_mul_f32 v84, v84, v120
    v_mul_f32 v85, v85, v121
    v_mul_f32 v86, v86, v122
    v_mul_f32 v87, v87, v123
    v_cvt_pk_bf16_f32 v156, v84, v85
    v_cvt_pk_bf16_f32 v157, v86, v87
    ds_write_b64 v248, v[156:157] offset:0
    v_mul_f32 v88, v88, v124
    v_mul_f32 v89, v89, v125
    v_mul_f32 v90, v90, v126
    v_mul_f32 v91, v91, v127
    v_cvt_pk_bf16_f32 v158, v88, v89
    v_cvt_pk_bf16_f32 v159, v90, v91
    ds_write_b64 v248, v[158:159] offset:512
    v_mul_f32 v92, v92, v128
    v_mul_f32 v93, v93, v129
    v_mul_f32 v94, v94, v130
    v_mul_f32 v95, v95, v131
    v_cvt_pk_bf16_f32 v160, v92, v93
    v_cvt_pk_bf16_f32 v161, v94, v95
    ds_write_b64 v248, v[160:161] offset:1024
    v_mul_f32 v96, v96, v132
    v_mul_f32 v97, v97, v133
    v_mul_f32 v98, v98, v134
    v_mul_f32 v99, v99, v135
    v_cvt_pk_bf16_f32 v162, v96, v97
    v_cvt_pk_bf16_f32 v163, v98, v99
    ds_write_b64 v248, v[162:163] offset:1536
    v_mul_f32 v100, v100, v136
    v_mul_f32 v101, v101, v137
    v_mul_f32 v102, v102, v138
    v_mul_f32 v103, v103, v139
    v_cvt_pk_bf16_f32 v164, v100, v101
    v_cvt_pk_bf16_f32 v165, v102, v103
    ds_write_b64 v248, v[164:165] offset:2048
    v_mul_f32 v104, v104, v140
    v_mul_f32 v105, v105, v141
    v_mul_f32 v106, v106, v142
    v_mul_f32 v107, v107, v143
    v_cvt_pk_bf16_f32 v166, v104, v105
    v_cvt_pk_bf16_f32 v167, v106, v107
    ds_write_b64 v248, v[166:167] offset:2560
    v_mul_f32 v108, v108, v144
    v_mul_f32 v109, v109, v145
    v_mul_f32 v110, v110, v146
    v_mul_f32 v111, v111, v147
    v_cvt_pk_bf16_f32 v168, v108, v109
    v_cvt_pk_bf16_f32 v169, v110, v111
    ds_write_b64 v248, v[168:169] offset:3072
    v_mul_f32 v112, v112, v148
    v_mul_f32 v113, v113, v149
    v_mul_f32 v114, v114, v150
    v_mul_f32 v115, v115, v151
    v_cvt_pk_bf16_f32 v170, v112, v113
    v_cvt_pk_bf16_f32 v171, v114, v115
    ds_write_b64 v248, v[170:171] offset:3584
    v_mul_f32 v116, v116, v152
    v_mul_f32 v117, v117, v153
    v_mul_f32 v118, v118, v154
    v_mul_f32 v119, v119, v155
    v_cvt_pk_bf16_f32 v172, v116, v117
    v_cvt_pk_bf16_f32 v173, v118, v119
    ds_write_b64 v248, v[172:173] offset:4096
    v_lshrrev_b32 v249, 4, v247
    v_lshlrev_b32 v249, 2, v249
    v_lshrrev_b32 v250, 2, v247
    v_and_b32 v250, 3, v250
    v_add_u32 v249, v249, v250
    v_and_b32 v251, 6, v249
    v_mul_u32_u24 v249, 384, v249
    v_and_b32 v250, 3, v247
    v_lshl_add_u32 v249, v250, 3, v249
    s_waitcnt vmcnt(0) lgkmcnt(0)
    s_barrier
    s_mul_i32 s46, s41, 9216
    s_add_u32 s46, s46, 98304
    v_lshl_add_u32 v248, v247, 3, s46
    ds_read_b64 v[0:1], v248 offset:0
    ds_read_b64 v[2:3], v248 offset:512
    ds_read_b64 v[4:5], v248 offset:1024
    ds_read_b64 v[6:7], v248 offset:1536
    ds_read_b64 v[8:9], v248 offset:2048
    ds_read_b64 v[10:11], v248 offset:2560
    ds_read_b64 v[12:13], v248 offset:3072
    ds_read_b64 v[14:15], v248 offset:3584
    ds_read_b64 v[16:17], v248 offset:4096
    ds_read_b64 v[20:21], v248 offset:4608
    ds_read_b64 v[22:23], v248 offset:5120
    ds_read_b64 v[24:25], v248 offset:5632
    ds_read_b64 v[26:27], v248 offset:6144
    ds_read_b64 v[28:29], v248 offset:6656
    ds_read_b64 v[30:31], v248 offset:7168
    ds_read_b64 v[32:33], v248 offset:7680
    ds_read_b64 v[34:35], v248 offset:8192
    ds_read_b64 v[36:37], v248 offset:8704
    v_xor_b32 v250, 0, v251
    v_lshl_add_u32 v40, v250, 4, v249
    v_add_u32 v44, 55296, v40
    v_xor_b32 v250, 2, v251
    v_lshl_add_u32 v41, v250, 4, v249
    v_add_u32 v45, 55296, v41
    v_xor_b32 v250, 4, v251
    v_lshl_add_u32 v42, v250, 4, v249
    v_add_u32 v46, 55296, v42
    v_xor_b32 v250, 6, v251
    v_lshl_add_u32 v43, v250, 4, v249
    v_add_u32 v47, 55296, v43
    v_and_b32 v249, 15, v247
    v_lshrrev_b32 v250, 5, v247
    v_lshl_add_u32 v249, v250, 4, v249
    v_lshrrev_b32 v250, 4, v247
    v_and_b32 v250, 1, v250
    v_lshl_add_u32 v249, v250, 5, v249
    s_mul_i32 s46, s41, 36864
    v_lshl_add_u32 v48, v249, 4, s46
    ds_read_b64_tr_b16 v[52:53], v42 offset:128
    ds_read_b64_tr_b16 v[54:55], v42 offset:6272
    ds_read_b64_tr_b16 v[56:57], v42 offset:12416
    ds_read_b64_tr_b16 v[58:59], v42 offset:18560
    ds_read_b64_tr_b16 v[60:61], v42 offset:24704
    ds_read_b64_tr_b16 v[62:63], v42 offset:30848
    ds_read_b64_tr_b16 v[64:65], v42 offset:36992
    ds_read_b64_tr_b16 v[66:67], v42 offset:43136
    ds_read_b64_tr_b16 v[68:69], v42 offset:49280
    s_waitcnt lgkmcnt(9)
    s_barrier
    s_add_u32 m0, s55, 55296
    s_mov_b32 s49, 384
    buffer_load_dwordx4 v244, s[32:35], s49 offen lds
    s_add_u32 m0, s55, 56320
    s_mov_b32 s49, 384
    buffer_load_dwordx4 v245, s[32:35], s49 offen lds
    s_add_u32 m0, s55, 57344
    s_mov_b32 s49, 384
    buffer_load_dwordx4 v246, s[32:35], s49 offen lds
    s_add_u32 m0, s55, 58368
    s_mov_b32 s49, 9600
    buffer_load_dwordx4 v244, s[32:35], s49 offen lds
    s_add_u32 m0, s55, 59392
    s_mov_b32 s49, 9600
    buffer_load_dwordx4 v245, s[32:35], s49 offen lds
    s_add_u32 m0, s55, 60416
    s_mov_b32 s49, 9600
    buffer_load_dwordx4 v246, s[32:35], s49 offen lds
    s_mov_b32 exec_hi, 0xffff
    s_add_u32 m0, s55, 61440
    s_mov_b32 s49, 18816
    buffer_load_dwordx4 v244, s[32:35], s49 offen lds
    s_mov_b32 exec_hi, -1
    s_waitcnt lgkmcnt(0)
    v_mfma_f32_16x16x32_bf16 v[108:111], v[52:55], v[0:3], 0
    v_mfma_f32_16x16x32_bf16 v[108:111], v[56:59], v[4:7], v[108:111]
    ds_read_b64_tr_b16 v[70:71], v43 offset:128
    ds_read_b64_tr_b16 v[72:73], v43 offset:6272
    ds_read_b64_tr_b16 v[74:75], v43 offset:12416
    ds_read_b64_tr_b16 v[76:77], v43 offset:18560
    ds_read_b64_tr_b16 v[78:79], v43 offset:24704
    v_mfma_f32_16x16x32_bf16 v[108:111], v[60:63], v[8:11], v[108:111]
    v_mfma_f32_16x16x32_bf16 v[108:111], v[64:67], v[12:15], v[108:111]
    v_mfma_f32_16x16x32_bf16 v[112:115], v[52:55], v[20:23], 0
    v_mfma_f32_16x16x32_bf16 v[112:115], v[56:59], v[24:27], v[112:115]
    ds_read_b64_tr_b16 v[80:81], v43 offset:30848
    ds_read_b64_tr_b16 v[82:83], v43 offset:36992
    ds_read_b64_tr_b16 v[84:85], v43 offset:43136
    ds_read_b64_tr_b16 v[86:87], v43 offset:49280
    v_mfma_f32_16x16x32_bf16 v[112:115], v[60:63], v[28:31], v[112:115]
    v_mfma_f32_16x16x32_bf16 v[112:115], v[64:67], v[32:35], v[112:115]
    s_nop 1
    v_mfma_f32_16x16x16_bf16 v[108:111], v[68:69], v[16:17], v[108:111]
    v_mfma_f32_16x16x16_bf16 v[112:115], v[68:69], v[36:37], v[112:115]
    s_waitcnt lgkmcnt(0)
    v_mfma_f32_16x16x32_bf16 v[116:119], v[70:73], v[0:3], 0
    v_mfma_f32_16x16x32_bf16 v[116:119], v[74:77], v[4:7], v[116:119]
    ds_read_b64_tr_b16 v[88:89], v40 offset:256
    ds_read_b64_tr_b16 v[90:91], v40 offset:6400
    ds_read_b64_tr_b16 v[92:93], v40 offset:12544
    ds_read_b64_tr_b16 v[94:95], v40 offset:18688
    ds_read_b64_tr_b16 v[96:97], v40 offset:24832
    v_mfma_f32_16x16x32_bf16 v[116:119], v[78:81], v[8:11], v[116:119]
    v_mfma_f32_16x16x32_bf16 v[116:119], v[82:85], v[12:15], v[116:119]
    v_mfma_f32_16x16x32_bf16 v[120:123], v[70:73], v[20:23], 0
    v_mfma_f32_16x16x32_bf16 v[120:123], v[74:77], v[24:27], v[120:123]
    ds_read_b64_tr_b16 v[98:99], v40 offset:30976
    ds_read_b64_tr_b16 v[100:101], v40 offset:37120
    ds_read_b64_tr_b16 v[102:103], v40 offset:43264
    ds_read_b64_tr_b16 v[104:105], v40 offset:49408
    v_mfma_f32_16x16x32_bf16 v[120:123], v[78:81], v[28:31], v[120:123]
    v_mfma_f32_16x16x32_bf16 v[120:123], v[82:85], v[32:35], v[120:123]
    s_nop 1
    v_mfma_f32_16x16x16_bf16 v[116:119], v[86:87], v[16:17], v[116:119]
    v_mfma_f32_16x16x16_bf16 v[120:123], v[86:87], v[36:37], v[120:123]
    v_cvt_pk_bf16_f32 v124, v108, v109
    v_cvt_pk_bf16_f32 v125, v110, v111
    v_cvt_pk_bf16_f32 v126, v112, v113
    v_cvt_pk_bf16_f32 v127, v114, v115
    s_mov_b32 s48, 6144
    s_nop 0
    v_permlane32_swap_b32 v124, v126
    v_permlane32_swap_b32 v125, v127
    s_nop 0
    buffer_store_dwordx4 v[124:127], v48, s[36:39], s48 offen sc0 sc1
    s_waitcnt lgkmcnt(0)
    v_mfma_f32_16x16x32_bf16 v[108:111], v[88:91], v[0:3], 0
    v_mfma_f32_16x16x32_bf16 v[108:111], v[92:95], v[4:7], v[108:111]
    ds_read_b64_tr_b16 v[52:53], v41 offset:256
    ds_read_b64_tr_b16 v[54:55], v41 offset:6400
    ds_read_b64_tr_b16 v[56:57], v41 offset:12544
    ds_read_b64_tr_b16 v[58:59], v41 offset:18688
    ds_read_b64_tr_b16 v[60:61], v41 offset:24832
    v_mfma_f32_16x16x32_bf16 v[108:111], v[96:99], v[8:11], v[108:111]
    v_mfma_f32_16x16x32_bf16 v[108:111], v[100:103], v[12:15], v[108:111]
    v_mfma_f32_16x16x32_bf16 v[112:115], v[88:91], v[20:23], 0
    v_mfma_f32_16x16x32_bf16 v[112:115], v[92:95], v[24:27], v[112:115]
    ds_read_b64_tr_b16 v[62:63], v41 offset:30976
    ds_read_b64_tr_b16 v[64:65], v41 offset:37120
    ds_read_b64_tr_b16 v[66:67], v41 offset:43264
    ds_read_b64_tr_b16 v[68:69], v41 offset:49408
    v_mfma_f32_16x16x32_bf16 v[112:115], v[96:99], v[28:31], v[112:115]
    v_mfma_f32_16x16x32_bf16 v[112:115], v[100:103], v[32:35], v[112:115]
    s_nop 1
    v_mfma_f32_16x16x16_bf16 v[108:111], v[104:105], v[16:17], v[108:111]
    v_mfma_f32_16x16x16_bf16 v[112:115], v[104:105], v[36:37], v[112:115]
    v_cvt_pk_bf16_f32 v128, v116, v117
    v_cvt_pk_bf16_f32 v129, v118, v119
    v_cvt_pk_bf16_f32 v130, v120, v121
    v_cvt_pk_bf16_f32 v131, v122, v123
    s_mov_b32 s48, 7168
    s_nop 0
    v_permlane32_swap_b32 v128, v130
    v_permlane32_swap_b32 v129, v131
    s_nop 0
    buffer_store_dwordx4 v[128:131], v48, s[36:39], s48 offen sc0 sc1
    s_waitcnt lgkmcnt(0)
    v_mfma_f32_16x16x32_bf16 v[116:119], v[52:55], v[0:3], 0
    v_mfma_f32_16x16x32_bf16 v[116:119], v[56:59], v[4:7], v[116:119]
    ds_read_b64_tr_b16 v[70:71], v42 offset:256
    ds_read_b64_tr_b16 v[72:73], v42 offset:6400
    ds_read_b64_tr_b16 v[74:75], v42 offset:12544
    ds_read_b64_tr_b16 v[76:77], v42 offset:18688
    ds_read_b64_tr_b16 v[78:79], v42 offset:24832
    v_mfma_f32_16x16x32_bf16 v[116:119], v[60:63], v[8:11], v[116:119]
    v_mfma_f32_16x16x32_bf16 v[116:119], v[64:67], v[12:15], v[116:119]
    v_mfma_f32_16x16x32_bf16 v[120:123], v[52:55], v[20:23], 0
    v_mfma_f32_16x16x32_bf16 v[120:123], v[56:59], v[24:27], v[120:123]
    ds_read_b64_tr_b16 v[80:81], v42 offset:30976
    ds_read_b64_tr_b16 v[82:83], v42 offset:37120
    ds_read_b64_tr_b16 v[84:85], v42 offset:43264
    ds_read_b64_tr_b16 v[86:87], v42 offset:49408
    v_mfma_f32_16x16x32_bf16 v[120:123], v[60:63], v[28:31], v[120:123]
    v_mfma_f32_16x16x32_bf16 v[120:123], v[64:67], v[32:35], v[120:123]
    s_nop 1
    v_mfma_f32_16x16x16_bf16 v[116:119], v[68:69], v[16:17], v[116:119]
    v_mfma_f32_16x16x16_bf16 v[120:123], v[68:69], v[36:37], v[120:123]
    v_cvt_pk_bf16_f32 v124, v108, v109
    v_cvt_pk_bf16_f32 v125, v110, v111
    v_cvt_pk_bf16_f32 v126, v112, v113
    v_cvt_pk_bf16_f32 v127, v114, v115
    s_mov_b32 s48, 8192
    s_nop 0
    v_permlane32_swap_b32 v124, v126
    v_permlane32_swap_b32 v125, v127
    s_nop 0
    buffer_store_dwordx4 v[124:127], v48, s[36:39], s48 offen sc0 sc1
    s_waitcnt lgkmcnt(0)
    v_mfma_f32_16x16x32_bf16 v[108:111], v[70:73], v[0:3], 0
    v_mfma_f32_16x16x32_bf16 v[108:111], v[74:77], v[4:7], v[108:111]
    ds_read_b64_tr_b16 v[88:89], v43 offset:256
    ds_read_b64_tr_b16 v[90:91], v43 offset:6400
    ds_read_b64_tr_b16 v[92:93], v43 offset:12544
    ds_read_b64_tr_b16 v[94:95], v43 offset:18688
    ds_read_b64_tr_b16 v[96:97], v43 offset:24832
    v_mfma_f32_16x16x32_bf16 v[108:111], v[78:81], v[8:11], v[108:111]
    v_mfma_f32_16x16x32_bf16 v[108:111], v[82:85], v[12:15], v[108:111]
    v_mfma_f32_16x16x32_bf16 v[112:115], v[70:73], v[20:23], 0
    v_mfma_f32_16x16x32_bf16 v[112:115], v[74:77], v[24:27], v[112:115]
    ds_read_b64_tr_b16 v[98:99], v43 offset:30976
    ds_read_b64_tr_b16 v[100:101], v43 offset:37120
    ds_read_b64_tr_b16 v[102:103], v43 offset:43264
    ds_read_b64_tr_b16 v[104:105], v43 offset:49408
    v_mfma_f32_16x16x32_bf16 v[112:115], v[78:81], v[28:31], v[112:115]
    v_mfma_f32_16x16x32_bf16 v[112:115], v[82:85], v[32:35], v[112:115]
    s_nop 1
    v_mfma_f32_16x16x16_bf16 v[108:111], v[86:87], v[16:17], v[108:111]
    v_mfma_f32_16x16x16_bf16 v[112:115], v[86:87], v[36:37], v[112:115]
    v_cvt_pk_bf16_f32 v128, v116, v117
    v_cvt_pk_bf16_f32 v129, v118, v119
    v_cvt_pk_bf16_f32 v130, v120, v121
    v_cvt_pk_bf16_f32 v131, v122, v123
    s_mov_b32 s48, 9216
    s_nop 0
    v_permlane32_swap_b32 v128, v130
    v_permlane32_swap_b32 v129, v131
    s_nop 0
    buffer_store_dwordx4 v[128:131], v48, s[36:39], s48 offen sc0 sc1
    s_waitcnt vmcnt(4) lgkmcnt(0)
    s_barrier
    s_add_u32 m0, s55, 0
    s_mov_b32 s49, 768
    buffer_load_dwordx4 v244, s[32:35], s49 offen lds
    s_add_u32 m0, s55, 1024
    s_mov_b32 s49, 768
    buffer_load_dwordx4 v245, s[32:35], s49 offen lds
    s_add_u32 m0, s55, 2048
    s_mov_b32 s49, 768
    buffer_load_dwordx4 v246, s[32:35], s49 offen lds
    s_add_u32 m0, s55, 3072
    s_mov_b32 s49, 9984
    buffer_load_dwordx4 v244, s[32:35], s49 offen lds
    s_add_u32 m0, s55, 4096
    s_mov_b32 s49, 9984
    buffer_load_dwordx4 v245, s[32:35], s49 offen lds
    s_add_u32 m0, s55, 5120
    s_mov_b32 s49, 9984
    buffer_load_dwordx4 v246, s[32:35], s49 offen lds
    s_mov_b32 exec_hi, 0xffff
    s_add_u32 m0, s55, 6144
    s_mov_b32 s49, 19200
    buffer_load_dwordx4 v244, s[32:35], s49 offen lds
    s_mov_b32 exec_hi, -1
    v_mfma_f32_16x16x32_bf16 v[116:119], v[88:91], v[0:3], 0
    v_mfma_f32_16x16x32_bf16 v[116:119], v[92:95], v[4:7], v[116:119]
    ds_read_b64_tr_b16 v[52:53], v46 offset:128
    ds_read_b64_tr_b16 v[54:55], v46 offset:6272
    ds_read_b64_tr_b16 v[56:57], v46 offset:12416
    ds_read_b64_tr_b16 v[58:59], v46 offset:18560
    ds_read_b64_tr_b16 v[60:61], v46 offset:24704
    v_mfma_f32_16x16x32_bf16 v[116:119], v[96:99], v[8:11], v[116:119]
    v_mfma_f32_16x16x32_bf16 v[116:119], v[100:103], v[12:15], v[116:119]
    v_mfma_f32_16x16x32_bf16 v[120:123], v[88:91], v[20:23], 0
    v_mfma_f32_16x16x32_bf16 v[120:123], v[92:95], v[24:27], v[120:123]
    ds_read_b64_tr_b16 v[62:63], v46 offset:30848
    ds_read_b64_tr_b16 v[64:65], v46 offset:36992
    ds_read_b64_tr_b16 v[66:67], v46 offset:43136
    ds_read_b64_tr_b16 v[68:69], v46 offset:49280
    v_mfma_f32_16x16x32_bf16 v[120:123], v[96:99], v[28:31], v[120:123]
    v_mfma_f32_16x16x32_bf16 v[120:123], v[100:103], v[32:35], v[120:123]
    s_nop 1
    v_mfma_f32_16x16x16_bf16 v[116:119], v[104:105], v[16:17], v[116:119]
    v_mfma_f32_16x16x16_bf16 v[120:123], v[104:105], v[36:37], v[120:123]
    v_cvt_pk_bf16_f32 v124, v108, v109
    v_cvt_pk_bf16_f32 v125, v110, v111
    v_cvt_pk_bf16_f32 v126, v112, v113
    v_cvt_pk_bf16_f32 v127, v114, v115
    s_mov_b32 s48, 10240
    s_nop 0
    v_permlane32_swap_b32 v124, v126
    v_permlane32_swap_b32 v125, v127
    s_nop 0
    buffer_store_dwordx4 v[124:127], v48, s[36:39], s48 offen sc0 sc1
    s_waitcnt lgkmcnt(0)
    v_mfma_f32_16x16x32_bf16 v[108:111], v[52:55], v[0:3], 0
    v_mfma_f32_16x16x32_bf16 v[108:111], v[56:59], v[4:7], v[108:111]
    ds_read_b64_tr_b16 v[70:71], v47 offset:128
    ds_read_b64_tr_b16 v[72:73], v47 offset:6272
    ds_read_b64_tr_b16 v[74:75], v47 offset:12416
    ds_read_b64_tr_b16 v[76:77], v47 offset:18560
    ds_read_b64_tr_b16 v[78:79], v47 offset:24704
    v_mfma_f32_16x16x32_bf16 v[108:111], v[60:63], v[8:11], v[108:111]
    v_mfma_f32_16x16x32_bf16 v[108:111], v[64:67], v[12:15], v[108:111]
    v_mfma_f32_16x16x32_bf16 v[112:115], v[52:55], v[20:23], 0
    v_mfma_f32_16x16x32_bf16 v[112:115], v[56:59], v[24:27], v[112:115]
    ds_read_b64_tr_b16 v[80:81], v47 offset:30848
    ds_read_b64_tr_b16 v[82:83], v47 offset:36992
    ds_read_b64_tr_b16 v[84:85], v47 offset:43136
    ds_read_b64_tr_b16 v[86:87], v47 offset:49280
    v_mfma_f32_16x16x32_bf16 v[112:115], v[60:63], v[28:31], v[112:115]
    v_mfma_f32_16x16x32_bf16 v[112:115], v[64:67], v[32:35], v[112:115]
    s_nop 1
    v_mfma_f32_16x16x16_bf16 v[108:111], v[68:69], v[16:17], v[108:111]
    v_mfma_f32_16x16x16_bf16 v[112:115], v[68:69], v[36:37], v[112:115]
    v_cvt_pk_bf16_f32 v128, v116, v117
    v_cvt_pk_bf16_f32 v129, v118, v119
    v_cvt_pk_bf16_f32 v130, v120, v121
    v_cvt_pk_bf16_f32 v131, v122, v123
    s_mov_b32 s48, 11264
    s_nop 0
    v_permlane32_swap_b32 v128, v130
    v_permlane32_swap_b32 v129, v131
    s_nop 0
    buffer_store_dwordx4 v[128:131], v48, s[36:39], s48 offen sc0 sc1
    s_waitcnt lgkmcnt(0)
    v_mfma_f32_16x16x32_bf16 v[116:119], v[70:73], v[0:3], 0
    v_mfma_f32_16x16x32_bf16 v[116:119], v[74:77], v[4:7], v[116:119]
    ds_read_b64_tr_b16 v[88:89], v44 offset:256
    ds_read_b64_tr_b16 v[90:91], v44 offset:6400
    ds_read_b64_tr_b16 v[92:93], v44 offset:12544
    ds_read_b64_tr_b16 v[94:95], v44 offset:18688
    ds_read_b64_tr_b16 v[96:97], v44 offset:24832
    v_mfma_f32_16x16x32_bf16 v[116:119], v[78:81], v[8:11], v[116:119]
    v_mfma_f32_16x16x32_bf16 v[116:119], v[82:85], v[12:15], v[116:119]
    v_mfma_f32_16x16x32_bf16 v[120:123], v[70:73], v[20:23], 0
    v_mfma_f32_16x16x32_bf16 v[120:123], v[74:77], v[24:27], v[120:123]
    ds_read_b64_tr_b16 v[98:99], v44 offset:30976
    ds_read_b64_tr_b16 v[100:101], v44 offset:37120
    ds_read_b64_tr_b16 v[102:103], v44 offset:43264
    ds_read_b64_tr_b16 v[104:105], v44 offset:49408
    v_mfma_f32_16x16x32_bf16 v[120:123], v[78:81], v[28:31], v[120:123]
    v_mfma_f32_16x16x32_bf16 v[120:123], v[82:85], v[32:35], v[120:123]
    s_nop 1
    v_mfma_f32_16x16x16_bf16 v[116:119], v[86:87], v[16:17], v[116:119]
    v_mfma_f32_16x16x16_bf16 v[120:123], v[86:87], v[36:37], v[120:123]
    v_cvt_pk_bf16_f32 v124, v108, v109
    v_cvt_pk_bf16_f32 v125, v110, v111
    v_cvt_pk_bf16_f32 v126, v112, v113
    v_cvt_pk_bf16_f32 v127, v114, v115
    s_mov_b32 s48, 18432
    s_nop 0
    v_permlane32_swap_b32 v124, v126
    v_permlane32_swap_b32 v125, v127
    s_nop 0
    buffer_store_dwordx4 v[124:127], v48, s[36:39], s48 offen sc0 sc1
    s_waitcnt lgkmcnt(0)
    v_mfma_f32_16x16x32_bf16 v[108:111], v[88:91], v[0:3], 0
    v_mfma_f32_16x16x32_bf16 v[108:111], v[92:95], v[4:7], v[108:111]
    ds_read_b64_tr_b16 v[52:53], v45 offset:256
    ds_read_b64_tr_b16 v[54:55], v45 offset:6400
    ds_read_b64_tr_b16 v[56:57], v45 offset:12544
    ds_read_b64_tr_b16 v[58:59], v45 offset:18688
    ds_read_b64_tr_b16 v[60:61], v45 offset:24832
    v_mfma_f32_16x16x32_bf16 v[108:111], v[96:99], v[8:11], v[108:111]
    v_mfma_f32_16x16x32_bf16 v[108:111], v[100:103], v[12:15], v[108:111]
    v_mfma_f32_16x16x32_bf16 v[112:115], v[88:91], v[20:23], 0
    v_mfma_f32_16x16x32_bf16 v[112:115], v[92:95], v[24:27], v[112:115]
    ds_read_b64_tr_b16 v[62:63], v45 offset:30976
    ds_read_b64_tr_b16 v[64:65], v45 offset:37120
    ds_read_b64_tr_b16 v[66:67], v45 offset:43264
    ds_read_b64_tr_b16 v[68:69], v45 offset:49408
    v_mfma_f32_16x16x32_bf16 v[112:115], v[96:99], v[28:31], v[112:115]
    v_mfma_f32_16x16x32_bf16 v[112:115], v[100:103], v[32:35], v[112:115]
    s_nop 1
    v_mfma_f32_16x16x16_bf16 v[108:111], v[104:105], v[16:17], v[108:111]
    v_mfma_f32_16x16x16_bf16 v[112:115], v[104:105], v[36:37], v[112:115]
    v_cvt_pk_bf16_f32 v128, v116, v117
    v_cvt_pk_bf16_f32 v129, v118, v119
    v_cvt_pk_bf16_f32 v130, v120, v121
    v_cvt_pk_bf16_f32 v131, v122, v123
    s_mov_b32 s48, 19456
    s_nop 0
    v_permlane32_swap_b32 v128, v130
    v_permlane32_swap_b32 v129, v131
    s_nop 0
    buffer_store_dwordx4 v[128:131], v48, s[36:39], s48 offen sc0 sc1
    s_waitcnt lgkmcnt(0)
    v_mfma_f32_16x16x32_bf16 v[116:119], v[52:55], v[0:3], 0
    v_mfma_f32_16x16x32_bf16 v[116:119], v[56:59], v[4:7], v[116:119]
    ds_read_b64_tr_b16 v[70:71], v46 offset:256
    ds_read_b64_tr_b16 v[72:73], v46 offset:6400
    ds_read_b64_tr_b16 v[74:75], v46 offset:12544
    ds_read_b64_tr_b16 v[76:77], v46 offset:18688
    ds_read_b64_tr_b16 v[78:79], v46 offset:24832
    v_mfma_f32_16x16x32_bf16 v[116:119], v[60:63], v[8:11], v[116:119]
    v_mfma_f32_16x16x32_bf16 v[116:119], v[64:67], v[12:15], v[116:119]
    v_mfma_f32_16x16x32_bf16 v[120:123], v[52:55], v[20:23], 0
    v_mfma_f32_16x16x32_bf16 v[120:123], v[56:59], v[24:27], v[120:123]
    ds_read_b64_tr_b16 v[80:81], v46 offset:30976
    ds_read_b64_tr_b16 v[82:83], v46 offset:37120
    ds_read_b64_tr_b16 v[84:85], v46 offset:43264
    ds_read_b64_tr_b16 v[86:87], v46 offset:49408
    v_mfma_f32_16x16x32_bf16 v[120:123], v[60:63], v[28:31], v[120:123]
    v_mfma_f32_16x16x32_bf16 v[120:123], v[64:67], v[32:35], v[120:123]
    s_nop 1
    v_mfma_f32_16x16x16_bf16 v[116:119], v[68:69], v[16:17], v[116:119]
    v_mfma_f32_16x16x16_bf16 v[120:123], v[68:69], v[36:37], v[120:123]
    v_cvt_pk_bf16_f32 v124, v108, v109
    v_cvt_pk_bf16_f32 v125, v110, v111
    v_cvt_pk_bf16_f32 v126, v112, v113
    v_cvt_pk_bf16_f32 v127, v114, v115
    s_mov_b32 s48, 20480
    s_nop 0
    v_permlane32_swap_b32 v124, v126
    v_permlane32_swap_b32 v125, v127
    s_nop 0
    buffer_store_dwordx4 v[124:127], v48, s[36:39], s48 offen sc0 sc1
    s_waitcnt lgkmcnt(0)
    v_mfma_f32_16x16x32_bf16 v[108:111], v[70:73], v[0:3], 0
    v_mfma_f32_16x16x32_bf16 v[108:111], v[74:77], v[4:7], v[108:111]
    ds_read_b64_tr_b16 v[88:89], v47 offset:256
    ds_read_b64_tr_b16 v[90:91], v47 offset:6400
    ds_read_b64_tr_b16 v[92:93], v47 offset:12544
    ds_read_b64_tr_b16 v[94:95], v47 offset:18688
    ds_read_b64_tr_b16 v[96:97], v47 offset:24832
    v_mfma_f32_16x16x32_bf16 v[108:111], v[78:81], v[8:11], v[108:111]
    v_mfma_f32_16x16x32_bf16 v[108:111], v[82:85], v[12:15], v[108:111]
    v_mfma_f32_16x16x32_bf16 v[112:115], v[70:73], v[20:23], 0
    v_mfma_f32_16x16x32_bf16 v[112:115], v[74:77], v[24:27], v[112:115]
    ds_read_b64_tr_b16 v[98:99], v47 offset:30976
    ds_read_b64_tr_b16 v[100:101], v47 offset:37120
    ds_read_b64_tr_b16 v[102:103], v47 offset:43264
    ds_read_b64_tr_b16 v[104:105], v47 offset:49408
    v_mfma_f32_16x16x32_bf16 v[112:115], v[78:81], v[28:31], v[112:115]
    v_mfma_f32_16x16x32_bf16 v[112:115], v[82:85], v[32:35], v[112:115]
    s_nop 1
    v_mfma_f32_16x16x16_bf16 v[108:111], v[86:87], v[16:17], v[108:111]
    v_mfma_f32_16x16x16_bf16 v[112:115], v[86:87], v[36:37], v[112:115]
    v_cvt_pk_bf16_f32 v128, v116, v117
    v_cvt_pk_bf16_f32 v129, v118, v119
    v_cvt_pk_bf16_f32 v130, v120, v121
    v_cvt_pk_bf16_f32 v131, v122, v123
    s_mov_b32 s48, 21504
    s_nop 0
    v_permlane32_swap_b32 v128, v130
    v_permlane32_swap_b32 v129, v131
    s_nop 0
    buffer_store_dwordx4 v[128:131], v48, s[36:39], s48 offen sc0 sc1
    s_waitcnt vmcnt(6) lgkmcnt(0)
    s_barrier
    v_mfma_f32_16x16x32_bf16 v[116:119], v[88:91], v[0:3], 0
    v_mfma_f32_16x16x32_bf16 v[116:119], v[92:95], v[4:7], v[116:119]
    ds_read_b64_tr_b16 v[52:53], v42 offset:128
    ds_read_b64_tr_b16 v[54:55], v42 offset:6272
    ds_read_b64_tr_b16 v[56:57], v42 offset:12416
    ds_read_b64_tr_b16 v[58:59], v42 offset:18560
    ds_read_b64_tr_b16 v[60:61], v42 offset:24704
    v_mfma_f32_16x16x32_bf16 v[116:119], v[96:99], v[8:11], v[116:119]
    v_mfma_f32_16x16x32_bf16 v[116:119], v[100:103], v[12:15], v[116:119]
    v_mfma_f32_16x16x32_bf16 v[120:123], v[88:91], v[20:23], 0
    v_mfma_f32_16x16x32_bf16 v[120:123], v[92:95], v[24:27], v[120:123]
    ds_read_b64_tr_b16 v[62:63], v42 offset:30848
    ds_read_b64_tr_b16 v[64:65], v42 offset:36992
    ds_read_b64_tr_b16 v[66:67], v42 offset:43136
    ds_read_b64_tr_b16 v[68:69], v42 offset:49280
    v_mfma_f32_16x16x32_bf16 v[120:123], v[96:99], v[28:31], v[120:123]
    v_mfma_f32_16x16x32_bf16 v[120:123], v[100:103], v[32:35], v[120:123]
    s_nop 1
    v_mfma_f32_16x16x16_bf16 v[116:119], v[104:105], v[16:17], v[116:119]
    v_mfma_f32_16x16x16_bf16 v[120:123], v[104:105], v[36:37], v[120:123]
    v_cvt_pk_bf16_f32 v124, v108, v109
    v_cvt_pk_bf16_f32 v125, v110, v111
    v_cvt_pk_bf16_f32 v126, v112, v113
    v_cvt_pk_bf16_f32 v127, v114, v115
    s_mov_b32 s48, 22528
    s_nop 0
    v_permlane32_swap_b32 v124, v126
    v_permlane32_swap_b32 v125, v127
    s_nop 0
    buffer_store_dwordx4 v[124:127], v48, s[36:39], s48 offen sc0 sc1
    s_waitcnt lgkmcnt(0)
    v_mfma_f32_16x16x32_bf16 v[108:111], v[52:55], v[0:3], 0
    v_mfma_f32_16x16x32_bf16 v[108:111], v[56:59], v[4:7], v[108:111]
    ds_read_b64_tr_b16 v[70:71], v43 offset:128
    ds_read_b64_tr_b16 v[72:73], v43 offset:6272
    ds_read_b64_tr_b16 v[74:75], v43 offset:12416
    ds_read_b64_tr_b16 v[76:77], v43 offset:18560
    ds_read_b64_tr_b16 v[78:79], v43 offset:24704
    v_mfma_f32_16x16x32_bf16 v[108:111], v[60:63], v[8:11], v[108:111]
    v_mfma_f32_16x16x32_bf16 v[108:111], v[64:67], v[12:15], v[108:111]
    v_mfma_f32_16x16x32_bf16 v[112:115], v[52:55], v[20:23], 0
    v_mfma_f32_16x16x32_bf16 v[112:115], v[56:59], v[24:27], v[112:115]
    ds_read_b64_tr_b16 v[80:81], v43 offset:30848
    ds_read_b64_tr_b16 v[82:83], v43 offset:36992
    ds_read_b64_tr_b16 v[84:85], v43 offset:43136
    ds_read_b64_tr_b16 v[86:87], v43 offset:49280
    v_mfma_f32_16x16x32_bf16 v[112:115], v[60:63], v[28:31], v[112:115]
    v_mfma_f32_16x16x32_bf16 v[112:115], v[64:67], v[32:35], v[112:115]
    s_nop 1
    v_mfma_f32_16x16x16_bf16 v[108:111], v[68:69], v[16:17], v[108:111]
    v_mfma_f32_16x16x16_bf16 v[112:115], v[68:69], v[36:37], v[112:115]
    v_cvt_pk_bf16_f32 v128, v116, v117
    v_cvt_pk_bf16_f32 v129, v118, v119
    v_cvt_pk_bf16_f32 v130, v120, v121
    v_cvt_pk_bf16_f32 v131, v122, v123
    s_mov_b32 s48, 23552
    s_nop 0
    v_permlane32_swap_b32 v128, v130
    v_permlane32_swap_b32 v129, v131
    s_nop 0
    buffer_store_dwordx4 v[128:131], v48, s[36:39], s48 offen sc0 sc1
    s_waitcnt lgkmcnt(0)
    v_mfma_f32_16x16x32_bf16 v[116:119], v[70:73], v[0:3], 0
    v_mfma_f32_16x16x32_bf16 v[116:119], v[74:77], v[4:7], v[116:119]
    ds_read_b64_tr_b16 v[88:89], v40 offset:256
    ds_read_b64_tr_b16 v[90:91], v40 offset:6400
    ds_read_b64_tr_b16 v[92:93], v40 offset:12544
    ds_read_b64_tr_b16 v[94:95], v40 offset:18688
    ds_read_b64_tr_b16 v[96:97], v40 offset:24832
    v_mfma_f32_16x16x32_bf16 v[116:119], v[78:81], v[8:11], v[116:119]
    v_mfma_f32_16x16x32_bf16 v[116:119], v[82:85], v[12:15], v[116:119]
    v_mfma_f32_16x16x32_bf16 v[120:123], v[70:73], v[20:23], 0
    v_mfma_f32_16x16x32_bf16 v[120:123], v[74:77], v[24:27], v[120:123]
    ds_read_b64_tr_b16 v[98:99], v40 offset:30976
    ds_read_b64_tr_b16 v[100:101], v40 offset:37120
    ds_read_b64_tr_b16 v[102:103], v40 offset:43264
    ds_read_b64_tr_b16 v[104:105], v40 offset:49408
    v_mfma_f32_16x16x32_bf16 v[120:123], v[78:81], v[28:31], v[120:123]
    v_mfma_f32_16x16x32_bf16 v[120:123], v[82:85], v[32:35], v[120:123]
    s_nop 1
    v_mfma_f32_16x16x16_bf16 v[116:119], v[86:87], v[16:17], v[116:119]
    v_mfma_f32_16x16x16_bf16 v[120:123], v[86:87], v[36:37], v[120:123]
    v_cvt_pk_bf16_f32 v124, v108, v109
    v_cvt_pk_bf16_f32 v125, v110, v111
    v_cvt_pk_bf16_f32 v126, v112, v113
    v_cvt_pk_bf16_f32 v127, v114, v115
    s_mov_b32 s48, 30720
    s_nop 0
    v_permlane32_swap_b32 v124, v126
    v_permlane32_swap_b32 v125, v127
    s_nop 0
    buffer_store_dwordx4 v[124:127], v48, s[36:39], s48 offen sc0 sc1
    s_waitcnt lgkmcnt(0)
    v_mfma_f32_16x16x32_bf16 v[108:111], v[88:91], v[0:3], 0
    v_mfma_f32_16x16x32_bf16 v[108:111], v[92:95], v[4:7], v[108:111]
    ds_read_b64_tr_b16 v[52:53], v41 offset:256
    ds_read_b64_tr_b16 v[54:55], v41 offset:6400
    ds_read_b64_tr_b16 v[56:57], v41 offset:12544
    ds_read_b64_tr_b16 v[58:59], v41 offset:18688
    ds_read_b64_tr_b16 v[60:61], v41 offset:24832
    v_mfma_f32_16x16x32_bf16 v[108:111], v[96:99], v[8:11], v[108:111]
    v_mfma_f32_16x16x32_bf16 v[108:111], v[100:103], v[12:15], v[108:111]
    v_mfma_f32_16x16x32_bf16 v[112:115], v[88:91], v[20:23], 0
    v_mfma_f32_16x16x32_bf16 v[112:115], v[92:95], v[24:27], v[112:115]
    ds_read_b64_tr_b16 v[62:63], v41 offset:30976
    ds_read_b64_tr_b16 v[64:65], v41 offset:37120
    ds_read_b64_tr_b16 v[66:67], v41 offset:43264
    ds_read_b64_tr_b16 v[68:69], v41 offset:49408
    v_mfma_f32_16x16x32_bf16 v[112:115], v[96:99], v[28:31], v[112:115]
    v_mfma_f32_16x16x32_bf16 v[112:115], v[100:103], v[32:35], v[112:115]
    s_nop 1
    v_mfma_f32_16x16x16_bf16 v[108:111], v[104:105], v[16:17], v[108:111]
    v_mfma_f32_16x16x16_bf16 v[112:115], v[104:105], v[36:37], v[112:115]
    v_cvt_pk_bf16_f32 v128, v116, v117
    v_cvt_pk_bf16_f32 v129, v118, v119
    v_cvt_pk_bf16_f32 v130, v120, v121
    v_cvt_pk_bf16_f32 v131, v122, v123
    s_mov_b32 s48, 31744
    s_nop 0
    v_permlane32_swap_b32 v128, v130
    v_permlane32_swap_b32 v129, v131
    s_nop 0
    buffer_store_dwordx4 v[128:131], v48, s[36:39], s48 offen sc0 sc1
    s_waitcnt lgkmcnt(0)
    v_mfma_f32_16x16x32_bf16 v[116:119], v[52:55], v[0:3], 0
    v_mfma_f32_16x16x32_bf16 v[116:119], v[56:59], v[4:7], v[116:119]
    ds_read_b64_tr_b16 v[70:71], v42 offset:256
    ds_read_b64_tr_b16 v[72:73], v42 offset:6400
    ds_read_b64_tr_b16 v[74:75], v42 offset:12544
    ds_read_b64_tr_b16 v[76:77], v42 offset:18688
    ds_read_b64_tr_b16 v[78:79], v42 offset:24832
    v_mfma_f32_16x16x32_bf16 v[116:119], v[60:63], v[8:11], v[116:119]
    v_mfma_f32_16x16x32_bf16 v[116:119], v[64:67], v[12:15], v[116:119]
    v_mfma_f32_16x16x32_bf16 v[120:123], v[52:55], v[20:23], 0
    v_mfma_f32_16x16x32_bf16 v[120:123], v[56:59], v[24:27], v[120:123]
    ds_read_b64_tr_b16 v[80:81], v42 offset:30976
    ds_read_b64_tr_b16 v[82:83], v42 offset:37120
    ds_read_b64_tr_b16 v[84:85], v42 offset:43264
    ds_read_b64_tr_b16 v[86:87], v42 offset:49408
    v_mfma_f32_16x16x32_bf16 v[120:123], v[60:63], v[28:31], v[120:123]
    v_mfma_f32_16x16x32_bf16 v[120:123], v[64:67], v[32:35], v[120:123]
    s_nop 1
    v_mfma_f32_16x16x16_bf16 v[116:119], v[68:69], v[16:17], v[116:119]
    v_mfma_f32_16x16x16_bf16 v[120:123], v[68:69], v[36:37], v[120:123]
    v_cvt_pk_bf16_f32 v124, v108, v109
    v_cvt_pk_bf16_f32 v125, v110, v111
    v_cvt_pk_bf16_f32 v126, v112, v113
    v_cvt_pk_bf16_f32 v127, v114, v115
    s_mov_b32 s48, 32768
    s_nop 0
    v_permlane32_swap_b32 v124, v126
    v_permlane32_swap_b32 v125, v127
    s_nop 0
    buffer_store_dwordx4 v[124:127], v48, s[36:39], s48 offen sc0 sc1
    s_waitcnt lgkmcnt(0)
    v_mfma_f32_16x16x32_bf16 v[108:111], v[70:73], v[0:3], 0
    v_mfma_f32_16x16x32_bf16 v[108:111], v[74:77], v[4:7], v[108:111]
    ds_read_b64_tr_b16 v[88:89], v43 offset:256
    ds_read_b64_tr_b16 v[90:91], v43 offset:6400
    ds_read_b64_tr_b16 v[92:93], v43 offset:12544
    ds_read_b64_tr_b16 v[94:95], v43 offset:18688
    ds_read_b64_tr_b16 v[96:97], v43 offset:24832
    v_mfma_f32_16x16x32_bf16 v[108:111], v[78:81], v[8:11], v[108:111]
    v_mfma_f32_16x16x32_bf16 v[108:111], v[82:85], v[12:15], v[108:111]
    v_mfma_f32_16x16x32_bf16 v[112:115], v[70:73], v[20:23], 0
    v_mfma_f32_16x16x32_bf16 v[112:115], v[74:77], v[24:27], v[112:115]
    ds_read_b64_tr_b16 v[98:99], v43 offset:30976
    ds_read_b64_tr_b16 v[100:101], v43 offset:37120
    ds_read_b64_tr_b16 v[102:103], v43 offset:43264
    ds_read_b64_tr_b16 v[104:105], v43 offset:49408
    v_mfma_f32_16x16x32_bf16 v[112:115], v[78:81], v[28:31], v[112:115]
    v_mfma_f32_16x16x32_bf16 v[112:115], v[82:85], v[32:35], v[112:115]
    s_nop 1
    v_mfma_f32_16x16x16_bf16 v[108:111], v[86:87], v[16:17], v[108:111]
    v_mfma_f32_16x16x16_bf16 v[112:115], v[86:87], v[36:37], v[112:115]
    v_cvt_pk_bf16_f32 v128, v116, v117
    v_cvt_pk_bf16_f32 v129, v118, v119
    v_cvt_pk_bf16_f32 v130, v120, v121
    v_cvt_pk_bf16_f32 v131, v122, v123
    s_mov_b32 s48, 33792
    s_nop 0
    v_permlane32_swap_b32 v128, v130
    v_permlane32_swap_b32 v129, v131
    s_nop 0
    buffer_store_dwordx4 v[128:131], v48, s[36:39], s48 offen sc0 sc1
    s_waitcnt lgkmcnt(0)
    v_mfma_f32_16x16x32_bf16 v[116:119], v[88:91], v[0:3], 0
    v_mfma_f32_16x16x32_bf16 v[116:119], v[92:95], v[4:7], v[116:119]
    v_mfma_f32_16x16x32_bf16 v[116:119], v[96:99], v[8:11], v[116:119]
    v_mfma_f32_16x16x32_bf16 v[116:119], v[100:103], v[12:15], v[116:119]
    v_mfma_f32_16x16x32_bf16 v[120:123], v[88:91], v[20:23], 0
    v_mfma_f32_16x16x32_bf16 v[120:123], v[92:95], v[24:27], v[120:123]
    v_mfma_f32_16x16x32_bf16 v[120:123], v[96:99], v[28:31], v[120:123]
    v_mfma_f32_16x16x32_bf16 v[120:123], v[100:103], v[32:35], v[120:123]
    s_nop 1
    v_mfma_f32_16x16x16_bf16 v[116:119], v[104:105], v[16:17], v[116:119]
    v_mfma_f32_16x16x16_bf16 v[120:123], v[104:105], v[36:37], v[120:123]
    v_cvt_pk_bf16_f32 v124, v108, v109
    v_cvt_pk_bf16_f32 v125, v110, v111
    v_cvt_pk_bf16_f32 v126, v112, v113
    v_cvt_pk_bf16_f32 v127, v114, v115
    s_mov_b32 s48, 34816
    s_nop 0
    v_permlane32_swap_b32 v124, v126
    v_permlane32_swap_b32 v125, v127
    s_nop 0
    buffer_store_dwordx4 v[124:127], v48, s[36:39], s48 offen sc0 sc1
    s_nop 7
    s_nop 1
    v_cvt_pk_bf16_f32 v128, v116, v117
    v_cvt_pk_bf16_f32 v129, v118, v119
    v_cvt_pk_bf16_f32 v130, v120, v121
    v_cvt_pk_bf16_f32 v131, v122, v123
    s_mov_b32 s48, 35840
    s_nop 0
    v_permlane32_swap_b32 v128, v130
    v_permlane32_swap_b32 v129, v131
    s_nop 0
    buffer_store_dwordx4 v[128:131], v48, s[36:39], s48 offen sc0 sc1
    s_waitcnt vmcnt(0) lgkmcnt(0)
    v_mbcnt_lo_u32_b32 v1, -1, 0
    v_mbcnt_hi_u32_b32 v1, -1, v1
    s_load_dwordx2 s[4:5], s[0:1], 0
    s_load_dwordx4 s[12:15], s[0:1], 48
    s_load_dwordx2 s[20:21], s[0:1], 64
    s_barrier
    s_waitcnt lgkmcnt(0)
    s_mov_b32 s16, s14
    s_and_b32 s17, s15, 0xffff
    s_mov_b32 s18, 0x100
    s_mov_b32 s19, 0x20000
    s_lshl_b32 s47, s44, 7
    s_add_u32 s47, s47, 46137344
    s_add_u32 s36, s20, s47
    s_addc_u32 s37, s21, 0
    s_and_b32 s37, s37, 0xffff
    s_mov_b32 s38, 64
    s_mov_b32 s39, 0x20000
    v_mov_b32 v6, 240
    s_mov_b32 s47, 0
L_tag_a1:
    buffer_load_dword v5, v6, s[16:19], 0 offen sc1
    s_waitcnt vmcnt(0)
    v_readfirstlane_b32 s58, v5
    s_add_u32 s47, s47, 1
    s_nop 2
    s_cmp_lg_u32 s58, 0
    s_cbranch_scc1 L_tagok_a1
    s_cmp_lt_u32 s47, 200000
    s_cbranch_scc1 L_tag_a1
L_tagok_a1:
    s_cmp_lg_u32 s40, 0
    s_cbranch_scc1 L_t_nosig_a1
    s_add_u32 s46, s43, 12
    s_lshl_b32 s46, s46, 2
    v_mov_b32 v4, s58
    v_mov_b32 v5, s46
    s_mov_b64 exec, 1
    buffer_store_dword v4, v5, s[36:39], 0 offen sc0 sc1
    s_mov_b64 exec, -1
L_t_nosig_a1:
    s_endpgm
.section .rodata,"a"
.p2align 6
.amdhsa_kernel parallel_sum__linear_attn_block__dense_activation_silu__prompt_kernel
  .amdhsa_next_free_vgpr 256
  .amdhsa_next_free_sgpr 96
  .amdhsa_accum_offset 256
  .amdhsa_group_segment_fixed_size 0
  .amdhsa_kernarg_size 72
  .amdhsa_user_sgpr_count 2
  .amdhsa_user_sgpr_kernarg_segment_ptr 1
  .amdhsa_system_sgpr_workgroup_id_x 1
.end_amdhsa_kernel
```
